```python
import torch

def _softmax(x, axis=-1):
    return torch.softmax(x, dim=axis)
def _gelu(x):
    return torch.nn.functional.gelu(x, approximate="tanh")
def _silu(x):
    return torch.nn.functional.silu(x)
def _sigmoid(x):
    return torch.sigmoid(x)
def _layernorm(x, axis=-1, eps=1e-5):
    m = x.mean(dim=axis, keepdim=True)
    v = x.var(dim=axis, keepdim=True, unbiased=False)
    return (x - m) / torch.sqrt(v + eps)
def _scatter_add(tgt, idx, src, axis=0):
    return tgt.clone().index_add_(axis, idx, src)
def _segment_sum(src, seg, n):
    out = torch.zeros((n,) + src.shape[1:], dtype=src.dtype)
    return out.index_add_(0, seg, src)
def _pad(x, pw):
    flat = tuple(v for pair in reversed(pw) for v in pair)
    return torch.nn.functional.pad(x, flat)

kernel_name = 'concat_heads__spectral_gfnet__ssm_conv_s4d__prompt'

def setup_inputs():

    _w = (lambda a: (lambda t: t.to(torch.bfloat16) if t.is_floating_point() else t)(torch.as_tensor(a)))
    def _A_setup():
        B, S, D = 1, 2048, 1024
        Df = D // 2 + 1
        return {
            "x": _w((lambda *s: torch.randn(*s, dtype=torch.bfloat16) * 0.05)(B, S, D)),
            "w_r": _w((lambda *s: torch.randn(*s, dtype=torch.bfloat16) * 0.8)(S, Df) * 0.02),
            "w_i": _w((lambda *s: torch.randn(*s, dtype=torch.bfloat16) * 0.8)(S, Df) * 0.02),
        }
    _A_in = _A_setup()

    def _B_setup():
        Bsz, L, D, N = 1, 2048, 1024, 128
        return {
            "u": _w((lambda *s: torch.randn(*s, dtype=torch.bfloat16) * 0.05)(Bsz, L, D)),
            "log_A_real": _w((lambda *s: torch.randn(*s, dtype=torch.bfloat16) * 6.4)(D, N) * 0.5),
            "A_imag": _w((lambda *s: torch.randn(*s, dtype=torch.bfloat16) * 0.05)(D, N) * 3.14),
            "C_real": _w((lambda *s: torch.randn(*s, dtype=torch.bfloat16) * 0.05)(D, N) / N ** 0.5),
            "C_imag": _w((lambda *s: torch.randn(*s, dtype=torch.bfloat16) * 0.05)(D, N) / N ** 0.5),
            "log_dt": _w((lambda *s: torch.randn(*s, dtype=torch.bfloat16) * 0.05)(D) * 0.5 - 4.0),
            "D_skip": _w((lambda *s: torch.randn(*s, dtype=torch.bfloat16) * 0.05)(D)),
        }
    _B_in = _B_setup()

    return {
        "A_x": _A_in["x"],
        "A_w_r": _A_in["w_r"],
        "A_w_i": _A_in["w_i"],
        "B_u": _B_in["u"],
        "B_log_A_real": _B_in["log_A_real"],
        "B_A_imag": _B_in["A_imag"],
        "B_C_real": _B_in["C_real"],
        "B_C_imag": _B_in["C_imag"],
        "B_log_dt": _B_in["log_dt"],
        "B_D_skip": _B_in["D_skip"],
    }

def reference(A_x, A_w_r, A_w_i, B_u, B_log_A_real, B_A_imag, B_C_real, B_C_imag, B_log_dt, B_D_skip):
    def _A_ref(x, w_r, w_i):
        B, S, D = x.shape
        X = (lambda x, axes=(-2,-1): torch.fft.rfft2(x.float(), dim=axes))(x, axes=(-2, -1))
        W = w_r + 1j * w_i
        X = X * W
        y = (lambda x, s, axes=(-2,-1): torch.fft.irfft2(x, s=s, dim=axes).to(torch.bfloat16))(X, (S, D), axes=(-2, -1))
        return y

    def _B_ref(u, log_A_real, A_imag, C_real, C_imag, log_dt, D_skip):
        L = u.shape[1]
        dt = torch.exp(log_dt)
        A = -torch.exp(log_A_real) + 1j * A_imag
        C = (C_real + 1j * C_imag) * dt[:, None]
        pos = (lambda x, dt: x.to(dt))(torch.arange(L), log_dt.dtype)
        P = torch.exp((A * dt[:, None])[:, :, None] * pos[None, None, :])
        K = 2.0 * torch.einsum("dn,dnl->dl", C, P).real
        L2 = 2 * L
        u_t = (lambda x, *d: x.permute(*d))(u, 0, 2, 1)
        Kf = (lambda x, *a, **k: torch.fft.rfft(x.float(), *a, **k))(K, L2)
        Uf = (lambda x, *a, **k: torch.fft.rfft(x.float(), *a, **k))(u_t, L2)
        y = (lambda x, *a, **k: torch.fft.irfft(x, *a, **k).to(torch.bfloat16))(Uf * Kf[None, :, :], L2)[:, :, :L]
        y = (lambda x, *d: x.permute(*d))(y, 0, 2, 1)
        return y + u * D_skip[None, None, :]

    a = _A_ref(A_x, A_w_r, A_w_i)
    b = _B_ref(B_u, B_log_A_real, B_A_imag, B_C_real, B_C_imag, B_log_dt, B_D_skip)
    return torch.concatenate([a, b], axis=-1)
```

```asm
; @launch kernel=k1_kernel grid=(256,1,1) block=(512,1,1) lds=139264
; @launch kernel=k2_kernel grid=(392,1,1) block=(512,1,1) lds=67840
; @launch kernel=k3_kernel grid=(192,1,1) block=(512,1,1) lds=57344
.amdgcn_target "amdgcn-amd-amdhsa--gfx950"
.text
.globl k1_kernel
.p2align 8
.type k1_kernel,@function
k1_kernel:
    v_and_b32 v1, 63, v0
    v_lshrrev_b32 v2, 6, v0
    s_nop 0
    v_readfirstlane_b32 s16, v2
    s_cmp_ge_u32 s2, 128
    s_cbranch_scc1 k1_b
    s_load_dwordx2 s[24:25], s[0:1], 0
    s_load_dwordx2 s[26:27], s[0:1], 96
    s_getpc_b64 s[12:13]
    s_add_u32 s12, s12, tab1@rel32@lo+4
    s_addc_u32 s13, s13, tab1@rel32@hi+12
    s_mov_b32 s14, 20480
    s_mov_b32 s15, 0x20000
    s_and_b32 s30, s2, 7
    s_lshr_b32 s31, s2, 4
    s_lshl_b32 s31, s31, 3
    s_add_u32 s30, s30, s31
    s_lshr_b32 s31, s2, 3
    s_and_b32 s31, s31, 1
    v_lshlrev_b32 v2, 4, v1
    v_and_b32 v3, 31, v1
    v_lshrrev_b32 v4, 5, v1
    v_lshlrev_b32 v5, 6, v3
    v_lshl_add_u32 v5, v4, 4, v5
    s_waitcnt lgkmcnt(0)
    s_mov_b32 s4, s24
    s_mov_b32 s5, s25
    s_mov_b32 s6, 4194304
    s_mov_b32 s7, 0x20000
    s_mov_b32 s8, s26
    s_mov_b32 s9, s27
    s_mov_b32 s10, 4718592
    s_mov_b32 s11, 0x20000
    s_lshl_b32 s29, s31, 6
    s_add_u32 s29, s29, s30
    s_lshl_b32 s17, s16, 8
    s_add_u32 s17, s17, s29
    s_lshl_b32 s17, s17, 11
    s_add_u32 s19, s17, 262144
    buffer_load_dwordx4 v[8:11], v5, s[4:7], s17 offen
    buffer_load_dwordx4 v[12:15], v5, s[4:7], s17 offen offset:32
    buffer_load_dwordx4 v[232:235], v5, s[4:7], s19 offen
    buffer_load_dwordx4 v[236:239], v5, s[4:7], s19 offen offset:32
    buffer_load_dwordx4 v[16:19], v2, s[12:15], 0 offen offset:0
    buffer_load_dwordx4 v[20:23], v2, s[12:15], 0 offen offset:1024
    buffer_load_dwordx4 v[24:27], v2, s[12:15], 0 offen offset:2048
    buffer_load_dwordx4 v[28:31], v2, s[12:15], 0 offen offset:3072
    s_movk_i32 s20, 4096
    buffer_load_dwordx4 v[32:35], v2, s[12:15], s20 offen offset:0
    s_movk_i32 s20, 4096
    buffer_load_dwordx4 v[36:39], v2, s[12:15], s20 offen offset:1024
    s_movk_i32 s20, 4096
    buffer_load_dwordx4 v[40:43], v2, s[12:15], s20 offen offset:2048
    s_movk_i32 s20, 4096
    buffer_load_dwordx4 v[44:47], v2, s[12:15], s20 offen offset:3072
    s_movk_i32 s20, 8192
    buffer_load_dwordx4 v[48:51], v2, s[12:15], s20 offen offset:0
    s_movk_i32 s20, 8192
    buffer_load_dwordx4 v[52:55], v2, s[12:15], s20 offen offset:1024
    s_movk_i32 s20, 8192
    buffer_load_dwordx4 v[56:59], v2, s[12:15], s20 offen offset:2048
    s_movk_i32 s20, 8192
    buffer_load_dwordx4 v[60:63], v2, s[12:15], s20 offen offset:3072
    s_movk_i32 s20, 12288
    buffer_load_dwordx4 v[64:67], v2, s[12:15], s20 offen offset:0
    s_movk_i32 s20, 12288
    buffer_load_dwordx4 v[68:71], v2, s[12:15], s20 offen offset:1024
    s_movk_i32 s20, 12288
    buffer_load_dwordx4 v[72:75], v2, s[12:15], s20 offen offset:2048
    s_movk_i32 s20, 12288
    buffer_load_dwordx4 v[76:79], v2, s[12:15], s20 offen offset:3072
    s_movk_i32 s20, 16384
    buffer_load_dwordx4 v[80:83], v2, s[12:15], s20 offen offset:0
    s_movk_i32 s20, 16384
    buffer_load_dwordx4 v[84:87], v2, s[12:15], s20 offen offset:1024
    s_movk_i32 s20, 16384
    buffer_load_dwordx4 v[224:227], v2, s[12:15], s20 offen offset:2048
    s_movk_i32 s20, 16384
    buffer_load_dwordx4 v[228:231], v2, s[12:15], s20 offen offset:3072
    v_mul_u32_u24 v6, 80, v3
    v_mul_u32_u24 v7, 10240, v4
    v_add_u32 v6, v6, v7
    s_lshl_b32 s18, s16, 3
    v_add_u32 v6, s18, v6
    s_add_u32 s18, s18, 40960
    v_mov_b32 v7, s18
    v_cvt_f32_u32 v212, s29
    v_mul_f32 v212, 0x3a000000, v212
    v_lshlrev_b32 v213, 2, v4
    v_cvt_f32_u32 v213, v213
    v_add_f32 v208, 0x00000000, v213
    v_mul_f32 v208, v208, v212
    v_cos_f32 v240, v208
    v_sin_f32 v248, v208
    v_add_f32 v208, 0x3f800000, v213
    v_mul_f32 v208, v208, v212
    v_cos_f32 v241, v208
    v_sin_f32 v249, v208
    v_add_f32 v208, 0x40000000, v213
    v_mul_f32 v208, v208, v212
    v_cos_f32 v242, v208
    v_sin_f32 v250, v208
    v_add_f32 v208, 0x40400000, v213
    v_mul_f32 v208, v208, v212
    v_cos_f32 v243, v208
    v_sin_f32 v251, v208
    v_add_f32 v208, 0x41000000, v213
    v_mul_f32 v208, v208, v212
    v_cos_f32 v244, v208
    v_sin_f32 v252, v208
    v_add_f32 v208, 0x41100000, v213
    v_mul_f32 v208, v208, v212
    v_cos_f32 v245, v208
    v_sin_f32 v253, v208
    v_add_f32 v208, 0x41200000, v213
    v_mul_f32 v208, v208, v212
    v_cos_f32 v246, v208
    v_sin_f32 v254, v208
    v_add_f32 v208, 0x41300000, v213
    v_mul_f32 v208, v208, v212
    v_cos_f32 v247, v208
    v_sin_f32 v255, v208
    s_waitcnt vmcnt(0)
    v_mfma_f32_32x32x16_bf16 v[88:103], v[8:11], v[16:19], 0
    v_mfma_f32_32x32x16_bf16 v[88:103], v[12:15], v[20:23], v[88:103]
    s_nop 11
    v_cvt_pk_bf16_f32 v104, v88, v89
    v_cvt_pk_bf16_f32 v105, v90, v91
    v_cvt_pk_bf16_f32 v106, v92, v93
    v_cvt_pk_bf16_f32 v107, v94, v95
    v_cvt_pk_bf16_f32 v108, v96, v97
    v_cvt_pk_bf16_f32 v109, v98, v99
    v_cvt_pk_bf16_f32 v110, v100, v101
    v_cvt_pk_bf16_f32 v111, v102, v103
    v_mfma_f32_32x32x16_bf16 v[112:127], v[104:107], v[24:27], 0
    v_mfma_f32_32x32x16_bf16 v[128:143], v[104:107], v[32:35], 0
    v_mfma_f32_32x32x16_bf16 v[112:127], v[108:111], v[28:31], v[112:127]
    v_mfma_f32_32x32x16_bf16 v[128:143], v[108:111], v[36:39], v[128:143]
    v_mfma_f32_32x32x16_bf16 v[88:103], v[232:235], v[16:19], 0
    v_mfma_f32_32x32x16_bf16 v[88:103], v[236:239], v[20:23], v[88:103]
    s_nop 8
    v_sub_f32 v208, v112, v113
    v_add_f32 v208, v208, v114
    v_sub_f32 v208, v208, v115
    v_add_f32 v208, v208, v116
    v_sub_f32 v208, v208, v117
    v_add_f32 v208, v208, v118
    v_sub_f32 v208, v208, v119
    v_add_f32 v208, v208, v120
    v_sub_f32 v208, v208, v121
    v_add_f32 v208, v208, v122
    v_sub_f32 v208, v208, v123
    v_add_f32 v208, v208, v124
    v_sub_f32 v208, v208, v125
    v_add_f32 v208, v208, v126
    v_sub_f32 v208, v208, v127
    s_nop 0
    v_readlane_b32 s22, v208, 0
    v_readlane_b32 s23, v208, 32
    v_mul_f32 v210, v112, v40
    v_mul_f32 v211, v128, v40
    v_fma_f32 v210, v128, v56, v210
    v_fma_f32 v211, -v112, v56, v211
    v_mul_f32 v212, v113, v41
    v_mul_f32 v213, v129, v41
    v_fma_f32 v212, v129, v57, v212
    v_fma_f32 v213, -v113, v57, v213
    v_cvt_pk_bf16_f32 v176, v210, v212
    v_cvt_pk_bf16_f32 v184, v211, v213
    v_mul_f32 v214, v114, v42
    v_mul_f32 v215, v130, v42
    v_fma_f32 v214, v130, v58, v214
    v_cvt_pk_bf16_f32 v104, v88, v89
    v_cvt_pk_bf16_f32 v105, v90, v91
    v_cvt_pk_bf16_f32 v106, v92, v93
    v_cvt_pk_bf16_f32 v107, v94, v95
    v_cvt_pk_bf16_f32 v108, v96, v97
    v_cvt_pk_bf16_f32 v109, v98, v99
    v_cvt_pk_bf16_f32 v110, v100, v101
    v_cvt_pk_bf16_f32 v111, v102, v103
    v_fma_f32 v215, -v114, v58, v215
    v_mul_f32 v216, v115, v43
    v_mul_f32 v217, v131, v43
    v_fma_f32 v216, v131, v59, v216
    v_fma_f32 v217, -v115, v59, v217
    v_cvt_pk_bf16_f32 v177, v214, v216
    v_cvt_pk_bf16_f32 v185, v215, v217
    v_mul_f32 v210, v116, v44
    v_mul_f32 v211, v132, v44
    v_fma_f32 v210, v132, v60, v210
    v_fma_f32 v211, -v116, v60, v211
    v_mul_f32 v212, v117, v45
    v_mul_f32 v213, v133, v45
    v_fma_f32 v212, v133, v61, v212
    v_fma_f32 v213, -v117, v61, v213
    v_cvt_pk_bf16_f32 v178, v210, v212
    v_cvt_pk_bf16_f32 v186, v211, v213
    v_mul_f32 v214, v118, v46
    v_mul_f32 v215, v134, v46
    v_fma_f32 v214, v134, v62, v214
    v_fma_f32 v215, -v118, v62, v215
    v_mul_f32 v216, v119, v47
    v_mul_f32 v217, v135, v47
    v_fma_f32 v216, v135, v63, v216
    v_fma_f32 v217, -v119, v63, v217
    v_cvt_pk_bf16_f32 v179, v214, v216
    v_cvt_pk_bf16_f32 v187, v215, v217
    s_nop 0
    v_mfma_f32_32x32x16_bf16 v[192:207], v[72:75], v[176:179], 0
    v_mfma_f32_32x32x16_bf16 v[192:207], v[80:83], v[184:187], v[192:207]
    v_mul_f32 v210, v120, v48
    v_mul_f32 v211, v136, v48
    v_fma_f32 v210, v136, v64, v210
    v_mfma_f32_32x32x16_bf16 v[144:159], v[104:107], v[24:27], 0
    v_mfma_f32_32x32x16_bf16 v[160:175], v[104:107], v[32:35], 0
    v_mfma_f32_32x32x16_bf16 v[144:159], v[108:111], v[28:31], v[144:159]
    v_mfma_f32_32x32x16_bf16 v[160:175], v[108:111], v[36:39], v[160:175]
    v_fma_f32 v211, -v120, v64, v211
    v_mul_f32 v212, v121, v49
    v_mul_f32 v213, v137, v49
    v_fma_f32 v212, v137, v65, v212
    v_fma_f32 v213, -v121, v65, v213
    v_cvt_pk_bf16_f32 v180, v210, v212
    v_cvt_pk_bf16_f32 v188, v211, v213
    v_mul_f32 v214, v122, v50
    v_mul_f32 v215, v138, v50
    v_fma_f32 v214, v138, v66, v214
    v_fma_f32 v215, -v122, v66, v215
    v_mul_f32 v216, v123, v51
    v_mul_f32 v217, v139, v51
    v_fma_f32 v216, v139, v67, v216
    v_fma_f32 v217, -v123, v67, v217
    v_cvt_pk_bf16_f32 v181, v214, v216
    v_cvt_pk_bf16_f32 v189, v215, v217
    v_mul_f32 v210, v124, v52
    v_mul_f32 v211, v140, v52
    v_fma_f32 v210, v140, v68, v210
    v_fma_f32 v211, -v124, v68, v211
    v_mul_f32 v212, v125, v53
    v_mul_f32 v213, v141, v53
    v_fma_f32 v212, v141, v69, v212
    v_fma_f32 v213, -v125, v69, v213
    v_cvt_pk_bf16_f32 v182, v210, v212
    v_cvt_pk_bf16_f32 v190, v211, v213
    v_mul_f32 v214, v126, v54
    v_mul_f32 v215, v142, v54
    v_fma_f32 v214, v142, v70, v214
    v_fma_f32 v215, -v126, v70, v215
    v_mul_f32 v216, v127, v55
    v_mul_f32 v217, v143, v55
    v_fma_f32 v216, v143, v71, v216
    v_fma_f32 v217, -v127, v71, v217
    v_cvt_pk_bf16_f32 v183, v214, v216
    v_cvt_pk_bf16_f32 v191, v215, v217
    v_mov_b32 v208, s22
    v_add_f32 v208, s23, v208
    v_cvt_pk_bf16_f32 v208, v208, 0
    ds_write_b32 v7, v208 offset:0
    v_mfma_f32_32x32x16_bf16 v[192:207], v[76:79], v[180:183], v[192:207]
    v_mfma_f32_32x32x16_bf16 v[192:207], v[84:87], v[188:191], v[192:207]
    v_sub_f32 v208, v144, v145
    v_add_f32 v208, v208, v146
    v_sub_f32 v208, v208, v147
    v_add_f32 v208, v208, v148
    v_sub_f32 v208, v208, v149
    v_add_f32 v208, v208, v150
    v_sub_f32 v208, v208, v151
    v_add_f32 v208, v208, v152
    v_sub_f32 v208, v208, v153
    v_add_f32 v208, v208, v154
    v_sub_f32 v208, v208, v155
    v_add_f32 v208, v208, v156
    v_sub_f32 v208, v208, v157
    v_add_f32 v208, v208, v158
    v_cvt_pk_bf16_f32 v220, v192, v200
    ds_write_b32 v6, v220 offset:0
    v_cvt_pk_bf16_f32 v221, v193, v201
    ds_write_b32 v6, v221 offset:2560
    v_cvt_pk_bf16_f32 v222, v194, v202
    ds_write_b32 v6, v222 offset:5120
    v_cvt_pk_bf16_f32 v223, v195, v203
    ds_write_b32 v6, v223 offset:7680
    v_cvt_pk_bf16_f32 v220, v196, v204
    ds_write_b32 v6, v220 offset:20480
    v_cvt_pk_bf16_f32 v221, v197, v205
    ds_write_b32 v6, v221 offset:23040
    v_cvt_pk_bf16_f32 v222, v198, v206
    ds_write_b32 v6, v222 offset:25600
    v_cvt_pk_bf16_f32 v223, v199, v207
    ds_write_b32 v6, v223 offset:28160
    v_sub_f32 v208, v208, v159
    s_nop 0
    v_readlane_b32 s22, v208, 0
    v_readlane_b32 s23, v208, 32
    v_mul_f32 v210, v144, v40
    v_mul_f32 v211, v160, v40
    v_fma_f32 v210, v160, v56, v210
    v_fma_f32 v211, -v144, v56, v211
    v_mul_f32 v212, v145, v41
    v_mul_f32 v213, v161, v41
    v_fma_f32 v212, v161, v57, v212
    v_fma_f32 v213, -v145, v57, v213
    v_cvt_pk_bf16_f32 v176, v210, v212
    v_cvt_pk_bf16_f32 v184, v211, v213
    v_mul_f32 v214, v146, v42
    v_mul_f32 v215, v162, v42
    v_fma_f32 v214, v162, v58, v214
    v_fma_f32 v215, -v146, v58, v215
    v_mul_f32 v216, v147, v43
    v_mul_f32 v217, v163, v43
    v_fma_f32 v216, v163, v59, v216
    v_fma_f32 v217, -v147, v59, v217
    v_cvt_pk_bf16_f32 v177, v214, v216
    v_cvt_pk_bf16_f32 v185, v215, v217
    v_mul_f32 v210, v148, v44
    v_mul_f32 v211, v164, v44
    v_fma_f32 v210, v164, v60, v210
    v_fma_f32 v211, -v148, v60, v211
    v_mul_f32 v212, v149, v45
    v_mul_f32 v213, v165, v45
    v_fma_f32 v212, v165, v61, v212
    v_fma_f32 v213, -v149, v61, v213
    v_cvt_pk_bf16_f32 v178, v210, v212
    v_cvt_pk_bf16_f32 v186, v211, v213
    v_mul_f32 v214, v150, v46
    v_mul_f32 v215, v166, v46
    v_fma_f32 v214, v166, v62, v214
    v_fma_f32 v215, -v150, v62, v215
    v_mul_f32 v216, v151, v47
    v_mul_f32 v217, v167, v47
    v_fma_f32 v216, v167, v63, v216
    v_fma_f32 v217, -v151, v63, v217
    v_cvt_pk_bf16_f32 v179, v214, v216
    v_cvt_pk_bf16_f32 v187, v215, v217
    s_nop 0
    v_mfma_f32_32x32x16_bf16 v[192:207], v[72:75], v[176:179], 0
    v_mfma_f32_32x32x16_bf16 v[192:207], v[80:83], v[184:187], v[192:207]
    v_mul_f32 v210, v152, v48
    v_mul_f32 v211, v168, v48
    v_fma_f32 v210, v168, v64, v210
    v_fma_f32 v211, -v152, v64, v211
    v_mul_f32 v212, v153, v49
    v_mul_f32 v213, v169, v49
    v_fma_f32 v212, v169, v65, v212
    v_fma_f32 v213, -v153, v65, v213
    v_cvt_pk_bf16_f32 v180, v210, v212
    v_cvt_pk_bf16_f32 v188, v211, v213
    v_mul_f32 v214, v154, v50
    v_mul_f32 v215, v170, v50
    v_fma_f32 v214, v170, v66, v214
    v_fma_f32 v215, -v154, v66, v215
    v_mul_f32 v216, v155, v51
    v_mul_f32 v217, v171, v51
    v_fma_f32 v216, v171, v67, v216
    v_fma_f32 v217, -v155, v67, v217
    v_cvt_pk_bf16_f32 v181, v214, v216
    v_cvt_pk_bf16_f32 v189, v215, v217
    v_mul_f32 v210, v156, v52
    v_mul_f32 v211, v172, v52
    v_fma_f32 v210, v172, v68, v210
    v_fma_f32 v211, -v156, v68, v211
    v_mul_f32 v212, v157, v53
    v_mul_f32 v213, v173, v53
    v_fma_f32 v212, v173, v69, v212
    v_fma_f32 v213, -v157, v69, v213
    v_cvt_pk_bf16_f32 v182, v210, v212
    v_cvt_pk_bf16_f32 v190, v211, v213
    v_mul_f32 v214, v158, v54
    v_mul_f32 v215, v174, v54
    v_fma_f32 v214, v174, v70, v214
    v_fma_f32 v215, -v158, v70, v215
    v_mul_f32 v216, v159, v55
    v_mul_f32 v217, v175, v55
    v_fma_f32 v216, v175, v71, v216
    v_fma_f32 v217, -v159, v71, v217
    v_cvt_pk_bf16_f32 v183, v214, v216
    v_cvt_pk_bf16_f32 v191, v215, v217
    v_mov_b32 v208, s22
    v_add_f32 v208, s23, v208
    v_cvt_pk_bf16_f32 v208, v208, 0
    ds_write_b32 v7, v208 offset:4
    v_mfma_f32_32x32x16_bf16 v[192:207], v[76:79], v[180:183], v[192:207]
    v_mfma_f32_32x32x16_bf16 v[192:207], v[84:87], v[188:191], v[192:207]
    s_nop 11
    v_cvt_pk_bf16_f32 v220, v192, v200
    ds_write_b32 v6, v220 offset:4
    v_cvt_pk_bf16_f32 v221, v193, v201
    ds_write_b32 v6, v221 offset:2564
    v_cvt_pk_bf16_f32 v222, v194, v202
    ds_write_b32 v6, v222 offset:5124
    v_cvt_pk_bf16_f32 v223, v195, v203
    ds_write_b32 v6, v223 offset:7684
    v_cvt_pk_bf16_f32 v220, v196, v204
    ds_write_b32 v6, v220 offset:20484
    v_cvt_pk_bf16_f32 v221, v197, v205
    ds_write_b32 v6, v221 offset:23044
    v_cvt_pk_bf16_f32 v222, v198, v206
    ds_write_b32 v6, v222 offset:25604
    v_cvt_pk_bf16_f32 v223, v199, v207
    ds_write_b32 v6, v223 offset:28164
    v_mul_u32_u24 v6, 80, v3
    v_lshl_add_u32 v6, v4, 4, v6
    s_mul_i32 s18, s16, 2560
    v_add_u32 v6, s18, v6
    v_mul_u32_u24 v7, 1114112, v4
    v_lshl_add_u32 v7, v3, 2, v7
    s_lshl_b32 s21, s16, 14
    s_lshl_b32 s22, s29, 7
    s_add_u32 s21, s21, s22
    s_waitcnt lgkmcnt(0)
    s_barrier
    s_mul_i32 s18, s16, 6144
    s_add_u32 s18, s18, 45056
    v_lshlrev_b32 v8, 9, v4
    v_lshl_add_u32 v8, v3, 2, v8
    v_add_u32 v8, s18, v8
    v_lshlrev_b32 v9, 4, v1
    v_add_u32 v9, s18, v9
    v_lshlrev_b32 v7, 4, v1
    s_mul_i32 s21, s29, 4096
    s_mul_hi_u32 s24, s16, 2147483648
    s_mul_i32 s25, s24, 2
    s_sub_u32 s25, s16, s25
    s_mul_i32 s24, s24, 524288
    s_lshl_b32 s25, s25, 11
    s_add_u32 s24, s24, s25
    s_add_u32 s24, s24, s21
    s_add_u32 s26, s16, 8
    s_mul_hi_u32 s25, s26, 2147483648
    s_mul_i32 s27, s25, 2
    s_sub_u32 s27, s26, s27
    s_mul_i32 s25, s25, 524288
    s_lshl_b32 s27, s27, 11
    s_add_u32 s25, s25, s27
    s_add_u32 s25, s25, s21
    s_add_u32 s26, s21, 4194304
    ds_read_b128 v[40:43], v6 offset:0
    ds_read_b128 v[44:47], v6 offset:32
    ds_read_b128 v[48:51], v6 offset:20480
    ds_read_b128 v[52:55], v6 offset:20512
    ds_read_b128 v[56:59], v6 offset:23040
    ds_read_b128 v[60:63], v6 offset:23072
    s_waitcnt lgkmcnt(4)
    v_mfma_f32_32x32x16_bf16 v[72:87], v[224:227], v[40:43], 0
    v_mfma_f32_32x32x16_bf16 v[72:87], v[228:231], v[44:47], v[72:87]
    s_waitcnt lgkmcnt(2)
    v_mfma_f32_32x32x16_bf16 v[88:103], v[224:227], v[48:51], 0
    v_mfma_f32_32x32x16_bf16 v[88:103], v[228:231], v[52:55], v[88:103]
    s_waitcnt lgkmcnt(0)
    v_mfma_f32_32x32x16_bf16 v[104:119], v[224:227], v[56:59], 0
    v_mfma_f32_32x32x16_bf16 v[104:119], v[228:231], v[60:63], v[104:119]
    s_nop 5
    v_mul_f32 v152, v72, v240
    v_mul_f32 v153, v80, v240
    v_fma_f32 v152, v80, v248, v152
    v_fma_f32 v153, -v72, v248, v153
    v_cvt_pk_bf16_f32 v136, v152, v153
    ds_write_b32 v8, v136 offset:0
    v_mul_f32 v154, v73, v241
    v_mul_f32 v155, v81, v241
    v_fma_f32 v154, v81, v249, v154
    v_fma_f32 v155, -v73, v249, v155
    v_cvt_pk_bf16_f32 v137, v154, v155
    ds_write_b32 v8, v137 offset:128
    v_mul_f32 v152, v74, v242
    v_mul_f32 v153, v82, v242
    v_fma_f32 v152, v82, v250, v152
    v_fma_f32 v153, -v74, v250, v153
    v_cvt_pk_bf16_f32 v138, v152, v153
    ds_write_b32 v8, v138 offset:256
    v_mul_f32 v154, v75, v243
    v_mul_f32 v155, v83, v243
    v_fma_f32 v154, v83, v251, v154
    v_fma_f32 v155, -v75, v251, v155
    v_cvt_pk_bf16_f32 v139, v154, v155
    ds_write_b32 v8, v139 offset:384
    v_mul_f32 v152, v76, v244
    v_mul_f32 v153, v84, v244
    v_fma_f32 v152, v84, v252, v152
    v_fma_f32 v153, -v76, v252, v153
    v_cvt_pk_bf16_f32 v136, v152, v153
    ds_write_b32 v8, v136 offset:1024
    v_mul_f32 v154, v77, v245
    v_mul_f32 v155, v85, v245
    v_fma_f32 v154, v85, v253, v154
    v_fma_f32 v155, -v77, v253, v155
    v_cvt_pk_bf16_f32 v137, v154, v155
    ds_write_b32 v8, v137 offset:1152
    v_mul_f32 v152, v78, v246
    v_mul_f32 v153, v86, v246
    v_fma_f32 v152, v86, v254, v152
    v_fma_f32 v153, -v78, v254, v153
    v_cvt_pk_bf16_f32 v138, v152, v153
    ds_write_b32 v8, v138 offset:1280
    v_mul_f32 v154, v79, v247
    v_mul_f32 v155, v87, v247
    v_fma_f32 v154, v87, v255, v154
    v_fma_f32 v155, -v79, v255, v155
    v_cvt_pk_bf16_f32 v139, v154, v155
    ds_write_b32 v8, v139 offset:1408
    s_waitcnt lgkmcnt(0)
    ds_read_b128 v[160:163], v9 offset:0
    ds_read_b128 v[164:167], v9 offset:1024
    s_mov_b32 s22, s24
    s_waitcnt lgkmcnt(1)
    buffer_store_dwordx4 v[160:163], v7, s[8:11], s22 offen sc1
    s_waitcnt lgkmcnt(0)
    buffer_store_dwordx4 v[164:167], v7, s[8:11], s22 offen offset:1024 sc1
    v_mul_f32 v152, v88, v240
    v_mul_f32 v153, v96, v240
    v_fma_f32 v152, v96, v248, v152
    v_fma_f32 v153, -v88, v248, v153
    v_cvt_pk_bf16_f32 v136, v152, v153
    ds_write_b32 v8, v136 offset:2048
    v_mul_f32 v154, v89, v241
    v_mul_f32 v155, v97, v241
    v_fma_f32 v154, v97, v249, v154
    v_fma_f32 v155, -v89, v249, v155
    v_cvt_pk_bf16_f32 v137, v154, v155
    ds_write_b32 v8, v137 offset:2176
    v_mul_f32 v152, v90, v242
    v_mul_f32 v153, v98, v242
    v_fma_f32 v152, v98, v250, v152
    v_fma_f32 v153, -v90, v250, v153
    v_cvt_pk_bf16_f32 v138, v152, v153
    ds_write_b32 v8, v138 offset:2304
    v_mul_f32 v154, v91, v243
    v_mul_f32 v155, v99, v243
    v_fma_f32 v154, v99, v251, v154
    v_fma_f32 v155, -v91, v251, v155
    v_cvt_pk_bf16_f32 v139, v154, v155
    ds_write_b32 v8, v139 offset:2432
    v_mul_f32 v152, v92, v244
    v_mul_f32 v153, v100, v244
    v_fma_f32 v152, v100, v252, v152
    v_fma_f32 v153, -v92, v252, v153
    v_cvt_pk_bf16_f32 v136, v152, v153
    ds_write_b32 v8, v136 offset:3072
    v_mul_f32 v154, v93, v245
    v_mul_f32 v155, v101, v245
    v_fma_f32 v154, v101, v253, v154
    v_fma_f32 v155, -v93, v253, v155
    v_cvt_pk_bf16_f32 v137, v154, v155
    ds_write_b32 v8, v137 offset:3200
    v_mul_f32 v152, v94, v246
    v_mul_f32 v153, v102, v246
    v_fma_f32 v152, v102, v254, v152
    v_fma_f32 v153, -v94, v254, v153
    v_cvt_pk_bf16_f32 v138, v152, v153
    ds_write_b32 v8, v138 offset:3328
    v_mul_f32 v154, v95, v247
    v_mul_f32 v155, v103, v247
    v_fma_f32 v154, v103, v255, v154
    v_fma_f32 v155, -v95, v255, v155
    v_cvt_pk_bf16_f32 v139, v154, v155
    ds_write_b32 v8, v139 offset:3456
    s_waitcnt lgkmcnt(0)
    ds_read_b128 v[168:171], v9 offset:2048
    ds_read_b128 v[172:175], v9 offset:3072
    s_mov_b32 s22, s25
    s_waitcnt lgkmcnt(1)
    buffer_store_dwordx4 v[168:171], v7, s[8:11], s22 offen sc1
    s_waitcnt lgkmcnt(0)
    buffer_store_dwordx4 v[172:175], v7, s[8:11], s22 offen offset:1024 sc1
    s_cmp_eq_u32 s16, 7
    s_cbranch_scc0 a1_fin
    v_mul_f32 v152, v104, v240
    v_mul_f32 v153, v112, v240
    v_fma_f32 v152, v112, v248, v152
    v_fma_f32 v153, -v104, v248, v153
    v_cvt_pk_bf16_f32 v136, v152, v153
    ds_write_b32 v8, v136 offset:4096
    v_mul_f32 v154, v105, v241
    v_mul_f32 v155, v113, v241
    v_fma_f32 v154, v113, v249, v154
    v_fma_f32 v155, -v105, v249, v155
    v_cvt_pk_bf16_f32 v137, v154, v155
    ds_write_b32 v8, v137 offset:4224
    v_mul_f32 v152, v106, v242
    v_mul_f32 v153, v114, v242
    v_fma_f32 v152, v114, v250, v152
    v_fma_f32 v153, -v106, v250, v153
    v_cvt_pk_bf16_f32 v138, v152, v153
    ds_write_b32 v8, v138 offset:4352
    v_mul_f32 v154, v107, v243
    v_mul_f32 v155, v115, v243
    v_fma_f32 v154, v115, v251, v154
    v_fma_f32 v155, -v107, v251, v155
    v_cvt_pk_bf16_f32 v139, v154, v155
    ds_write_b32 v8, v139 offset:4480
    v_mul_f32 v152, v108, v244
    v_mul_f32 v153, v116, v244
    v_fma_f32 v152, v116, v252, v152
    v_fma_f32 v153, -v108, v252, v153
    v_cvt_pk_bf16_f32 v136, v152, v153
    ds_write_b32 v8, v136 offset:5120
    v_mul_f32 v154, v109, v245
    v_mul_f32 v155, v117, v245
    v_fma_f32 v154, v117, v253, v154
    v_fma_f32 v155, -v109, v253, v155
    v_cvt_pk_bf16_f32 v137, v154, v155
    ds_write_b32 v8, v137 offset:5248
    v_mul_f32 v152, v110, v246
    v_mul_f32 v153, v118, v246
    v_fma_f32 v152, v118, v254, v152
    v_fma_f32 v153, -v110, v254, v153
    v_cvt_pk_bf16_f32 v138, v152, v153
    ds_write_b32 v8, v138 offset:5376
    v_mul_f32 v154, v111, v247
    v_mul_f32 v155, v119, v247
    v_fma_f32 v154, v119, v255, v154
    v_fma_f32 v155, -v111, v255, v155
    v_cvt_pk_bf16_f32 v139, v154, v155
    ds_write_b32 v8, v139 offset:5504
    s_waitcnt lgkmcnt(0)
    ds_read_b128 v[176:179], v9 offset:4096
    ds_read_b128 v[180:183], v9 offset:5120
    s_mov_b32 s22, s26
    s_waitcnt lgkmcnt(1)
    buffer_store_dwordx4 v[176:179], v7, s[8:11], s22 offen sc1
    s_waitcnt lgkmcnt(0)
    buffer_store_dwordx4 v[180:183], v7, s[8:11], s22 offen offset:1024 sc1
    s_nop 1
a1_fin:
    s_endpgm
k1_b:
    s_sub_u32 s2, s2, 64
    s_cmp_ge_u32 s2, 192
    s_cbranch_scc1 k1_d
    s_load_dwordx8 s[40:47], s[0:1], 32
    s_load_dwordx2 s[48:49], s[0:1], 64
    s_load_dwordx2 s[50:51], s[0:1], 96
    s_load_dwordx2 s[52:53], s[0:1], 24
    s_sub_u32 s54, s2, 64
    s_lshl_b32 s54, s54, 2
    s_add_u32 s54, s54, s16
    s_lshr_b32 s55, s54, 4
    s_and_b32 s56, s54, 15
    v_and_b32 v160, 7, v1
    v_lshrrev_b32 v161, 3, v1
    v_lshlrev_b32 v162, 14, v161
    v_lshl_add_u32 v162, v160, 4, v162
    v_lshlrev_b32 v163, 15, v160
    v_lshl_add_u32 v163, v161, 4, v163
    s_sub_u32 s17, s2, 64
    s_lshl_b32 s17, s17, 3
    s_add_u32 s17, s17, s16
    s_mul_i32 s18, s16, 17408
    v_and_b32 v3, 15, v1
    v_lshrrev_b32 v4, 4, v1
    s_waitcnt lgkmcnt(0)
    s_mov_b32 s8, s40
    s_mov_b32 s9, s41
    s_mov_b32 s10, 262144
    s_mov_b32 s11, 0x20000
    s_mov_b32 s12, s42
    s_mov_b32 s13, s43
    s_mov_b32 s14, 262144
    s_mov_b32 s15, 0x20000
    s_mov_b32 s20, s44
    s_mov_b32 s21, s45
    s_mov_b32 s22, 262144
    s_mov_b32 s23, 0x20000
    s_mov_b32 s24, s46
    s_mov_b32 s25, s47
    s_mov_b32 s26, 262144
    s_mov_b32 s27, 0x20000
    s_mov_b32 s28, s48
    s_mov_b32 s29, s49
    s_mov_b32 s30, 2048
    s_mov_b32 s31, 0x20000
    s_add_u32 s32, s50, 18874368
    s_addc_u32 s33, s51, 0
    s_mov_b32 s34, 1376256
    s_mov_b32 s35, 0x20000
    s_lshl_b32 s19, s17, 8
    v_lshlrev_b32 v5, 1, v1
    buffer_load_ushort v16, v5, s[8:11], s19 offen offset:0
    buffer_load_ushort v17, v5, s[12:15], s19 offen offset:0
    buffer_load_ushort v18, v5, s[20:23], s19 offen offset:0
    buffer_load_ushort v19, v5, s[24:27], s19 offen offset:0
    buffer_load_ushort v20, v5, s[8:11], s19 offen offset:128
    buffer_load_ushort v21, v5, s[12:15], s19 offen offset:128
    buffer_load_ushort v22, v5, s[20:23], s19 offen offset:128
    buffer_load_ushort v23, v5, s[24:27], s19 offen offset:128
    s_lshl_b32 s19, s17, 1
    v_mov_b32 v6, 0
    buffer_load_ushort v10, v6, s[28:31], s19 offen
    s_mov_b32 s36, s52
    s_mov_b32 s37, s53
    s_mov_b32 s38, 4194304
    s_mov_b32 s39, 0x20000
    s_add_u32 s64, s50, 10485760
    s_addc_u32 s65, s51, 0
    s_mov_b32 s66, 4194304
    s_mov_b32 s67, 0x20000
    s_lshl_b32 s57, s55, 17
    s_lshl_b32 s58, s56, 7
    s_add_u32 s57, s57, s58
    s_add_u32 s58, s57, 0
    buffer_load_dwordx4 v[168:171], v162, s[36:39], s58 offen
    s_add_u32 s58, s57, 2048
    buffer_load_dwordx4 v[172:175], v162, s[36:39], s58 offen
    s_add_u32 s58, s57, 4096
    buffer_load_dwordx4 v[176:179], v162, s[36:39], s58 offen
    s_add_u32 s58, s57, 6144
    buffer_load_dwordx4 v[180:183], v162, s[36:39], s58 offen
    s_add_u32 s58, s57, 8192
    buffer_load_dwordx4 v[184:187], v162, s[36:39], s58 offen
    s_add_u32 s58, s57, 10240
    buffer_load_dwordx4 v[188:191], v162, s[36:39], s58 offen
    s_add_u32 s58, s57, 12288
    buffer_load_dwordx4 v[192:195], v162, s[36:39], s58 offen
    s_add_u32 s58, s57, 14336
    buffer_load_dwordx4 v[196:199], v162, s[36:39], s58 offen
    s_lshl_b32 s57, s56, 18
    buffer_load_dword v164, v6, s[64:67], s57 offen
    s_mul_i32 s57, s17, 1344
    buffer_load_dword v164, v6, s[32:35], s57 offen
    v_mul_u32_u24 v5, 1088, v4
    v_bfe_u32 v6, v1, 2, 2
    v_mul_u32_u24 v6, 272, v6
    v_and_b32 v7, 3, v1
    v_lshl_add_u32 v6, v7, 2, v6
    v_add3_u32 v5, v5, v6, s18
    v_mul_u32_u24 v8, 272, v4
    v_lshl_add_u32 v8, v3, 4, v8
    v_add_u32 v8, s18, v8
    v_mov_b32 v128, 0
    v_mov_b32 v129, 0
    v_mov_b32 v130, 0
    v_mov_b32 v131, 0
    v_mov_b32 v132, 0
    v_mov_b32 v133, 0
    v_mov_b32 v134, 0
    v_mov_b32 v135, 0
    v_mov_b32 v136, 0
    v_mov_b32 v137, 0
    v_mov_b32 v138, 0
    v_mov_b32 v139, 0
    s_waitcnt vmcnt(10)
    s_cmp_lt_u32 s16, 4
    s_cbranch_scc1 kg_nopf
    s_sub_u32 s57, s2, 64
    s_lshr_b32 s57, s57, 3
    s_lshl_b32 s57, s57, 2
    s_add_u32 s57, s57, s16
    s_sub_u32 s57, s57, 4
    v_lshlrev_b32 v165, 4, v1
    s_getpc_b64 s[84:85]
    s_add_u32 s84, s84, tab2@rel32@lo+4
    s_addc_u32 s85, s85, tab2@rel32@hi+12
    s_mov_b32 s86, 69632
    s_mov_b32 s87, 0x20000
    s_lshl_b32 s58, s57, 11
    buffer_load_dwordx4 v[216:219], v165, s[84:87], s58 offen
    buffer_load_dwordx4 v[216:219], v165, s[84:87], s58 offen offset:1024
    s_getpc_b64 s[84:85]
    s_add_u32 s84, s84, k2_kernel@rel32@lo+4
    s_addc_u32 s85, s85, k2_kernel@rel32@hi+12
    s_mov_b32 s86, code_end-k2_kernel
    s_mov_b32 s87, 0x20000
    s_lshl_b32 s58, s57, 10
    buffer_load_dwordx4 v[216:219], v165, s[84:87], s58 offen
kg_nopf:
    v_lshlrev_b32 v10, 16, v10
    v_mul_f32 v10, 0x3fb8aa3b, v10
    v_exp_f32 v10, v10
    s_nop 0
    v_cvt_pk_bf16_f32 v10, v10, 0
    v_lshlrev_b32 v10, 16, v10
    v_add_f32 v9, v10, v10
    s_mov_b32 s62, 0
    s_nop 0
kg_loop:
    v_lshlrev_b32 v12, 16, v16
    v_lshlrev_b32 v13, 16, v17
    v_lshlrev_b32 v14, 16, v18
    v_lshlrev_b32 v15, 16, v19
    v_mul_f32 v24, 0x3fb8aa3b, v12
    v_exp_f32 v24, v24
    s_nop 0
    v_cvt_pk_bf16_f32 v24, v24, 0
    v_lshlrev_b32 v24, 16, v24
    v_mul_f32 v24, v24, v10
    v_mul_f32 v12, 0x3fb8aa3b, v24
    v_mul_f32 v13, v13, v10
    v_mul_f32 v13, 0x3e22f983, v13
    v_mul_f32 v14, v14, v9
    v_mul_f32 v15, v15, v9
    v_mov_b32 v16, v20
    v_mov_b32 v17, v21
    v_mov_b32 v18, v22
    v_mov_b32 v19, v23
    v_mul_f32 v24, 0xbf800000, v12
    v_mul_f32 v25, 0x3f800000, v13
    v_fract_f32 v25, v25
    v_exp_f32 v24, v24
    v_cos_f32 v32, v25
    v_sin_f32 v33, v25
    v_mul_f32 v32, v32, v24
    v_mul_f32 v33, v33, v24
    v_mul_f32 v24, 0xc3000000, v12
    v_mul_f32 v25, 0x43000000, v13
    v_fract_f32 v25, v25
    v_exp_f32 v24, v24
    v_cos_f32 v48, v25
    v_sin_f32 v49, v25
    v_mul_f32 v48, v48, v24
    v_mul_f32 v49, v49, v24
    v_mul_f32 v24, v33, v33
    v_mul_f32 v35, v32, v33
    v_fma_f32 v34, v32, v32, -v24
    v_fma_f32 v35, v33, v32, v35
    v_mul_f32 v24, v35, v33
    v_mul_f32 v37, v34, v33
    v_fma_f32 v36, v34, v32, -v24
    v_fma_f32 v37, v35, v32, v37
    v_mul_f32 v24, v35, v35
    v_mul_f32 v39, v34, v35
    v_fma_f32 v38, v34, v34, -v24
    v_fma_f32 v39, v35, v34, v39
    v_mul_f32 v24, v39, v33
    v_mul_f32 v41, v38, v33
    v_fma_f32 v40, v38, v32, -v24
    v_fma_f32 v41, v39, v32, v41
    v_mul_f32 v24, v39, v35
    v_mul_f32 v43, v38, v35
    v_fma_f32 v42, v38, v34, -v24
    v_fma_f32 v43, v39, v34, v43
    v_mul_f32 v24, v39, v37
    v_mul_f32 v45, v38, v37
    v_fma_f32 v44, v38, v36, -v24
    v_fma_f32 v45, v39, v36, v45
    v_mul_f32 v24, v39, v39
    v_mul_f32 v47, v38, v39
    v_fma_f32 v46, v38, v38, -v24
    v_fma_f32 v47, v39, v38, v47
    v_cvt_pk_bf16_f32 v58, v14, -v15
    ds_write_b32 v5, v58 offset:0
    v_mul_f32 v27, v15, v33
    v_mov_b32 v56, 0x3f80
    v_mul_f32 v65, v14, v33
    v_fma_f32 v64, v14, v32, -v27
    v_fma_f32 v65, v15, v32, v65
    ds_write_b32 v5, v56 offset:13056
    v_cvt_pk_bf16_f32 v59, v64, -v65
    ds_write_b32 v5, v59 offset:16
    v_mul_f32 v27, v15, v35
    v_cvt_pk_bf16_f32 v57, v46, v47
    v_mul_f32 v67, v14, v35
    v_fma_f32 v66, v14, v34, -v27
    v_fma_f32 v67, v15, v34, v67
    ds_write_b32 v5, v57 offset:13072
    v_cvt_pk_bf16_f32 v58, v66, -v67
    ds_write_b32 v5, v58 offset:32
    v_mul_f32 v27, v15, v37
    v_mul_f32 v26, v47, v47
    v_mul_f32 v65, v14, v37
    v_fma_f32 v64, v14, v36, -v27
    v_fma_f32 v65, v15, v36, v65
    v_mul_f32 v61, v46, v47
    v_cvt_pk_bf16_f32 v59, v64, -v65
    ds_write_b32 v5, v59 offset:48
    v_mul_f32 v27, v15, v39
    v_fma_f32 v60, v46, v46, -v26
    v_mul_f32 v67, v14, v39
    v_fma_f32 v66, v14, v38, -v27
    v_fma_f32 v67, v15, v38, v67
    v_fma_f32 v61, v47, v46, v61
    v_cvt_pk_bf16_f32 v58, v66, -v67
    ds_write_b32 v5, v58 offset:64
    v_mul_f32 v27, v15, v41
    v_cvt_pk_bf16_f32 v56, v60, v61
    v_mul_f32 v65, v14, v41
    v_fma_f32 v64, v14, v40, -v27
    v_fma_f32 v65, v15, v40, v65
    ds_write_b32 v5, v56 offset:13088
    v_cvt_pk_bf16_f32 v59, v64, -v65
    ds_write_b32 v5, v59 offset:80
    v_mul_f32 v27, v15, v43
    v_mul_f32 v26, v61, v47
    v_mul_f32 v67, v14, v43
    v_fma_f32 v66, v14, v42, -v27
    v_fma_f32 v67, v15, v42, v67
    v_mul_f32 v63, v60, v47
    v_cvt_pk_bf16_f32 v58, v66, -v67
    ds_write_b32 v5, v58 offset:96
    v_mul_f32 v27, v15, v45
    v_fma_f32 v62, v60, v46, -v26
    v_mul_f32 v65, v14, v45
    v_fma_f32 v64, v14, v44, -v27
    v_fma_f32 v65, v15, v44, v65
    v_fma_f32 v63, v61, v46, v63
    v_cvt_pk_bf16_f32 v59, v64, -v65
    ds_write_b32 v5, v59 offset:112
    v_mul_f32 v28, v15, v49
    v_cvt_pk_bf16_f32 v57, v62, v63
    v_mul_f32 v53, v14, v49
    v_fma_f32 v52, v14, v48, -v28
    v_fma_f32 v53, v15, v48, v53
    ds_write_b32 v5, v57 offset:13104
    v_cvt_pk_bf16_f32 v58, v52, -v53
    ds_write_b32 v5, v58 offset:128
    v_mul_f32 v27, v53, v33
    v_mul_f32 v26, v63, v47
    v_mul_f32 v67, v52, v33
    v_fma_f32 v66, v52, v32, -v27
    v_fma_f32 v67, v53, v32, v67
    v_mul_f32 v61, v62, v47
    v_cvt_pk_bf16_f32 v59, v66, -v67
    ds_write_b32 v5, v59 offset:144
    v_mul_f32 v27, v53, v35
    v_fma_f32 v60, v62, v46, -v26
    v_mul_f32 v65, v52, v35
    v_fma_f32 v64, v52, v34, -v27
    v_fma_f32 v65, v53, v34, v65
    v_fma_f32 v61, v63, v46, v61
    v_cvt_pk_bf16_f32 v58, v64, -v65
    ds_write_b32 v5, v58 offset:160
    v_mul_f32 v27, v53, v37
    v_cvt_pk_bf16_f32 v56, v60, v61
    v_mul_f32 v67, v52, v37
    v_fma_f32 v66, v52, v36, -v27
    v_fma_f32 v67, v53, v36, v67
    ds_write_b32 v5, v56 offset:13120
    v_cvt_pk_bf16_f32 v59, v66, -v67
    ds_write_b32 v5, v59 offset:176
    v_mul_f32 v27, v53, v39
    v_mul_f32 v26, v61, v47
    v_mul_f32 v65, v52, v39
    v_fma_f32 v64, v52, v38, -v27
    v_fma_f32 v65, v53, v38, v65
    v_mul_f32 v63, v60, v47
    v_cvt_pk_bf16_f32 v58, v64, -v65
    ds_write_b32 v5, v58 offset:192
    v_mul_f32 v27, v53, v41
    v_fma_f32 v62, v60, v46, -v26
    v_mul_f32 v67, v52, v41
    v_fma_f32 v66, v52, v40, -v27
    v_fma_f32 v67, v53, v40, v67
    v_fma_f32 v63, v61, v46, v63
    v_cvt_pk_bf16_f32 v59, v66, -v67
    ds_write_b32 v5, v59 offset:208
    v_mul_f32 v27, v53, v43
    v_cvt_pk_bf16_f32 v57, v62, v63
    v_mul_f32 v65, v52, v43
    v_fma_f32 v64, v52, v42, -v27
    v_fma_f32 v65, v53, v42, v65
    ds_write_b32 v5, v57 offset:13136
    v_cvt_pk_bf16_f32 v58, v64, -v65
    ds_write_b32 v5, v58 offset:224
    v_mul_f32 v27, v53, v45
    v_mul_f32 v26, v63, v47
    v_mul_f32 v67, v52, v45
    v_fma_f32 v66, v52, v44, -v27
    v_fma_f32 v67, v53, v44, v67
    v_mul_f32 v61, v62, v47
    v_cvt_pk_bf16_f32 v59, v66, -v67
    ds_write_b32 v5, v59 offset:240
    v_mul_f32 v28, v53, v49
    v_fma_f32 v60, v62, v46, -v26
    v_mul_f32 v51, v52, v49
    v_fma_f32 v50, v52, v48, -v28
    v_fma_f32 v51, v53, v48, v51
    v_fma_f32 v61, v63, v46, v61
    v_cvt_pk_bf16_f32 v58, v50, -v51
    ds_write_b32 v5, v58 offset:4352
    v_mul_f32 v27, v51, v35
    v_cvt_pk_bf16_f32 v56, v60, v61
    v_mul_f32 v65, v50, v35
    v_fma_f32 v64, v50, v34, -v27
    v_fma_f32 v65, v51, v34, v65
    ds_write_b32 v5, v56 offset:13152
    v_cvt_pk_bf16_f32 v59, v64, -v65
    ds_write_b32 v5, v59 offset:4368
    v_mul_f32 v27, v51, v39
    v_mul_f32 v26, v61, v47
    v_mul_f32 v67, v50, v39
    v_fma_f32 v66, v50, v38, -v27
    v_fma_f32 v67, v51, v38, v67
    v_mul_f32 v63, v60, v47
    v_cvt_pk_bf16_f32 v58, v66, -v67
    ds_write_b32 v5, v58 offset:4384
    v_mul_f32 v27, v51, v43
    v_fma_f32 v62, v60, v46, -v26
    v_mul_f32 v65, v50, v43
    v_fma_f32 v64, v50, v42, -v27
    v_fma_f32 v65, v51, v42, v65
    v_fma_f32 v63, v61, v46, v63
    v_cvt_pk_bf16_f32 v59, v64, -v65
    ds_write_b32 v5, v59 offset:4400
    v_mul_f32 v28, v51, v49
    v_cvt_pk_bf16_f32 v57, v62, v63
    v_mul_f32 v53, v50, v49
    v_fma_f32 v52, v50, v48, -v28
    v_fma_f32 v53, v51, v48, v53
    ds_write_b32 v5, v57 offset:13168
    v_cvt_pk_bf16_f32 v58, v52, -v53
    ds_write_b32 v5, v58 offset:4416
    v_mul_f32 v27, v53, v35
    v_mul_f32 v26, v63, v47
    v_mul_f32 v67, v52, v35
    v_fma_f32 v66, v52, v34, -v27
    v_fma_f32 v67, v53, v34, v67
    v_mul_f32 v61, v62, v47
    v_cvt_pk_bf16_f32 v59, v66, -v67
    ds_write_b32 v5, v59 offset:4432
    v_mul_f32 v27, v53, v39
    v_fma_f32 v60, v62, v46, -v26
    v_mul_f32 v65, v52, v39
    v_fma_f32 v64, v52, v38, -v27
    v_fma_f32 v65, v53, v38, v65
    v_fma_f32 v61, v63, v46, v61
    v_cvt_pk_bf16_f32 v58, v64, -v65
    ds_write_b32 v5, v58 offset:4448
    v_mul_f32 v27, v53, v43
    v_cvt_pk_bf16_f32 v56, v60, v61
    v_mul_f32 v67, v52, v43
    v_fma_f32 v66, v52, v42, -v27
    v_fma_f32 v67, v53, v42, v67
    ds_write_b32 v5, v56 offset:13184
    v_cvt_pk_bf16_f32 v59, v66, -v67
    ds_write_b32 v5, v59 offset:4464
    v_mul_f32 v28, v53, v49
    v_mul_f32 v26, v61, v47
    v_mul_f32 v51, v52, v49
    v_fma_f32 v50, v52, v48, -v28
    v_fma_f32 v51, v53, v48, v51
    v_mul_f32 v63, v60, v47
    v_cvt_pk_bf16_f32 v58, v50, -v51
    ds_write_b32 v5, v58 offset:4480
    v_mul_f32 v27, v51, v39
    v_fma_f32 v62, v60, v46, -v26
    v_mul_f32 v65, v50, v39
    v_fma_f32 v64, v50, v38, -v27
    v_fma_f32 v65, v51, v38, v65
    v_fma_f32 v63, v61, v46, v63
    v_cvt_pk_bf16_f32 v59, v64, -v65
    ds_write_b32 v5, v59 offset:4496
    v_mul_f32 v28, v51, v49
    v_cvt_pk_bf16_f32 v57, v62, v63
    v_mul_f32 v53, v50, v49
    v_fma_f32 v52, v50, v48, -v28
    v_fma_f32 v53, v51, v48, v53
    ds_write_b32 v5, v57 offset:13200
    v_cvt_pk_bf16_f32 v58, v52, -v53
    ds_write_b32 v5, v58 offset:4512
    v_mul_f32 v27, v53, v39
    v_mul_f32 v26, v63, v47
    v_mul_f32 v67, v52, v39
    v_fma_f32 v66, v52, v38, -v27
    v_fma_f32 v67, v53, v38, v67
    v_mul_f32 v61, v62, v47
    v_cvt_pk_bf16_f32 v59, v66, -v67
    ds_write_b32 v5, v59 offset:4528
    v_mul_f32 v28, v53, v49
    v_fma_f32 v60, v62, v46, -v26
    v_mul_f32 v51, v52, v49
    v_fma_f32 v50, v52, v48, -v28
    v_fma_f32 v51, v53, v48, v51
    v_fma_f32 v61, v63, v46, v61
    v_cvt_pk_bf16_f32 v58, v50, -v51
    ds_write_b32 v5, v58 offset:4544
    v_mul_f32 v27, v51, v39
    v_cvt_pk_bf16_f32 v56, v60, v61
    v_mul_f32 v65, v50, v39
    v_fma_f32 v64, v50, v38, -v27
    v_fma_f32 v65, v51, v38, v65
    ds_write_b32 v5, v56 offset:13216
    v_cvt_pk_bf16_f32 v59, v64, -v65
    ds_write_b32 v5, v59 offset:4560
    v_mul_f32 v28, v51, v49
    v_mul_f32 v26, v61, v47
    v_mul_f32 v53, v50, v49
    v_fma_f32 v52, v50, v48, -v28
    v_fma_f32 v53, v51, v48, v53
    v_mul_f32 v63, v60, v47
    v_cvt_pk_bf16_f32 v58, v52, -v53
    ds_write_b32 v5, v58 offset:4576
    v_mul_f32 v27, v53, v39
    v_fma_f32 v62, v60, v46, -v26
    v_mul_f32 v67, v52, v39
    v_fma_f32 v66, v52, v38, -v27
    v_fma_f32 v67, v53, v38, v67
    v_fma_f32 v63, v61, v46, v63
    v_cvt_pk_bf16_f32 v59, v66, -v67
    ds_write_b32 v5, v59 offset:4592
    v_mul_f32 v28, v53, v49
    v_cvt_pk_bf16_f32 v57, v62, v63
    v_mul_f32 v51, v52, v49
    v_fma_f32 v50, v52, v48, -v28
    v_fma_f32 v51, v53, v48, v51
    ds_write_b32 v5, v57 offset:13232
    v_cvt_pk_bf16_f32 v58, v50, -v51
    ds_write_b32 v5, v58 offset:8704
    v_mul_f32 v28, v51, v49
    v_mul_f32 v26, v63, v47
    v_mul_f32 v53, v50, v49
    v_fma_f32 v52, v50, v48, -v28
    v_fma_f32 v53, v51, v48, v53
    v_mul_f32 v61, v62, v47
    v_cvt_pk_bf16_f32 v59, v52, -v53
    ds_write_b32 v5, v59 offset:8720
    v_mul_f32 v28, v53, v49
    v_fma_f32 v60, v62, v46, -v26
    v_mul_f32 v51, v52, v49
    v_fma_f32 v50, v52, v48, -v28
    v_fma_f32 v51, v53, v48, v51
    v_fma_f32 v61, v63, v46, v61
    v_cvt_pk_bf16_f32 v58, v50, -v51
    ds_write_b32 v5, v58 offset:8736
    v_mul_f32 v28, v51, v49
    v_cvt_pk_bf16_f32 v56, v60, v61
    v_mul_f32 v53, v50, v49
    v_fma_f32 v52, v50, v48, -v28
    v_fma_f32 v53, v51, v48, v53
    ds_write_b32 v5, v56 offset:13248
    v_cvt_pk_bf16_f32 v59, v52, -v53
    ds_write_b32 v5, v59 offset:8752
    v_mul_f32 v28, v53, v49
    v_mul_f32 v26, v61, v47
    v_mul_f32 v51, v52, v49
    v_fma_f32 v50, v52, v48, -v28
    v_fma_f32 v51, v53, v48, v51
    v_mul_f32 v63, v60, v47
    v_cvt_pk_bf16_f32 v58, v50, -v51
    ds_write_b32 v5, v58 offset:8768
    v_mul_f32 v28, v51, v49
    v_fma_f32 v62, v60, v46, -v26
    v_mul_f32 v53, v50, v49
    v_fma_f32 v52, v50, v48, -v28
    v_fma_f32 v53, v51, v48, v53
    v_fma_f32 v63, v61, v46, v63
    v_cvt_pk_bf16_f32 v59, v52, -v53
    ds_write_b32 v5, v59 offset:8784
    v_mul_f32 v28, v53, v49
    v_cvt_pk_bf16_f32 v57, v62, v63
    v_mul_f32 v51, v52, v49
    v_fma_f32 v50, v52, v48, -v28
    v_fma_f32 v51, v53, v48, v51
    ds_write_b32 v5, v57 offset:13264
    v_cvt_pk_bf16_f32 v58, v50, -v51
    ds_write_b32 v5, v58 offset:8800
    v_mul_f32 v28, v51, v49
    v_mul_f32 v26, v63, v47
    v_mul_f32 v53, v50, v49
    v_fma_f32 v52, v50, v48, -v28
    v_fma_f32 v53, v51, v48, v53
    v_mul_f32 v61, v62, v47
    v_cvt_pk_bf16_f32 v59, v52, -v53
    ds_write_b32 v5, v59 offset:8816
    v_mul_f32 v28, v53, v49
    v_fma_f32 v60, v62, v46, -v26
    v_mul_f32 v51, v52, v49
    v_fma_f32 v50, v52, v48, -v28
    v_fma_f32 v51, v53, v48, v51
    v_fma_f32 v61, v63, v46, v61
    v_cvt_pk_bf16_f32 v58, v50, -v51
    ds_write_b32 v5, v58 offset:8832
    v_cvt_pk_bf16_f32 v56, v60, v61
    ds_write_b32 v5, v56 offset:13280
    v_mul_f32 v26, v61, v47
    v_mul_f32 v63, v60, v47
    v_fma_f32 v62, v60, v46, -v26
    v_fma_f32 v63, v61, v46, v63
    v_cvt_pk_bf16_f32 v57, v62, v63
    ds_write_b32 v5, v57 offset:13296
    s_waitcnt lgkmcnt(0)
    ds_read_b128 v[72:75], v8 offset:13056
    ds_read_b128 v[76:79], v8 offset:14144
    ds_read_b128 v[80:83], v8 offset:15232
    ds_read_b128 v[84:87], v8 offset:16320
    ds_read_b128 v[88:91], v8 offset:0
    ds_read_b128 v[92:95], v8 offset:1088
    ds_read_b128 v[96:99], v8 offset:2176
    ds_read_b128 v[100:103], v8 offset:3264
    ds_read_b128 v[104:107], v8 offset:4352
    ds_read_b128 v[108:111], v8 offset:5440
    ds_read_b128 v[112:115], v8 offset:6528
    ds_read_b128 v[116:119], v8 offset:7616
    ds_read_b128 v[140:143], v8 offset:8704
    ds_read_b128 v[144:147], v8 offset:9792
    ds_read_b128 v[148:151], v8 offset:10880
    ds_read_b128 v[152:155], v8 offset:11968
    s_waitcnt lgkmcnt(0)
    v_mfma_f32_16x16x32_bf16 v[128:131], v[88:91], v[72:75], v[128:131]
    v_mfma_f32_16x16x32_bf16 v[132:135], v[104:107], v[72:75], v[132:135]
    v_mfma_f32_16x16x32_bf16 v[136:139], v[140:143], v[72:75], v[136:139]
    v_mfma_f32_16x16x32_bf16 v[128:131], v[92:95], v[76:79], v[128:131]
    v_mfma_f32_16x16x32_bf16 v[132:135], v[108:111], v[76:79], v[132:135]
    v_mfma_f32_16x16x32_bf16 v[136:139], v[144:147], v[76:79], v[136:139]
    v_mfma_f32_16x16x32_bf16 v[128:131], v[96:99], v[80:83], v[128:131]
    v_mfma_f32_16x16x32_bf16 v[132:135], v[112:115], v[80:83], v[132:135]
    v_mfma_f32_16x16x32_bf16 v[136:139], v[148:151], v[80:83], v[136:139]
    v_mfma_f32_16x16x32_bf16 v[128:131], v[100:103], v[84:87], v[128:131]
    v_mfma_f32_16x16x32_bf16 v[132:135], v[116:119], v[84:87], v[132:135]
    v_mfma_f32_16x16x32_bf16 v[136:139], v[152:155], v[84:87], v[136:139]
    s_add_u32 s62, s62, 1
    s_cmp_lt_u32 s62, 2
    s_nop 5
    s_cbranch_scc1 kg_loop
    s_waitcnt vmcnt(0)
    s_cmp_lt_u32 s16, 4
    s_cbranch_scc0 ut_nost
    s_mov_b32 s60, 0x05040100
    s_mov_b32 s61, 0x07060302
    s_lshl_b32 s57, s56, 18
    s_lshl_b32 s58, s55, 7
    s_add_u32 s57, s57, s58
    v_perm_b32 v200, v172, v168, s60
    v_perm_b32 v201, v180, v176, s60
    v_perm_b32 v202, v188, v184, s60
    v_perm_b32 v203, v196, v192, s60
    s_add_u32 s58, s57, 0
    buffer_store_dwordx4 v[200:203], v163, s[64:67], s58 offen sc1
    v_perm_b32 v204, v172, v168, s61
    v_perm_b32 v205, v180, v176, s61
    v_perm_b32 v206, v188, v184, s61
    v_perm_b32 v207, v196, v192, s61
    s_add_u32 s58, s57, 4096
    buffer_store_dwordx4 v[204:207], v163, s[64:67], s58 offen sc1
    v_perm_b32 v208, v173, v169, s60
    v_perm_b32 v209, v181, v177, s60
    v_perm_b32 v210, v189, v185, s60
    v_perm_b32 v211, v197, v193, s60
    s_add_u32 s58, s57, 8192
    buffer_store_dwordx4 v[208:211], v163, s[64:67], s58 offen sc1
    v_perm_b32 v212, v173, v169, s61
    v_perm_b32 v213, v181, v177, s61
    v_perm_b32 v214, v189, v185, s61
    v_perm_b32 v215, v197, v193, s61
    s_add_u32 s58, s57, 12288
    buffer_store_dwordx4 v[212:215], v163, s[64:67], s58 offen sc1
    v_perm_b32 v200, v174, v170, s60
    v_perm_b32 v201, v182, v178, s60
    v_perm_b32 v202, v190, v186, s60
    v_perm_b32 v203, v198, v194, s60
    s_add_u32 s58, s57, 16384
    buffer_store_dwordx4 v[200:203], v163, s[64:67], s58 offen sc1
    v_perm_b32 v204, v174, v170, s61
    v_perm_b32 v205, v182, v178, s61
    v_perm_b32 v206, v190, v186, s61
    v_perm_b32 v207, v198, v194, s61
    s_add_u32 s58, s57, 20480
    buffer_store_dwordx4 v[204:207], v163, s[64:67], s58 offen sc1
    v_perm_b32 v208, v175, v171, s60
    v_perm_b32 v209, v183, v179, s60
    v_perm_b32 v210, v191, v187, s60
    v_perm_b32 v211, v199, v195, s60
    s_add_u32 s58, s57, 24576
    buffer_store_dwordx4 v[208:211], v163, s[64:67], s58 offen sc1
    v_perm_b32 v212, v175, v171, s61
    v_perm_b32 v213, v183, v179, s61
    v_perm_b32 v214, v191, v187, s61
    v_perm_b32 v215, v199, v195, s61
    s_add_u32 s58, s57, 28672
    buffer_store_dwordx4 v[212:215], v163, s[64:67], s58 offen sc1
    s_nop 1
ut_nost:
    s_mul_i32 s19, s17, 1344
    v_lshrrev_b32 v6, 1, v4
    v_lshlrev_b32 v6, 7, v6
    v_and_b32 v7, 1, v4
    v_lshl_add_u32 v6, v7, 2, v6
    v_lshl_add_u32 v6, v3, 3, v6
    v_lshlrev_b32 v6, 1, v6
    v_cmp_gt_u32 vcc, 2, v4
    v_lshlrev_b32 v7, 2, v3
    v_lshlrev_b32 v8, 1, v3
    v_cndmask_b32 v7, v8, v7, vcc
    v_lshl_add_u32 v7, v4, 6, v7
    v_lshlrev_b32 v7, 1, v7
    v_mov_b32 v8, 60
    v_cndmask_b32 v8, v8, 0, vcc
    v_add_u32 v8, v7, v8
    v_cvt_pk_bf16_f32 v24, v128, v129
    v_cvt_pk_bf16_f32 v25, v130, v131
    v_add_u32 v6, s18, v6
    ds_write_b64 v6, v[24:25]
    v_cvt_pk_bf16_f32 v26, v132, v133
    v_cvt_pk_bf16_f32 v27, v134, v135
    v_add_u32 v7, s18, v7
    ds_write_b32 v7, v26 offset:512
    v_add_u32 v8, s18, v8
    ds_write_b32 v8, v27 offset:516
    v_lshl_add_u32 v6, v4, 6, v3
    v_lshlrev_b32 v6, 1, v6
    v_add_u32 v6, s18, v6
    v_cvt_pk_bf16_f32 v28, v136, 0
    v_cvt_pk_bf16_f32 v29, v137, 0
    v_cvt_pk_bf16_f32 v30, v138, 0
    v_cvt_pk_bf16_f32 v31, v139, 0
    s_mov_b32 exec_hi, 0
    ds_write_b16 v6, v28 offset:1024
    ds_write_b16 v6, v29 offset:1056
    ds_write_b16 v6, v30 offset:1088
    ds_write_b16 v6, v31 offset:1120
    s_mov_b32 exec_lo, 0
    s_mov_b32 exec_hi, 1
    ds_write_b32 v6, v28 offset:1024
    s_mov_b64 exec, -1
    v_lshlrev_b32 v7, 4, v1
    v_add_u32 v6, s18, v7
    s_waitcnt lgkmcnt(0)
    ds_read_b128 v[32:35], v6
    ds_read_b128 v[36:39], v6 offset:1024
    s_waitcnt lgkmcnt(1)
    buffer_store_dwordx4 v[32:35], v7, s[32:35], s19 offen sc1
    s_waitcnt lgkmcnt(0)
    s_mov_b32 exec_lo, 0xfffff
    s_mov_b32 exec_hi, 0
    buffer_store_dwordx4 v[36:39], v7, s[32:35], s19 offen offset:1024 sc1
    s_mov_b64 exec, -1
    s_endpgm
k1_d:
    s_endpgm
.globl k2_kernel
.p2align 8
.type k2_kernel,@function
k2_kernel:
    v_and_b32 v1, 63, v0
    v_lshrrev_b32 v2, 6, v0
    s_nop 0
    v_readfirstlane_b32 s16, v2
    s_cmp_ge_u32 s2, 256
    s_cbranch_scc1 k2_b
    s_load_dwordx2 s[40:41], s[0:1], 72
    s_load_dwordx2 s[42:43], s[0:1], 96
    s_getpc_b64 s[64:65]
    s_add_u32 s64, s64, tabX@rel32@lo+4
    s_addc_u32 s65, s65, tabX@rel32@hi+12
    s_mov_b32 s66, 12288
    s_mov_b32 s67, 0x20000
    s_lshr_b32 s62, s16, 1
    s_and_b32 s63, s16, 1
    s_lshl_b32 s17, s2, 2
    s_add_u32 s17, s17, s62
    s_mul_i32 s18, s62, 16960
    v_and_b32 v3, 15, v1
    v_lshrrev_b32 v4, 4, v1
    v_lshlrev_b32 v2, 4, v1
    v_lshlrev_b32 v8, 5, v1
    s_lshl_b32 s56, s63, 11
    s_add_u32 s57, s56, 0
    buffer_load_dwordx4 v[24:27], v8, s[64:67], s57 offen
    buffer_load_dword v36, v8, s[64:67], s57 offen offset:16
    s_add_u32 s57, s56, 4096
    buffer_load_dwordx4 v[28:31], v8, s[64:67], s57 offen
    buffer_load_dword v37, v8, s[64:67], s57 offen offset:16
    s_add_u32 s57, s56, 8192
    buffer_load_dwordx4 v[32:35], v8, s[64:67], s57 offen
    buffer_load_dword v38, v8, s[64:67], s57 offen offset:16
    s_waitcnt lgkmcnt(0)
    s_mov_b32 s32, s40
    s_mov_b32 s33, s41
    s_mov_b32 s34, 2048
    s_mov_b32 s35, 0x20000
    s_add_u32 s4, s42, 10485760
    s_addc_u32 s5, s43, 0
    s_mov_b32 s6, 4194304
    s_mov_b32 s7, 0x20000
    s_add_u32 s8, s42, 18874368
    s_addc_u32 s9, s43, 0
    s_mov_b32 s10, 1376256
    s_mov_b32 s11, 0x20000
    s_add_u32 s12, s42, 14680064
    s_addc_u32 s13, s43, 0
    s_mov_b32 s14, 4194304
    s_mov_b32 s15, 0x20000
    s_mul_i32 s19, s17, 1344
    s_lshl_b32 s56, s63, 10
    s_add_u32 s19, s19, s56
    buffer_load_dwordx4 v[16:19], v2, s[8:11], s19 offen
    s_lshl_b32 s19, s17, 12
    s_lshl_b32 s57, s63, 11
    s_add_u32 s19, s19, s57
    buffer_load_dwordx4 v[112:115], v2, s[4:7], s19 offen offset:0
    buffer_load_dwordx4 v[116:119], v2, s[4:7], s19 offen offset:1024
    s_lshl_b32 s19, s17, 1
    v_mov_b32 v6, 0
    buffer_load_ushort v11, v6, s[32:35], s19 offen
    s_add_u32 s56, s56, s18
    v_add_u32 v6, s56, v2
    v_mov_b32 v9, s18
    s_waitcnt vmcnt(3)
    ds_write_b128 v6, v[16:19]
    s_waitcnt lgkmcnt(0)
    s_barrier
    v_add_u32_sdwa v12, v24, v9 dst_sel:DWORD dst_unused:UNUSED_PAD src0_sel:WORD_0 src1_sel:DWORD
    ds_read_u16 v40, v12
    v_add_u32_sdwa v13, v24, v9 dst_sel:DWORD dst_unused:UNUSED_PAD src0_sel:WORD_1 src1_sel:DWORD
    ds_read_u16 v41, v13
    v_add_u32_sdwa v14, v25, v9 dst_sel:DWORD dst_unused:UNUSED_PAD src0_sel:WORD_0 src1_sel:DWORD
    ds_read_u16 v42, v14
    v_add_u32_sdwa v15, v25, v9 dst_sel:DWORD dst_unused:UNUSED_PAD src0_sel:WORD_1 src1_sel:DWORD
    ds_read_u16 v43, v15
    v_add_u32_sdwa v12, v26, v9 dst_sel:DWORD dst_unused:UNUSED_PAD src0_sel:WORD_0 src1_sel:DWORD
    ds_read_u16 v44, v12
    v_add_u32_sdwa v13, v26, v9 dst_sel:DWORD dst_unused:UNUSED_PAD src0_sel:WORD_1 src1_sel:DWORD
    ds_read_u16 v45, v13
    v_add_u32_sdwa v14, v27, v9 dst_sel:DWORD dst_unused:UNUSED_PAD src0_sel:WORD_0 src1_sel:DWORD
    ds_read_u16 v46, v14
    v_add_u32_sdwa v15, v27, v9 dst_sel:DWORD dst_unused:UNUSED_PAD src0_sel:WORD_1 src1_sel:DWORD
    ds_read_u16 v47, v15
    v_add_u32_sdwa v12, v36, v9 dst_sel:DWORD dst_unused:UNUSED_PAD src0_sel:WORD_0 src1_sel:DWORD
    ds_read_u16 v48, v12
    v_add_u32_sdwa v12, v28, v9 dst_sel:DWORD dst_unused:UNUSED_PAD src0_sel:WORD_0 src1_sel:DWORD
    ds_read_u16 v50, v12
    v_add_u32_sdwa v13, v28, v9 dst_sel:DWORD dst_unused:UNUSED_PAD src0_sel:WORD_1 src1_sel:DWORD
    ds_read_u16 v51, v13
    v_add_u32_sdwa v14, v29, v9 dst_sel:DWORD dst_unused:UNUSED_PAD src0_sel:WORD_0 src1_sel:DWORD
    ds_read_u16 v52, v14
    v_add_u32_sdwa v15, v29, v9 dst_sel:DWORD dst_unused:UNUSED_PAD src0_sel:WORD_1 src1_sel:DWORD
    ds_read_u16 v53, v15
    v_add_u32_sdwa v12, v30, v9 dst_sel:DWORD dst_unused:UNUSED_PAD src0_sel:WORD_0 src1_sel:DWORD
    ds_read_u16 v54, v12
    v_add_u32_sdwa v13, v30, v9 dst_sel:DWORD dst_unused:UNUSED_PAD src0_sel:WORD_1 src1_sel:DWORD
    ds_read_u16 v55, v13
    v_add_u32_sdwa v14, v31, v9 dst_sel:DWORD dst_unused:UNUSED_PAD src0_sel:WORD_0 src1_sel:DWORD
    ds_read_u16 v56, v14
    v_add_u32_sdwa v15, v31, v9 dst_sel:DWORD dst_unused:UNUSED_PAD src0_sel:WORD_1 src1_sel:DWORD
    ds_read_u16 v57, v15
    v_add_u32_sdwa v12, v37, v9 dst_sel:DWORD dst_unused:UNUSED_PAD src0_sel:WORD_0 src1_sel:DWORD
    ds_read_u16 v58, v12
    v_add_u32_sdwa v12, v32, v9 dst_sel:DWORD dst_unused:UNUSED_PAD src0_sel:WORD_0 src1_sel:DWORD
    ds_read_u16 v60, v12
    v_add_u32_sdwa v13, v32, v9 dst_sel:DWORD dst_unused:UNUSED_PAD src0_sel:WORD_1 src1_sel:DWORD
    ds_read_u16 v61, v13
    v_add_u32_sdwa v14, v33, v9 dst_sel:DWORD dst_unused:UNUSED_PAD src0_sel:WORD_0 src1_sel:DWORD
    ds_read_u16 v62, v14
    v_add_u32_sdwa v15, v33, v9 dst_sel:DWORD dst_unused:UNUSED_PAD src0_sel:WORD_1 src1_sel:DWORD
    ds_read_u16 v63, v15
    v_add_u32_sdwa v12, v34, v9 dst_sel:DWORD dst_unused:UNUSED_PAD src0_sel:WORD_0 src1_sel:DWORD
    ds_read_u16 v64, v12
    v_add_u32_sdwa v13, v34, v9 dst_sel:DWORD dst_unused:UNUSED_PAD src0_sel:WORD_1 src1_sel:DWORD
    ds_read_u16 v65, v13
    v_add_u32_sdwa v14, v35, v9 dst_sel:DWORD dst_unused:UNUSED_PAD src0_sel:WORD_0 src1_sel:DWORD
    ds_read_u16 v66, v14
    v_add_u32_sdwa v15, v35, v9 dst_sel:DWORD dst_unused:UNUSED_PAD src0_sel:WORD_1 src1_sel:DWORD
    ds_read_u16 v67, v15
    v_add_u32_sdwa v12, v38, v9 dst_sel:DWORD dst_unused:UNUSED_PAD src0_sel:WORD_0 src1_sel:DWORD
    ds_read_u16 v68, v12
    s_waitcnt lgkmcnt(0)
    v_lshl_or_b32 v72, v41, 16, v40
    v_lshl_or_b32 v76, v42, 16, v41
    v_lshl_or_b32 v73, v43, 16, v42
    v_lshl_or_b32 v77, v44, 16, v43
    v_lshl_or_b32 v74, v45, 16, v44
    v_lshl_or_b32 v78, v46, 16, v45
    v_lshl_or_b32 v75, v47, 16, v46
    v_lshl_or_b32 v79, v48, 16, v47
    ds_write_b128 v6, v[72:75] offset:4672
    ds_write_b128 v6, v[76:79] offset:10816
    v_lshl_or_b32 v80, v51, 16, v50
    v_lshl_or_b32 v84, v52, 16, v51
    v_lshl_or_b32 v81, v53, 16, v52
    v_lshl_or_b32 v85, v54, 16, v53
    v_lshl_or_b32 v82, v55, 16, v54
    v_lshl_or_b32 v86, v56, 16, v55
    v_lshl_or_b32 v83, v57, 16, v56
    v_lshl_or_b32 v87, v58, 16, v57
    ds_write_b128 v6, v[80:83] offset:6720
    ds_write_b128 v6, v[84:87] offset:12864
    v_lshl_or_b32 v88, v61, 16, v60
    v_lshl_or_b32 v92, v62, 16, v61
    v_lshl_or_b32 v89, v63, 16, v62
    v_lshl_or_b32 v93, v64, 16, v63
    v_lshl_or_b32 v90, v65, 16, v64
    v_lshl_or_b32 v94, v66, 16, v65
    v_lshl_or_b32 v91, v67, 16, v66
    v_lshl_or_b32 v95, v68, 16, v67
    ds_write_b128 v6, v[88:91] offset:8768
    ds_write_b128 v6, v[92:95] offset:14912
    s_barrier
    v_mov_b32 v12, 0
    v_mov_b32 v13, 0
    v_mov_b32 v14, 0
    v_mov_b32 v15, 0
    v_and_b32 v7, 0x1f0, v2
    v_add_u32 v7, s18, v7
    ds_write_b128 v7, v[12:15] offset:0
    v_and_b32 v7, 0x30, v2
    v_add_u32 v7, s18, v7
    ds_write_b128 v7, v[12:15] offset:4608
    s_add_u32 s57, s57, s18
    v_add_u32 v7, s57, v2
    s_waitcnt vmcnt(0)
    ds_write_b128 v7, v[112:115] offset:512
    ds_write_b128 v7, v[116:119] offset:1536
    v_lshlrev_b32 v11, 16, v11
    v_lshlrev_b32 v5, 3, v4
    v_sub_u32 v5, v5, v3
    v_add_u32 v5, 2064, v5
    v_and_b32 v7, 1, v5
    v_and_b32 v5, -2, v5
    v_lshlrev_b32 v5, 1, v5
    v_mul_u32_u24 v7, 6144, v7
    v_add3_u32 v5, v5, v7, s18
    v_add_u32 v5, 4672, v5
    s_lshl_b32 s56, s63, 6
    v_subrev_u32 v5, s56, v5
    v_lshlrev_b32 v6, 5, v3
    v_lshl_add_u32 v6, v4, 4, v6
    v_add_u32 v6, s18, v6
    v_subrev_u32 v6, s56, v6
    v_mov_b32 v16, 0
    v_mov_b32 v17, 0
    v_mov_b32 v18, 0
    v_mov_b32 v19, 0
    v_mov_b32 v20, 0
    v_mov_b32 v21, 0
    v_mov_b32 v22, 0
    v_mov_b32 v23, 0
    v_mov_b32 v24, 0
    v_mov_b32 v25, 0
    v_mov_b32 v26, 0
    v_mov_b32 v27, 0
    v_mov_b32 v28, 0
    v_mov_b32 v29, 0
    v_mov_b32 v30, 0
    v_mov_b32 v31, 0
    v_mov_b32 v32, 0
    v_mov_b32 v33, 0
    v_mov_b32 v34, 0
    v_mov_b32 v35, 0
    v_mov_b32 v36, 0
    v_mov_b32 v37, 0
    v_mov_b32 v38, 0
    v_mov_b32 v39, 0
    v_mov_b32 v40, 0
    v_mov_b32 v41, 0
    v_mov_b32 v42, 0
    v_mov_b32 v43, 0
    v_mov_b32 v44, 0
    v_mov_b32 v45, 0
    v_mov_b32 v46, 0
    v_mov_b32 v47, 0
    s_waitcnt lgkmcnt(0)
    s_barrier
    s_cmp_eq_u32 s63, 0
    s_cbranch_scc0 c2_noextra
    ds_read_b128 v[12:15], v6 offset:0
    v_subrev_u32 v7, 512, v5
    ds_read2_b32 v[80:81], v7 offset0:0 offset1:1
    ds_read2_b32 v[82:83], v7 offset0:2 offset1:3
    v_subrev_u32 v7, 1024, v5
    ds_read2_b32 v[84:85], v7 offset0:0 offset1:1
    ds_read2_b32 v[86:87], v7 offset0:2 offset1:3
    v_subrev_u32 v7, 1536, v5
    ds_read2_b32 v[88:89], v7 offset0:0 offset1:1
    ds_read2_b32 v[90:91], v7 offset0:2 offset1:3
    v_subrev_u32 v7, 2048, v5
    ds_read2_b32 v[92:93], v7 offset0:0 offset1:1
    ds_read2_b32 v[94:95], v7 offset0:2 offset1:3
    v_subrev_u32 v7, 2560, v5
    ds_read2_b32 v[96:97], v7 offset0:0 offset1:1
    ds_read2_b32 v[98:99], v7 offset0:2 offset1:3
    v_subrev_u32 v7, 3072, v5
    ds_read2_b32 v[100:101], v7 offset0:0 offset1:1
    ds_read2_b32 v[102:103], v7 offset0:2 offset1:3
    v_subrev_u32 v7, 3584, v5
    ds_read2_b32 v[104:105], v7 offset0:0 offset1:1
    ds_read2_b32 v[106:107], v7 offset0:2 offset1:3
    v_subrev_u32 v7, 4096, v5
    ds_read2_b32 v[108:109], v7 offset0:0 offset1:1
    ds_read2_b32 v[110:111], v7 offset0:2 offset1:3
    s_waitcnt lgkmcnt(0)
    v_mfma_f32_16x16x32_bf16 v[16:19], v[80:83], v[12:15], v[16:19]
    v_mfma_f32_16x16x32_bf16 v[20:23], v[84:87], v[12:15], v[20:23]
    v_mfma_f32_16x16x32_bf16 v[24:27], v[88:91], v[12:15], v[24:27]
    v_mfma_f32_16x16x32_bf16 v[28:31], v[92:95], v[12:15], v[28:31]
    v_mfma_f32_16x16x32_bf16 v[32:35], v[96:99], v[12:15], v[32:35]
    v_mfma_f32_16x16x32_bf16 v[36:39], v[100:103], v[12:15], v[36:39]
    v_mfma_f32_16x16x32_bf16 v[40:43], v[104:107], v[12:15], v[40:43]
    v_mfma_f32_16x16x32_bf16 v[44:47], v[108:111], v[12:15], v[44:47]
    s_nop 7
c2_noextra:
    ds_read_b128 v[48:51], v6 offset:512
    ds_read_b128 v[52:55], v6 offset:1024
    ds_read_b128 v[56:59], v6 offset:1536
    ds_read_b128 v[60:63], v6 offset:2048
    ds_read_b128 v[64:67], v6 offset:2560
    ds_read_b128 v[68:71], v6 offset:3072
    ds_read_b128 v[72:75], v6 offset:3584
    ds_read_b128 v[76:79], v6 offset:4096
    v_subrev_u32 v7, 0, v5
    ds_read2_b32 v[112:113], v7 offset0:0 offset1:1
    ds_read2_b32 v[114:115], v7 offset0:2 offset1:3
    v_subrev_u32 v7, 512, v5
    ds_read2_b32 v[116:117], v7 offset0:0 offset1:1
    ds_read2_b32 v[118:119], v7 offset0:2 offset1:3
    v_subrev_u32 v7, 1024, v5
    ds_read2_b32 v[120:121], v7 offset0:0 offset1:1
    ds_read2_b32 v[122:123], v7 offset0:2 offset1:3
    s_waitcnt lgkmcnt(4)
    v_mfma_f32_16x16x32_bf16 v[16:19], v[112:115], v[48:51], v[16:19]
    v_mfma_f32_16x16x32_bf16 v[20:23], v[112:115], v[52:55], v[20:23]
    v_mfma_f32_16x16x32_bf16 v[24:27], v[112:115], v[56:59], v[24:27]
    v_mfma_f32_16x16x32_bf16 v[28:31], v[112:115], v[60:63], v[28:31]
    v_mfma_f32_16x16x32_bf16 v[32:35], v[112:115], v[64:67], v[32:35]
    v_mfma_f32_16x16x32_bf16 v[36:39], v[112:115], v[68:71], v[36:39]
    v_mfma_f32_16x16x32_bf16 v[40:43], v[112:115], v[72:75], v[40:43]
    v_mfma_f32_16x16x32_bf16 v[44:47], v[112:115], v[76:79], v[44:47]
    ds_read_b128 v[80:83], v6 offset:384
    ds_read_b128 v[84:87], v6 offset:896
    ds_read_b128 v[88:91], v6 offset:1408
    ds_read_b128 v[92:95], v6 offset:1920
    ds_read_b128 v[96:99], v6 offset:2432
    ds_read_b128 v[100:103], v6 offset:2944
    ds_read_b128 v[104:107], v6 offset:3456
    ds_read_b128 v[108:111], v6 offset:3968
    v_subrev_u32 v7, 1536, v5
    ds_read2_b32 v[124:125], v7 offset0:0 offset1:1
    ds_read2_b32 v[126:127], v7 offset0:2 offset1:3
    s_waitcnt lgkmcnt(12)
    v_mfma_f32_16x16x32_bf16 v[20:23], v[116:119], v[48:51], v[20:23]
    v_mfma_f32_16x16x32_bf16 v[24:27], v[116:119], v[52:55], v[24:27]
    v_mfma_f32_16x16x32_bf16 v[28:31], v[116:119], v[56:59], v[28:31]
    v_mfma_f32_16x16x32_bf16 v[32:35], v[116:119], v[60:63], v[32:35]
    v_mfma_f32_16x16x32_bf16 v[36:39], v[116:119], v[64:67], v[36:39]
    v_mfma_f32_16x16x32_bf16 v[40:43], v[116:119], v[68:71], v[40:43]
    v_mfma_f32_16x16x32_bf16 v[44:47], v[116:119], v[72:75], v[44:47]
    v_subrev_u32 v7, 2048, v5
    ds_read2_b32 v[112:113], v7 offset0:0 offset1:1
    ds_read2_b32 v[114:115], v7 offset0:2 offset1:3
    s_waitcnt lgkmcnt(12)
    v_mfma_f32_16x16x32_bf16 v[24:27], v[120:123], v[48:51], v[24:27]
    v_mfma_f32_16x16x32_bf16 v[28:31], v[120:123], v[52:55], v[28:31]
    v_mfma_f32_16x16x32_bf16 v[32:35], v[120:123], v[56:59], v[32:35]
    v_mfma_f32_16x16x32_bf16 v[36:39], v[120:123], v[60:63], v[36:39]
    v_mfma_f32_16x16x32_bf16 v[40:43], v[120:123], v[64:67], v[40:43]
    v_mfma_f32_16x16x32_bf16 v[44:47], v[120:123], v[68:71], v[44:47]
    v_subrev_u32 v7, 2560, v5
    ds_read2_b32 v[116:117], v7 offset0:0 offset1:1
    ds_read2_b32 v[118:119], v7 offset0:2 offset1:3
    s_waitcnt lgkmcnt(4)
    v_mfma_f32_16x16x32_bf16 v[28:31], v[124:127], v[48:51], v[28:31]
    v_mfma_f32_16x16x32_bf16 v[32:35], v[124:127], v[52:55], v[32:35]
    v_mfma_f32_16x16x32_bf16 v[36:39], v[124:127], v[56:59], v[36:39]
    v_mfma_f32_16x16x32_bf16 v[40:43], v[124:127], v[60:63], v[40:43]
    v_mfma_f32_16x16x32_bf16 v[44:47], v[124:127], v[64:67], v[44:47]
    v_subrev_u32 v7, 3072, v5
    ds_read2_b32 v[120:121], v7 offset0:0 offset1:1
    ds_read2_b32 v[122:123], v7 offset0:2 offset1:3
    s_waitcnt lgkmcnt(4)
    v_mfma_f32_16x16x32_bf16 v[32:35], v[112:115], v[48:51], v[32:35]
    v_mfma_f32_16x16x32_bf16 v[36:39], v[112:115], v[52:55], v[36:39]
    v_mfma_f32_16x16x32_bf16 v[40:43], v[112:115], v[56:59], v[40:43]
    v_mfma_f32_16x16x32_bf16 v[44:47], v[112:115], v[60:63], v[44:47]
    v_subrev_u32 v7, 3584, v5
    ds_read2_b32 v[124:125], v7 offset0:0 offset1:1
    ds_read2_b32 v[126:127], v7 offset0:2 offset1:3
    s_waitcnt lgkmcnt(4)
    v_mfma_f32_16x16x32_bf16 v[36:39], v[116:119], v[48:51], v[36:39]
    v_mfma_f32_16x16x32_bf16 v[40:43], v[116:119], v[52:55], v[40:43]
    v_mfma_f32_16x16x32_bf16 v[44:47], v[116:119], v[56:59], v[44:47]
    v_subrev_u32 v7, 128, v5
    ds_read2_b32 v[112:113], v7 offset0:0 offset1:1
    ds_read2_b32 v[114:115], v7 offset0:2 offset1:3
    s_waitcnt lgkmcnt(4)
    v_mfma_f32_16x16x32_bf16 v[40:43], v[120:123], v[48:51], v[40:43]
    v_mfma_f32_16x16x32_bf16 v[44:47], v[120:123], v[52:55], v[44:47]
    v_subrev_u32 v7, 640, v5
    ds_read2_b32 v[116:117], v7 offset0:0 offset1:1
    ds_read2_b32 v[118:119], v7 offset0:2 offset1:3
    s_waitcnt lgkmcnt(4)
    v_mfma_f32_16x16x32_bf16 v[44:47], v[124:127], v[48:51], v[44:47]
    v_subrev_u32 v7, 1152, v5
    ds_read2_b32 v[120:121], v7 offset0:0 offset1:1
    ds_read2_b32 v[122:123], v7 offset0:2 offset1:3
    s_waitcnt lgkmcnt(4)
    v_mfma_f32_16x16x32_bf16 v[16:19], v[112:115], v[80:83], v[16:19]
    v_mfma_f32_16x16x32_bf16 v[20:23], v[112:115], v[84:87], v[20:23]
    v_mfma_f32_16x16x32_bf16 v[24:27], v[112:115], v[88:91], v[24:27]
    v_mfma_f32_16x16x32_bf16 v[28:31], v[112:115], v[92:95], v[28:31]
    v_mfma_f32_16x16x32_bf16 v[32:35], v[112:115], v[96:99], v[32:35]
    v_mfma_f32_16x16x32_bf16 v[36:39], v[112:115], v[100:103], v[36:39]
    v_mfma_f32_16x16x32_bf16 v[40:43], v[112:115], v[104:107], v[40:43]
    v_mfma_f32_16x16x32_bf16 v[44:47], v[112:115], v[108:111], v[44:47]
    ds_read_b128 v[48:51], v6 offset:256
    ds_read_b128 v[52:55], v6 offset:768
    ds_read_b128 v[56:59], v6 offset:1280
    ds_read_b128 v[60:63], v6 offset:1792
    ds_read_b128 v[64:67], v6 offset:2304
    ds_read_b128 v[68:71], v6 offset:2816
    ds_read_b128 v[72:75], v6 offset:3328
    ds_read_b128 v[76:79], v6 offset:3840
    v_subrev_u32 v7, 1664, v5
    ds_read2_b32 v[124:125], v7 offset0:0 offset1:1
    ds_read2_b32 v[126:127], v7 offset0:2 offset1:3
    s_waitcnt lgkmcnt(12)
    v_mfma_f32_16x16x32_bf16 v[20:23], v[116:119], v[80:83], v[20:23]
    v_mfma_f32_16x16x32_bf16 v[24:27], v[116:119], v[84:87], v[24:27]
    v_mfma_f32_16x16x32_bf16 v[28:31], v[116:119], v[88:91], v[28:31]
    v_mfma_f32_16x16x32_bf16 v[32:35], v[116:119], v[92:95], v[32:35]
    v_mfma_f32_16x16x32_bf16 v[36:39], v[116:119], v[96:99], v[36:39]
    v_mfma_f32_16x16x32_bf16 v[40:43], v[116:119], v[100:103], v[40:43]
    v_mfma_f32_16x16x32_bf16 v[44:47], v[116:119], v[104:107], v[44:47]
    v_subrev_u32 v7, 2176, v5
    ds_read2_b32 v[112:113], v7 offset0:0 offset1:1
    ds_read2_b32 v[114:115], v7 offset0:2 offset1:3
    s_waitcnt lgkmcnt(12)
    v_mfma_f32_16x16x32_bf16 v[24:27], v[120:123], v[80:83], v[24:27]
    v_mfma_f32_16x16x32_bf16 v[28:31], v[120:123], v[84:87], v[28:31]
    v_mfma_f32_16x16x32_bf16 v[32:35], v[120:123], v[88:91], v[32:35]
    v_mfma_f32_16x16x32_bf16 v[36:39], v[120:123], v[92:95], v[36:39]
    v_mfma_f32_16x16x32_bf16 v[40:43], v[120:123], v[96:99], v[40:43]
    v_mfma_f32_16x16x32_bf16 v[44:47], v[120:123], v[100:103], v[44:47]
    v_subrev_u32 v7, 2688, v5
    ds_read2_b32 v[116:117], v7 offset0:0 offset1:1
    ds_read2_b32 v[118:119], v7 offset0:2 offset1:3
    s_waitcnt lgkmcnt(4)
    v_mfma_f32_16x16x32_bf16 v[28:31], v[124:127], v[80:83], v[28:31]
    v_mfma_f32_16x16x32_bf16 v[32:35], v[124:127], v[84:87], v[32:35]
    v_mfma_f32_16x16x32_bf16 v[36:39], v[124:127], v[88:91], v[36:39]
    v_mfma_f32_16x16x32_bf16 v[40:43], v[124:127], v[92:95], v[40:43]
    v_mfma_f32_16x16x32_bf16 v[44:47], v[124:127], v[96:99], v[44:47]
    v_subrev_u32 v7, 3200, v5
    ds_read2_b32 v[120:121], v7 offset0:0 offset1:1
    ds_read2_b32 v[122:123], v7 offset0:2 offset1:3
    s_waitcnt lgkmcnt(4)
    v_mfma_f32_16x16x32_bf16 v[32:35], v[112:115], v[80:83], v[32:35]
    v_mfma_f32_16x16x32_bf16 v[36:39], v[112:115], v[84:87], v[36:39]
    v_mfma_f32_16x16x32_bf16 v[40:43], v[112:115], v[88:91], v[40:43]
    v_mfma_f32_16x16x32_bf16 v[44:47], v[112:115], v[92:95], v[44:47]
    v_subrev_u32 v7, 3712, v5
    ds_read2_b32 v[124:125], v7 offset0:0 offset1:1
    ds_read2_b32 v[126:127], v7 offset0:2 offset1:3
    s_waitcnt lgkmcnt(4)
    v_mfma_f32_16x16x32_bf16 v[36:39], v[116:119], v[80:83], v[36:39]
    v_mfma_f32_16x16x32_bf16 v[40:43], v[116:119], v[84:87], v[40:43]
    v_mfma_f32_16x16x32_bf16 v[44:47], v[116:119], v[88:91], v[44:47]
    v_subrev_u32 v7, 256, v5
    ds_read2_b32 v[112:113], v7 offset0:0 offset1:1
    ds_read2_b32 v[114:115], v7 offset0:2 offset1:3
    s_waitcnt lgkmcnt(4)
    v_mfma_f32_16x16x32_bf16 v[40:43], v[120:123], v[80:83], v[40:43]
    v_mfma_f32_16x16x32_bf16 v[44:47], v[120:123], v[84:87], v[44:47]
    v_subrev_u32 v7, 768, v5
    ds_read2_b32 v[116:117], v7 offset0:0 offset1:1
    ds_read2_b32 v[118:119], v7 offset0:2 offset1:3
    s_waitcnt lgkmcnt(4)
    v_mfma_f32_16x16x32_bf16 v[44:47], v[124:127], v[80:83], v[44:47]
    v_subrev_u32 v7, 1280, v5
    ds_read2_b32 v[120:121], v7 offset0:0 offset1:1
    ds_read2_b32 v[122:123], v7 offset0:2 offset1:3
    s_waitcnt lgkmcnt(4)
    v_mfma_f32_16x16x32_bf16 v[16:19], v[112:115], v[48:51], v[16:19]
    v_mfma_f32_16x16x32_bf16 v[20:23], v[112:115], v[52:55], v[20:23]
    v_mfma_f32_16x16x32_bf16 v[24:27], v[112:115], v[56:59], v[24:27]
    v_mfma_f32_16x16x32_bf16 v[28:31], v[112:115], v[60:63], v[28:31]
    v_mfma_f32_16x16x32_bf16 v[32:35], v[112:115], v[64:67], v[32:35]
    v_mfma_f32_16x16x32_bf16 v[36:39], v[112:115], v[68:71], v[36:39]
    v_mfma_f32_16x16x32_bf16 v[40:43], v[112:115], v[72:75], v[40:43]
    v_mfma_f32_16x16x32_bf16 v[44:47], v[112:115], v[76:79], v[44:47]
    ds_read_b128 v[80:83], v6 offset:128
    ds_read_b128 v[84:87], v6 offset:640
    ds_read_b128 v[88:91], v6 offset:1152
    ds_read_b128 v[92:95], v6 offset:1664
    ds_read_b128 v[96:99], v6 offset:2176
    ds_read_b128 v[100:103], v6 offset:2688
    ds_read_b128 v[104:107], v6 offset:3200
    ds_read_b128 v[108:111], v6 offset:3712
    v_subrev_u32 v7, 1792, v5
    ds_read2_b32 v[124:125], v7 offset0:0 offset1:1
    ds_read2_b32 v[126:127], v7 offset0:2 offset1:3
    s_waitcnt lgkmcnt(12)
    v_mfma_f32_16x16x32_bf16 v[20:23], v[116:119], v[48:51], v[20:23]
    v_mfma_f32_16x16x32_bf16 v[24:27], v[116:119], v[52:55], v[24:27]
    v_mfma_f32_16x16x32_bf16 v[28:31], v[116:119], v[56:59], v[28:31]
    v_mfma_f32_16x16x32_bf16 v[32:35], v[116:119], v[60:63], v[32:35]
    v_mfma_f32_16x16x32_bf16 v[36:39], v[116:119], v[64:67], v[36:39]
    v_mfma_f32_16x16x32_bf16 v[40:43], v[116:119], v[68:71], v[40:43]
    v_mfma_f32_16x16x32_bf16 v[44:47], v[116:119], v[72:75], v[44:47]
    v_subrev_u32 v7, 2304, v5
    ds_read2_b32 v[112:113], v7 offset0:0 offset1:1
    ds_read2_b32 v[114:115], v7 offset0:2 offset1:3
    s_waitcnt lgkmcnt(12)
    v_mfma_f32_16x16x32_bf16 v[24:27], v[120:123], v[48:51], v[24:27]
    v_mfma_f32_16x16x32_bf16 v[28:31], v[120:123], v[52:55], v[28:31]
    v_mfma_f32_16x16x32_bf16 v[32:35], v[120:123], v[56:59], v[32:35]
    v_mfma_f32_16x16x32_bf16 v[36:39], v[120:123], v[60:63], v[36:39]
    v_mfma_f32_16x16x32_bf16 v[40:43], v[120:123], v[64:67], v[40:43]
    v_mfma_f32_16x16x32_bf16 v[44:47], v[120:123], v[68:71], v[44:47]
    v_subrev_u32 v7, 2816, v5
    ds_read2_b32 v[116:117], v7 offset0:0 offset1:1
    ds_read2_b32 v[118:119], v7 offset0:2 offset1:3
    s_waitcnt lgkmcnt(4)
    v_mfma_f32_16x16x32_bf16 v[28:31], v[124:127], v[48:51], v[28:31]
    v_mfma_f32_16x16x32_bf16 v[32:35], v[124:127], v[52:55], v[32:35]
    v_mfma_f32_16x16x32_bf16 v[36:39], v[124:127], v[56:59], v[36:39]
    v_mfma_f32_16x16x32_bf16 v[40:43], v[124:127], v[60:63], v[40:43]
    v_mfma_f32_16x16x32_bf16 v[44:47], v[124:127], v[64:67], v[44:47]
    v_subrev_u32 v7, 3328, v5
    ds_read2_b32 v[120:121], v7 offset0:0 offset1:1
    ds_read2_b32 v[122:123], v7 offset0:2 offset1:3
    s_waitcnt lgkmcnt(4)
    v_mfma_f32_16x16x32_bf16 v[32:35], v[112:115], v[48:51], v[32:35]
    v_mfma_f32_16x16x32_bf16 v[36:39], v[112:115], v[52:55], v[36:39]
    v_mfma_f32_16x16x32_bf16 v[40:43], v[112:115], v[56:59], v[40:43]
    v_mfma_f32_16x16x32_bf16 v[44:47], v[112:115], v[60:63], v[44:47]
    v_subrev_u32 v7, 3840, v5
    ds_read2_b32 v[124:125], v7 offset0:0 offset1:1
    ds_read2_b32 v[126:127], v7 offset0:2 offset1:3
    s_waitcnt lgkmcnt(4)
    v_mfma_f32_16x16x32_bf16 v[36:39], v[116:119], v[48:51], v[36:39]
    v_mfma_f32_16x16x32_bf16 v[40:43], v[116:119], v[52:55], v[40:43]
    v_mfma_f32_16x16x32_bf16 v[44:47], v[116:119], v[56:59], v[44:47]
    v_subrev_u32 v7, 384, v5
    ds_read2_b32 v[112:113], v7 offset0:0 offset1:1
    ds_read2_b32 v[114:115], v7 offset0:2 offset1:3
    s_waitcnt lgkmcnt(4)
    v_mfma_f32_16x16x32_bf16 v[40:43], v[120:123], v[48:51], v[40:43]
    v_mfma_f32_16x16x32_bf16 v[44:47], v[120:123], v[52:55], v[44:47]
    v_subrev_u32 v7, 896, v5
    ds_read2_b32 v[116:117], v7 offset0:0 offset1:1
    ds_read2_b32 v[118:119], v7 offset0:2 offset1:3
    s_waitcnt lgkmcnt(4)
    v_mfma_f32_16x16x32_bf16 v[44:47], v[124:127], v[48:51], v[44:47]
    v_subrev_u32 v7, 1408, v5
    ds_read2_b32 v[120:121], v7 offset0:0 offset1:1
    ds_read2_b32 v[122:123], v7 offset0:2 offset1:3
    s_waitcnt lgkmcnt(4)
    v_mfma_f32_16x16x32_bf16 v[16:19], v[112:115], v[80:83], v[16:19]
    v_mfma_f32_16x16x32_bf16 v[20:23], v[112:115], v[84:87], v[20:23]
    v_mfma_f32_16x16x32_bf16 v[24:27], v[112:115], v[88:91], v[24:27]
    v_mfma_f32_16x16x32_bf16 v[28:31], v[112:115], v[92:95], v[28:31]
    v_mfma_f32_16x16x32_bf16 v[32:35], v[112:115], v[96:99], v[32:35]
    v_mfma_f32_16x16x32_bf16 v[36:39], v[112:115], v[100:103], v[36:39]
    v_mfma_f32_16x16x32_bf16 v[40:43], v[112:115], v[104:107], v[40:43]
    v_mfma_f32_16x16x32_bf16 v[44:47], v[112:115], v[108:111], v[44:47]
    v_subrev_u32 v7, 1920, v5
    ds_read2_b32 v[124:125], v7 offset0:0 offset1:1
    ds_read2_b32 v[126:127], v7 offset0:2 offset1:3
    s_waitcnt lgkmcnt(4)
    v_mfma_f32_16x16x32_bf16 v[20:23], v[116:119], v[80:83], v[20:23]
    v_mfma_f32_16x16x32_bf16 v[24:27], v[116:119], v[84:87], v[24:27]
    v_mfma_f32_16x16x32_bf16 v[28:31], v[116:119], v[88:91], v[28:31]
    v_mfma_f32_16x16x32_bf16 v[32:35], v[116:119], v[92:95], v[32:35]
    v_mfma_f32_16x16x32_bf16 v[36:39], v[116:119], v[96:99], v[36:39]
    v_mfma_f32_16x16x32_bf16 v[40:43], v[116:119], v[100:103], v[40:43]
    v_mfma_f32_16x16x32_bf16 v[44:47], v[116:119], v[104:107], v[44:47]
    v_subrev_u32 v7, 2432, v5
    ds_read2_b32 v[112:113], v7 offset0:0 offset1:1
    ds_read2_b32 v[114:115], v7 offset0:2 offset1:3
    s_waitcnt lgkmcnt(4)
    v_mfma_f32_16x16x32_bf16 v[24:27], v[120:123], v[80:83], v[24:27]
    v_mfma_f32_16x16x32_bf16 v[28:31], v[120:123], v[84:87], v[28:31]
    v_mfma_f32_16x16x32_bf16 v[32:35], v[120:123], v[88:91], v[32:35]
    v_mfma_f32_16x16x32_bf16 v[36:39], v[120:123], v[92:95], v[36:39]
    v_mfma_f32_16x16x32_bf16 v[40:43], v[120:123], v[96:99], v[40:43]
    v_mfma_f32_16x16x32_bf16 v[44:47], v[120:123], v[100:103], v[44:47]
    v_subrev_u32 v7, 2944, v5
    ds_read2_b32 v[116:117], v7 offset0:0 offset1:1
    ds_read2_b32 v[118:119], v7 offset0:2 offset1:3
    s_waitcnt lgkmcnt(4)
    v_mfma_f32_16x16x32_bf16 v[28:31], v[124:127], v[80:83], v[28:31]
    v_mfma_f32_16x16x32_bf16 v[32:35], v[124:127], v[84:87], v[32:35]
    v_mfma_f32_16x16x32_bf16 v[36:39], v[124:127], v[88:91], v[36:39]
    v_mfma_f32_16x16x32_bf16 v[40:43], v[124:127], v[92:95], v[40:43]
    v_mfma_f32_16x16x32_bf16 v[44:47], v[124:127], v[96:99], v[44:47]
    v_subrev_u32 v7, 3456, v5
    ds_read2_b32 v[120:121], v7 offset0:0 offset1:1
    ds_read2_b32 v[122:123], v7 offset0:2 offset1:3
    s_waitcnt lgkmcnt(4)
    v_mfma_f32_16x16x32_bf16 v[32:35], v[112:115], v[80:83], v[32:35]
    v_mfma_f32_16x16x32_bf16 v[36:39], v[112:115], v[84:87], v[36:39]
    v_mfma_f32_16x16x32_bf16 v[40:43], v[112:115], v[88:91], v[40:43]
    v_mfma_f32_16x16x32_bf16 v[44:47], v[112:115], v[92:95], v[44:47]
    v_subrev_u32 v7, 3968, v5
    ds_read2_b32 v[124:125], v7 offset0:0 offset1:1
    ds_read2_b32 v[126:127], v7 offset0:2 offset1:3
    s_waitcnt lgkmcnt(4)
    v_mfma_f32_16x16x32_bf16 v[36:39], v[116:119], v[80:83], v[36:39]
    v_mfma_f32_16x16x32_bf16 v[40:43], v[116:119], v[84:87], v[40:43]
    v_mfma_f32_16x16x32_bf16 v[44:47], v[116:119], v[88:91], v[44:47]
    s_waitcnt lgkmcnt(2)
    v_mfma_f32_16x16x32_bf16 v[40:43], v[120:123], v[80:83], v[40:43]
    v_mfma_f32_16x16x32_bf16 v[44:47], v[120:123], v[84:87], v[44:47]
    s_waitcnt lgkmcnt(0)
    v_mfma_f32_16x16x32_bf16 v[44:47], v[124:127], v[80:83], v[44:47]
    s_barrier
    s_lshl_b32 s56, s63, 12
    s_add_u32 s56, s56, s18
    v_add_u32 v7, s56, v2
    s_xor_b32 s57, s63, 1
    s_lshl_b32 s57, s57, 12
    s_add_u32 s57, s57, s18
    v_add_u32 v8, s57, v2
    s_cmp_eq_u32 s63, 0
    s_cbranch_scc0 c2_x1
    ds_write_b128 v7, v[32:35] offset:4672
    ds_write_b128 v7, v[36:39] offset:5696
    ds_write_b128 v7, v[40:43] offset:6720
    ds_write_b128 v7, v[44:47] offset:7744
    s_branch c2_x2
c2_x1:
    ds_write_b128 v7, v[16:19] offset:4672
    ds_write_b128 v7, v[20:23] offset:5696
    ds_write_b128 v7, v[24:27] offset:6720
    ds_write_b128 v7, v[28:31] offset:7744
    v_mov_b32 v16, v32
    v_mov_b32 v17, v33
    v_mov_b32 v18, v34
    v_mov_b32 v19, v35
    v_mov_b32 v20, v36
    v_mov_b32 v21, v37
    v_mov_b32 v22, v38
    v_mov_b32 v23, v39
    v_mov_b32 v24, v40
    v_mov_b32 v25, v41
    v_mov_b32 v26, v42
    v_mov_b32 v27, v43
    v_mov_b32 v28, v44
    v_mov_b32 v29, v45
    v_mov_b32 v30, v46
    v_mov_b32 v31, v47
    s_nop 1
c2_x2:
    v_lshlrev_b32 v5, 5, v3
    v_lshl_add_u32 v5, v4, 3, v5
    s_lshl_b32 s56, s63, 11
    s_add_u32 s57, s56, s18
    v_add_u32 v6, s57, v5
    ds_read_b64 v[48:49], v6 offset:512
    ds_read_b64 v[50:51], v6 offset:1024
    ds_read_b64 v[52:53], v6 offset:1536
    ds_read_b64 v[54:55], v6 offset:2048
    s_lshl_b32 s19, s17, 12
    s_add_u32 s19, s19, s56
    v_and_b32 v10, 1, v4
    v_mul_u32_u24 v10, 504, v10
    v_add_u32 v10, v10, v5
    s_waitcnt lgkmcnt(0)
    s_barrier
    ds_read_b128 v[64:67], v8 offset:4672
    ds_read_b128 v[68:71], v8 offset:5696
    ds_read_b128 v[72:75], v8 offset:6720
    ds_read_b128 v[76:79], v8 offset:7744
    s_waitcnt lgkmcnt(0)
    v_add_f32 v16, v16, v64
    v_add_f32 v17, v17, v65
    v_lshlrev_b32 v100, 16, v48
    v_and_b32 v101, 0xffff0000, v48
    v_mul_f32 v100, v100, v11
    v_mul_f32 v101, v101, v11
    v_cvt_pk_bf16_f32 v100, v100, v101
    v_cvt_pk_bf16_f32 v102, v16, v17
    v_lshlrev_b32 v103, 16, v100
    v_and_b32 v100, 0xffff0000, v100
    v_lshlrev_b32 v104, 16, v102
    v_and_b32 v102, 0xffff0000, v102
    v_add_f32 v103, v103, v104
    v_add_f32 v100, v100, v102
    v_cvt_pk_bf16_f32 v108, v103, v100
    v_add_f32 v18, v18, v66
    v_add_f32 v19, v19, v67
    v_lshlrev_b32 v100, 16, v49
    v_and_b32 v101, 0xffff0000, v49
    v_mul_f32 v100, v100, v11
    v_mul_f32 v101, v101, v11
    v_cvt_pk_bf16_f32 v100, v100, v101
    v_cvt_pk_bf16_f32 v102, v18, v19
    v_lshlrev_b32 v103, 16, v100
    v_and_b32 v100, 0xffff0000, v100
    v_lshlrev_b32 v104, 16, v102
    v_and_b32 v102, 0xffff0000, v102
    v_add_f32 v103, v103, v104
    v_add_f32 v100, v100, v102
    v_cvt_pk_bf16_f32 v109, v103, v100
    v_add_f32 v20, v20, v68
    v_add_f32 v21, v21, v69
    v_lshlrev_b32 v100, 16, v50
    v_and_b32 v101, 0xffff0000, v50
    v_mul_f32 v100, v100, v11
    v_mul_f32 v101, v101, v11
    v_cvt_pk_bf16_f32 v100, v100, v101
    v_cvt_pk_bf16_f32 v102, v20, v21
    v_lshlrev_b32 v103, 16, v100
    v_and_b32 v100, 0xffff0000, v100
    v_lshlrev_b32 v104, 16, v102
    v_and_b32 v102, 0xffff0000, v102
    v_add_f32 v103, v103, v104
    v_add_f32 v100, v100, v102
    v_cvt_pk_bf16_f32 v110, v103, v100
    v_add_f32 v22, v22, v70
    v_add_f32 v23, v23, v71
    v_lshlrev_b32 v100, 16, v51
    v_and_b32 v101, 0xffff0000, v51
    v_mul_f32 v100, v100, v11
    v_mul_f32 v101, v101, v11
    v_cvt_pk_bf16_f32 v100, v100, v101
    v_cvt_pk_bf16_f32 v102, v22, v23
    v_lshlrev_b32 v103, 16, v100
    v_and_b32 v100, 0xffff0000, v100
    v_lshlrev_b32 v104, 16, v102
    v_and_b32 v102, 0xffff0000, v102
    v_add_f32 v103, v103, v104
    v_add_f32 v100, v100, v102
    v_cvt_pk_bf16_f32 v111, v103, v100
    v_permlane16_swap_b32 v108, v110
    s_nop 0
    v_permlane16_swap_b32 v109, v111
    buffer_store_dwordx4 v[108:111], v10, s[12:15], s19 offen offset:0 sc1
    v_add_f32 v24, v24, v72
    v_add_f32 v25, v25, v73
    v_lshlrev_b32 v100, 16, v52
    v_and_b32 v101, 0xffff0000, v52
    v_mul_f32 v100, v100, v11
    v_mul_f32 v101, v101, v11
    v_cvt_pk_bf16_f32 v100, v100, v101
    v_cvt_pk_bf16_f32 v102, v24, v25
    v_lshlrev_b32 v103, 16, v100
    v_and_b32 v100, 0xffff0000, v100
    v_lshlrev_b32 v104, 16, v102
    v_and_b32 v102, 0xffff0000, v102
    v_add_f32 v103, v103, v104
    v_add_f32 v100, v100, v102
    v_cvt_pk_bf16_f32 v112, v103, v100
    v_add_f32 v26, v26, v74
    v_add_f32 v27, v27, v75
    v_lshlrev_b32 v100, 16, v53
    v_and_b32 v101, 0xffff0000, v53
    v_mul_f32 v100, v100, v11
    v_mul_f32 v101, v101, v11
    v_cvt_pk_bf16_f32 v100, v100, v101
    v_cvt_pk_bf16_f32 v102, v26, v27
    v_lshlrev_b32 v103, 16, v100
    v_and_b32 v100, 0xffff0000, v100
    v_lshlrev_b32 v104, 16, v102
    v_and_b32 v102, 0xffff0000, v102
    v_add_f32 v103, v103, v104
    v_add_f32 v100, v100, v102
    v_cvt_pk_bf16_f32 v113, v103, v100
    v_add_f32 v28, v28, v76
    v_add_f32 v29, v29, v77
    v_lshlrev_b32 v100, 16, v54
    v_and_b32 v101, 0xffff0000, v54
    v_mul_f32 v100, v100, v11
    v_mul_f32 v101, v101, v11
    v_cvt_pk_bf16_f32 v100, v100, v101
    v_cvt_pk_bf16_f32 v102, v28, v29
    v_lshlrev_b32 v103, 16, v100
    v_and_b32 v100, 0xffff0000, v100
    v_lshlrev_b32 v104, 16, v102
    v_and_b32 v102, 0xffff0000, v102
    v_add_f32 v103, v103, v104
    v_add_f32 v100, v100, v102
    v_cvt_pk_bf16_f32 v114, v103, v100
    v_add_f32 v30, v30, v78
    v_add_f32 v31, v31, v79
    v_lshlrev_b32 v100, 16, v55
    v_and_b32 v101, 0xffff0000, v55
    v_mul_f32 v100, v100, v11
    v_mul_f32 v101, v101, v11
    v_cvt_pk_bf16_f32 v100, v100, v101
    v_cvt_pk_bf16_f32 v102, v30, v31
    v_lshlrev_b32 v103, 16, v100
    v_and_b32 v100, 0xffff0000, v100
    v_lshlrev_b32 v104, 16, v102
    v_and_b32 v102, 0xffff0000, v102
    v_add_f32 v103, v103, v104
    v_add_f32 v100, v100, v102
    v_cvt_pk_bf16_f32 v115, v103, v100
    v_permlane16_swap_b32 v112, v114
    s_nop 0
    v_permlane16_swap_b32 v113, v115
    buffer_store_dwordx4 v[112:115], v10, s[12:15], s19 offen offset:1024 sc1
    s_endpgm
    s_nop 0
k2_b:
    s_cmp_ge_u32 s2, 392
    s_cbranch_scc1 k2_c
    s_load_dwordx4 s[24:27], s[0:1], 8
    s_load_dwordx2 s[28:29], s[0:1], 96
    s_getpc_b64 s[12:13]
    s_add_u32 s12, s12, tab2@rel32@lo+4
    s_addc_u32 s13, s13, tab2@rel32@hi+12
    s_mov_b32 s14, 32768
    s_mov_b32 s15, 0x20000
    s_sub_u32 s3, s2, 256
    s_lshr_b32 s17, s3, 3
    s_lshl_b32 s17, s17, 1
    s_bfe_u32 s19, s16, 0x10001
    s_add_u32 s17, s17, s19
    s_and_b32 s31, s3, 7
    s_lshl_b32 s31, s31, 1
    s_lshr_b32 s19, s16, 2
    s_add_u32 s31, s31, s19
    s_and_b32 s30, s16, 1
    s_lshl_b32 s18, s30, 4
    s_add_u32 s18, s18, s31
    v_lshlrev_b32 v2, 4, v1
    v_and_b32 v3, 15, v1
    v_lshrrev_b32 v4, 4, v1
    s_lshl_b32 s20, s16, 12
    buffer_load_dwordx4 v[88:91], v2, s[12:15], s20 offen offset:0
    buffer_load_dwordx4 v[92:95], v2, s[12:15], s20 offen offset:1024
    buffer_load_dwordx4 v[96:99], v2, s[12:15], s20 offen offset:2048
    buffer_load_dwordx4 v[100:103], v2, s[12:15], s20 offen offset:3072
    s_waitcnt lgkmcnt(0)
    s_mov_b32 s4, s28
    s_mov_b32 s5, s29
    s_mov_b32 s6, 4718592
    s_mov_b32 s7, 0x20000
    s_add_u32 s8, s28, 5242880
    s_addc_u32 s9, s29, 0
    s_mov_b32 s10, 4456448
    s_mov_b32 s11, 0x20000
    s_mov_b32 s32, s24
    s_mov_b32 s33, s25
    s_mov_b32 s34, 2101248
    s_mov_b32 s35, 0x20000
    s_mov_b32 s36, s26
    s_mov_b32 s37, s27
    s_mov_b32 s38, 2101248
    s_mov_b32 s39, 0x20000
    s_lshr_b32 s19, s17, 1
    s_mul_hi_u32 s21, s19, 2147483648
    s_mul_i32 s22, s21, 2
    s_sub_u32 s22, s19, s22
    s_mul_i32 s19, s21, 524288
    s_lshl_b32 s22, s22, 11
    s_add_u32 s19, s19, s22
    s_lshl_b32 s21, s31, 7
    s_add_u32 s19, s19, s21
    s_and_b32 s21, s17, 1
    s_lshl_b32 s21, s21, 6
    s_add_u32 s19, s19, s21
    v_mul_u32_u24 v5, 16384, v4
    v_lshl_add_u32 v5, v3, 2, v5
    s_add_u32 s21, s19, 0
    buffer_load_dword v8, v5, s[4:7], s21 offen
    s_add_u32 s21, s19, 4096
    buffer_load_dword v9, v5, s[4:7], s21 offen
    s_add_u32 s21, s19, 8192
    buffer_load_dword v10, v5, s[4:7], s21 offen
    s_add_u32 s21, s19, 12288
    buffer_load_dword v11, v5, s[4:7], s21 offen
    s_add_u32 s21, s19, 65536
    buffer_load_dword v12, v5, s[4:7], s21 offen
    s_add_u32 s21, s19, 69632
    buffer_load_dword v13, v5, s[4:7], s21 offen
    s_add_u32 s21, s19, 73728
    buffer_load_dword v14, v5, s[4:7], s21 offen
    s_add_u32 s21, s19, 77824
    buffer_load_dword v15, v5, s[4:7], s21 offen
    s_add_u32 s21, s19, 131072
    buffer_load_dword v16, v5, s[4:7], s21 offen
    s_add_u32 s21, s19, 135168
    buffer_load_dword v17, v5, s[4:7], s21 offen
    s_add_u32 s21, s19, 139264
    buffer_load_dword v18, v5, s[4:7], s21 offen
    s_add_u32 s21, s19, 143360
    buffer_load_dword v19, v5, s[4:7], s21 offen
    s_add_u32 s21, s19, 196608
    buffer_load_dword v20, v5, s[4:7], s21 offen
    s_add_u32 s21, s19, 200704
    buffer_load_dword v21, v5, s[4:7], s21 offen
    s_add_u32 s21, s19, 204800
    buffer_load_dword v22, v5, s[4:7], s21 offen
    s_add_u32 s21, s19, 208896
    buffer_load_dword v23, v5, s[4:7], s21 offen
    s_add_u32 s21, s19, 262144
    buffer_load_dword v56, v5, s[4:7], s21 offen
    s_add_u32 s21, s19, 266240
    buffer_load_dword v57, v5, s[4:7], s21 offen
    s_add_u32 s21, s19, 270336
    buffer_load_dword v58, v5, s[4:7], s21 offen
    s_add_u32 s21, s19, 274432
    buffer_load_dword v59, v5, s[4:7], s21 offen
    s_add_u32 s21, s19, 327680
    buffer_load_dword v60, v5, s[4:7], s21 offen
    s_add_u32 s21, s19, 331776
    buffer_load_dword v61, v5, s[4:7], s21 offen
    s_add_u32 s21, s19, 335872
    buffer_load_dword v62, v5, s[4:7], s21 offen
    s_add_u32 s21, s19, 339968
    buffer_load_dword v63, v5, s[4:7], s21 offen
    s_add_u32 s21, s19, 393216
    buffer_load_dword v64, v5, s[4:7], s21 offen
    s_add_u32 s21, s19, 397312
    buffer_load_dword v65, v5, s[4:7], s21 offen
    s_add_u32 s21, s19, 401408
    buffer_load_dword v66, v5, s[4:7], s21 offen
    s_add_u32 s21, s19, 405504
    buffer_load_dword v67, v5, s[4:7], s21 offen
    s_add_u32 s21, s19, 458752
    buffer_load_dword v68, v5, s[4:7], s21 offen
    s_add_u32 s21, s19, 462848
    buffer_load_dword v69, v5, s[4:7], s21 offen
    s_add_u32 s21, s19, 466944
    buffer_load_dword v70, v5, s[4:7], s21 offen
    s_add_u32 s21, s19, 471040
    buffer_load_dword v71, v5, s[4:7], s21 offen
    v_add_u32 v7, s20, v2
    v_cvt_f32_u32 v6, s30
    v_mul_f32 v6, 0x3c000000, v6
    v_lshlrev_b32 v124, 2, v4
    v_cvt_f32_u32 v124, v124
    v_add_f32 v120, 0x00000000, v124
    v_mul_f32 v120, v120, v6
    v_cos_f32 v24, v120
    v_sin_f32 v40, v120
    v_add_f32 v120, 0x3f800000, v124
    v_mul_f32 v120, v120, v6
    v_cos_f32 v25, v120
    v_sin_f32 v41, v120
    v_add_f32 v120, 0x40000000, v124
    v_mul_f32 v120, v120, v6
    v_cos_f32 v26, v120
    v_sin_f32 v42, v120
    v_add_f32 v120, 0x40400000, v124
    v_mul_f32 v120, v120, v6
    v_cos_f32 v27, v120
    v_sin_f32 v43, v120
    v_add_f32 v120, 0x41800000, v124
    v_mul_f32 v120, v120, v6
    v_cos_f32 v28, v120
    v_sin_f32 v44, v120
    v_add_f32 v120, 0x41880000, v124
    v_mul_f32 v120, v120, v6
    v_cos_f32 v29, v120
    v_sin_f32 v45, v120
    v_add_f32 v120, 0x41900000, v124
    v_mul_f32 v120, v120, v6
    v_cos_f32 v30, v120
    v_sin_f32 v46, v120
    v_add_f32 v120, 0x41980000, v124
    v_mul_f32 v120, v120, v6
    v_cos_f32 v31, v120
    v_sin_f32 v47, v120
    v_add_f32 v120, 0x42000000, v124
    v_mul_f32 v120, v120, v6
    v_cos_f32 v32, v120
    v_sin_f32 v48, v120
    v_add_f32 v120, 0x42040000, v124
    v_mul_f32 v120, v120, v6
    v_cos_f32 v33, v120
    v_sin_f32 v49, v120
    v_add_f32 v120, 0x42080000, v124
    v_mul_f32 v120, v120, v6
    v_cos_f32 v34, v120
    v_sin_f32 v50, v120
    v_add_f32 v120, 0x420c0000, v124
    v_mul_f32 v120, v120, v6
    v_cos_f32 v35, v120
    v_sin_f32 v51, v120
    v_add_f32 v120, 0x42400000, v124
    v_mul_f32 v120, v120, v6
    v_cos_f32 v36, v120
    v_sin_f32 v52, v120
    v_add_f32 v120, 0x42440000, v124
    v_mul_f32 v120, v120, v6
    v_cos_f32 v37, v120
    v_sin_f32 v53, v120
    v_add_f32 v120, 0x42480000, v124
    v_mul_f32 v120, v120, v6
    v_cos_f32 v38, v120
    v_sin_f32 v54, v120
    v_add_f32 v120, 0x424c0000, v124
    v_mul_f32 v120, v120, v6
    v_cos_f32 v39, v120
    v_sin_f32 v55, v120
    s_waitcnt vmcnt(32)
    ds_write_b128 v7, v[88:91] offset:0
    ds_write_b128 v7, v[92:95] offset:1024
    ds_write_b128 v7, v[96:99] offset:2048
    ds_write_b128 v7, v[100:103] offset:3072
    s_cmp_eq_u32 s30, 0
    s_cselect_b32 s23, 1.0, -1.0
    s_waitcnt vmcnt(0)
    v_lshlrev_b32 v120, 16, v8
    v_and_b32 v121, 0xffff0000, v8
    v_lshlrev_b32 v122, 16, v56
    v_and_b32 v123, 0xffff0000, v56
    v_fma_f32 v120, v122, s23, v120
    v_fma_f32 v121, v123, s23, v121
    v_mul_f32 v122, v120, v24
    v_mul_f32 v123, v121, v24
    v_fma_f32 v122, v121, v40, v122
    v_fma_f32 v123, -v120, v40, v123
    v_cvt_pk_bf16_f32 v8, v122, v123
    v_lshlrev_b32 v124, 16, v9
    v_and_b32 v125, 0xffff0000, v9
    v_lshlrev_b32 v126, 16, v57
    v_and_b32 v127, 0xffff0000, v57
    v_fma_f32 v124, v126, s23, v124
    v_fma_f32 v125, v127, s23, v125
    v_mul_f32 v126, v124, v25
    v_mul_f32 v127, v125, v25
    v_fma_f32 v126, v125, v41, v126
    v_fma_f32 v127, -v124, v41, v127
    v_cvt_pk_bf16_f32 v9, v126, v127
    v_lshlrev_b32 v120, 16, v10
    v_and_b32 v121, 0xffff0000, v10
    v_lshlrev_b32 v122, 16, v58
    v_and_b32 v123, 0xffff0000, v58
    v_fma_f32 v120, v122, s23, v120
    v_fma_f32 v121, v123, s23, v121
    v_mul_f32 v122, v120, v26
    v_mul_f32 v123, v121, v26
    v_fma_f32 v122, v121, v42, v122
    v_fma_f32 v123, -v120, v42, v123
    v_cvt_pk_bf16_f32 v10, v122, v123
    v_lshlrev_b32 v124, 16, v11
    v_and_b32 v125, 0xffff0000, v11
    v_lshlrev_b32 v126, 16, v59
    v_and_b32 v127, 0xffff0000, v59
    v_fma_f32 v124, v126, s23, v124
    v_fma_f32 v125, v127, s23, v125
    v_mul_f32 v126, v124, v27
    v_mul_f32 v127, v125, v27
    v_fma_f32 v126, v125, v43, v126
    v_fma_f32 v127, -v124, v43, v127
    v_cvt_pk_bf16_f32 v11, v126, v127
    v_lshlrev_b32 v120, 16, v12
    v_and_b32 v121, 0xffff0000, v12
    v_lshlrev_b32 v122, 16, v60
    v_and_b32 v123, 0xffff0000, v60
    v_fma_f32 v120, v122, s23, v120
    v_fma_f32 v121, v123, s23, v121
    v_mul_f32 v122, v120, v28
    v_mul_f32 v123, v121, v28
    v_fma_f32 v122, v121, v44, v122
    v_fma_f32 v123, -v120, v44, v123
    v_cvt_pk_bf16_f32 v12, v122, v123
    v_lshlrev_b32 v124, 16, v13
    v_and_b32 v125, 0xffff0000, v13
    v_lshlrev_b32 v126, 16, v61
    v_and_b32 v127, 0xffff0000, v61
    v_fma_f32 v124, v126, s23, v124
    v_fma_f32 v125, v127, s23, v125
    v_mul_f32 v126, v124, v29
    v_mul_f32 v127, v125, v29
    v_fma_f32 v126, v125, v45, v126
    v_fma_f32 v127, -v124, v45, v127
    v_cvt_pk_bf16_f32 v13, v126, v127
    v_lshlrev_b32 v120, 16, v14
    v_and_b32 v121, 0xffff0000, v14
    v_lshlrev_b32 v122, 16, v62
    v_and_b32 v123, 0xffff0000, v62
    v_fma_f32 v120, v122, s23, v120
    v_fma_f32 v121, v123, s23, v121
    v_mul_f32 v122, v120, v30
    v_mul_f32 v123, v121, v30
    v_fma_f32 v122, v121, v46, v122
    v_fma_f32 v123, -v120, v46, v123
    v_cvt_pk_bf16_f32 v14, v122, v123
    v_lshlrev_b32 v124, 16, v15
    v_and_b32 v125, 0xffff0000, v15
    v_lshlrev_b32 v126, 16, v63
    v_and_b32 v127, 0xffff0000, v63
    v_fma_f32 v124, v126, s23, v124
    v_fma_f32 v125, v127, s23, v125
    v_mul_f32 v126, v124, v31
    v_mul_f32 v127, v125, v31
    v_fma_f32 v126, v125, v47, v126
    v_fma_f32 v127, -v124, v47, v127
    v_cvt_pk_bf16_f32 v15, v126, v127
    v_lshlrev_b32 v120, 16, v16
    v_and_b32 v121, 0xffff0000, v16
    v_lshlrev_b32 v122, 16, v64
    v_and_b32 v123, 0xffff0000, v64
    v_fma_f32 v120, v122, s23, v120
    v_fma_f32 v121, v123, s23, v121
    v_mul_f32 v122, v120, v32
    v_mul_f32 v123, v121, v32
    v_fma_f32 v122, v121, v48, v122
    v_fma_f32 v123, -v120, v48, v123
    v_cvt_pk_bf16_f32 v16, v122, v123
    v_lshlrev_b32 v124, 16, v17
    v_and_b32 v125, 0xffff0000, v17
    v_lshlrev_b32 v126, 16, v65
    v_and_b32 v127, 0xffff0000, v65
    v_fma_f32 v124, v126, s23, v124
    v_fma_f32 v125, v127, s23, v125
    v_mul_f32 v126, v124, v33
    v_mul_f32 v127, v125, v33
    v_fma_f32 v126, v125, v49, v126
    v_fma_f32 v127, -v124, v49, v127
    v_cvt_pk_bf16_f32 v17, v126, v127
    v_lshlrev_b32 v120, 16, v18
    v_and_b32 v121, 0xffff0000, v18
    v_lshlrev_b32 v122, 16, v66
    v_and_b32 v123, 0xffff0000, v66
    v_fma_f32 v120, v122, s23, v120
    v_fma_f32 v121, v123, s23, v121
    v_mul_f32 v122, v120, v34
    v_mul_f32 v123, v121, v34
    v_fma_f32 v122, v121, v50, v122
    v_fma_f32 v123, -v120, v50, v123
    v_cvt_pk_bf16_f32 v18, v122, v123
    v_lshlrev_b32 v124, 16, v19
    v_and_b32 v125, 0xffff0000, v19
    v_lshlrev_b32 v126, 16, v67
    v_and_b32 v127, 0xffff0000, v67
    v_fma_f32 v124, v126, s23, v124
    v_fma_f32 v125, v127, s23, v125
    v_mul_f32 v126, v124, v35
    v_mul_f32 v127, v125, v35
    v_fma_f32 v126, v125, v51, v126
    v_fma_f32 v127, -v124, v51, v127
    v_cvt_pk_bf16_f32 v19, v126, v127
    v_lshlrev_b32 v120, 16, v20
    v_and_b32 v121, 0xffff0000, v20
    v_lshlrev_b32 v122, 16, v68
    v_and_b32 v123, 0xffff0000, v68
    v_fma_f32 v120, v122, s23, v120
    v_fma_f32 v121, v123, s23, v121
    v_mul_f32 v122, v120, v36
    v_mul_f32 v123, v121, v36
    v_fma_f32 v122, v121, v52, v122
    v_fma_f32 v123, -v120, v52, v123
    v_cvt_pk_bf16_f32 v20, v122, v123
    v_lshlrev_b32 v124, 16, v21
    v_and_b32 v125, 0xffff0000, v21
    v_lshlrev_b32 v126, 16, v69
    v_and_b32 v127, 0xffff0000, v69
    v_fma_f32 v124, v126, s23, v124
    v_fma_f32 v125, v127, s23, v125
    v_mul_f32 v126, v124, v37
    v_mul_f32 v127, v125, v37
    v_fma_f32 v126, v125, v53, v126
    v_fma_f32 v127, -v124, v53, v127
    v_cvt_pk_bf16_f32 v21, v126, v127
    v_lshlrev_b32 v120, 16, v22
    v_and_b32 v121, 0xffff0000, v22
    v_lshlrev_b32 v122, 16, v70
    v_and_b32 v123, 0xffff0000, v70
    v_fma_f32 v120, v122, s23, v120
    v_fma_f32 v121, v123, s23, v121
    v_mul_f32 v122, v120, v38
    v_mul_f32 v123, v121, v38
    v_fma_f32 v122, v121, v54, v122
    v_fma_f32 v123, -v120, v54, v123
    v_cvt_pk_bf16_f32 v22, v122, v123
    v_lshlrev_b32 v124, 16, v23
    v_and_b32 v125, 0xffff0000, v23
    v_lshlrev_b32 v126, 16, v71
    v_and_b32 v127, 0xffff0000, v71
    v_fma_f32 v124, v126, s23, v124
    v_fma_f32 v125, v127, s23, v125
    v_mul_f32 v126, v124, v39
    v_mul_f32 v127, v125, v39
    v_fma_f32 v126, v125, v55, v126
    v_fma_f32 v127, -v124, v55, v127
    v_cvt_pk_bf16_f32 v23, v126, v127
    v_mul_u32_u24 v6, 131328, v4
    v_lshl_add_u32 v6, v3, 1, v6
    s_mul_i32 s21, s18, 1026
    s_lshl_b32 s22, s17, 5
    s_add_u32 s21, s21, s22
    s_add_u32 s22, s21, 0
    buffer_load_ushort v56, v6, s[32:35], s22 offen
    buffer_load_ushort v72, v6, s[36:39], s22 offen
    s_add_u32 s22, s21, 32832
    buffer_load_ushort v57, v6, s[32:35], s22 offen
    buffer_load_ushort v73, v6, s[36:39], s22 offen
    s_add_u32 s22, s21, 65664
    buffer_load_ushort v58, v6, s[32:35], s22 offen
    buffer_load_ushort v74, v6, s[36:39], s22 offen
    s_add_u32 s22, s21, 98496
    buffer_load_ushort v59, v6, s[32:35], s22 offen
    buffer_load_ushort v75, v6, s[36:39], s22 offen
    s_add_u32 s22, s21, 525312
    buffer_load_ushort v60, v6, s[32:35], s22 offen
    buffer_load_ushort v76, v6, s[36:39], s22 offen
    s_add_u32 s22, s21, 558144
    buffer_load_ushort v61, v6, s[32:35], s22 offen
    buffer_load_ushort v77, v6, s[36:39], s22 offen
    s_add_u32 s22, s21, 590976
    buffer_load_ushort v62, v6, s[32:35], s22 offen
    buffer_load_ushort v78, v6, s[36:39], s22 offen
    s_add_u32 s22, s21, 623808
    buffer_load_ushort v63, v6, s[32:35], s22 offen
    buffer_load_ushort v79, v6, s[36:39], s22 offen
    s_add_u32 s22, s21, 1050624
    buffer_load_ushort v64, v6, s[32:35], s22 offen
    buffer_load_ushort v80, v6, s[36:39], s22 offen
    s_add_u32 s22, s21, 1083456
    buffer_load_ushort v65, v6, s[32:35], s22 offen
    buffer_load_ushort v81, v6, s[36:39], s22 offen
    s_add_u32 s22, s21, 1116288
    buffer_load_ushort v66, v6, s[32:35], s22 offen
    buffer_load_ushort v82, v6, s[36:39], s22 offen
    s_add_u32 s22, s21, 1149120
    buffer_load_ushort v67, v6, s[32:35], s22 offen
    buffer_load_ushort v83, v6, s[36:39], s22 offen
    s_add_u32 s22, s21, 1575936
    buffer_load_ushort v68, v6, s[32:35], s22 offen
    buffer_load_ushort v84, v6, s[36:39], s22 offen
    s_add_u32 s22, s21, 1608768
    buffer_load_ushort v69, v6, s[32:35], s22 offen
    buffer_load_ushort v85, v6, s[36:39], s22 offen
    s_add_u32 s22, s21, 1641600
    buffer_load_ushort v70, v6, s[32:35], s22 offen
    buffer_load_ushort v86, v6, s[36:39], s22 offen
    s_add_u32 s22, s21, 1674432
    buffer_load_ushort v71, v6, s[32:35], s22 offen
    buffer_load_ushort v87, v6, s[36:39], s22 offen
    s_waitcnt lgkmcnt(0)
    s_barrier
    ds_read_b128 v[88:91], v2 offset:0
    ds_read_b128 v[92:95], v2 offset:4096
    ds_read_b128 v[96:99], v2 offset:8192
    ds_read_b128 v[100:103], v2 offset:12288
    ds_read_b128 v[104:107], v2 offset:16384
    ds_read_b128 v[108:111], v2 offset:20480
    ds_read_b128 v[112:115], v2 offset:24576
    s_waitcnt lgkmcnt(6)
    v_mfma_f32_16x16x32_bf16 v[24:27], v[88:91], v[8:11], 0
    ds_read_b128 v[116:119], v2 offset:28672
    s_waitcnt lgkmcnt(6)
    v_mfma_f32_16x16x32_bf16 v[28:31], v[92:95], v[8:11], 0
    ds_read_b128 v[88:91], v2 offset:1024
    s_waitcnt lgkmcnt(6)
    v_mfma_f32_16x16x32_bf16 v[32:35], v[96:99], v[8:11], 0
    ds_read_b128 v[92:95], v2 offset:5120
    s_waitcnt lgkmcnt(6)
    v_mfma_f32_16x16x32_bf16 v[36:39], v[100:103], v[8:11], 0
    ds_read_b128 v[96:99], v2 offset:9216
    s_waitcnt lgkmcnt(6)
    v_mfma_f32_16x16x32_bf16 v[40:43], v[104:107], v[8:11], 0
    ds_read_b128 v[100:103], v2 offset:13312
    s_waitcnt lgkmcnt(6)
    v_mfma_f32_16x16x32_bf16 v[44:47], v[108:111], v[8:11], 0
    ds_read_b128 v[104:107], v2 offset:17408
    s_waitcnt lgkmcnt(6)
    v_mfma_f32_16x16x32_bf16 v[48:51], v[112:115], v[8:11], 0
    ds_read_b128 v[108:111], v2 offset:21504
    s_waitcnt lgkmcnt(6)
    v_mfma_f32_16x16x32_bf16 v[52:55], v[116:119], v[8:11], 0
    ds_read_b128 v[112:115], v2 offset:25600
    s_waitcnt lgkmcnt(6)
    v_mfma_f32_16x16x32_bf16 v[24:27], v[88:91], v[12:15], v[24:27]
    ds_read_b128 v[116:119], v2 offset:29696
    s_waitcnt lgkmcnt(6)
    v_mfma_f32_16x16x32_bf16 v[28:31], v[92:95], v[12:15], v[28:31]
    ds_read_b128 v[88:91], v2 offset:2048
    s_waitcnt lgkmcnt(6)
    v_mfma_f32_16x16x32_bf16 v[32:35], v[96:99], v[12:15], v[32:35]
    ds_read_b128 v[92:95], v2 offset:6144
    s_waitcnt lgkmcnt(6)
    v_mfma_f32_16x16x32_bf16 v[36:39], v[100:103], v[12:15], v[36:39]
    ds_read_b128 v[96:99], v2 offset:10240
    s_waitcnt lgkmcnt(6)
    v_mfma_f32_16x16x32_bf16 v[40:43], v[104:107], v[12:15], v[40:43]
    ds_read_b128 v[100:103], v2 offset:14336
    s_waitcnt lgkmcnt(6)
    v_mfma_f32_16x16x32_bf16 v[44:47], v[108:111], v[12:15], v[44:47]
    ds_read_b128 v[104:107], v2 offset:18432
    s_waitcnt lgkmcnt(6)
    v_mfma_f32_16x16x32_bf16 v[48:51], v[112:115], v[12:15], v[48:51]
    ds_read_b128 v[108:111], v2 offset:22528
    s_waitcnt lgkmcnt(6)
    v_mfma_f32_16x16x32_bf16 v[52:55], v[116:119], v[12:15], v[52:55]
    ds_read_b128 v[112:115], v2 offset:26624
    s_waitcnt lgkmcnt(6)
    v_mfma_f32_16x16x32_bf16 v[24:27], v[88:91], v[16:19], v[24:27]
    ds_read_b128 v[116:119], v2 offset:30720
    s_waitcnt lgkmcnt(6)
    v_mfma_f32_16x16x32_bf16 v[28:31], v[92:95], v[16:19], v[28:31]
    ds_read_b128 v[88:91], v2 offset:3072
    s_waitcnt lgkmcnt(6)
    v_mfma_f32_16x16x32_bf16 v[32:35], v[96:99], v[16:19], v[32:35]
    ds_read_b128 v[92:95], v2 offset:7168
    s_waitcnt lgkmcnt(6)
    v_mfma_f32_16x16x32_bf16 v[36:39], v[100:103], v[16:19], v[36:39]
    ds_read_b128 v[96:99], v2 offset:11264
    s_waitcnt lgkmcnt(6)
    v_mfma_f32_16x16x32_bf16 v[40:43], v[104:107], v[16:19], v[40:43]
    ds_read_b128 v[100:103], v2 offset:15360
    s_waitcnt lgkmcnt(6)
    v_mfma_f32_16x16x32_bf16 v[44:47], v[108:111], v[16:19], v[44:47]
    ds_read_b128 v[104:107], v2 offset:19456
    s_waitcnt lgkmcnt(6)
    v_mfma_f32_16x16x32_bf16 v[48:51], v[112:115], v[16:19], v[48:51]
    ds_read_b128 v[108:111], v2 offset:23552
    s_waitcnt lgkmcnt(6)
    v_mfma_f32_16x16x32_bf16 v[52:55], v[116:119], v[16:19], v[52:55]
    ds_read_b128 v[112:115], v2 offset:27648
    s_waitcnt lgkmcnt(6)
    v_mfma_f32_16x16x32_bf16 v[24:27], v[88:91], v[20:23], v[24:27]
    ds_read_b128 v[116:119], v2 offset:31744
    s_waitcnt lgkmcnt(6)
    v_mfma_f32_16x16x32_bf16 v[28:31], v[92:95], v[20:23], v[28:31]
    s_waitcnt lgkmcnt(5)
    v_mfma_f32_16x16x32_bf16 v[32:35], v[96:99], v[20:23], v[32:35]
    s_waitcnt lgkmcnt(4)
    v_mfma_f32_16x16x32_bf16 v[36:39], v[100:103], v[20:23], v[36:39]
    s_waitcnt lgkmcnt(3)
    v_mfma_f32_16x16x32_bf16 v[40:43], v[104:107], v[20:23], v[40:43]
    s_waitcnt lgkmcnt(2)
    v_mfma_f32_16x16x32_bf16 v[44:47], v[108:111], v[20:23], v[44:47]
    s_waitcnt lgkmcnt(1)
    v_mfma_f32_16x16x32_bf16 v[48:51], v[112:115], v[20:23], v[48:51]
    s_waitcnt lgkmcnt(0)
    v_mfma_f32_16x16x32_bf16 v[52:55], v[116:119], v[20:23], v[52:55]
    s_waitcnt vmcnt(0)
    v_lshlrev_b32 v120, 16, v56
    v_lshlrev_b32 v121, 16, v72
    v_mul_f32 v122, v24, v120
    v_mul_f32 v123, v24, v121
    v_fma_f32 v122, -v40, v121, v122
    v_fma_f32 v123, -v40, v120, -v123
    v_cvt_pk_bf16_f32 v8, v122, v123
    v_lshlrev_b32 v120, 16, v57
    v_lshlrev_b32 v121, 16, v73
    v_mul_f32 v122, v25, v120
    v_mul_f32 v123, v25, v121
    v_fma_f32 v122, -v41, v121, v122
    v_fma_f32 v123, -v41, v120, -v123
    v_cvt_pk_bf16_f32 v9, v122, v123
    v_lshlrev_b32 v120, 16, v58
    v_lshlrev_b32 v121, 16, v74
    v_mul_f32 v122, v26, v120
    v_mul_f32 v123, v26, v121
    v_fma_f32 v122, -v42, v121, v122
    v_fma_f32 v123, -v42, v120, -v123
    v_cvt_pk_bf16_f32 v10, v122, v123
    v_lshlrev_b32 v120, 16, v59
    v_lshlrev_b32 v121, 16, v75
    v_mul_f32 v122, v27, v120
    v_mul_f32 v123, v27, v121
    v_fma_f32 v122, -v43, v121, v122
    v_fma_f32 v123, -v43, v120, -v123
    v_cvt_pk_bf16_f32 v11, v122, v123
    v_lshlrev_b32 v120, 16, v60
    v_lshlrev_b32 v121, 16, v76
    v_mul_f32 v122, v28, v120
    v_mul_f32 v123, v28, v121
    v_fma_f32 v122, -v44, v121, v122
    v_fma_f32 v123, -v44, v120, -v123
    v_cvt_pk_bf16_f32 v12, v122, v123
    v_lshlrev_b32 v120, 16, v61
    v_lshlrev_b32 v121, 16, v77
    v_mul_f32 v122, v29, v120
    v_mul_f32 v123, v29, v121
    v_fma_f32 v122, -v45, v121, v122
    v_fma_f32 v123, -v45, v120, -v123
    v_cvt_pk_bf16_f32 v13, v122, v123
    v_lshlrev_b32 v120, 16, v62
    v_lshlrev_b32 v121, 16, v78
    v_mul_f32 v122, v30, v120
    v_mul_f32 v123, v30, v121
    v_fma_f32 v122, -v46, v121, v122
    v_fma_f32 v123, -v46, v120, -v123
    v_cvt_pk_bf16_f32 v14, v122, v123
    v_lshlrev_b32 v120, 16, v63
    v_lshlrev_b32 v121, 16, v79
    v_mul_f32 v122, v31, v120
    v_mul_f32 v123, v31, v121
    v_fma_f32 v122, -v47, v121, v122
    v_fma_f32 v123, -v47, v120, -v123
    v_cvt_pk_bf16_f32 v15, v122, v123
    v_lshlrev_b32 v120, 16, v64
    v_lshlrev_b32 v121, 16, v80
    v_mul_f32 v122, v32, v120
    v_mul_f32 v123, v32, v121
    v_fma_f32 v122, -v48, v121, v122
    v_fma_f32 v123, -v48, v120, -v123
    v_cvt_pk_bf16_f32 v16, v122, v123
    v_lshlrev_b32 v120, 16, v65
    v_lshlrev_b32 v121, 16, v81
    v_mul_f32 v122, v33, v120
    v_mul_f32 v123, v33, v121
    v_fma_f32 v122, -v49, v121, v122
    v_fma_f32 v123, -v49, v120, -v123
    v_cvt_pk_bf16_f32 v17, v122, v123
    v_lshlrev_b32 v120, 16, v66
    v_lshlrev_b32 v121, 16, v82
    v_mul_f32 v122, v34, v120
    v_mul_f32 v123, v34, v121
    v_fma_f32 v122, -v50, v121, v122
    v_fma_f32 v123, -v50, v120, -v123
    v_cvt_pk_bf16_f32 v18, v122, v123
    v_lshlrev_b32 v120, 16, v67
    v_lshlrev_b32 v121, 16, v83
    v_mul_f32 v122, v35, v120
    v_mul_f32 v123, v35, v121
    v_fma_f32 v122, -v51, v121, v122
    v_fma_f32 v123, -v51, v120, -v123
    v_cvt_pk_bf16_f32 v19, v122, v123
    v_lshlrev_b32 v120, 16, v68
    v_lshlrev_b32 v121, 16, v84
    v_mul_f32 v122, v36, v120
    v_mul_f32 v123, v36, v121
    v_fma_f32 v122, -v52, v121, v122
    v_fma_f32 v123, -v52, v120, -v123
    v_cvt_pk_bf16_f32 v20, v122, v123
    v_lshlrev_b32 v120, 16, v69
    v_lshlrev_b32 v121, 16, v85
    v_mul_f32 v122, v37, v120
    v_mul_f32 v123, v37, v121
    v_fma_f32 v122, -v53, v121, v122
    v_fma_f32 v123, -v53, v120, -v123
    v_cvt_pk_bf16_f32 v21, v122, v123
    v_lshlrev_b32 v120, 16, v70
    v_lshlrev_b32 v121, 16, v86
    v_mul_f32 v122, v38, v120
    v_mul_f32 v123, v38, v121
    v_fma_f32 v122, -v54, v121, v122
    v_fma_f32 v123, -v54, v120, -v123
    v_cvt_pk_bf16_f32 v22, v122, v123
    v_lshlrev_b32 v120, 16, v71
    v_lshlrev_b32 v121, 16, v87
    v_mul_f32 v122, v39, v120
    v_mul_f32 v123, v39, v121
    v_fma_f32 v122, -v55, v121, v122
    v_fma_f32 v123, -v55, v120, -v123
    v_cvt_pk_bf16_f32 v23, v122, v123
    ds_read_b128 v[88:91], v2 offset:0
    ds_read_b128 v[92:95], v2 offset:4096
    ds_read_b128 v[96:99], v2 offset:8192
    ds_read_b128 v[100:103], v2 offset:12288
    ds_read_b128 v[104:107], v2 offset:16384
    ds_read_b128 v[108:111], v2 offset:20480
    ds_read_b128 v[112:115], v2 offset:24576
    s_waitcnt lgkmcnt(6)
    v_mfma_f32_16x16x32_bf16 v[24:27], v[88:91], v[8:11], 0
    ds_read_b128 v[116:119], v2 offset:28672
    s_waitcnt lgkmcnt(6)
    v_mfma_f32_16x16x32_bf16 v[28:31], v[92:95], v[8:11], 0
    ds_read_b128 v[88:91], v2 offset:1024
    s_waitcnt lgkmcnt(6)
    v_mfma_f32_16x16x32_bf16 v[32:35], v[96:99], v[8:11], 0
    ds_read_b128 v[92:95], v2 offset:5120
    s_waitcnt lgkmcnt(6)
    v_mfma_f32_16x16x32_bf16 v[36:39], v[100:103], v[8:11], 0
    ds_read_b128 v[96:99], v2 offset:9216
    s_waitcnt lgkmcnt(6)
    v_mfma_f32_16x16x32_bf16 v[40:43], v[104:107], v[8:11], 0
    ds_read_b128 v[100:103], v2 offset:13312
    s_waitcnt lgkmcnt(6)
    v_mfma_f32_16x16x32_bf16 v[44:47], v[108:111], v[8:11], 0
    ds_read_b128 v[104:107], v2 offset:17408
    s_waitcnt lgkmcnt(6)
    v_mfma_f32_16x16x32_bf16 v[48:51], v[112:115], v[8:11], 0
    ds_read_b128 v[108:111], v2 offset:21504
    s_waitcnt lgkmcnt(6)
    v_mfma_f32_16x16x32_bf16 v[52:55], v[116:119], v[8:11], 0
    ds_read_b128 v[112:115], v2 offset:25600
    s_waitcnt lgkmcnt(6)
    v_mfma_f32_16x16x32_bf16 v[24:27], v[88:91], v[12:15], v[24:27]
    ds_read_b128 v[116:119], v2 offset:29696
    s_waitcnt lgkmcnt(6)
    v_mfma_f32_16x16x32_bf16 v[28:31], v[92:95], v[12:15], v[28:31]
    ds_read_b128 v[88:91], v2 offset:2048
    s_waitcnt lgkmcnt(6)
    v_mfma_f32_16x16x32_bf16 v[32:35], v[96:99], v[12:15], v[32:35]
    ds_read_b128 v[92:95], v2 offset:6144
    s_waitcnt lgkmcnt(6)
    v_mfma_f32_16x16x32_bf16 v[36:39], v[100:103], v[12:15], v[36:39]
    ds_read_b128 v[96:99], v2 offset:10240
    s_waitcnt lgkmcnt(6)
    v_mfma_f32_16x16x32_bf16 v[40:43], v[104:107], v[12:15], v[40:43]
    ds_read_b128 v[100:103], v2 offset:14336
    s_waitcnt lgkmcnt(6)
    v_mfma_f32_16x16x32_bf16 v[44:47], v[108:111], v[12:15], v[44:47]
    ds_read_b128 v[104:107], v2 offset:18432
    s_waitcnt lgkmcnt(6)
    v_mfma_f32_16x16x32_bf16 v[48:51], v[112:115], v[12:15], v[48:51]
    ds_read_b128 v[108:111], v2 offset:22528
    s_waitcnt lgkmcnt(6)
    v_mfma_f32_16x16x32_bf16 v[52:55], v[116:119], v[12:15], v[52:55]
    ds_read_b128 v[112:115], v2 offset:26624
    s_waitcnt lgkmcnt(6)
    v_mfma_f32_16x16x32_bf16 v[24:27], v[88:91], v[16:19], v[24:27]
    ds_read_b128 v[116:119], v2 offset:30720
    s_waitcnt lgkmcnt(6)
    v_mfma_f32_16x16x32_bf16 v[28:31], v[92:95], v[16:19], v[28:31]
    ds_read_b128 v[88:91], v2 offset:3072
    s_waitcnt lgkmcnt(6)
    v_mfma_f32_16x16x32_bf16 v[32:35], v[96:99], v[16:19], v[32:35]
    ds_read_b128 v[92:95], v2 offset:7168
    s_waitcnt lgkmcnt(6)
    v_mfma_f32_16x16x32_bf16 v[36:39], v[100:103], v[16:19], v[36:39]
    ds_read_b128 v[96:99], v2 offset:11264
    s_waitcnt lgkmcnt(6)
    v_mfma_f32_16x16x32_bf16 v[40:43], v[104:107], v[16:19], v[40:43]
    ds_read_b128 v[100:103], v2 offset:15360
    s_waitcnt lgkmcnt(6)
    v_mfma_f32_16x16x32_bf16 v[44:47], v[108:111], v[16:19], v[44:47]
    ds_read_b128 v[104:107], v2 offset:19456
    s_waitcnt lgkmcnt(6)
    v_mfma_f32_16x16x32_bf16 v[48:51], v[112:115], v[16:19], v[48:51]
    ds_read_b128 v[108:111], v2 offset:23552
    s_waitcnt lgkmcnt(6)
    v_mfma_f32_16x16x32_bf16 v[52:55], v[116:119], v[16:19], v[52:55]
    ds_read_b128 v[112:115], v2 offset:27648
    s_waitcnt lgkmcnt(6)
    v_mfma_f32_16x16x32_bf16 v[24:27], v[88:91], v[20:23], v[24:27]
    ds_read_b128 v[116:119], v2 offset:31744
    s_waitcnt lgkmcnt(6)
    v_mfma_f32_16x16x32_bf16 v[28:31], v[92:95], v[20:23], v[28:31]
    s_waitcnt lgkmcnt(5)
    v_mfma_f32_16x16x32_bf16 v[32:35], v[96:99], v[20:23], v[32:35]
    s_waitcnt lgkmcnt(4)
    v_mfma_f32_16x16x32_bf16 v[36:39], v[100:103], v[20:23], v[36:39]
    s_waitcnt lgkmcnt(3)
    v_mfma_f32_16x16x32_bf16 v[40:43], v[104:107], v[20:23], v[40:43]
    s_waitcnt lgkmcnt(2)
    v_mfma_f32_16x16x32_bf16 v[44:47], v[108:111], v[20:23], v[44:47]
    s_waitcnt lgkmcnt(1)
    v_mfma_f32_16x16x32_bf16 v[48:51], v[112:115], v[20:23], v[48:51]
    s_waitcnt lgkmcnt(0)
    v_mfma_f32_16x16x32_bf16 v[52:55], v[116:119], v[20:23], v[52:55]
    v_cvt_f32_u32 v7, s18
    v_mul_f32 v7, 0x3a000000, v7
    s_lshl_b32 s22, s17, 4
    v_add_u32 v5, s22, v3
    v_and_b32 v5, 511, v5
    v_cmp_eq_u32 vcc, 0, v5
    v_mov_b32 v5, 0x35800000
    v_mov_b32 v6, 0x35000000
    v_cndmask_b32 v5, v5, v6, vcc
    v_lshlrev_b32 v124, 2, v4
    v_cvt_f32_u32 v124, v124
    v_add_f32 v120, 0x00000000, v124
    v_mul_f32 v120, v120, v7
    v_cos_f32 v121, v120
    v_sin_f32 v122, v120
    v_mul_f32 v56, v121, v5
    v_mul_f32 v72, v122, v5
    v_add_f32 v120, 0x3f800000, v124
    v_mul_f32 v120, v120, v7
    v_cos_f32 v121, v120
    v_sin_f32 v122, v120
    v_mul_f32 v57, v121, v5
    v_mul_f32 v73, v122, v5
    v_add_f32 v120, 0x40000000, v124
    v_mul_f32 v120, v120, v7
    v_cos_f32 v121, v120
    v_sin_f32 v122, v120
    v_mul_f32 v58, v121, v5
    v_mul_f32 v74, v122, v5
    v_add_f32 v120, 0x40400000, v124
    v_mul_f32 v120, v120, v7
    v_cos_f32 v121, v120
    v_sin_f32 v122, v120
    v_mul_f32 v59, v121, v5
    v_mul_f32 v75, v122, v5
    v_add_f32 v120, 0x41800000, v124
    v_mul_f32 v120, v120, v7
    v_cos_f32 v121, v120
    v_sin_f32 v122, v120
    v_mul_f32 v60, v121, v5
    v_mul_f32 v76, v122, v5
    v_add_f32 v120, 0x41880000, v124
    v_mul_f32 v120, v120, v7
    v_cos_f32 v121, v120
    v_sin_f32 v122, v120
    v_mul_f32 v61, v121, v5
    v_mul_f32 v77, v122, v5
    v_add_f32 v120, 0x41900000, v124
    v_mul_f32 v120, v120, v7
    v_cos_f32 v121, v120
    v_sin_f32 v122, v120
    v_mul_f32 v62, v121, v5
    v_mul_f32 v78, v122, v5
    v_add_f32 v120, 0x41980000, v124
    v_mul_f32 v120, v120, v7
    v_cos_f32 v121, v120
    v_sin_f32 v122, v120
    v_mul_f32 v63, v121, v5
    v_mul_f32 v79, v122, v5
    v_add_f32 v120, 0x42000000, v124
    v_mul_f32 v120, v120, v7
    v_cos_f32 v121, v120
    v_sin_f32 v122, v120
    v_mul_f32 v64, v121, v5
    v_mul_f32 v80, v122, v5
    v_add_f32 v120, 0x42040000, v124
    v_mul_f32 v120, v120, v7
    v_cos_f32 v121, v120
    v_sin_f32 v122, v120
    v_mul_f32 v65, v121, v5
    v_mul_f32 v81, v122, v5
    v_add_f32 v120, 0x42080000, v124
    v_mul_f32 v120, v120, v7
    v_cos_f32 v121, v120
    v_sin_f32 v122, v120
    v_mul_f32 v66, v121, v5
    v_mul_f32 v82, v122, v5
    v_add_f32 v120, 0x420c0000, v124
    v_mul_f32 v120, v120, v7
    v_cos_f32 v121, v120
    v_sin_f32 v122, v120
    v_mul_f32 v67, v121, v5
    v_mul_f32 v83, v122, v5
    v_add_f32 v120, 0x42400000, v124
    v_mul_f32 v120, v120, v7
    v_cos_f32 v121, v120
    v_sin_f32 v122, v120
    v_mul_f32 v68, v121, v5
    v_mul_f32 v84, v122, v5
    v_add_f32 v120, 0x42440000, v124
    v_mul_f32 v120, v120, v7
    v_cos_f32 v121, v120
    v_sin_f32 v122, v120
    v_mul_f32 v69, v121, v5
    v_mul_f32 v85, v122, v5
    v_add_f32 v120, 0x42480000, v124
    v_mul_f32 v120, v120, v7
    v_cos_f32 v121, v120
    v_sin_f32 v122, v120
    v_mul_f32 v70, v121, v5
    v_mul_f32 v86, v122, v5
    v_add_f32 v120, 0x424c0000, v124
    v_mul_f32 v120, v120, v7
    v_cos_f32 v121, v120
    v_sin_f32 v122, v120
    v_mul_f32 v71, v121, v5
    v_mul_f32 v87, v122, v5
    s_lshl_b32 s20, s16, 12
    s_add_u32 s20, s20, 32768
    v_lshlrev_b32 v5, 8, v4
    v_lshl_add_u32 v5, v3, 2, v5
    v_add_u32 v5, s20, v5
    v_add_u32 v6, s20, v2
    v_lshrrev_b32 v7, 2, v1
    v_lshlrev_b32 v7, 12, v7
    v_and_b32 v126, 3, v1
    v_lshl_add_u32 v7, v126, 4, v7
    s_lshr_b32 s21, s17, 1
    s_lshl_b32 s21, s21, 18
    s_lshl_b32 s22, s18, 7
    s_add_u32 s21, s21, s22
    s_and_b32 s22, s17, 1
    s_lshl_b32 s22, s22, 6
    s_add_u32 s21, s21, s22
    v_mul_f32 v122, v24, v56
    v_mul_f32 v123, v24, v72
    v_fma_f32 v122, v40, v72, v122
    v_fma_f32 v123, -v40, v56, v123
    v_cvt_pk_bf16_f32 v8, v122, v123
    ds_write_b32 v5, v8 offset:0
    v_mul_f32 v122, v25, v57
    v_mul_f32 v123, v25, v73
    v_fma_f32 v122, v41, v73, v122
    v_fma_f32 v123, -v41, v57, v123
    v_cvt_pk_bf16_f32 v9, v122, v123
    ds_write_b32 v5, v9 offset:64
    v_mul_f32 v122, v26, v58
    v_mul_f32 v123, v26, v74
    v_fma_f32 v122, v42, v74, v122
    v_fma_f32 v123, -v42, v58, v123
    v_cvt_pk_bf16_f32 v10, v122, v123
    ds_write_b32 v5, v10 offset:128
    v_mul_f32 v122, v27, v59
    v_mul_f32 v123, v27, v75
    v_fma_f32 v122, v43, v75, v122
    v_fma_f32 v123, -v43, v59, v123
    v_cvt_pk_bf16_f32 v11, v122, v123
    ds_write_b32 v5, v11 offset:192
    v_mul_f32 v122, v28, v60
    v_mul_f32 v123, v28, v76
    v_fma_f32 v122, v44, v76, v122
    v_fma_f32 v123, -v44, v60, v123
    v_cvt_pk_bf16_f32 v12, v122, v123
    ds_write_b32 v5, v12 offset:1024
    v_mul_f32 v122, v29, v61
    v_mul_f32 v123, v29, v77
    v_fma_f32 v122, v45, v77, v122
    v_fma_f32 v123, -v45, v61, v123
    v_cvt_pk_bf16_f32 v13, v122, v123
    ds_write_b32 v5, v13 offset:1088
    v_mul_f32 v122, v30, v62
    v_mul_f32 v123, v30, v78
    v_fma_f32 v122, v46, v78, v122
    v_fma_f32 v123, -v46, v62, v123
    v_cvt_pk_bf16_f32 v14, v122, v123
    ds_write_b32 v5, v14 offset:1152
    v_mul_f32 v122, v31, v63
    v_mul_f32 v123, v31, v79
    v_fma_f32 v122, v47, v79, v122
    v_fma_f32 v123, -v47, v63, v123
    v_cvt_pk_bf16_f32 v15, v122, v123
    ds_write_b32 v5, v15 offset:1216
    v_mul_f32 v122, v32, v64
    v_mul_f32 v123, v32, v80
    v_fma_f32 v122, v48, v80, v122
    v_fma_f32 v123, -v48, v64, v123
    v_cvt_pk_bf16_f32 v16, v122, v123
    ds_write_b32 v5, v16 offset:2048
    v_mul_f32 v122, v33, v65
    v_mul_f32 v123, v33, v81
    v_fma_f32 v122, v49, v81, v122
    v_fma_f32 v123, -v49, v65, v123
    v_cvt_pk_bf16_f32 v17, v122, v123
    ds_write_b32 v5, v17 offset:2112
    v_mul_f32 v122, v34, v66
    v_mul_f32 v123, v34, v82
    v_fma_f32 v122, v50, v82, v122
    v_fma_f32 v123, -v50, v66, v123
    v_cvt_pk_bf16_f32 v18, v122, v123
    ds_write_b32 v5, v18 offset:2176
    v_mul_f32 v122, v35, v67
    v_mul_f32 v123, v35, v83
    v_fma_f32 v122, v51, v83, v122
    v_fma_f32 v123, -v51, v67, v123
    v_cvt_pk_bf16_f32 v19, v122, v123
    ds_write_b32 v5, v19 offset:2240
    v_mul_f32 v122, v36, v68
    v_mul_f32 v123, v36, v84
    v_fma_f32 v122, v52, v84, v122
    v_fma_f32 v123, -v52, v68, v123
    v_cvt_pk_bf16_f32 v20, v122, v123
    ds_write_b32 v5, v20 offset:3072
    v_mul_f32 v122, v37, v69
    v_mul_f32 v123, v37, v85
    v_fma_f32 v122, v53, v85, v122
    v_fma_f32 v123, -v53, v69, v123
    v_cvt_pk_bf16_f32 v21, v122, v123
    ds_write_b32 v5, v21 offset:3136
    v_mul_f32 v122, v38, v70
    v_mul_f32 v123, v38, v86
    v_fma_f32 v122, v54, v86, v122
    v_fma_f32 v123, -v54, v70, v123
    v_cvt_pk_bf16_f32 v22, v122, v123
    ds_write_b32 v5, v22 offset:3200
    v_mul_f32 v122, v39, v71
    v_mul_f32 v123, v39, v87
    v_fma_f32 v122, v55, v87, v122
    v_fma_f32 v123, -v55, v71, v123
    v_cvt_pk_bf16_f32 v23, v122, v123
    ds_write_b32 v5, v23 offset:3264
    s_waitcnt lgkmcnt(0)
    ds_read_b128 v[88:91], v6 offset:0
    ds_read_b128 v[92:95], v6 offset:1024
    ds_read_b128 v[96:99], v6 offset:2048
    ds_read_b128 v[100:103], v6 offset:3072
    s_add_u32 s22, s21, 0
    s_waitcnt lgkmcnt(3)
    buffer_store_dwordx4 v[88:91], v7, s[8:11], s22 offen sc1
    s_add_u32 s22, s21, 65536
    s_waitcnt lgkmcnt(2)
    buffer_store_dwordx4 v[92:95], v7, s[8:11], s22 offen sc1
    s_add_u32 s22, s21, 131072
    s_waitcnt lgkmcnt(1)
    buffer_store_dwordx4 v[96:99], v7, s[8:11], s22 offen sc1
    s_add_u32 s22, s21, 196608
    s_waitcnt lgkmcnt(0)
    buffer_store_dwordx4 v[100:103], v7, s[8:11], s22 offen sc1
    s_endpgm
    s_nop 0
k2_c:
    s_endpgm
.globl k3_kernel
.p2align 8
.type k3_kernel,@function
k3_kernel:
    v_and_b32 v1, 63, v0
    v_lshrrev_b32 v2, 6, v0
    s_nop 0
    v_readfirstlane_b32 s16, v2
    s_cmp_ge_u32 s2, 128
    s_cbranch_scc1 k3_b
    s_load_dwordx2 s[24:25], s[0:1], 80
    s_load_dwordx2 s[26:27], s[0:1], 96
    s_getpc_b64 s[12:13]
    s_add_u32 s12, s12, tab3@rel32@lo+4
    s_addc_u32 s13, s13, tab3@rel32@hi+12
    s_mov_b32 s14, 24576
    s_mov_b32 s15, 0x20000
    s_and_b32 s30, s2, 7
    s_lshr_b32 s31, s2, 4
    s_lshl_b32 s31, s31, 3
    s_add_u32 s30, s30, s31
    s_lshr_b32 s31, s2, 3
    s_and_b32 s31, s31, 1
    v_lshlrev_b32 v2, 4, v1
    v_and_b32 v3, 31, v1
    v_lshrrev_b32 v4, 5, v1
    s_lshl_b32 s20, s31, 2
    s_add_u32 s20, s20, s16
    s_add_u32 s19, s16, 4
    s_cmp_lt_u32 s16, 4
    s_cselect_b32 s20, s20, s19
    s_lshl_b32 s20, s20, 10
    buffer_load_dwordx4 v[232:235], v2, s[12:15], s20 offen
    s_add_u32 s20, s16, 12
    s_lshl_b32 s20, s20, 10
    buffer_load_dwordx4 v[236:239], v2, s[12:15], s20 offen
    s_add_u32 s20, s16, 20
    s_lshl_b32 s20, s20, 10
    buffer_load_dwordx4 v[240:243], v2, s[12:15], s20 offen
    s_waitcnt lgkmcnt(0)
    s_mov_b32 s4, s24
    s_mov_b32 s5, s25
    s_mov_b32 s6, 8388608
    s_mov_b32 s7, 0x20000
    s_add_u32 s8, s26, 5242880
    s_addc_u32 s9, s27, 0
    s_mov_b32 s10, 4456448
    s_mov_b32 s11, 0x20000
    v_lshlrev_b32 v5, 9, v4
    v_lshl_add_u32 v5, v3, 2, v5
    s_lshl_b32 s21, s16, 6
    s_add_u32 s21, s21, s30
    s_lshl_b32 s21, s21, 12
    s_add_u32 s22, s21, 2097152
    s_add_u32 s23, s30, 1024
    s_lshl_b32 s23, s23, 12
    buffer_load_dword v112, v5, s[8:11], s21 offen offset:0
    buffer_load_dword v113, v5, s[8:11], s21 offen offset:128
    buffer_load_dword v114, v5, s[8:11], s21 offen offset:256
    buffer_load_dword v115, v5, s[8:11], s21 offen offset:384
    buffer_load_dword v116, v5, s[8:11], s21 offen offset:1024
    buffer_load_dword v117, v5, s[8:11], s21 offen offset:1152
    buffer_load_dword v118, v5, s[8:11], s21 offen offset:1280
    buffer_load_dword v119, v5, s[8:11], s21 offen offset:1408
    buffer_load_dword v120, v5, s[8:11], s21 offen offset:2048
    buffer_load_dword v121, v5, s[8:11], s21 offen offset:2176
    buffer_load_dword v122, v5, s[8:11], s21 offen offset:2304
    buffer_load_dword v123, v5, s[8:11], s21 offen offset:2432
    buffer_load_dword v124, v5, s[8:11], s21 offen offset:3072
    buffer_load_dword v125, v5, s[8:11], s21 offen offset:3200
    buffer_load_dword v126, v5, s[8:11], s21 offen offset:3328
    buffer_load_dword v127, v5, s[8:11], s21 offen offset:3456
    buffer_load_dword v128, v5, s[8:11], s22 offen offset:0
    buffer_load_dword v129, v5, s[8:11], s22 offen offset:128
    buffer_load_dword v130, v5, s[8:11], s22 offen offset:256
    buffer_load_dword v131, v5, s[8:11], s22 offen offset:384
    buffer_load_dword v132, v5, s[8:11], s22 offen offset:1024
    buffer_load_dword v133, v5, s[8:11], s22 offen offset:1152
    buffer_load_dword v134, v5, s[8:11], s22 offen offset:1280
    buffer_load_dword v135, v5, s[8:11], s22 offen offset:1408
    buffer_load_dword v136, v5, s[8:11], s22 offen offset:2048
    buffer_load_dword v137, v5, s[8:11], s22 offen offset:2176
    buffer_load_dword v138, v5, s[8:11], s22 offen offset:2304
    buffer_load_dword v139, v5, s[8:11], s22 offen offset:2432
    buffer_load_dword v140, v5, s[8:11], s22 offen offset:3072
    buffer_load_dword v141, v5, s[8:11], s22 offen offset:3200
    buffer_load_dword v142, v5, s[8:11], s22 offen offset:3328
    buffer_load_dword v143, v5, s[8:11], s22 offen offset:3456
    s_cmp_eq_u32 s16, 7
    s_cbranch_scc0 a3_nl3
    buffer_load_dword v144, v5, s[8:11], s23 offen offset:0
    buffer_load_dword v145, v5, s[8:11], s23 offen offset:128
    buffer_load_dword v146, v5, s[8:11], s23 offen offset:256
    buffer_load_dword v147, v5, s[8:11], s23 offen offset:384
    buffer_load_dword v148, v5, s[8:11], s23 offen offset:1024
    buffer_load_dword v149, v5, s[8:11], s23 offen offset:1152
    buffer_load_dword v150, v5, s[8:11], s23 offen offset:1280
    buffer_load_dword v151, v5, s[8:11], s23 offen offset:1408
    buffer_load_dword v152, v5, s[8:11], s23 offen offset:2048
    buffer_load_dword v153, v5, s[8:11], s23 offen offset:2176
    buffer_load_dword v154, v5, s[8:11], s23 offen offset:2304
    buffer_load_dword v155, v5, s[8:11], s23 offen offset:2432
    buffer_load_dword v156, v5, s[8:11], s23 offen offset:3072
    buffer_load_dword v157, v5, s[8:11], s23 offen offset:3200
    buffer_load_dword v158, v5, s[8:11], s23 offen offset:3328
    buffer_load_dword v159, v5, s[8:11], s23 offen offset:3456
a3_nl3:
    s_lshl_b32 s20, s16, 10
    s_add_u32 s20, s20, 36864
    v_add_u32 v9, s20, v2
    v_add_u32 v10, 36864, v2
    s_cmp_eq_u32 s16, 7
    s_cbranch_scc1 a3_tw7
    s_waitcnt vmcnt(32)
    s_branch a3_tw
a3_tw7:
    s_waitcnt vmcnt(48)
a3_tw:
    ds_write_b128 v9, v[232:235]
    ds_write_b128 v9, v[236:239] offset:8192
    s_cmp_lt_u32 s16, 4
    s_cbranch_scc0 a3_tw2
    ds_write_b128 v9, v[240:243] offset:16384
a3_tw2:
    s_waitcnt lgkmcnt(0)
    s_barrier
    ds_read_b128 v[16:19], v10 offset:0
    ds_read_b128 v[20:23], v10 offset:1024
    ds_read_b128 v[24:27], v10 offset:2048
    ds_read_b128 v[28:31], v10 offset:3072
    ds_read_b128 v[48:51], v10 offset:4096
    ds_read_b128 v[52:55], v10 offset:5120
    ds_read_b128 v[56:59], v10 offset:6144
    ds_read_b128 v[60:63], v10 offset:7168
    ds_read_b128 v[64:67], v10 offset:8192
    ds_read_b128 v[68:71], v10 offset:9216
    ds_read_b128 v[72:75], v10 offset:10240
    ds_read_b128 v[76:79], v10 offset:11264
    ds_read_b128 v[80:83], v10 offset:12288
    ds_read_b128 v[84:87], v10 offset:13312
    ds_read_b128 v[88:91], v10 offset:14336
    ds_read_b128 v[92:95], v10 offset:15360
    ds_read_b128 v[96:99], v10 offset:16384
    ds_read_b128 v[100:103], v10 offset:17408
    ds_read_b128 v[104:107], v10 offset:18432
    ds_read_b128 v[108:111], v10 offset:19456
    s_waitcnt lgkmcnt(15)
    v_mul_u32_u24 v6, 8704, v4
    v_lshl_add_u32 v6, v3, 2, v6
    v_mov_b32 v7, v6
    s_lshl_b32 s18, s16, 7
    v_add_u32 v6, s18, v6
    s_cmp_eq_u32 s16, 7
    s_cbranch_scc1 a3_w7
    s_waitcnt vmcnt(16)
    v_mfma_f32_32x32x16_bf16 v[160:175], v[16:19], v[112:115], 0
    v_mfma_f32_32x32x16_bf16 v[160:175], v[20:23], v[116:119], v[160:175]
    v_mfma_f32_32x32x16_bf16 v[160:175], v[24:27], v[120:123], v[160:175]
    v_mfma_f32_32x32x16_bf16 v[160:175], v[28:31], v[124:127], v[160:175]
    s_waitcnt vmcnt(0)
    v_mfma_f32_32x32x16_bf16 v[176:191], v[16:19], v[128:131], 0
    v_mfma_f32_32x32x16_bf16 v[176:191], v[20:23], v[132:135], v[176:191]
    v_mfma_f32_32x32x16_bf16 v[176:191], v[24:27], v[136:139], v[176:191]
    v_mfma_f32_32x32x16_bf16 v[176:191], v[28:31], v[140:143], v[176:191]
    s_nop 6
    v_cvt_pk_bf16_f32 v224, v160, v168
    ds_write_b32 v6, v224 offset:0
    v_cvt_pk_bf16_f32 v225, v161, v169
    ds_write_b32 v6, v225 offset:2176
    v_cvt_pk_bf16_f32 v226, v162, v170
    ds_write_b32 v6, v226 offset:4352
    v_cvt_pk_bf16_f32 v227, v163, v171
    ds_write_b32 v6, v227 offset:6528
    v_cvt_pk_bf16_f32 v228, v164, v172
    ds_write_b32 v6, v228 offset:17408
    v_cvt_pk_bf16_f32 v229, v165, v173
    ds_write_b32 v6, v229 offset:19584
    v_cvt_pk_bf16_f32 v230, v166, v174
    ds_write_b32 v6, v230 offset:21760
    v_cvt_pk_bf16_f32 v231, v167, v175
    ds_write_b32 v6, v231 offset:23936
    v_cvt_pk_bf16_f32 v224, v176, v184
    ds_write_b32 v6, v224 offset:1024
    v_cvt_pk_bf16_f32 v225, v177, v185
    ds_write_b32 v6, v225 offset:3200
    v_cvt_pk_bf16_f32 v226, v178, v186
    ds_write_b32 v6, v226 offset:5376
    v_cvt_pk_bf16_f32 v227, v179, v187
    ds_write_b32 v6, v227 offset:7552
    v_cvt_pk_bf16_f32 v228, v180, v188
    ds_write_b32 v6, v228 offset:18432
    v_cvt_pk_bf16_f32 v229, v181, v189
    ds_write_b32 v6, v229 offset:20608
    v_cvt_pk_bf16_f32 v230, v182, v190
    ds_write_b32 v6, v230 offset:22784
    v_cvt_pk_bf16_f32 v231, v183, v191
    ds_write_b32 v6, v231 offset:24960
    s_branch a3_t_done
a3_w7:
    s_waitcnt vmcnt(32)
    v_mfma_f32_32x32x16_bf16 v[160:175], v[16:19], v[112:115], 0
    v_mfma_f32_32x32x16_bf16 v[160:175], v[20:23], v[116:119], v[160:175]
    v_mfma_f32_32x32x16_bf16 v[160:175], v[24:27], v[120:123], v[160:175]
    v_mfma_f32_32x32x16_bf16 v[160:175], v[28:31], v[124:127], v[160:175]
    s_waitcnt vmcnt(16)
    v_mfma_f32_32x32x16_bf16 v[176:191], v[16:19], v[128:131], 0
    v_mfma_f32_32x32x16_bf16 v[176:191], v[20:23], v[132:135], v[176:191]
    v_mfma_f32_32x32x16_bf16 v[176:191], v[24:27], v[136:139], v[176:191]
    v_mfma_f32_32x32x16_bf16 v[176:191], v[28:31], v[140:143], v[176:191]
    s_waitcnt vmcnt(0)
    v_mfma_f32_32x32x16_bf16 v[192:207], v[16:19], v[144:147], 0
    v_mfma_f32_32x32x16_bf16 v[192:207], v[20:23], v[148:151], v[192:207]
    v_mfma_f32_32x32x16_bf16 v[192:207], v[24:27], v[152:155], v[192:207]
    v_mfma_f32_32x32x16_bf16 v[192:207], v[28:31], v[156:159], v[192:207]
    s_nop 1
    v_cvt_pk_bf16_f32 v224, v160, v168
    ds_write_b32 v6, v224 offset:0
    v_cvt_pk_bf16_f32 v225, v161, v169
    ds_write_b32 v6, v225 offset:2176
    v_cvt_pk_bf16_f32 v226, v162, v170
    ds_write_b32 v6, v226 offset:4352
    v_cvt_pk_bf16_f32 v227, v163, v171
    ds_write_b32 v6, v227 offset:6528
    v_cvt_pk_bf16_f32 v228, v164, v172
    ds_write_b32 v6, v228 offset:17408
    v_cvt_pk_bf16_f32 v229, v165, v173
    ds_write_b32 v6, v229 offset:19584
    v_cvt_pk_bf16_f32 v230, v166, v174
    ds_write_b32 v6, v230 offset:21760
    v_cvt_pk_bf16_f32 v231, v167, v175
    ds_write_b32 v6, v231 offset:23936
    v_cvt_pk_bf16_f32 v224, v176, v184
    ds_write_b32 v6, v224 offset:1024
    v_cvt_pk_bf16_f32 v225, v177, v185
    ds_write_b32 v6, v225 offset:3200
    v_cvt_pk_bf16_f32 v226, v178, v186
    ds_write_b32 v6, v226 offset:5376
    v_cvt_pk_bf16_f32 v227, v179, v187
    ds_write_b32 v6, v227 offset:7552
    v_cvt_pk_bf16_f32 v228, v180, v188
    ds_write_b32 v6, v228 offset:18432
    v_cvt_pk_bf16_f32 v229, v181, v189
    ds_write_b32 v6, v229 offset:20608
    v_cvt_pk_bf16_f32 v230, v182, v190
    ds_write_b32 v6, v230 offset:22784
    v_cvt_pk_bf16_f32 v231, v183, v191
    ds_write_b32 v6, v231 offset:24960
    v_cvt_pk_bf16_f32 v224, v192, v200
    ds_write_b32 v7, v224 offset:2048
    v_cvt_pk_bf16_f32 v225, v193, v201
    ds_write_b32 v7, v225 offset:4224
    v_cvt_pk_bf16_f32 v226, v194, v202
    ds_write_b32 v7, v226 offset:6400
    v_cvt_pk_bf16_f32 v227, v195, v203
    ds_write_b32 v7, v227 offset:8576
    v_cvt_pk_bf16_f32 v228, v196, v204
    ds_write_b32 v7, v228 offset:19456
    v_cvt_pk_bf16_f32 v229, v197, v205
    ds_write_b32 v7, v229 offset:21632
    v_cvt_pk_bf16_f32 v230, v198, v206
    ds_write_b32 v7, v230 offset:23808
    v_cvt_pk_bf16_f32 v231, v199, v207
    ds_write_b32 v7, v231 offset:25984
    s_nop 0
a3_t_done:
    s_mul_i32 s18, s16, 4352
    v_add_u32 v6, s18, v5
    s_add_u32 s18, s18, 2048
    v_mov_b32 v7, s18
    v_lshlrev_b32 v8, 6, v3
    v_lshl_add_u32 v8, v4, 3, v8
    s_lshl_b32 s17, s16, 8
    s_lshl_b32 s19, s31, 6
    s_add_u32 s17, s17, s19
    s_add_u32 s17, s17, s30
    s_lshl_b32 s17, s17, 12
    s_waitcnt lgkmcnt(0)
    s_barrier
    ds_read_b32 v16, v6 offset:0
    ds_read_b32 v17, v6 offset:128
    ds_read_b32 v18, v6 offset:256
    ds_read_b32 v19, v6 offset:384
    ds_read_b32 v20, v6 offset:1024
    ds_read_b32 v21, v6 offset:1152
    ds_read_b32 v22, v6 offset:1280
    ds_read_b32 v23, v6 offset:1408
    ds_read_b32 v40, v7 offset:0
    ds_read_b32 v28, v6 offset:2176
    ds_read_b32 v29, v6 offset:2304
    ds_read_b32 v30, v6 offset:2432
    ds_read_b32 v31, v6 offset:2560
    ds_read_b32 v32, v6 offset:3200
    ds_read_b32 v33, v6 offset:3328
    ds_read_b32 v34, v6 offset:3456
    ds_read_b32 v35, v6 offset:3584
    ds_read_b32 v41, v7 offset:2176
    s_waitcnt lgkmcnt(9)
    v_mfma_f32_32x32x16_bf16 v[112:127], v[16:19], v[48:51], 0
    v_mfma_f32_32x32x16_bf16 v[128:143], v[16:19], v[56:59], 0
    v_mfma_f32_32x32x16_bf16 v[112:127], v[20:23], v[52:55], v[112:127]
    v_mfma_f32_32x32x16_bf16 v[128:143], v[20:23], v[60:63], v[128:143]
    s_waitcnt lgkmcnt(0)
    v_mfma_f32_32x32x16_bf16 v[144:159], v[28:31], v[48:51], 0
    v_mfma_f32_32x32x16_bf16 v[160:175], v[28:31], v[56:59], 0
    v_mfma_f32_32x32x16_bf16 v[144:159], v[32:35], v[52:55], v[144:159]
    v_mfma_f32_32x32x16_bf16 v[160:175], v[32:35], v[60:63], v[160:175]
    v_lshlrev_b32 v40, 16, v40
    v_mov_b32 v192, v40
    v_sub_f32 v193, 0, v40
    v_mov_b32 v194, v40
    v_sub_f32 v195, 0, v40
    v_mov_b32 v196, v40
    v_sub_f32 v197, 0, v40
    v_mov_b32 v198, v40
    v_sub_f32 v199, 0, v40
    v_mov_b32 v200, v40
    v_sub_f32 v201, 0, v40
    v_mov_b32 v202, v40
    v_sub_f32 v203, 0, v40
    v_mov_b32 v204, v40
    v_sub_f32 v205, 0, v40
    v_mov_b32 v206, v40
    v_sub_f32 v207, 0, v40
    v_mul_f32 v224, v112, v64
    v_mul_f32 v225, v128, v64
    v_fma_f32 v224, -v128, v80, v224
    v_fma_f32 v225, v112, v80, v225
    v_cvt_pk_bf16_f32 v176, v224, v225
    v_mul_f32 v226, v113, v65
    v_mul_f32 v227, v129, v65
    v_fma_f32 v226, -v129, v81, v226
    v_fma_f32 v227, v113, v81, v227
    v_cvt_pk_bf16_f32 v177, v226, v227
    v_mul_f32 v224, v114, v66
    v_mul_f32 v225, v130, v66
    v_fma_f32 v224, -v130, v82, v224
    v_fma_f32 v225, v114, v82, v225
    v_cvt_pk_bf16_f32 v178, v224, v225
    v_mul_f32 v226, v115, v67
    v_mul_f32 v227, v131, v67
    v_fma_f32 v226, -v131, v83, v226
    v_fma_f32 v227, v115, v83, v227
    v_cvt_pk_bf16_f32 v179, v226, v227
    v_mul_f32 v224, v116, v68
    v_mul_f32 v225, v132, v68
    v_fma_f32 v224, -v132, v84, v224
    v_fma_f32 v225, v116, v84, v225
    v_cvt_pk_bf16_f32 v180, v224, v225
    v_mul_f32 v226, v117, v69
    v_mul_f32 v227, v133, v69
    v_fma_f32 v226, -v133, v85, v226
    v_fma_f32 v227, v117, v85, v227
    v_cvt_pk_bf16_f32 v181, v226, v227
    v_mul_f32 v224, v118, v70
    v_mul_f32 v225, v134, v70
    v_fma_f32 v224, -v134, v86, v224
    v_fma_f32 v225, v118, v86, v225
    v_cvt_pk_bf16_f32 v182, v224, v225
    v_mul_f32 v226, v119, v71
    v_mul_f32 v227, v135, v71
    v_fma_f32 v226, -v135, v87, v226
    v_fma_f32 v227, v119, v87, v227
    v_cvt_pk_bf16_f32 v183, v226, v227
    v_mfma_f32_32x32x16_bf16 v[192:207], v[176:179], v[96:99], v[192:207]
    v_mul_f32 v224, v120, v72
    v_mul_f32 v225, v136, v72
    v_fma_f32 v224, -v136, v88, v224
    v_fma_f32 v225, v120, v88, v225
    v_cvt_pk_bf16_f32 v184, v224, v225
    v_mul_f32 v226, v121, v73
    v_mul_f32 v227, v137, v73
    v_fma_f32 v226, -v137, v89, v226
    v_fma_f32 v227, v121, v89, v227
    v_cvt_pk_bf16_f32 v185, v226, v227
    v_mul_f32 v224, v122, v74
    v_mul_f32 v225, v138, v74
    v_fma_f32 v224, -v138, v90, v224
    v_fma_f32 v225, v122, v90, v225
    v_cvt_pk_bf16_f32 v186, v224, v225
    v_mul_f32 v226, v123, v75
    v_mul_f32 v227, v139, v75
    v_fma_f32 v226, -v139, v91, v226
    v_fma_f32 v227, v123, v91, v227
    v_cvt_pk_bf16_f32 v187, v226, v227
    v_mfma_f32_32x32x16_bf16 v[192:207], v[180:183], v[100:103], v[192:207]
    v_mul_f32 v224, v124, v76
    v_mul_f32 v225, v140, v76
    v_fma_f32 v224, -v140, v92, v224
    v_fma_f32 v225, v124, v92, v225
    v_cvt_pk_bf16_f32 v188, v224, v225
    v_mul_f32 v226, v125, v77
    v_mul_f32 v227, v141, v77
    v_fma_f32 v226, -v141, v93, v226
    v_fma_f32 v227, v125, v93, v227
    v_cvt_pk_bf16_f32 v189, v226, v227
    v_mul_f32 v224, v126, v78
    v_mul_f32 v225, v142, v78
    v_fma_f32 v224, -v142, v94, v224
    v_fma_f32 v225, v126, v94, v225
    v_cvt_pk_bf16_f32 v190, v224, v225
    v_mul_f32 v226, v127, v79
    v_mul_f32 v227, v143, v79
    v_fma_f32 v226, -v143, v95, v226
    v_fma_f32 v227, v127, v95, v227
    v_cvt_pk_bf16_f32 v191, v226, v227
    v_mfma_f32_32x32x16_bf16 v[192:207], v[184:187], v[104:107], v[192:207]
    s_nop 0
    v_mfma_f32_32x32x16_bf16 v[192:207], v[188:191], v[108:111], v[192:207]
    v_lshlrev_b32 v41, 16, v41
    v_mov_b32 v208, v41
    v_sub_f32 v209, 0, v41
    v_mov_b32 v210, v41
    v_sub_f32 v211, 0, v41
    v_mov_b32 v212, v41
    v_sub_f32 v213, 0, v41
    v_mov_b32 v214, v41
    v_sub_f32 v215, 0, v41
    v_mov_b32 v216, v41
    v_sub_f32 v217, 0, v41
    v_mov_b32 v218, v41
    v_sub_f32 v219, 0, v41
    v_mov_b32 v220, v41
    v_sub_f32 v221, 0, v41
    v_mov_b32 v222, v41
    v_sub_f32 v223, 0, v41
    v_mul_f32 v224, v144, v64
    v_mul_f32 v225, v160, v64
    v_fma_f32 v224, -v160, v80, v224
    s_add_u32 s22, s17, 0
    v_cvt_pk_bf16_f32 v228, v192, v193
    v_cvt_pk_bf16_f32 v229, v194, v195
    buffer_store_dwordx2 v[228:229], v8, s[4:7], s22 offen offset:0
    v_cvt_pk_bf16_f32 v230, v196, v197
    v_cvt_pk_bf16_f32 v231, v198, v199
    buffer_store_dwordx2 v[230:231], v8, s[4:7], s22 offen offset:16
    v_cvt_pk_bf16_f32 v232, v200, v201
    v_cvt_pk_bf16_f32 v233, v202, v203
    buffer_store_dwordx2 v[232:233], v8, s[4:7], s22 offen offset:32
    v_cvt_pk_bf16_f32 v234, v204, v205
    v_cvt_pk_bf16_f32 v235, v206, v207
    buffer_store_dwordx2 v[234:235], v8, s[4:7], s22 offen offset:48
    v_fma_f32 v225, v144, v80, v225
    v_cvt_pk_bf16_f32 v176, v224, v225
    v_mul_f32 v226, v145, v65
    v_mul_f32 v227, v161, v65
    v_fma_f32 v226, -v161, v81, v226
    v_fma_f32 v227, v145, v81, v227
    v_cvt_pk_bf16_f32 v177, v226, v227
    v_mul_f32 v224, v146, v66
    v_mul_f32 v225, v162, v66
    v_fma_f32 v224, -v162, v82, v224
    v_fma_f32 v225, v146, v82, v225
    v_cvt_pk_bf16_f32 v178, v224, v225
    v_mul_f32 v226, v147, v67
    v_mul_f32 v227, v163, v67
    v_fma_f32 v226, -v163, v83, v226
    v_fma_f32 v227, v147, v83, v227
    v_cvt_pk_bf16_f32 v179, v226, v227
    v_mul_f32 v224, v148, v68
    v_mul_f32 v225, v164, v68
    v_fma_f32 v224, -v164, v84, v224
    v_fma_f32 v225, v148, v84, v225
    v_cvt_pk_bf16_f32 v180, v224, v225
    v_mul_f32 v226, v149, v69
    v_mul_f32 v227, v165, v69
    v_fma_f32 v226, -v165, v85, v226
    v_fma_f32 v227, v149, v85, v227
    v_cvt_pk_bf16_f32 v181, v226, v227
    v_mul_f32 v224, v150, v70
    v_mul_f32 v225, v166, v70
    v_fma_f32 v224, -v166, v86, v224
    v_fma_f32 v225, v150, v86, v225
    v_cvt_pk_bf16_f32 v182, v224, v225
    v_mul_f32 v226, v151, v71
    v_mul_f32 v227, v167, v71
    v_fma_f32 v226, -v167, v87, v226
    v_fma_f32 v227, v151, v87, v227
    v_cvt_pk_bf16_f32 v183, v226, v227
    v_mfma_f32_32x32x16_bf16 v[208:223], v[176:179], v[96:99], v[208:223]
    v_mul_f32 v224, v152, v72
    v_mul_f32 v225, v168, v72
    v_fma_f32 v224, -v168, v88, v224
    v_fma_f32 v225, v152, v88, v225
    v_cvt_pk_bf16_f32 v184, v224, v225
    v_mul_f32 v226, v153, v73
    v_mul_f32 v227, v169, v73
    v_fma_f32 v226, -v169, v89, v226
    v_fma_f32 v227, v153, v89, v227
    v_cvt_pk_bf16_f32 v185, v226, v227
    v_mul_f32 v224, v154, v74
    v_mul_f32 v225, v170, v74
    v_fma_f32 v224, -v170, v90, v224
    v_fma_f32 v225, v154, v90, v225
    v_cvt_pk_bf16_f32 v186, v224, v225
    v_mul_f32 v226, v155, v75
    v_mul_f32 v227, v171, v75
    v_fma_f32 v226, -v171, v91, v226
    v_fma_f32 v227, v155, v91, v227
    v_cvt_pk_bf16_f32 v187, v226, v227
    v_mfma_f32_32x32x16_bf16 v[208:223], v[180:183], v[100:103], v[208:223]
    v_mul_f32 v224, v156, v76
    v_mul_f32 v225, v172, v76
    v_fma_f32 v224, -v172, v92, v224
    v_fma_f32 v225, v156, v92, v225
    v_cvt_pk_bf16_f32 v188, v224, v225
    v_mul_f32 v226, v157, v77
    v_mul_f32 v227, v173, v77
    v_fma_f32 v226, -v173, v93, v226
    v_fma_f32 v227, v157, v93, v227
    v_cvt_pk_bf16_f32 v189, v226, v227
    v_mul_f32 v224, v158, v78
    v_mul_f32 v225, v174, v78
    v_fma_f32 v224, -v174, v94, v224
    v_fma_f32 v225, v158, v94, v225
    v_cvt_pk_bf16_f32 v190, v224, v225
    v_mul_f32 v226, v159, v79
    v_mul_f32 v227, v175, v79
    v_fma_f32 v226, -v175, v95, v226
    v_fma_f32 v227, v159, v95, v227
    v_cvt_pk_bf16_f32 v191, v226, v227
    v_mfma_f32_32x32x16_bf16 v[208:223], v[184:187], v[104:107], v[208:223]
    s_nop 0
    v_mfma_f32_32x32x16_bf16 v[208:223], v[188:191], v[108:111], v[208:223]
    s_add_u32 s22, s17, 524288
    s_nop 10
    v_cvt_pk_bf16_f32 v228, v208, v209
    v_cvt_pk_bf16_f32 v229, v210, v211
    buffer_store_dwordx2 v[228:229], v8, s[4:7], s22 offen offset:0
    v_cvt_pk_bf16_f32 v230, v212, v213
    v_cvt_pk_bf16_f32 v231, v214, v215
    buffer_store_dwordx2 v[230:231], v8, s[4:7], s22 offen offset:16
    v_cvt_pk_bf16_f32 v232, v216, v217
    v_cvt_pk_bf16_f32 v233, v218, v219
    buffer_store_dwordx2 v[232:233], v8, s[4:7], s22 offen offset:32
    v_cvt_pk_bf16_f32 v234, v220, v221
    v_cvt_pk_bf16_f32 v235, v222, v223
    buffer_store_dwordx2 v[234:235], v8, s[4:7], s22 offen offset:48
    s_endpgm
k3_b:
    s_sub_u32 s2, s2, 64
    s_cmp_ge_u32 s2, 128
    s_cbranch_scc1 k3_c
    s_load_dwordx2 s[40:41], s[0:1], 80
    s_sub_u32 s17, s2, 64
    s_load_dwordx2 s[42:43], s[0:1], 96
    s_lshl_b32 s17, s17, 3
    s_add_u32 s17, s17, s16
    s_lshr_b32 s18, s17, 4
    s_and_b32 s19, s17, 15
    v_and_b32 v3, 7, v1
    v_lshrrev_b32 v4, 3, v1
    s_mov_b32 s60, 0x05040100
    s_mov_b32 s61, 0x07060302
    s_waitcnt lgkmcnt(0)
    s_add_u32 s4, s42, 14680064
    s_addc_u32 s5, s43, 0
    s_mov_b32 s6, 4194304
    s_mov_b32 s7, 0x20000
    s_mov_b32 s8, s40
    s_mov_b32 s9, s41
    s_mov_b32 s10, 8388608
    s_mov_b32 s11, 0x20000
    v_lshlrev_b32 v5, 15, v4
    v_lshl_add_u32 v5, v3, 4, v5
    s_lshl_b32 s20, s19, 18
    s_lshl_b32 s21, s18, 7
    s_add_u32 s20, s20, s21
    v_lshlrev_b32 v6, 15, v3
    v_lshl_add_u32 v6, v4, 4, v6
    s_lshl_b32 s22, s18, 18
    s_lshl_b32 s21, s19, 7
    s_add_u32 s22, s22, s21
    s_add_u32 s22, s22, 2048
    s_add_u32 s23, s20, 0
    buffer_load_dwordx4 v[16:19], v5, s[4:7], s23 offen
    s_add_u32 s23, s20, 4096
    buffer_load_dwordx4 v[20:23], v5, s[4:7], s23 offen
    s_add_u32 s23, s20, 8192
    buffer_load_dwordx4 v[24:27], v5, s[4:7], s23 offen
    s_add_u32 s23, s20, 12288
    buffer_load_dwordx4 v[28:31], v5, s[4:7], s23 offen
    s_add_u32 s23, s20, 16384
    buffer_load_dwordx4 v[32:35], v5, s[4:7], s23 offen
    s_add_u32 s23, s20, 20480
    buffer_load_dwordx4 v[36:39], v5, s[4:7], s23 offen
    s_add_u32 s23, s20, 24576
    buffer_load_dwordx4 v[40:43], v5, s[4:7], s23 offen
    s_add_u32 s23, s20, 28672
    buffer_load_dwordx4 v[44:47], v5, s[4:7], s23 offen
    s_waitcnt vmcnt(0)
    v_perm_b32 v48, v20, v16, s60
    v_perm_b32 v49, v28, v24, s60
    v_perm_b32 v50, v36, v32, s60
    v_perm_b32 v51, v44, v40, s60
    s_add_u32 s23, s22, 0
    buffer_store_dwordx4 v[48:51], v6, s[8:11], s23 offen
    v_perm_b32 v52, v20, v16, s61
    v_perm_b32 v53, v28, v24, s61
    v_perm_b32 v54, v36, v32, s61
    v_perm_b32 v55, v44, v40, s61
    s_add_u32 s23, s22, 4096
    buffer_store_dwordx4 v[52:55], v6, s[8:11], s23 offen
    v_perm_b32 v56, v21, v17, s60
    v_perm_b32 v57, v29, v25, s60
    v_perm_b32 v58, v37, v33, s60
    v_perm_b32 v59, v45, v41, s60
    s_add_u32 s23, s22, 8192
    buffer_store_dwordx4 v[56:59], v6, s[8:11], s23 offen
    v_perm_b32 v60, v21, v17, s61
    v_perm_b32 v61, v29, v25, s61
    v_perm_b32 v62, v37, v33, s61
    v_perm_b32 v63, v45, v41, s61
    s_add_u32 s23, s22, 12288
    buffer_store_dwordx4 v[60:63], v6, s[8:11], s23 offen
    v_perm_b32 v64, v22, v18, s60
    v_perm_b32 v65, v30, v26, s60
    v_perm_b32 v66, v38, v34, s60
    v_perm_b32 v67, v46, v42, s60
    s_add_u32 s23, s22, 16384
    buffer_store_dwordx4 v[64:67], v6, s[8:11], s23 offen
    v_perm_b32 v68, v22, v18, s61
    v_perm_b32 v69, v30, v26, s61
    v_perm_b32 v70, v38, v34, s61
    v_perm_b32 v71, v46, v42, s61
    s_add_u32 s23, s22, 20480
    buffer_store_dwordx4 v[68:71], v6, s[8:11], s23 offen
    v_perm_b32 v72, v23, v19, s60
    v_perm_b32 v73, v31, v27, s60
    v_perm_b32 v74, v39, v35, s60
    v_perm_b32 v75, v47, v43, s60
    s_add_u32 s23, s22, 24576
    buffer_store_dwordx4 v[72:75], v6, s[8:11], s23 offen
    v_perm_b32 v76, v23, v19, s61
    v_perm_b32 v77, v31, v27, s61
    v_perm_b32 v78, v39, v35, s61
    v_perm_b32 v79, v47, v43, s61
    s_add_u32 s23, s22, 28672
    buffer_store_dwordx4 v[76:79], v6, s[8:11], s23 offen
    s_endpgm
    s_nop 0
k3_c:
    s_endpgm
code_end:
.section .rodata,"a"
.p2align 6
.amdhsa_kernel k1_kernel
  .amdhsa_next_free_vgpr 256
  .amdhsa_next_free_sgpr 102
  .amdhsa_accum_offset 256
  .amdhsa_group_segment_fixed_size 0
  .amdhsa_kernarg_size 104
  .amdhsa_user_sgpr_count 2
  .amdhsa_user_sgpr_kernarg_segment_ptr 1
  .amdhsa_system_sgpr_workgroup_id_x 1
.end_amdhsa_kernel
.p2align 6
.amdhsa_kernel k2_kernel
  .amdhsa_next_free_vgpr 128
  .amdhsa_next_free_sgpr 102
  .amdhsa_accum_offset 128
  .amdhsa_group_segment_fixed_size 0
  .amdhsa_kernarg_size 104
  .amdhsa_user_sgpr_count 2
  .amdhsa_user_sgpr_kernarg_segment_ptr 1
  .amdhsa_system_sgpr_workgroup_id_x 1
.end_amdhsa_kernel
.p2align 6
.amdhsa_kernel k3_kernel
  .amdhsa_next_free_vgpr 256
  .amdhsa_next_free_sgpr 102
  .amdhsa_accum_offset 256
  .amdhsa_group_segment_fixed_size 0
  .amdhsa_kernarg_size 104
  .amdhsa_user_sgpr_count 2
  .amdhsa_user_sgpr_kernarg_segment_ptr 1
  .amdhsa_system_sgpr_workgroup_id_x 1
.end_amdhsa_kernel
.p2align 8
.type tab1,@object
tab1:
.long 0x3f80,0x0,0x0,0x0,0x3f800000,0x0,0x0,0x0
.long 0x0,0x3f80,0x0,0x0,0x0,0x3f800000,0x0,0x0
.long 0x0,0x0,0x3f80,0x0,0x0,0x0,0x3f800000,0x0
.long 0x0,0x0,0x0,0x3f80,0x0,0x0,0x0,0x3f800000
.long 0x0,0x0,0x0,0x0,0x0,0x0,0x0,0x0
.long 0x0,0x0,0x0,0x0,0x0,0x0,0x0,0x0
.long 0x0,0x0,0x0,0x0,0x0,0x0,0x0,0x0
.long 0x0,0x0,0x0,0x0,0x0,0x0,0x0,0x0
.long 0x0,0x0,0x0,0x0,0x0,0x0,0x0,0x0
.long 0x0,0x0,0x0,0x0,0x0,0x0,0x0,0x0
.long 0x0,0x0,0x0,0x0,0x0,0x0,0x0,0x0
.long 0x0,0x0,0x0,0x0,0x0,0x0,0x0,0x0
.long 0x0,0x0,0x0,0x0,0x0,0x0,0x0,0x0
.long 0x0,0x0,0x0,0x0,0x0,0x0,0x0,0x0
.long 0x0,0x0,0x0,0x0,0x0,0x0,0x0,0x0
.long 0x0,0x0,0x0,0x0,0x0,0x0,0x0,0x0
.long 0x0,0x0,0x0,0x0,0x0,0x0,0x0,0x0
.long 0x0,0x0,0x0,0x0,0x0,0x0,0x0,0x0
.long 0x0,0x0,0x0,0x0,0x0,0x0,0x0,0x0
.long 0x0,0x0,0x0,0x0,0x0,0x0,0x0,0x0
.long 0x3f80,0x0,0x0,0x0,0x3f800000,0x0,0x0,0x0
.long 0x0,0x3f80,0x0,0x0,0x0,0x3f800000,0x0,0x0
.long 0x0,0x0,0x3f80,0x0,0x0,0x0,0x3f800000,0x0
.long 0x0,0x0,0x0,0x3f80,0x0,0x0,0x0,0x3f800000
.long 0x0,0x0,0x0,0x0,0x0,0x0,0x0,0x0
.long 0x0,0x0,0x0,0x0,0x0,0x0,0x0,0x0
.long 0x0,0x0,0x0,0x0,0x0,0x0,0x0,0x0
.long 0x0,0x0,0x0,0x0,0x0,0x0,0x0,0x0
.long 0x0,0x0,0x0,0x0,0x0,0x0,0x0,0x0
.long 0x0,0x0,0x0,0x0,0x0,0x0,0x0,0x0
.long 0x0,0x0,0x0,0x0,0x0,0x0,0x0,0x0
.long 0x0,0x0,0x0,0x0,0x0,0x0,0x0,0x0
.long 0x0,0x0,0x0,0x0,0x0,0x0,0x0,0x0
.long 0x0,0x0,0x0,0x0,0x0,0x0,0x0,0x0
.long 0x0,0x0,0x0,0x0,0x0,0x0,0x0,0x0
.long 0x0,0x0,0x0,0x0,0x0,0x0,0x0,0x0
.long 0x0,0x0,0x0,0x0,0x0,0x0,0x0,0x0
.long 0x0,0x0,0x0,0x0,0x0,0x0,0x0,0x0
.long 0x0,0x0,0x0,0x0,0x0,0x0,0x0,0x0
.long 0x0,0x0,0x0,0x0,0x0,0x0,0x0,0x0
.long 0x3f80,0x0,0x0,0x0,0x3f800000,0x0,0x0,0x0
.long 0x0,0x3f80,0x0,0x0,0x0,0x3f800000,0x0,0x0
.long 0x0,0x0,0x3f80,0x0,0x0,0x0,0x3f800000,0x0
.long 0x0,0x0,0x0,0x3f80,0x0,0x0,0x0,0x3f800000
.long 0x0,0x0,0x0,0x0,0x0,0x0,0x0,0x0
.long 0x0,0x0,0x0,0x0,0x0,0x0,0x0,0x0
.long 0x0,0x0,0x0,0x0,0x0,0x0,0x0,0x0
.long 0x0,0x0,0x0,0x0,0x0,0x0,0x0,0x0
.long 0x0,0x0,0x0,0x0,0x0,0x0,0x0,0x0
.long 0x0,0x0,0x0,0x0,0x0,0x0,0x0,0x0
.long 0x0,0x0,0x0,0x0,0x0,0x0,0x0,0x0
.long 0x0,0x0,0x0,0x0,0x0,0x0,0x0,0x0
.long 0x0,0x0,0x0,0x0,0x0,0x0,0x0,0x0
.long 0x0,0x0,0x0,0x0,0x0,0x0,0x0,0x0
.long 0x0,0x0,0x0,0x0,0x0,0x0,0x0,0x0
.long 0x0,0x0,0x0,0x0,0x0,0x0,0x0,0x0
.long 0x0,0x0,0x0,0x0,0x0,0x0,0x0,0x0
.long 0x0,0x0,0x0,0x0,0x0,0x0,0x0,0x0
.long 0x0,0x0,0x0,0x0,0x0,0x0,0x0,0x0
.long 0x0,0x0,0x0,0x0,0x0,0x0,0x0,0x0
.long 0x3f80,0x0,0x0,0x0,0x3f800000,0x0,0x0,0x0
.long 0x0,0x3f80,0x0,0x0,0x0,0x3f800000,0x0,0x0
.long 0x0,0x0,0x3f80,0x0,0x0,0x0,0x3f800000,0x0
.long 0x0,0x0,0x0,0x3f80,0x0,0x0,0x0,0x3f800000
.long 0x3f803f80,0x3f803f80,0x3f803f80,0x3f803f80,0x3f7b3f80,0x3f553f6d,0xbe48248d,0xbf0ebec4
.long 0x3f6d3f80,0x3ec43f35,0xbf6dbf80,0xbec4bf35,0x3f553f80,0xbe483ec4,0x3f0ea554,0x3f7b3f6d
.long 0x3f353f80,0xbf35248d,0x3f353f80,0xbf35248d,0x3f0e3f80,0xbf7bbec4,0xbf55248d,0xbe48bf6d
.long 0x3ec43f80,0xbf6dbf35,0xbec4bf80,0x3f6d3f35,0x3e483f80,0xbf0ebf6d,0x3f7ba554,0xbf553ec4
.long 0x248d3f80,0xa554bf80,0x248d3f80,0xa554bf80,0xbe483f80,0x3f0ebf6d,0xbf7b248d,0x3f553ec4
.long 0xbec43f80,0x3f6dbf35,0x3ec4bf80,0xbf6d3f35,0xbf0e3f80,0x3f7bbec4,0x3f55a554,0x3e48bf6d
.long 0xbf353f80,0x3f35a554,0xbf353f80,0x3f35a554,0xbf553f80,0x3e483ec4,0xbf0e248d,0xbf7b3f6d
.long 0xbf6d3f80,0xbec43f35,0x3f6dbf80,0x3ec4bf35,0xbf7b3f80,0xbf553f6d,0x3e48a554,0x3f0ebec4
.long 0xbf803f80,0xbf803f80,0xbf803f80,0xbf803f80,0xbf7b3f80,0xbf553f6d,0x3e48248d,0x3f0ebec4
.long 0xbf6d3f80,0xbec43f35,0x3f6dbf80,0x3ec4bf35,0xbf553f80,0x3e483ec4,0xbf0ea554,0xbf7b3f6d
.long 0xbf353f80,0x3f35248d,0xbf353f80,0x3f35248d,0xbf0e3f80,0x3f7bbec4,0x3f55248d,0x3e48bf6d
.long 0xbec43f80,0x3f6dbf35,0x3ec4bf80,0xbf6d3f35,0xbe483f80,0x3f0ebf6d,0xbf7ba554,0x3f553ec4
.long 0xa5543f80,0x248dbf80,0xa5543f80,0x248dbf80,0x3e483f80,0xbf0ebf6d,0x3f7b248d,0xbf553ec4
.long 0x3ec43f80,0xbf6dbf35,0xbec4bf80,0x3f6d3f35,0x3f0e3f80,0xbf7bbec4,0xbf55a554,0xbe48bf6d
.long 0x3f353f80,0xbf35a554,0x3f353f80,0xbf35a554,0x3f553f80,0xbe483ec4,0x3f0e248d,0x3f7b3f6d
.long 0x3f6d3f80,0x3ec43f35,0xbf6dbf80,0xbec4bf35,0x3f7b3f80,0x3f553f6d,0xbe48a554,0xbf0ebec4
.long 0x3f803f80,0x3f803f80,0x3f803f80,0x3f803f80,0x3f0e3f35,0x3e483ec4,0xbf55bf35,0xbf7bbf6d
.long 0xbec4248d,0xbf6dbf35,0x3ec4a554,0x3f6d3f35,0xbf7bbf35,0xbf0ebf6d,0x3e483f35,0xbf55bec4
.long 0xbf35bf80,0x3f35a554,0xbf35bf80,0x3f35a554,0x3e48bf35,0x3f553f6d,0x3f7b3f35,0xbf0e3ec4
.long 0x3f6da554,0xbec43f35,0xbf6d248d,0x3ec4bf35,0x3f553f35,0xbf7bbec4,0x3f0ebf35,0xbe483f6d
.long 0x248d3f80,0xa554bf80,0x248d3f80,0xa554bf80,0xbf553f35,0x3f7bbec4,0xbf0ebf35,0x3e483f6d
.long 0xbf6d248d,0x3ec43f35,0x3f6da554,0xbec4bf35,0xbe48bf35,0xbf553f6d,0xbf7b3f35,0x3f0e3ec4
.long 0x3f35bf80,0xbf35248d,0x3f35bf80,0xbf35248d,0x3f7bbf35,0x3f0ebf6d,0xbe483f35,0x3f55bec4
.long 0x3ec4a554,0x3f6dbf35,0xbec4248d,0xbf6d3f35,0xbf0e3f35,0xbe483ec4,0x3f55bf35,0x3f7bbf6d
.long 0xbf803f80,0xbf803f80,0xbf803f80,0xbf803f80,0xbf0e3f35,0xbe483ec4,0x3f55bf35,0x3f7bbf6d
.long 0x3ec4248d,0x3f6dbf35,0xbec4a554,0xbf6d3f35,0x3f7bbf35,0x3f0ebf6d,0xbe483f35,0x3f55bec4
.long 0x3f35bf80,0xbf35a554,0x3f35bf80,0xbf35a554,0xbe48bf35,0xbf553f6d,0xbf7b3f35,0x3f0e3ec4
.long 0xbf6da554,0x3ec43f35,0x3f6d248d,0xbec4bf35,0xbf553f35,0x3f7bbec4,0xbf0ebf35,0x3e483f6d
.long 0xa5543f80,0x248dbf80,0xa5543f80,0x248dbf80,0x3f553f35,0xbf7bbec4,0x3f0ebf35,0xbe483f6d
.long 0x3f6d248d,0xbec43f35,0xbf6da554,0x3ec4bf35,0x3e48bf35,0x3f553f6d,0x3f7b3f35,0xbf0e3ec4
.long 0xbf35bf80,0x3f35248d,0xbf35bf80,0x3f35248d,0xbf7bbf35,0xbf0ebf6d,0x3e483f35,0xbf55bec4
.long 0xbec4a554,0xbf6dbf35,0x3ec4248d,0x3f6d3f35,0x3f0e3f35,0x3e483ec4,0xbf55bf35,0xbf7bbf6d
.long 0x3f803f80,0x3f803f80,0x3f803f80,0x3f803f80,0xbf7bbf80,0xbf55bf6d,0x3e48a554,0x3f0e3ec4
.long 0x3f6d3f80,0x3ec43f35,0xbf6dbf80,0xbec4bf35,0xbf55bf80,0x3e48bec4,0xbf0e248d,0xbf7bbf6d
.long 0x3f353f80,0xbf35248d,0x3f353f80,0xbf35248d,0xbf0ebf80,0x3f7b3ec4,0x3f55a554,0x3e483f6d
.long 0x3ec43f80,0xbf6dbf35,0xbec4bf80,0x3f6d3f35,0xbe48bf80,0x3f0e3f6d,0xbf7b248d,0x3f55bec4
.long 0x248d3f80,0xa554bf80,0x248d3f80,0xa554bf80,0x3e48bf80,0xbf0e3f6d,0x3f7ba554,0xbf55bec4
.long 0xbec43f80,0x3f6dbf35,0x3ec4bf80,0xbf6d3f35,0x3f0ebf80,0xbf7b3ec4,0xbf55248d,0xbe483f6d
.long 0xbf353f80,0x3f35a554,0xbf353f80,0x3f35a554,0x3f55bf80,0xbe48bec4,0x3f0ea554,0x3f7bbf6d
.long 0xbf6d3f80,0xbec43f35,0x3f6dbf80,0x3ec4bf35,0x3f7bbf80,0x3f55bf6d,0xbe48248d,0xbf0e3ec4
.long 0xbf803f80,0xbf803f80,0xbf803f80,0xbf803f80,0x3f7bbf80,0x3f55bf6d,0xbe48a554,0xbf0e3ec4
.long 0xbf6d3f80,0xbec43f35,0x3f6dbf80,0x3ec4bf35,0x3f55bf80,0xbe48bec4,0x3f0e248d,0x3f7bbf6d
.long 0xbf353f80,0x3f35248d,0xbf353f80,0x3f35248d,0x3f0ebf80,0xbf7b3ec4,0xbf55a554,0xbe483f6d
.long 0xbec43f80,0x3f6dbf35,0x3ec4bf80,0xbf6d3f35,0x3e48bf80,0xbf0e3f6d,0x3f7b248d,0xbf55bec4
.long 0xa5543f80,0x248dbf80,0xa5543f80,0x248dbf80,0xbe48bf80,0x3f0e3f6d,0xbf7ba554,0x3f55bec4
.long 0x3ec43f80,0xbf6dbf35,0xbec4bf80,0x3f6d3f35,0xbf0ebf80,0x3f7b3ec4,0x3f55248d,0x3e483f6d
.long 0x3f353f80,0xbf35a554,0x3f353f80,0xbf35a554,0xbf55bf80,0x3e48bec4,0xbf0ea554,0xbf7bbf6d
.long 0x3f6d3f80,0x3ec43f35,0xbf6dbf80,0xbec4bf35,0xbf7bbf80,0xbf55bf6d,0x3e48248d,0x3f0e3ec4
.long 0x3f803f80,0x3f803f80,0x3f803f80,0x3f803f80,0xbf0ebf35,0xbe48bec4,0x3f553f35,0x3f7b3f6d
.long 0xbec4248d,0xbf6dbf35,0x3ec4a554,0x3f6d3f35,0x3f7b3f35,0x3f0e3f6d,0xbe48bf35,0x3f553ec4
.long 0xbf35bf80,0x3f35a554,0xbf35bf80,0x3f35a554,0xbe483f35,0xbf55bf6d,0xbf7bbf35,0x3f0ebec4
.long 0x3f6da554,0xbec43f35,0xbf6d248d,0x3ec4bf35,0xbf55bf35,0x3f7b3ec4,0xbf0e3f35,0x3e48bf6d
.long 0x248d3f80,0xa554bf80,0x248d3f80,0xa554bf80,0x3f55bf35,0xbf7b3ec4,0x3f0e3f35,0xbe48bf6d
.long 0xbf6d248d,0x3ec43f35,0x3f6da554,0xbec4bf35,0x3e483f35,0x3f55bf6d,0x3f7bbf35,0xbf0ebec4
.long 0x3f35bf80,0xbf35248d,0x3f35bf80,0xbf35248d,0xbf7b3f35,0xbf0e3f6d,0x3e48bf35,0xbf553ec4
.long 0x3ec4a554,0x3f6dbf35,0xbec4248d,0xbf6d3f35,0x3f0ebf35,0x3e48bec4,0xbf553f35,0xbf7b3f6d
.long 0xbf803f80,0xbf803f80,0xbf803f80,0xbf803f80,0x3f0ebf35,0x3e48bec4,0xbf553f35,0xbf7b3f6d
.long 0x3ec4248d,0x3f6dbf35,0xbec4a554,0xbf6d3f35,0xbf7b3f35,0xbf0e3f6d,0x3e48bf35,0xbf553ec4
.long 0x3f35bf80,0xbf35a554,0x3f35bf80,0xbf35a554,0x3e483f35,0x3f55bf6d,0x3f7bbf35,0xbf0ebec4
.long 0xbf6da554,0x3ec43f35,0x3f6d248d,0xbec4bf35,0x3f55bf35,0xbf7b3ec4,0x3f0e3f35,0xbe48bf6d
.long 0xa5543f80,0x248dbf80,0xa5543f80,0x248dbf80,0xbf55bf35,0x3f7b3ec4,0xbf0e3f35,0x3e48bf6d
.long 0x3f6d248d,0xbec43f35,0xbf6da554,0x3ec4bf35,0xbe483f35,0xbf55bf6d,0xbf7bbf35,0x3f0ebec4
.long 0xbf35bf80,0x3f35248d,0xbf35bf80,0x3f35248d,0x3f7b3f35,0x3f0e3f6d,0xbe48bf35,0x3f553ec4
.long 0xbec4a554,0xbf6dbf35,0x3ec4248d,0x3f6d3f35,0xbf0ebf35,0xbe48bec4,0x3f553f35,0x3f7b3f6d
.long 0x80008000,0x80008000,0x80008000,0x80008000,0xbe488000,0xbf0ebec4,0xbf7bbf80,0xbf55bf6d
.long 0xbec48000,0xbf6dbf35,0x3ec4a50d,0x3f6d3f35,0xbf0e8000,0xbf7bbf6d,0x3f553f80,0xbe483ec4
.long 0xbf358000,0xbf35bf80,0xbf358000,0xbf35bf80,0xbf558000,0xbe48bf6d,0xbf0ebf80,0x3f7b3ec4
.long 0xbf6d8000,0x3ec4bf35,0x3f6da50d,0xbec43f35,0xbf7b8000,0x3f55bec4,0x3e483f80,0xbf0ebf6d
.long 0xbf808000,0x3f80a50d,0xbf808000,0x3f80a50d,0xbf7b8000,0x3f553ec4,0x3e48bf80,0xbf0e3f6d
.long 0xbf6d8000,0x3ec43f35,0x3f6da50d,0xbec4bf35,0xbf558000,0xbe483f6d,0xbf0e3f80,0x3f7bbec4
.long 0xbf358000,0xbf353f80,0xbf358000,0xbf353f80,0xbf0e8000,0xbf7b3f6d,0x3f55bf80,0xbe48bec4
.long 0xbec48000,0xbf6d3f35,0x3ec4a50d,0x3f6dbf35,0xbe488000,0xbf0e3ec4,0xbf7b3f80,0xbf553f6d
.long 0xa50d8000,0xa50d8000,0xa50d8000,0xa50d8000,0x3e488000,0x3f0ebec4,0x3f7bbf80,0x3f55bf6d
.long 0x3ec48000,0x3f6dbf35,0xbec4a50d,0xbf6d3f35,0x3f0e8000,0x3f7bbf6d,0xbf553f80,0x3e483ec4
.long 0x3f358000,0x3f35bf80,0x3f358000,0x3f35bf80,0x3f558000,0x3e48bf6d,0x3f0ebf80,0xbf7b3ec4
.long 0x3f6d8000,0xbec4bf35,0xbf6da50d,0x3ec43f35,0x3f7b8000,0xbf55bec4,0xbe483f80,0x3f0ebf6d
.long 0x3f808000,0xbf80a50d,0x3f808000,0xbf80a50d,0x3f7b8000,0xbf553ec4,0xbe48bf80,0x3f0e3f6d
.long 0x3f6d8000,0xbec43f35,0xbf6da50d,0x3ec4bf35,0x3f558000,0x3e483f6d,0x3f0e3f80,0xbf7bbec4
.long 0x3f358000,0x3f353f80,0x3f358000,0x3f353f80,0x3f0e8000,0x3f7b3f6d,0xbf55bf80,0x3e48bec4
.long 0x3ec48000,0x3f6d3f35,0xbec4a50d,0xbf6dbf35,0x3e488000,0x3f0e3ec4,0x3f7b3f80,0x3f553f6d
.long 0x80008000,0x80008000,0x80008000,0x80008000,0xbf55bf35,0xbf7bbf6d,0xbf0ebf35,0xbe48bec4
.long 0xbf6dbf80,0xbec4bf35,0x3f6d3f80,0x3ec43f35,0xbe48bf35,0x3f553ec4,0xbf7bbf35,0xbf0ebf6d
.long 0x3f35a50d,0x3f353f80,0x3f35a50d,0x3f353f80,0x3f7b3f35,0xbf0e3ec4,0xbe483f35,0xbf55bf6d
.long 0x3ec43f80,0xbf6dbf35,0xbec4bf80,0x3f6d3f35,0xbf0e3f35,0x3e48bf6d,0x3f553f35,0xbf7bbec4
.long 0xbf808000,0x3f80a50d,0xbf808000,0x3f80a50d,0xbf0ebf35,0x3e483f6d,0x3f55bf35,0xbf7b3ec4
.long 0x3ec4bf80,0xbf6d3f35,0xbec43f80,0x3f6dbf35,0x3f7bbf35,0xbf0ebec4,0xbe48bf35,0xbf553f6d
.long 0x3f35a50d,0x3f35bf80,0x3f35a50d,0x3f35bf80,0xbe483f35,0x3f55bec4,0xbf7b3f35,0xbf0e3f6d
.long 0xbf6d3f80,0xbec43f35,0x3f6dbf80,0x3ec4bf35,0xbf553f35,0xbf7b3f6d,0xbf0e3f35,0xbe483ec4
.long 0xa50d8000,0xa50d8000,0xa50d8000,0xa50d8000,0x3f55bf35,0x3f7bbf6d,0x3f0ebf35,0x3e48bec4
.long 0x3f6dbf80,0x3ec4bf35,0xbf6d3f80,0xbec43f35,0x3e48bf35,0xbf553ec4,0x3f7bbf35,0x3f0ebf6d
.long 0xbf35a50d,0xbf353f80,0xbf35a50d,0xbf353f80,0xbf7b3f35,0x3f0e3ec4,0x3e483f35,0x3f55bf6d
.long 0xbec43f80,0x3f6dbf35,0x3ec4bf80,0xbf6d3f35,0x3f0e3f35,0xbe48bf6d,0xbf553f35,0x3f7bbec4
.long 0x3f808000,0xbf80a50d,0x3f808000,0xbf80a50d,0x3f0ebf35,0xbe483f6d,0xbf55bf35,0x3f7b3ec4
.long 0xbec4bf80,0x3f6d3f35,0x3ec43f80,0xbf6dbf35,0xbf7bbf35,0x3f0ebec4,0x3e48bf35,0x3f553f6d
.long 0xbf35a50d,0xbf35bf80,0xbf35a50d,0xbf35bf80,0x3e483f35,0xbf55bec4,0x3f7b3f35,0x3f0e3f6d
.long 0x3f6d3f80,0x3ec43f35,0xbf6dbf80,0xbec4bf35,0x3f553f35,0x3f7b3f6d,0x3f0e3f35,0x3e483ec4
.long 0x80008000,0x80008000,0x80008000,0x80008000,0x3e48a50d,0x3f0e3ec4,0x3f7b3f80,0x3f553f6d
.long 0xbec48000,0xbf6dbf35,0x3ec4a50d,0x3f6d3f35,0x3f0ea50d,0x3f7b3f6d,0xbf55bf80,0x3e48bec4
.long 0xbf358000,0xbf35bf80,0xbf358000,0xbf35bf80,0x3f55a50d,0x3e483f6d,0x3f0e3f80,0xbf7bbec4
.long 0xbf6d8000,0x3ec4bf35,0x3f6da50d,0xbec43f35,0x3f7ba50d,0xbf553ec4,0xbe48bf80,0x3f0e3f6d
.long 0xbf808000,0x3f80a50d,0xbf808000,0x3f80a50d,0x3f7ba50d,0xbf55bec4,0xbe483f80,0x3f0ebf6d
.long 0xbf6d8000,0x3ec43f35,0x3f6da50d,0xbec4bf35,0x3f55a50d,0x3e48bf6d,0x3f0ebf80,0xbf7b3ec4
.long 0xbf358000,0xbf353f80,0xbf358000,0xbf353f80,0x3f0ea50d,0x3f7bbf6d,0xbf553f80,0x3e483ec4
.long 0xbec48000,0xbf6d3f35,0x3ec4a50d,0x3f6dbf35,0x3e48a50d,0x3f0ebec4,0x3f7bbf80,0x3f55bf6d
.long 0xa50d8000,0xa50d8000,0xa50d8000,0xa50d8000,0xbe48a50d,0xbf0e3ec4,0xbf7b3f80,0xbf553f6d
.long 0x3ec48000,0x3f6dbf35,0xbec4a50d,0xbf6d3f35,0xbf0ea50d,0xbf7b3f6d,0x3f55bf80,0xbe48bec4
.long 0x3f358000,0x3f35bf80,0x3f358000,0x3f35bf80,0xbf55a50d,0xbe483f6d,0xbf0e3f80,0x3f7bbec4
.long 0x3f6d8000,0xbec4bf35,0xbf6da50d,0x3ec43f35,0xbf7ba50d,0x3f553ec4,0x3e48bf80,0xbf0e3f6d
.long 0x3f808000,0xbf80a50d,0x3f808000,0xbf80a50d,0xbf7ba50d,0x3f55bec4,0x3e483f80,0xbf0ebf6d
.long 0x3f6d8000,0xbec43f35,0xbf6da50d,0x3ec4bf35,0xbf55a50d,0xbe48bf6d,0xbf0ebf80,0x3f7b3ec4
.long 0x3f358000,0x3f353f80,0x3f358000,0x3f353f80,0xbf0ea50d,0xbf7bbf6d,0x3f553f80,0xbe483ec4
.long 0x3ec48000,0x3f6d3f35,0xbec4a50d,0xbf6dbf35,0xbe48a50d,0xbf0ebec4,0xbf7bbf80,0xbf55bf6d
.long 0x80008000,0x80008000,0x80008000,0x80008000,0x3f553f35,0x3f7b3f6d,0x3f0e3f35,0x3e483ec4
.long 0xbf6dbf80,0xbec4bf35,0x3f6d3f80,0x3ec43f35,0x3e483f35,0xbf55bec4,0x3f7b3f35,0x3f0e3f6d
.long 0x3f35a50d,0x3f353f80,0x3f35a50d,0x3f353f80,0xbf7bbf35,0x3f0ebec4,0x3e48bf35,0x3f553f6d
.long 0x3ec43f80,0xbf6dbf35,0xbec4bf80,0x3f6d3f35,0x3f0ebf35,0xbe483f6d,0xbf55bf35,0x3f7b3ec4
.long 0xbf808000,0x3f80a50d,0xbf808000,0x3f80a50d,0x3f0e3f35,0xbe48bf6d,0xbf553f35,0x3f7bbec4
.long 0x3ec4bf80,0xbf6d3f35,0xbec43f80,0x3f6dbf35,0xbf7b3f35,0x3f0e3ec4,0x3e483f35,0x3f55bf6d
.long 0x3f35a50d,0x3f35bf80,0x3f35a50d,0x3f35bf80,0x3e48bf35,0xbf553ec4,0x3f7bbf35,0x3f0ebf6d
.long 0xbf6d3f80,0xbec43f35,0x3f6dbf80,0x3ec4bf35,0x3f55bf35,0x3f7bbf6d,0x3f0ebf35,0x3e48bec4
.long 0xa50d8000,0xa50d8000,0xa50d8000,0xa50d8000,0xbf553f35,0xbf7b3f6d,0xbf0e3f35,0xbe483ec4
.long 0x3f6dbf80,0x3ec4bf35,0xbf6d3f80,0xbec43f35,0xbe483f35,0x3f55bec4,0xbf7b3f35,0xbf0e3f6d
.long 0xbf35a50d,0xbf353f80,0xbf35a50d,0xbf353f80,0x3f7bbf35,0xbf0ebec4,0xbe48bf35,0xbf553f6d
.long 0xbec43f80,0x3f6dbf35,0x3ec4bf80,0xbf6d3f35,0xbf0ebf35,0x3e483f6d,0x3f55bf35,0xbf7b3ec4
.long 0x3f808000,0xbf80a50d,0x3f808000,0xbf80a50d,0xbf0e3f35,0x3e48bf6d,0x3f553f35,0xbf7bbec4
.long 0xbec4bf80,0x3f6d3f35,0x3ec43f80,0xbf6dbf35,0x3f7b3f35,0xbf0e3ec4,0xbe483f35,0xbf55bf6d
.long 0xbf35a50d,0xbf35bf80,0xbf35a50d,0xbf35bf80,0xbe48bf35,0x3f553ec4,0xbf7bbf35,0xbf0ebf6d
.long 0x3f6d3f80,0x3ec43f35,0xbf6dbf80,0xbec4bf35,0xbf55bf35,0xbf7bbf6d,0xbf0ebf35,0xbe48bec4
.long 0x3f800000,0x3f800000,0x3f800000,0x3f800000,0x3f800000,0x3f7ffec4,0x3f7ffb11,0x3f7ff4e6
.long 0x3f800000,0x3f7ffb11,0x3f7fec43,0x3f7fd397,0x3f800000,0x3f7ff4e6,0x3f7fd397,0x3f7f9c18
.long 0x3f800000,0x3f7fec43,0x3f7fb10f,0x3f7f4e6d,0x3f800000,0x3f7fe129,0x3f7f84ab,0x3f7eea9d
.long 0x3f800000,0x3f7fd397,0x3f7f4e6d,0x3f7e70b0,0x3f800000,0x3f7fc38f,0x3f7f0e58,0x3f7de0b1
.long 0x3f800000,0x3f7fb10f,0x3f7ec46d,0x3f7d3aac,0x3f800000,0x3f7f9c18,0x3f7e70b0,0x3f7c7eb0
.long 0x3f800000,0x3f7f84ab,0x3f7e1324,0x3f7baccd,0x3f800000,0x3f7f6ac7,0x3f7dabcc,0x3f7ac516
.long 0x3f800000,0x3f7f4e6d,0x3f7d3aac,0x3f79c79d,0x3f800000,0x3f7f2f9d,0x3f7cbfc9,0x3f78b47b
.long 0x3f800000,0x3f7f0e58,0x3f7c3b28,0x3f778bc5,0x3f800000,0x3f7eea9d,0x3f7baccd,0x3f764d97
.long 0x3f800000,0x3f7ec46d,0x3f7b14be,0x3f74fa0b,0x3f800000,0x3f7e9bc9,0x3f7a7302,0x3f73913f
.long 0x3f800000,0x3f7e70b0,0x3f79c79d,0x3f721352,0x3f800000,0x3f7e4323,0x3f791298,0x3f708066
.long 0x3f800000,0x3f7e1324,0x3f7853f8,0x3f6ed89e,0x3f800000,0x3f7de0b1,0x3f778bc5,0x3f6d1c1d
.long 0x3f800000,0x3f7dabcc,0x3f76ba07,0x3f6b4b0c,0x3f800000,0x3f7d7474,0x3f75dec6,0x3f696591
.long 0x3f800000,0x3f7d3aac,0x3f74fa0b,0x3f676bd8,0x3f800000,0x3f7cfe73,0x3f740bdd,0x3f655e0b
.long 0x3f800000,0x3f7cbfc9,0x3f731447,0x3f633c5a,0x3f800000,0x3f7c7eb0,0x3f721352,0x3f6106f2
.long 0x3f800000,0x3f7c3b28,0x3f710908,0x3f5ebe05,0x3f800000,0x3f7bf531,0x3f6ff573,0x3f5c61c7
.long 0x3f800000,0x3f7baccd,0x3f6ed89e,0x3f59f26a,0x3f800000,0x3f7b61fc,0x3f6db293,0x3f577026
.long 0x3f800000,0x3f800000,0x3f800000,0x3f800000,0x3f7fec43,0x3f7fe129,0x3f7fd397,0x3f7fc38f
.long 0x3f7fb10f,0x3f7f84ab,0x3f7f4e6d,0x3f7f0e58,0x3f7f4e6d,0x3f7eea9d,0x3f7e70b0,0x3f7de0b1
.long 0x3f7ec46d,0x3f7e1324,0x3f7d3aac,0x3f7c3b28,0x3f7e1324,0x3f7cfe73,0x3f7baccd,0x3f7a1e84
.long 0x3f7d3aac,0x3f7baccd,0x3f79c79d,0x3f778bc5,0x3f7c3b28,0x3f7a1e84,0x3f778bc5,0x3f748422
.long 0x3f7b14be,0x3f7853f8,0x3f74fa0b,0x3f710908,0x3f79c79d,0x3f764d97,0x3f721352,0x3f6d1c1d
.long 0x3f7853f8,0x3f740bdd,0x3f6ed89e,0x3f68bf3c,0x3f76ba07,0x3f718f57,0x3f6b4b0c,0x3f63f473
.long 0x3f74fa0b,0x3f6ed89e,0x3f676bd8,0x3f5ebe05,0x3f731447,0x3f6be858,0x3f633c5a,0x3f591e6a
.long 0x3f710908,0x3f68bf3c,0x3f5ebe05,0x3f531849,0x3f6ed89e,0x3f655e0b,0x3f59f26a,0x3f4cae79
.long 0x3f6c835e,0x3f61c598,0x3f54db31,0x3f45e403,0x3f6a09a7,0x3f5df6be,0x3f4f7a1f,0x3f3ebc1b
.long 0x3f676bd8,0x3f59f26a,0x3f49d112,0x3f373a23,0x3f64aa59,0x3f55b993,0x3f43e200,0x3f2f61a5
.long 0x3f61c598,0x3f514d3d,0x3f3daef9,0x3f273656,0x3f5ebe05,0x3f4cae79,0x3f373a23,0x3f1ebc12
.long 0x3f5b941a,0x3f47de65,0x3f3085bb,0x3f15f6d9,0x3f584853,0x3f42de29,0x3f299415,0x3f0cead0
.long 0x3f54db31,0x3f3daef9,0x3f226799,0x3f039c3d,0x3f514d3d,0x3f385216,0x3f1b02c6,0x3ef41f07
.long 0x3f4d9f02,0x3f32c8c9,0x3f13682a,0x3ee0924f,0x3f49d112,0x3f2d1469,0x3f0b9a6b,0x3ecc9b8b
.long 0x3f45e403,0x3f273656,0x3f039c3d,0x3eb8442a,0x3f41d870,0x3f212ff9,0x3ef6e0cb,0x3ea395c5
.long 0x3f3daef9,0x3f1b02c6,0x3ee63375,0x3e8e9a22,0x3f396842,0x3f14b039,0x3ed53641,0x3e72b651
.long 0x3f800000,0x3f800000,0x3f800000,0x3f800000,0x3f7fb10f,0x3f7f9c18,0x3f7f84ab,0x3f7f6ac7
.long 0x3f7ec46d,0x3f7e70b0,0x3f7e1324,0x3f7dabcc,0x3f7d3aac,0x3f7c7eb0,0x3f7baccd,0x3f7ac516
.long 0x3f7b14be,0x3f79c79d,0x3f7853f8,0x3f76ba07,0x3f7853f8,0x3f764d97,0x3f740bdd,0x3f718f57
.long 0x3f74fa0b,0x3f721352,0x3f6ed89e,0x3f6b4b0c,0x3f710908,0x3f6d1c1d,0x3f68bf3c,0x3f63f473
.long 0x3f6c835e,0x3f676bd8,0x3f61c598,0x3f5b941a,0x3f676bd8,0x3f6106f2,0x3f59f26a,0x3f5233c6
.long 0x3f61c598,0x3f59f26a,0x3f514d3d,0x3f47de65,0x3f5b941a,0x3f5233c6,0x3f47de65,0x3f3ca003
.long 0x3f54db31,0x3f49d112,0x3f3daef9,0x3f3085bb,0x3f4d9f02,0x3f40d0da,0x3f32c8c9,0x3f239da9
.long 0x3f45e403,0x3f373a23,0x3f273656,0x3f15f6d9,0x3f3daef9,0x3f2d1469,0x3f1b02c6,0x3f07a136
.long 0x3f3504f3,0x3f226799,0x3f0e39da,0x3ef15aea,0x3f2beb4a,0x3f173c07,0x3f00e7e4,0x3ed25a09
.long 0x3f226799,0x3f0b9a6b,0x3ee63375,0x3eb263ef,0x3f187fc0,0x3eff17b2,0x3ec9b953,0x3e919ddd
.long 0x3f0e39da,0x3ee63375,0x3eac7cd4,0x3e605c13,0x3f039c3d,0x3ecc9b8b,0x3e8e9a22,0x3e1c76de
.long 0x3ef15aea,0x3eb263ef,0x3e605c13,0x3dafb680,0x3edae880,0x3e97a117,0x3e22abb6,0x3c96c9b6
.long 0x3ec3ef15,0x3e78cfcc,0x3dc8bd36,0xbd48fb30,0x3eac7cd4,0x3e419b37,0x3d16c32c,0xbdee3876
.long 0x3e94a031,0x3e09cf86,0xbcc90ab0,0xbe3b6ecf,0x3e78cfcc,0x3da3308c,0xbdafb680,0xbe7ee6e1
.long 0x3e47c5c2,0x3cc90ab0,0xbe164083,0xbea09ae5,0x3e164083,0xbcfb49ba,0xbe541501,0xbec1071e
.long 0x3dc8bd36,0xbdafb680,0xbe888e93,0xbee0924f,0x3d48fb30,0xbe1008b7,0xbea68f12,0xbeff17b2
.long 0x3f800000,0x3f800000,0x3f800000,0x3f800000,0x3f7f4e6d,0x3f7f2f9d,0x3f7f0e58,0x3f7eea9d
.long 0x3f7d3aac,0x3f7cbfc9,0x3f7c3b28,0x3f7baccd,0x3f79c79d,0x3f78b47b,0x3f778bc5,0x3f764d97
.long 0x3f74fa0b,0x3f731447,0x3f710908,0x3f6ed89e,0x3f6ed89e,0x3f6be858,0x3f68bf3c,0x3f655e0b
.long 0x3f676bd8,0x3f633c5a,0x3f5ebe05,0x3f59f26a,0x3f5ebe05,0x3f591e6a,0x3f531849,0x3f4cae79
.long 0x3f54db31,0x3f4d9f02,0x3f45e403,0x3f3daef9,0x3f49d112,0x3f40d0da,0x3f373a23,0x3f2d1469
.long 0x3f3daef9,0x3f32c8c9,0x3f273656,0x3f1b02c6,0x3f3085bb,0x3f239da9,0x3f15f6d9,0x3f07a136
.long 0x3f226799,0x3f13682a,0x3f039c3d,0x3ee63375,0x3f13682a,0x3f0242b1,0x3ee0924f,0x3ebb31a0
.long 0x3f039c3d,0x3ee0924f,0x3eb8442a,0x3e8e9a22,0x3ee63375,0x3ebb31a0,0x3e8e9a22,0x3e419b37
.long 0x3ec3ef15,0x3e94a031,0x3e47c5c2,0x3dc8bd36,0x3ea09ae5,0x3e5a3997,0x3de1bc2e,0x3bc90f88
.long 0x3e78cfcc,0x3e09cf86,0x3cc90ab0,0xbdafb680,0x3e2f10a2,0x3d621469,0xbd7b2b74,0xbe354098
.long 0x3dc8bd36,0xbcc90ab0,0xbe164083,0xbe888e93,0x3cc90ab0,0xbdd53db9,0xbe6c9a7f,0xbeb554ec
.long 0xbd48fb30,0xbe3b6ecf,0xbea09ae5,0xbee0924f,0xbdfab273,0xbe8586ce,0xbec9b953,0xbf04f484
.long 0xbe47c5c2,0xbeac7cd4,0xbef15aea,0xbf187fc0,0xbe888e93,0xbed25a09,0xbf0b9a6b,0xbf2ac082
.long 0xbeac7cd4,0xbef6e0cb,0xbf1d7fd1,0xbf3b8f3b,0xbecf7bca,0xbf0cead0,0xbf2e3bde,0xbf4ac77f
.long 0xbef15aea,0xbf1d7fd1,0xbf3daef9,0xbf584853,0xbf08f59b,0xbf2d1469,0xbf4bbbf8,0xbf63f473
.long 0xbf187fc0,0xbf3b8f3b,0xbf584853,0xbf6db293,0xbf273656,0xbf48d8b3,0xbf633c5a,0xbf756d97
.long 0x3f800000,0x3f800000,0x3f800000,0x3f800000,0x3f7ec46d,0x3f7e9bc9,0x3f7e70b0,0x3f7e4323
.long 0x3f7b14be,0x3f7a7302,0x3f79c79d,0x3f791298,0x3f74fa0b,0x3f73913f,0x3f721352,0x3f708066
.long 0x3f6c835e,0x3f6a09a7,0x3f676bd8,0x3f64aa59,0x3f61c598,0x3f5df6be,0x3f59f26a,0x3f55b993
.long 0x3f54db31,0x3f4f7a1f,0x3f49d112,0x3f43e200,0x3f45e403,0x3f3ebc1b,0x3f373a23,0x3f2f61a5
.long 0x3f3504f3,0x3f2beb4a,0x3f226799,0x3f187fc0,0x3f226799,0x3f173c07,0x3f0b9a6b,0x3eff17b2
.long 0x3f0e39da,0x3f00e7e4,0x3ee63375,0x3ec9b953,0x3ef15aea,0x3ed25a09,0x3eb263ef,0x3e919ddd
.long 0x3ec3ef15,0x3ea09ae5,0x3e78cfcc,0x3e2f10a2,0x3e94a031,0x3e5a3997,0x3e09cf86,0x3d621469
.long 0x3e47c5c2,0x3de1bc2e,0x3cc90ab0,0xbd7b2b74,0x3dc8bd36,0x3bc90f88,0xbdafb680,0xbe354098
.long 0x248d3132,0xbdc8bd36,0xbe47c5c2,0xbe94a031,0xbdc8bd36,0xbe4dee60,0xbe9aa086,0xbecc9b8b
.long 0xbe47c5c2,0xbe9aa086,0xbecf7bca,0xbf00e7e4,0xbe94a031,0xbecc9b8b,0xbf00e7e4,0xbf19c200
.long 0xbec3ef15,0xbefc5d27,0xbf187fc0,0xbf3085bb,0xbef15aea,0xbf14b039,0xbf2e3bde,0xbf44e3f5
.long 0xbf0e39da,0xbf299415,0xbf41d870,0xbf5695e5,0xbf226799,0xbf3ca003,0xbf531849,0xbf655e0b
.long 0xbf3504f3,0xbf4d9f02,0xbf61c598,0xbf710908,0xbf45e403,0xbf5c61c7,0xbf6db293,0xbf796e4e
.long 0xbf54db31,0xbf68bf3c,0xbf76ba07,0xbf7e70b0,0xbf61c598,0xbf7294f8,0xbf7cbfc9,0xbf7ffec4
.long 0xbf6c835e,0xbf79c79d,0xbf7fb10f,0xbf7e1324,0xbf74fa0b,0xbf7e4323,0xbf7f84ab,0xbf78b47b
.long 0xbf7b14be,0xbf7ffb11,0xbf7c3b28,0xbf6ff573,0xbf7ec46d,0xbf7eea9d,0xbf75dec6,0xbf63f473
.long 0x3f800000,0x3f800000,0x3f800000,0x3f800000,0x3f7e1324,0x3f7de0b1,0x3f7dabcc,0x3f7d7474
.long 0x3f7853f8,0x3f778bc5,0x3f76ba07,0x3f75dec6,0x3f6ed89e,0x3f6d1c1d,0x3f6b4b0c,0x3f696591
.long 0x3f61c598,0x3f5ebe05,0x3f5b941a,0x3f584853,0x3f514d3d,0x3f4cae79,0x3f47de65,0x3f42de29
.long 0x3f3daef9,0x3f373a23,0x3f3085bb,0x3f299415,0x3f273656,0x3f1ebc12,0x3f15f6d9,0x3f0cead0
.long 0x3f0e39da,0x3f039c3d,0x3ef15aea,0x3edae880,0x3ee63375,0x3ecc9b8b,0x3eb263ef,0x3e97a117
.long 0x3eac7cd4,0x3e8e9a22,0x3e605c13,0x3e22abb6,0x3e605c13,0x3e1c76de,0x3dafb680,0x3c96c9b6
.long 0x3dc8bd36,0x3cc90ab0,0xbd48fb30,0xbdfab273,0xbcc90ab0,0xbdd53db9,0xbe3b6ecf,0xbe8586ce
.long 0xbe164083,0xbe6c9a7f,0xbea09ae5,0xbec9b953,0xbe888e93,0xbeb554ec,0xbee0924f,0xbf04f484
.long 0xbec3ef15,0xbef15aea,0xbf0e39da,0xbf226799,0xbefc5d27,0xbf14b039,0xbf299415,0xbf3ca003
.long 0xbf187fc0,0xbf2e3bde,0xbf41d870,0xbf531849,0xbf3085bb,0xbf44e3f5,0xbf5695e5,0xbf655e0b
.long 0xbf45e403,0xbf584853,0xbf676bd8,0xbf731447,0xbf584853,0xbf6816a8,0xbf740bdd,0xbf7bf531
.long 0xbf676bd8,0xbf740bdd,0xbf7c3b28,0xbf7fd397,0xbf731447,0xbf7bf531,0xbf7fd397,0xbf7e9bc9
.long 0xbf7b14be,0xbf7fb10f,0xbf7ec46d,0xbf7853f8,0xbf7f4e6d,0xbf7f2f9d,0xbf791298,0xbf6d1c1d
.long 0xbf7fb10f,0xbf7a7302,0xbf6ed89e,0xbf5d2d53,0xbf7c3b28,0xbf718f57,0xbf604621,0xbf48d8b3
.long 0xbf74fa0b,0xbf64aa59,0xbf4d9f02,0xbf3085bb,0xbf6a09a7,0xbf53fac3,0xbf373a23,0xbf14b039
.long 0xbf5b941a,0xbf3fc767,0xbf1d7fd1,0xbeebcbbb,0xbf49d112,0xbf286605,0xbf00e7e4,0xbea986c4
.long 0x3f800000,0x3f800000,0x3f800000,0x3f800000,0x3f7d3aac,0x3f7cfe73,0x3f7cbfc9,0x3f7c7eb0
.long 0x3f74fa0b,0x3f740bdd,0x3f731447,0x3f721352,0x3f676bd8,0x3f655e0b,0x3f633c5a,0x3f6106f2
.long 0x3f54db31,0x3f514d3d,0x3f4d9f02,0x3f49d112,0x3f3daef9,0x3f385216,0x3f32c8c9,0x3f2d1469
.long 0x3f226799,0x3f1b02c6,0x3f13682a,0x3f0b9a6b,0x3f039c3d,0x3ef41f07,0x3ee0924f,0x3ecc9b8b
.long 0x3ec3ef15,0x3eac7cd4,0x3e94a031,0x3e78cfcc,0x3e78cfcc,0x3e419b37,0x3e09cf86,0x3da3308c
.long 0x3dc8bd36,0x3d16c32c,0xbcc90ab0,0xbdafb680,0xbd48fb30,0xbdee3876,0xbe3b6ecf,0xbe7ee6e1
.long 0xbe47c5c2,0xbe888e93,0xbeac7cd4,0xbecf7bca,0xbeac7cd4,0xbed25a09,0xbef6e0cb,0xbf0cead0
.long 0xbef15aea,0xbf0b9a6b,0xbf1d7fd1,0xbf2e3bde,0xbf187fc0,0xbf2ac082,0xbf3b8f3b,0xbf4ac77f
.long 0xbf3504f3,0xbf45e403,0xbf54db31,0xbf61c598,0xbf4d9f02,0xbf5c61c7,0xbf68bf3c,0xbf7294f8
.long 0xbf61c598,0xbf6db293,0xbf76ba07,0xbf7cbfc9,0xbf710908,0xbf796e4e,0xbf7e70b0,0xbf7ffec4
.long 0xbf7b14be,0xbf7f4e6d,0xbf7fb10f,0xbf7c3b28,0xbf7fb10f,0xbf7f2f9d,0xbf7a7302,0xbf718f57
.long 0xbf7ec46d,0xbf791298,0xbf6ed89e,0xbf604621,0xbf7853f8,0xbf6d1c1d,0xbf5d2d53,0xbf48d8b3
.long 0xbf6c835e,0xbf5b941a,0xbf45e403,0xbf2beb4a,0xbf5b941a,0xbf44e3f5,0xbf299415,0xbf0a48ad
.long 0xbf45e403,0xbf299415,0xbf08f59b,0xbec9b953,0xbf2beb4a,0xbf0a48ad,0xbec9b953,0xbe72b651
.long 0xbf0e39da,0xbecf7bca,0xbe78cfcc,0xbd96a905,0xbedae880,0xbe8586ce,0xbdafb680,0x3dbc3ac3
.long 0xbe94a031,0xbde1bc2e,0x3d96a905,0x3e827dc0,0xbe164083,0x3d2fe007,0x3e6c9a7f,0x3ed25a09
.long 0x3f800000,0x3f800000,0x3f800000,0x3f800000,0x3f7c3b28,0x3f7bf531,0x3f7baccd,0x3f7b61fc
.long 0x3f710908,0x3f6ff573,0x3f6ed89e,0x3f6db293,0x3f5ebe05,0x3f5c61c7,0x3f59f26a,0x3f577026
.long 0x3f45e403,0x3f41d870,0x3f3daef9,0x3f396842,0x3f273656,0x3f212ff9,0x3f1b02c6,0x3f14b039
.long 0x3f039c3d,0x3ef6e0cb,0x3ee63375,0x3ed53641,0x3eb8442a,0x3ea395c5,0x3e8e9a22,0x3e72b651
.long 0x3e47c5c2,0x3e164083,0x3dc8bd36,0x3d48fb30,0x3cc90ab0,0xbcfb49ba,0xbdafb680,0xbe1008b7
.long 0xbe164083,0xbe541501,0xbe888e93,0xbea68f12,0xbea09ae5,0xbec1071e,0xbee0924f,0xbeff17b2
.long 0xbef15aea,0xbf08f59b,0xbf187fc0,0xbf273656,0xbf1d7fd1,0xbf2d1469,0xbf3b8f3b,0xbf48d8b3
.long 0xbf3daef9,0xbf4bbbf8,0xbf584853,0xbf633c5a,0xbf584853,0xbf63f473,0xbf6db293,0xbf756d97
.long 0xbf6c835e,0xbf74fa0b,0xbf7b14be,0xbf7ec46d,0xbf79c79d,0xbf7e4323,0xbf7ffb11,0xbf7eea9d
.long 0xbf7fb10f,0xbf7f84ab,0xbf7c3b28,0xbf75dec6,0xbf7e1324,0xbf78b47b,0xbf6ff573,0xbf63f473
.long 0xbf74fa0b,0xbf6a09a7,0xbf5b941a,0xbf49d112,0xbf64aa59,0xbf53fac3,0xbf3fc767,0xbf286605
.long 0xbf4d9f02,0xbf373a23,0xbf1d7fd1,0xbf00e7e4,0xbf3085bb,0xbf14b039,0xbeebcbbb,0xbea986c4
.long 0xbf0e39da,0xbedae880,0xbe94a031,0xbe164083,0xbecf7bca,0xbe8586ce,0xbde1bc2e,0x3d2fe007
.long 0xbe78cfcc,0xbdafb680,0x3d96a905,0x3e6c9a7f,0xbd96a905,0x3dbc3ac3,0x3e827dc0,0x3ed25a09
.long 0x3dc8bd36,0x3e888e93,0x3edae880,0x3f13682a,0x3e888e93,0x3eddbe79,0x3f15f6d9,0x3f385216
.long 0x3edae880,0x3f15f6d9,0x3f396842,0x3f5695e5,0x3f13682a,0x3f385216,0x3f5695e5,0x3f6d1c1d
.long 0x0,0x0,0x0,0x0,0x0,0x3bc90f88,0x3c490e90,0x3c96c9b6
.long 0x0,0x3c490e90,0x3cc90ab0,0x3d16c32c,0x0,0x3c96c9b6,0x3d16c32c,0x3d621469
.long 0x0,0x3cc90ab0,0x3d48fb30,0x3d96a905,0x0,0x3cfb49ba,0x3d7b2b74,0x3dbc3ac3
.long 0x0,0x3d16c32c,0x3d96a905,0x3de1bc2e,0x0,0x3d2fe007,0x3dafb680,0x3e039502
.long 0x0,0x3d48fb30,0x3dc8bd36,0x3e164083,0x0,0x3d621469,0x3de1bc2e,0x3e28defc
.long 0x0,0x3d7b2b74,0x3dfab273,0x3e3b6ecf,0x0,0x3d8a200a,0x3e09cf86,0x3e4dee60
.long 0x0,0x3d96a905,0x3e164083,0x3e605c13,0x0,0x3da3308c,0x3e22abb6,0x3e72b651
.long 0x0,0x3dafb680,0x3e2f10a2,0x3e827dc0,0x0,0x3dbc3ac3,0x3e3b6ecf,0x3e8b9507
.long 0x0,0x3dc8bd36,0x3e47c5c2,0x3e94a031,0x0,0x3dd53db9,0x3e541501,0x3e9d9e78
.long 0x0,0x3de1bc2e,0x3e605c13,0x3ea68f12,0x0,0x3dee3876,0x3e6c9a7f,0x3eaf713a
.long 0x0,0x3dfab273,0x3e78cfcc,0x3eb8442a,0x0,0x3e039502,0x3e827dc0,0x3ec1071e
.long 0x0,0x3e09cf86,0x3e888e93,0x3ec9b953,0x0,0x3e1008b7,0x3e8e9a22,0x3ed25a09
.long 0x0,0x3e164083,0x3e94a031,0x3edae880,0x0,0x3e1c76de,0x3e9aa086,0x3ee363fa
.long 0x0,0x3e22abb6,0x3ea09ae5,0x3eebcbbb,0x0,0x3e28defc,0x3ea68f12,0x3ef41f07
.long 0x0,0x3e2f10a2,0x3eac7cd4,0x3efc5d27,0x0,0x3e354098,0x3eb263ef,0x3f0242b1
.long 0x0,0x3e3b6ecf,0x3eb8442a,0x3f064b82,0x0,0x3e419b37,0x3ebe1d4a,0x3f0a48ad
.long 0x0,0x0,0x0,0x0,0x3cc90ab0,0x3cfb49ba,0x3d16c32c,0x3d2fe007
.long 0x3d48fb30,0x3d7b2b74,0x3d96a905,0x3dafb680,0x3d96a905,0x3dbc3ac3,0x3de1bc2e,0x3e039502
.long 0x3dc8bd36,0x3dfab273,0x3e164083,0x3e2f10a2,0x3dfab273,0x3e1c76de,0x3e3b6ecf,0x3e5a3997
.long 0x3e164083,0x3e3b6ecf,0x3e605c13,0x3e827dc0,0x3e2f10a2,0x3e5a3997,0x3e827dc0,0x3e97a117
.long 0x3e47c5c2,0x3e78cfcc,0x3e94a031,0x3eac7cd4,0x3e605c13,0x3e8b9507,0x3ea68f12,0x3ec1071e
.long 0x3e78cfcc,0x3e9aa086,0x3eb8442a,0x3ed53641,0x3e888e93,0x3ea986c4,0x3ec9b953,0x3ee900b7
.long 0x3e94a031,0x3eb8442a,0x3edae880,0x3efc5d27,0x3ea09ae5,0x3ec6d529,0x3eebcbbb,0x3f07a136
.long 0x3eac7cd4,0x3ed53641,0x3efc5d27,0x3f10d3cd,0x3eb8442a,0x3ee363fa,0x3f064b82,0x3f19c200
.long 0x3ec3ef15,0x3ef15aea,0x3f0e39da,0x3f226799,0x3ecf7bca,0x3eff17b2,0x3f15f6d9,0x3f2ac082
.long 0x3edae880,0x3f064b82,0x3f1d7fd1,0x3f32c8c9,0x3ee63375,0x3f0cead0,0x3f24d225,0x3f3a7ca4
.long 0x3ef15aea,0x3f13682a,0x3f2beb4a,0x3f41d870,0x3efc5d27,0x3f19c200,0x3f32c8c9,0x3f48d8b3
.long 0x3f039c3d,0x3f1ff6cb,0x3f396842,0x3f4f7a1f,0x3f08f59b,0x3f26050a,0x3f3fc767,0x3f55b993
.long 0x3f0e39da,0x3f2beb4a,0x3f45e403,0x3f5b941a,0x3f13682a,0x3f31a81d,0x3f4bbbf8,0x3f6106f2
.long 0x3f187fc0,0x3f373a23,0x3f514d3d,0x3f660f88,0x3f1d7fd1,0x3f3ca003,0x3f5695e5,0x3f6aab7b
.long 0x3f226799,0x3f41d870,0x3f5b941a,0x3f6ed89e,0x3f273656,0x3f46e22a,0x3f604621,0x3f7294f8
.long 0x3f2beb4a,0x3f4bbbf8,0x3f64aa59,0x3f75dec6,0x3f3085bb,0x3f5064af,0x3f68bf3c,0x3f78b47b
.long 0x0,0x0,0x0,0x0,0x3d48fb30,0x3d621469,0x3d7b2b74,0x3d8a200a
.long 0x3dc8bd36,0x3de1bc2e,0x3dfab273,0x3e09cf86,0x3e164083,0x3e28defc,0x3e3b6ecf,0x3e4dee60
.long 0x3e47c5c2,0x3e605c13,0x3e78cfcc,0x3e888e93,0x3e78cfcc,0x3e8b9507,0x3e9aa086,0x3ea986c4
.long 0x3e94a031,0x3ea68f12,0x3eb8442a,0x3ec9b953,0x3eac7cd4,0x3ec1071e,0x3ed53641,0x3ee900b7
.long 0x3ec3ef15,0x3edae880,0x3ef15aea,0x3f039c3d,0x3edae880,0x3ef41f07,0x3f064b82,0x3f121eb0
.long 0x3ef15aea,0x3f064b82,0x3f13682a,0x3f1ff6cb,0x3f039c3d,0x3f121eb0,0x3f1ff6cb,0x3f2d1469
.long 0x3f0e39da,0x3f1d7fd1,0x3f2beb4a,0x3f396842,0x3f187fc0,0x3f286605,0x3f373a23,0x3f44e3f5
.long 0x3f226799,0x3f32c8c9,0x3f41d870,0x3f4f7a1f,0x3f2beb4a,0x3f3ca003,0x3f4bbbf8,0x3f591e6a
.long 0x3f3504f3,0x3f45e403,0x3f54db31,0x3f61c598,0x3f3daef9,0x3f4e8d90,0x3f5d2d53,0x3f696591
.long 0x3f45e403,0x3f5695e5,0x3f64aa59,0x3f6ff573,0x3f4d9f02,0x3f5df6be,0x3f6b4b0c,0x3f756d97
.long 0x3f54db31,0x3f64aa59,0x3f710908,0x3f79c79d,0x3f5b941a,0x3f6aab7b,0x3f75dec6,0x3f7cfe73
.long 0x3f61c598,0x3f6ff573,0x3f79c79d,0x3f7f0e58,0x3f676bd8,0x3f748422,0x3f7cbfc9,0x3f7ff4e6
.long 0x3f6c835e,0x3f7853f8,0x3f7ec46d,0x3f7fb10f,0x3f710908,0x3f7b61fc,0x3f7fd397,0x3f7e4323
.long 0x3f74fa0b,0x3f7dabcc,0x3f7fec43,0x3f7baccd,0x3f7853f8,0x3f7f2f9d,0x3f7f0e58,0x3f77f110
.long 0x3f7b14be,0x3f7fec43,0x3f7d3aac,0x3f731447,0x3f7d3aac,0x3f7fe129,0x3f7a7302,0x3f6d1c1d
.long 0x3f7ec46d,0x3f7f0e58,0x3f76ba07,0x3f660f88,0x3f7fb10f,0x3f7d7474,0x3f721352,0x3f5df6be
.long 0x0,0x0,0x0,0x0,0x3d96a905,0x3da3308c,0x3dafb680,0x3dbc3ac3
.long 0x3e164083,0x3e22abb6,0x3e2f10a2,0x3e3b6ecf,0x3e605c13,0x3e72b651,0x3e827dc0,0x3e8b9507
.long 0x3e94a031,0x3ea09ae5,0x3eac7cd4,0x3eb8442a,0x3eb8442a,0x3ec6d529,0x3ed53641,0x3ee363fa
.long 0x3edae880,0x3eebcbbb,0x3efc5d27,0x3f064b82,0x3efc5d27,0x3f07a136,0x3f10d3cd,0x3f19c200
.long 0x3f0e39da,0x3f187fc0,0x3f226799,0x3f2beb4a,0x3f1d7fd1,0x3f286605,0x3f32c8c9,0x3f3ca003
.long 0x3f2beb4a,0x3f373a23,0x3f41d870,0x3f4bbbf8,0x3f396842,0x3f44e3f5,0x3f4f7a1f,0x3f591e6a
.long 0x3f45e403,0x3f514d3d,0x3f5b941a,0x3f64aa59,0x3f514d3d,0x3f5c61c7,0x3f660f88,0x3f6e46be
.long 0x3f5b941a,0x3f660f88,0x3f6ed89e,0x3f75dec6,0x3f64aa59,0x3f6e46be,0x3f75dec6,0x3f7b61fc
.long 0x3f6c835e,0x3f74fa0b,0x3f7b14be,0x3f7ec46d,0x3f731447,0x3f7a1e84,0x3f7e70b0,0x3f7ffec4
.long 0x3f7853f8,0x3f7dabcc,0x3f7fec43,0x3f7f0e58,0x3f7c3b28,0x3f7f9c18,0x3f7f84ab,0x3f7bf531
.long 0x3f7ec46d,0x3f7fec43,0x3f7d3aac,0x3f76ba07,0x3f7fec43,0x3f7e9bc9,0x3f791298,0x3f6f6830
.long 0x3f7fb10f,0x3f7baccd,0x3f731447,0x3f660f88,0x3f7e1324,0x3f772417,0x3f6b4b0c,0x3f5ac450
.long 0x3f7b14be,0x3f710908,0x3f61c598,0x3f4d9f02,0x3f76ba07,0x3f696591,0x3f5695e5,0x3f3ebc1b
.long 0x3f710908,0x3f604621,0x3f49d112,0x3f2e3bde,0x3f6a09a7,0x3f55b993,0x3f3b8f3b,0x3f1c420c
.long 0x3f61c598,0x3f49d112,0x3f2beb4a,0x3f08f59b,0x3f584853,0x3f3ca003,0x3f1b02c6,0x3ee900b7
.long 0x3f4d9f02,0x3f2e3bde,0x3f08f59b,0x3ebe1d4a,0x3f41d870,0x3f1ebc12,0x3eebcbbb,0x3e919ddd
.long 0x0,0x0,0x0,0x0,0x3dc8bd36,0x3dd53db9,0x3de1bc2e,0x3dee3876
.long 0x3e47c5c2,0x3e541501,0x3e605c13,0x3e6c9a7f,0x3e94a031,0x3e9d9e78,0x3ea68f12,0x3eaf713a
.long 0x3ec3ef15,0x3ecf7bca,0x3edae880,0x3ee63375,0x3ef15aea,0x3eff17b2,0x3f064b82,0x3f0cead0
.long 0x3f0e39da,0x3f15f6d9,0x3f1d7fd1,0x3f24d225,0x3f226799,0x3f2ac082,0x3f32c8c9,0x3f3a7ca4
.long 0x3f3504f3,0x3f3daef9,0x3f45e403,0x3f4d9f02,0x3f45e403,0x3f4e8d90,0x3f5695e5,0x3f5df6be
.long 0x3f54db31,0x3f5d2d53,0x3f64aa59,0x3f6b4b0c,0x3f61c598,0x3f696591,0x3f6ff573,0x3f756d97
.long 0x3f6c835e,0x3f731447,0x3f7853f8,0x3f7c3b28,0x3f74fa0b,0x3f7a1e84,0x3f7dabcc,0x3f7f9c18
.long 0x3f7b14be,0x3f7e70b0,0x3f7fec43,0x3f7f84ab,0x3f7ec46d,0x3f7ffec4,0x3f7f0e58,0x3f7bf531
.long 0x3f800000,0x3f7ec46d,0x3f7b14be,0x3f74fa0b,0x3f7ec46d,0x3f7ac516,0x3f740bdd,0x3f6aab7b
.long 0x3f7b14be,0x3f740bdd,0x3f6a09a7,0x3f5d2d53,0x3f74fa0b,0x3f6aab7b,0x3f5d2d53,0x3f4cae79
.long 0x3f6c835e,0x3f5ebe05,0x3f4d9f02,0x3f396842,0x3f61c598,0x3f5064af,0x3f3b8f3b,0x3f239da9
.long 0x3f54db31,0x3f3fc767,0x3f273656,0x3f0b9a6b,0x3f45e403,0x3f2d1469,0x3f10d3cd,0x3ee363fa
.long 0x3f3504f3,0x3f187fc0,0x3ef15aea,0x3eac7cd4,0x3f226799,0x3f0242b1,0x3ebe1d4a,0x3e667c66
.long 0x3f0e39da,0x3ed53641,0x3e888e93,0x3de1bc2e,0x3ef15aea,0x3ea395c5,0x3e22abb6,0xbbc90f88
.long 0x3ec3ef15,0x3e605c13,0x3d48fb30,0xbdfab273,0x3e94a031,0x3dee3876,0xbd7b2b74,0xbe72b651
.long 0x3e47c5c2,0x3c490e90,0xbe2f10a2,0xbeb263ef,0x3dc8bd36,0xbdbc3ac3,0xbe8e9a22,0xbee900b7
.long 0x0,0x0,0x0,0x0,0x3dfab273,0x3e039502,0x3e09cf86,0x3e1008b7
.long 0x3e78cfcc,0x3e827dc0,0x3e888e93,0x3e8e9a22,0x3eb8442a,0x3ec1071e,0x3ec9b953,0x3ed25a09
.long 0x3ef15aea,0x3efc5d27,0x3f039c3d,0x3f08f59b,0x3f13682a,0x3f19c200,0x3f1ff6cb,0x3f26050a
.long 0x3f2beb4a,0x3f32c8c9,0x3f396842,0x3f3fc767,0x3f41d870,0x3f48d8b3,0x3f4f7a1f,0x3f55b993
.long 0x3f54db31,0x3f5b941a,0x3f61c598,0x3f676bd8,0x3f64aa59,0x3f6aab7b,0x3f6ff573,0x3f748422
.long 0x3f710908,0x3f75dec6,0x3f79c79d,0x3f7cbfc9,0x3f79c79d,0x3f7cfe73,0x3f7f0e58,0x3f7ff4e6
.long 0x3f7ec46d,0x3f7fec43,0x3f7fb10f,0x3f7e1324,0x3f7fec43,0x3f7e9bc9,0x3f7baccd,0x3f772417
.long 0x3f7d3aac,0x3f791298,0x3f731447,0x3f6b4b0c,0x3f76ba07,0x3f6f6830,0x3f660f88,0x3f5ac450
.long 0x3f6c835e,0x3f61c598,0x3f54db31,0x3f45e403,0x3f5ebe05,0x3f5064af,0x3f3fc767,0x3f2d1469
.long 0x3f4d9f02,0x3f3b8f3b,0x3f273656,0x3f10d3cd,0x3f396842,0x3f239da9,0x3f0b9a6b,0x3ee363fa
.long 0x3f226799,0x3f08f59b,0x3edae880,0x3ea09ae5,0x3f08f59b,0x3ed8106b,0x3e9aa086,0x3e354098
.long 0x3edae880,0x3e9aa086,0x3e2f10a2,0x3d16c32c,0x3ea09ae5,0x3e354098,0x3d16c32c,0xbdd53db9
.long 0x3e47c5c2,0x3d48fb30,0xbdc8bd36,0xbe78cfcc,0x3d96a905,0xbda3308c,0xbe6c9a7f,0xbec1071e
.long 0xbd48fb30,0xbe541501,0xbeb8442a,0xbf00e7e4,0xbe2f10a2,0xbea986c4,0xbef6e0cb,0xbf1ebc12
.long 0xbe94a031,0xbee63375,0xbf187fc0,0xbf396842,0xbecf7bca,0xbf0f8784,0xbf32c8c9,0xbf5064af
.long 0xbf039c3d,0xbf299415,0xbf49d112,0xbf633c5a,0xbf1d7fd1,0xbf40d0da,0xbf5d2d53,0xbf718f57
.long 0x0,0x0,0x0,0x0,0x3e164083,0x3e1c76de,0x3e22abb6,0x3e28defc
.long 0x3e94a031,0x3e9aa086,0x3ea09ae5,0x3ea68f12,0x3edae880,0x3ee363fa,0x3eebcbbb,0x3ef41f07
.long 0x3f0e39da,0x3f13682a,0x3f187fc0,0x3f1d7fd1,0x3f2beb4a,0x3f31a81d,0x3f373a23,0x3f3ca003
.long 0x3f45e403,0x3f4bbbf8,0x3f514d3d,0x3f5695e5,0x3f5b941a,0x3f6106f2,0x3f660f88,0x3f6aab7b
.long 0x3f6c835e,0x3f710908,0x3f74fa0b,0x3f7853f8,0x3f7853f8,0x3f7b61fc,0x3f7dabcc,0x3f7f2f9d
.long 0x3f7ec46d,0x3f7fd397,0x3f7fec43,0x3f7f0e58,0x3f7fb10f,0x3f7e4323,0x3f7baccd,0x3f77f110
.long 0x3f7b14be,0x3f76ba07,0x3f710908,0x3f6a09a7,0x3f710908,0x3f696591,0x3f604621,0x3f55b993
.long 0x3f61c598,0x3f5695e5,0x3f49d112,0x3f3b8f3b,0x3f4d9f02,0x3f3ebc1b,0x3f2e3bde,0x3f1c420c
.long 0x3f3504f3,0x3f226799,0x3f0e39da,0x3ef15aea,0x3f187fc0,0x3f0242b1,0x3ed53641,0x3ea395c5
.long 0x3ef15aea,0x3ebe1d4a,0x3e888e93,0x3e22abb6,0x3eac7cd4,0x3e667c66,0x3de1bc2e,0xbbc90f88
.long 0x3e47c5c2,0x3d96a905,0xbd48fb30,0xbe2f10a2,0x3d48fb30,0xbda3308c,0xbe541501,0xbea986c4
.long 0xbdc8bd36,0xbe6c9a7f,0xbeb8442a,0xbef6e0cb,0xbe78cfcc,0xbec1071e,0xbf00e7e4,0xbf1ebc12
.long 0xbec3ef15,0xbf039c3d,0xbf226799,0xbf3daef9,0xbf039c3d,0xbf239da9,0xbf3fc767,0xbf577026
.long 0xbf226799,0xbf3fc767,0xbf584853,0xbf6b4b0c,0xbf3daef9,0xbf577026,0xbf6b4b0c,0xbf78b47b
.long 0xbf54db31,0xbf6a09a7,0xbf7853f8,0xbf7f4e6d,0xbf676bd8,0xbf772417,0xbf7f0e58,0xbf7eea9d
.long 0xbf74fa0b,0xbf7e70b0,0xbf7f4e6d,0xbf778bc5,0xbf7d3aac,0xbf7fc38f,0xbf791298,0xbf696591
.long 0x0,0x0,0x0,0x0,0x3e2f10a2,0x3e354098,0x3e3b6ecf,0x3e419b37
.long 0x3eac7cd4,0x3eb263ef,0x3eb8442a,0x3ebe1d4a,0x3efc5d27,0x3f0242b1,0x3f064b82,0x3f0a48ad
.long 0x3f226799,0x3f273656,0x3f2beb4a,0x3f3085bb,0x3f41d870,0x3f46e22a,0x3f4bbbf8,0x3f5064af
.long 0x3f5b941a,0x3f604621,0x3f64aa59,0x3f68bf3c,0x3f6ed89e,0x3f7294f8,0x3f75dec6,0x3f78b47b
.long 0x3f7b14be,0x3f7d3aac,0x3f7ec46d,0x3f7fb10f,0x3f7fec43,0x3f7fe129,0x3f7f0e58,0x3f7d7474
.long 0x3f7d3aac,0x3f7a7302,0x3f76ba07,0x3f721352,0x3f731447,0x3f6d1c1d,0x3f660f88,0x3f5df6be
.long 0x3f61c598,0x3f584853,0x3f4d9f02,0x3f41d870,0x3f49d112,0x3f3ca003,0x3f2e3bde,0x3f1ebc12
.long 0x3f2beb4a,0x3f1b02c6,0x3f08f59b,0x3eebcbbb,0x3f08f59b,0x3ee900b7,0x3ebe1d4a,0x3e919ddd
.long 0x3ec3ef15,0x3e94a031,0x3e47c5c2,0x3dc8bd36,0x3e605c13,0x3dee3876,0x3c490e90,0xbdbc3ac3
.long 0x3d48fb30,0xbd7b2b74,0xbe2f10a2,0xbe8e9a22,0xbdfab273,0xbe72b651,0xbeb263ef,0xbee900b7
.long 0xbe94a031,0xbecf7bca,0xbf039c3d,0xbf1d7fd1,0xbee63375,0xbf0f8784,0xbf299415,0xbf40d0da
.long 0xbf187fc0,0xbf32c8c9,0xbf49d112,0xbf5d2d53,0xbf396842,0xbf5064af,0xbf633c5a,0xbf718f57
.long 0xbf54db31,0xbf676bd8,0xbf74fa0b,0xbf7d3aac,0xbf6a09a7,0xbf772417,0xbf7e70b0,0xbf7fc38f
.long 0xbf7853f8,0xbf7f0e58,0xbf7f4e6d,0xbf791298,0xbf7f4e6d,0xbf7eea9d,0xbf778bc5,0xbf696591
.long 0xbf7ec46d,0xbf76ba07,0xbf676bd8,0xbf514d3d,0xbf76ba07,0xbf66becc,0xbf4f7a1f,0xbf31a81d
.long 0xbf676bd8,0xbf4f7a1f,0xbf3085bb,0xbf0b9a6b,0xbf514d3d,0xbf31a81d,0xbf0b9a6b,0xbec1071e
.long 0x3f803f80,0x3f803f80,0x3f803f80,0x3f803f80,0x3f7b3f80,0x3f553f6d,0xbe48248d,0xbf0ebec4
.long 0x3f6d3f80,0x3ec43f35,0xbf6dbf80,0xbec4bf35,0x3f553f80,0xbe483ec4,0x3f0ea554,0x3f7b3f6d
.long 0x3f353f80,0xbf35248d,0x3f353f80,0xbf35248d,0x3f0e3f80,0xbf7bbec4,0xbf55248d,0xbe48bf6d
.long 0x3ec43f80,0xbf6dbf35,0xbec4bf80,0x3f6d3f35,0x3e483f80,0xbf0ebf6d,0x3f7ba554,0xbf553ec4
.long 0x248d3f80,0xa554bf80,0x248d3f80,0xa554bf80,0xbe483f80,0x3f0ebf6d,0xbf7b248d,0x3f553ec4
.long 0xbec43f80,0x3f6dbf35,0x3ec4bf80,0xbf6d3f35,0xbf0e3f80,0x3f7bbec4,0x3f55a554,0x3e48bf6d
.long 0xbf353f80,0x3f35a554,0xbf353f80,0x3f35a554,0xbf553f80,0x3e483ec4,0xbf0e248d,0xbf7b3f6d
.long 0xbf6d3f80,0xbec43f35,0x3f6dbf80,0x3ec4bf35,0xbf7b3f80,0xbf553f6d,0x3e48a554,0x3f0ebec4
.long 0x80008000,0x80008000,0x80008000,0x80008000,0xbe488000,0xbf0ebec4,0xbf7bbf80,0xbf55bf6d
.long 0xbec48000,0xbf6dbf35,0x3ec4a50d,0x3f6d3f35,0xbf0e8000,0xbf7bbf6d,0x3f553f80,0xbe483ec4
.long 0xbf358000,0xbf35bf80,0xbf358000,0xbf35bf80,0xbf558000,0xbe48bf6d,0xbf0ebf80,0x3f7b3ec4
.long 0xbf6d8000,0x3ec4bf35,0x3f6da50d,0xbec43f35,0xbf7b8000,0x3f55bec4,0x3e483f80,0xbf0ebf6d
.long 0xbf808000,0x3f80a50d,0xbf808000,0x3f80a50d,0xbf7b8000,0x3f553ec4,0x3e48bf80,0xbf0e3f6d
.long 0xbf6d8000,0x3ec43f35,0x3f6da50d,0xbec4bf35,0xbf558000,0xbe483f6d,0xbf0e3f80,0x3f7bbec4
.long 0xbf358000,0xbf353f80,0xbf358000,0xbf353f80,0xbf0e8000,0xbf7b3f6d,0x3f55bf80,0xbe48bec4
.long 0xbec48000,0xbf6d3f35,0x3ec4a50d,0x3f6dbf35,0xbe488000,0xbf0e3ec4,0xbf7b3f80,0xbf553f6d
.long 0x3f803f80,0x3f803f80,0x3f803f80,0x3f803f80,0x3f0e3f35,0x3e483ec4,0xbf55bf35,0xbf7bbf6d
.long 0xbec4248d,0xbf6dbf35,0x3ec4a554,0x3f6d3f35,0xbf7bbf35,0xbf0ebf6d,0x3e483f35,0xbf55bec4
.long 0xbf35bf80,0x3f35a554,0xbf35bf80,0x3f35a554,0x3e48bf35,0x3f553f6d,0x3f7b3f35,0xbf0e3ec4
.long 0x3f6da554,0xbec43f35,0xbf6d248d,0x3ec4bf35,0x3f553f35,0xbf7bbec4,0x3f0ebf35,0xbe483f6d
.long 0x248d3f80,0xa554bf80,0x248d3f80,0xa554bf80,0xbf553f35,0x3f7bbec4,0xbf0ebf35,0x3e483f6d
.long 0xbf6d248d,0x3ec43f35,0x3f6da554,0xbec4bf35,0xbe48bf35,0xbf553f6d,0xbf7b3f35,0x3f0e3ec4
.long 0x3f35bf80,0xbf35248d,0x3f35bf80,0xbf35248d,0x3f7bbf35,0x3f0ebf6d,0xbe483f35,0x3f55bec4
.long 0x3ec4a554,0x3f6dbf35,0xbec4248d,0xbf6d3f35,0xbf0e3f35,0xbe483ec4,0x3f55bf35,0x3f7bbf6d
.long 0x80008000,0x80008000,0x80008000,0x80008000,0xbf55bf35,0xbf7bbf6d,0xbf0ebf35,0xbe48bec4
.long 0xbf6dbf80,0xbec4bf35,0x3f6d3f80,0x3ec43f35,0xbe48bf35,0x3f553ec4,0xbf7bbf35,0xbf0ebf6d
.long 0x3f35a50d,0x3f353f80,0x3f35a50d,0x3f353f80,0x3f7b3f35,0xbf0e3ec4,0xbe483f35,0xbf55bf6d
.long 0x3ec43f80,0xbf6dbf35,0xbec4bf80,0x3f6d3f35,0xbf0e3f35,0x3e48bf6d,0x3f553f35,0xbf7bbec4
.long 0xbf808000,0x3f80a50d,0xbf808000,0x3f80a50d,0xbf0ebf35,0x3e483f6d,0x3f55bf35,0xbf7b3ec4
.long 0x3ec4bf80,0xbf6d3f35,0xbec43f80,0x3f6dbf35,0x3f7bbf35,0xbf0ebec4,0xbe48bf35,0xbf553f6d
.long 0x3f35a50d,0x3f35bf80,0x3f35a50d,0x3f35bf80,0xbe483f35,0x3f55bec4,0xbf7b3f35,0xbf0e3f6d
.long 0xbf6d3f80,0xbec43f35,0x3f6dbf80,0x3ec4bf35,0xbf553f35,0xbf7b3f6d,0xbf0e3f35,0xbe483ec4
.long 0x3f803f80,0x3f803f80,0x3f803f80,0x3f803f80,0xbf7bbf80,0xbf55bf6d,0x3e48a554,0x3f0e3ec4
.long 0x3f6d3f80,0x3ec43f35,0xbf6dbf80,0xbec4bf35,0xbf55bf80,0x3e48bec4,0xbf0e248d,0xbf7bbf6d
.long 0x3f353f80,0xbf35248d,0x3f353f80,0xbf35248d,0xbf0ebf80,0x3f7b3ec4,0x3f55a554,0x3e483f6d
.long 0x3ec43f80,0xbf6dbf35,0xbec4bf80,0x3f6d3f35,0xbe48bf80,0x3f0e3f6d,0xbf7b248d,0x3f55bec4
.long 0x248d3f80,0xa554bf80,0x248d3f80,0xa554bf80,0x3e48bf80,0xbf0e3f6d,0x3f7ba554,0xbf55bec4
.long 0xbec43f80,0x3f6dbf35,0x3ec4bf80,0xbf6d3f35,0x3f0ebf80,0xbf7b3ec4,0xbf55248d,0xbe483f6d
.long 0xbf353f80,0x3f35a554,0xbf353f80,0x3f35a554,0x3f55bf80,0xbe48bec4,0x3f0ea554,0x3f7bbf6d
.long 0xbf6d3f80,0xbec43f35,0x3f6dbf80,0x3ec4bf35,0x3f7bbf80,0x3f55bf6d,0xbe48248d,0xbf0e3ec4
.long 0x80008000,0x80008000,0x80008000,0x80008000,0x3e48a50d,0x3f0e3ec4,0x3f7b3f80,0x3f553f6d
.long 0xbec48000,0xbf6dbf35,0x3ec4a50d,0x3f6d3f35,0x3f0ea50d,0x3f7b3f6d,0xbf55bf80,0x3e48bec4
.long 0xbf358000,0xbf35bf80,0xbf358000,0xbf35bf80,0x3f55a50d,0x3e483f6d,0x3f0e3f80,0xbf7bbec4
.long 0xbf6d8000,0x3ec4bf35,0x3f6da50d,0xbec43f35,0x3f7ba50d,0xbf553ec4,0xbe48bf80,0x3f0e3f6d
.long 0xbf808000,0x3f80a50d,0xbf808000,0x3f80a50d,0x3f7ba50d,0xbf55bec4,0xbe483f80,0x3f0ebf6d
.long 0xbf6d8000,0x3ec43f35,0x3f6da50d,0xbec4bf35,0x3f55a50d,0x3e48bf6d,0x3f0ebf80,0xbf7b3ec4
.long 0xbf358000,0xbf353f80,0xbf358000,0xbf353f80,0x3f0ea50d,0x3f7bbf6d,0xbf553f80,0x3e483ec4
.long 0xbec48000,0xbf6d3f35,0x3ec4a50d,0x3f6dbf35,0x3e48a50d,0x3f0ebec4,0x3f7bbf80,0x3f55bf6d
.long 0x3f803f80,0x3f803f80,0x3f803f80,0x3f803f80,0xbf0ebf35,0xbe48bec4,0x3f553f35,0x3f7b3f6d
.long 0xbec4248d,0xbf6dbf35,0x3ec4a554,0x3f6d3f35,0x3f7b3f35,0x3f0e3f6d,0xbe48bf35,0x3f553ec4
.long 0xbf35bf80,0x3f35a554,0xbf35bf80,0x3f35a554,0xbe483f35,0xbf55bf6d,0xbf7bbf35,0x3f0ebec4
.long 0x3f6da554,0xbec43f35,0xbf6d248d,0x3ec4bf35,0xbf55bf35,0x3f7b3ec4,0xbf0e3f35,0x3e48bf6d
.long 0x248d3f80,0xa554bf80,0x248d3f80,0xa554bf80,0x3f55bf35,0xbf7b3ec4,0x3f0e3f35,0xbe48bf6d
.long 0xbf6d248d,0x3ec43f35,0x3f6da554,0xbec4bf35,0x3e483f35,0x3f55bf6d,0x3f7bbf35,0xbf0ebec4
.long 0x3f35bf80,0xbf35248d,0x3f35bf80,0xbf35248d,0xbf7b3f35,0xbf0e3f6d,0x3e48bf35,0xbf553ec4
.long 0x3ec4a554,0x3f6dbf35,0xbec4248d,0xbf6d3f35,0x3f0ebf35,0x3e48bec4,0xbf553f35,0xbf7b3f6d
.long 0x80008000,0x80008000,0x80008000,0x80008000,0x3f553f35,0x3f7b3f6d,0x3f0e3f35,0x3e483ec4
.long 0xbf6dbf80,0xbec4bf35,0x3f6d3f80,0x3ec43f35,0x3e483f35,0xbf55bec4,0x3f7b3f35,0x3f0e3f6d
.long 0x3f35a50d,0x3f353f80,0x3f35a50d,0x3f353f80,0xbf7bbf35,0x3f0ebec4,0x3e48bf35,0x3f553f6d
.long 0x3ec43f80,0xbf6dbf35,0xbec4bf80,0x3f6d3f35,0x3f0ebf35,0xbe483f6d,0xbf55bf35,0x3f7b3ec4
.long 0xbf808000,0x3f80a50d,0xbf808000,0x3f80a50d,0x3f0e3f35,0xbe48bf6d,0xbf553f35,0x3f7bbec4
.long 0x3ec4bf80,0xbf6d3f35,0xbec43f80,0x3f6dbf35,0xbf7b3f35,0x3f0e3ec4,0x3e483f35,0x3f55bf6d
.long 0x3f35a50d,0x3f35bf80,0x3f35a50d,0x3f35bf80,0x3e48bf35,0xbf553ec4,0x3f7bbf35,0x3f0ebf6d
.long 0xbf6d3f80,0xbec43f35,0x3f6dbf80,0x3ec4bf35,0x3f55bf35,0x3f7bbf6d,0x3f0ebf35,0x3e48bec4
.long 0x0,0x0,0x0,0x0,0x3e480000,0x3f0e3ec4,0x3f7b3f80,0x3f553f6d
.long 0x3ec40000,0x3f6d3f35,0xbec4250d,0xbf6dbf35,0x3f0e0000,0x3f7b3f6d,0xbf55bf80,0x3e48bec4
.long 0x3f350000,0x3f353f80,0x3f350000,0x3f353f80,0x3f550000,0x3e483f6d,0x3f0e3f80,0xbf7bbec4
.long 0x3f6d0000,0xbec43f35,0xbf6d250d,0x3ec4bf35,0x3f7b0000,0xbf553ec4,0xbe48bf80,0x3f0e3f6d
.long 0x3f800000,0xbf80250d,0x3f800000,0xbf80250d,0x3f7b0000,0xbf55bec4,0xbe483f80,0x3f0ebf6d
.long 0x3f6d0000,0xbec4bf35,0xbf6d250d,0x3ec43f35,0x3f550000,0x3e48bf6d,0x3f0ebf80,0xbf7b3ec4
.long 0x3f350000,0x3f35bf80,0x3f350000,0x3f35bf80,0x3f0e0000,0x3f7bbf6d,0xbf553f80,0x3e483ec4
.long 0x3ec40000,0x3f6dbf35,0xbec4250d,0xbf6d3f35,0x3e480000,0x3f0ebec4,0x3f7bbf80,0x3f55bf6d
.long 0x3f803f80,0x3f803f80,0x3f803f80,0x3f803f80,0x3f7b3f80,0x3f553f6d,0xbe48248d,0xbf0ebec4
.long 0x3f6d3f80,0x3ec43f35,0xbf6dbf80,0xbec4bf35,0x3f553f80,0xbe483ec4,0x3f0ea554,0x3f7b3f6d
.long 0x3f353f80,0xbf35248d,0x3f353f80,0xbf35248d,0x3f0e3f80,0xbf7bbec4,0xbf55248d,0xbe48bf6d
.long 0x3ec43f80,0xbf6dbf35,0xbec4bf80,0x3f6d3f35,0x3e483f80,0xbf0ebf6d,0x3f7ba554,0xbf553ec4
.long 0x248d3f80,0xa554bf80,0x248d3f80,0xa554bf80,0xbe483f80,0x3f0ebf6d,0xbf7b248d,0x3f553ec4
.long 0xbec43f80,0x3f6dbf35,0x3ec4bf80,0xbf6d3f35,0xbf0e3f80,0x3f7bbec4,0x3f55a554,0x3e48bf6d
.long 0xbf353f80,0x3f35a554,0xbf353f80,0x3f35a554,0xbf553f80,0x3e483ec4,0xbf0e248d,0xbf7b3f6d
.long 0xbf6d3f80,0xbec43f35,0x3f6dbf80,0x3ec4bf35,0xbf7b3f80,0xbf553f6d,0x3e48a554,0x3f0ebec4
.long 0x0,0x0,0x0,0x0,0x3f553f35,0x3f7b3f6d,0x3f0e3f35,0x3e483ec4
.long 0x3f6d3f80,0x3ec43f35,0xbf6dbf80,0xbec4bf35,0x3e483f35,0xbf55bec4,0x3f7b3f35,0x3f0e3f6d
.long 0xbf35250d,0xbf35bf80,0xbf35250d,0xbf35bf80,0xbf7bbf35,0x3f0ebec4,0x3e48bf35,0x3f553f6d
.long 0xbec4bf80,0x3f6d3f35,0x3ec43f80,0xbf6dbf35,0x3f0ebf35,0xbe483f6d,0xbf55bf35,0x3f7b3ec4
.long 0x3f800000,0xbf80250d,0x3f800000,0xbf80250d,0x3f0e3f35,0xbe48bf6d,0xbf553f35,0x3f7bbec4
.long 0xbec43f80,0x3f6dbf35,0x3ec4bf80,0xbf6d3f35,0xbf7b3f35,0x3f0e3ec4,0x3e483f35,0x3f55bf6d
.long 0xbf35250d,0xbf353f80,0xbf35250d,0xbf353f80,0x3e48bf35,0xbf553ec4,0x3f7bbf35,0x3f0ebf6d
.long 0x3f6dbf80,0x3ec4bf35,0xbf6d3f80,0xbec43f35,0x3f55bf35,0x3f7bbf6d,0x3f0ebf35,0x3e48bec4
.long 0x3f803f80,0x3f803f80,0x3f803f80,0x3f803f80,0x3f0e3f35,0x3e483ec4,0xbf55bf35,0xbf7bbf6d
.long 0xbec4248d,0xbf6dbf35,0x3ec4a554,0x3f6d3f35,0xbf7bbf35,0xbf0ebf6d,0x3e483f35,0xbf55bec4
.long 0xbf35bf80,0x3f35a554,0xbf35bf80,0x3f35a554,0x3e48bf35,0x3f553f6d,0x3f7b3f35,0xbf0e3ec4
.long 0x3f6da554,0xbec43f35,0xbf6d248d,0x3ec4bf35,0x3f553f35,0xbf7bbec4,0x3f0ebf35,0xbe483f6d
.long 0x248d3f80,0xa554bf80,0x248d3f80,0xa554bf80,0xbf553f35,0x3f7bbec4,0xbf0ebf35,0x3e483f6d
.long 0xbf6d248d,0x3ec43f35,0x3f6da554,0xbec4bf35,0xbe48bf35,0xbf553f6d,0xbf7b3f35,0x3f0e3ec4
.long 0x3f35bf80,0xbf35248d,0x3f35bf80,0xbf35248d,0x3f7bbf35,0x3f0ebf6d,0xbe483f35,0x3f55bec4
.long 0x3ec4a554,0x3f6dbf35,0xbec4248d,0xbf6d3f35,0xbf0e3f35,0xbe483ec4,0x3f55bf35,0x3f7bbf6d
.long 0x0,0x0,0x0,0x0,0xbe48250d,0xbf0ebec4,0xbf7bbf80,0xbf55bf6d
.long 0x3ec40000,0x3f6d3f35,0xbec4250d,0xbf6dbf35,0xbf0e250d,0xbf7bbf6d,0x3f553f80,0xbe483ec4
.long 0x3f350000,0x3f353f80,0x3f350000,0x3f353f80,0xbf55250d,0xbe48bf6d,0xbf0ebf80,0x3f7b3ec4
.long 0x3f6d0000,0xbec43f35,0xbf6d250d,0x3ec4bf35,0xbf7b250d,0x3f55bec4,0x3e483f80,0xbf0ebf6d
.long 0x3f800000,0xbf80250d,0x3f800000,0xbf80250d,0xbf7b250d,0x3f553ec4,0x3e48bf80,0xbf0e3f6d
.long 0x3f6d0000,0xbec4bf35,0xbf6d250d,0x3ec43f35,0xbf55250d,0xbe483f6d,0xbf0e3f80,0x3f7bbec4
.long 0x3f350000,0x3f35bf80,0x3f350000,0x3f35bf80,0xbf0e250d,0xbf7b3f6d,0x3f55bf80,0xbe48bec4
.long 0x3ec40000,0x3f6dbf35,0xbec4250d,0xbf6d3f35,0xbe48250d,0xbf0e3ec4,0xbf7b3f80,0xbf553f6d
.long 0x3f803f80,0x3f803f80,0x3f803f80,0x3f803f80,0xbf7bbf80,0xbf55bf6d,0x3e48a554,0x3f0e3ec4
.long 0x3f6d3f80,0x3ec43f35,0xbf6dbf80,0xbec4bf35,0xbf55bf80,0x3e48bec4,0xbf0e248d,0xbf7bbf6d
.long 0x3f353f80,0xbf35248d,0x3f353f80,0xbf35248d,0xbf0ebf80,0x3f7b3ec4,0x3f55a554,0x3e483f6d
.long 0x3ec43f80,0xbf6dbf35,0xbec4bf80,0x3f6d3f35,0xbe48bf80,0x3f0e3f6d,0xbf7b248d,0x3f55bec4
.long 0x248d3f80,0xa554bf80,0x248d3f80,0xa554bf80,0x3e48bf80,0xbf0e3f6d,0x3f7ba554,0xbf55bec4
.long 0xbec43f80,0x3f6dbf35,0x3ec4bf80,0xbf6d3f35,0x3f0ebf80,0xbf7b3ec4,0xbf55248d,0xbe483f6d
.long 0xbf353f80,0x3f35a554,0xbf353f80,0x3f35a554,0x3f55bf80,0xbe48bec4,0x3f0ea554,0x3f7bbf6d
.long 0xbf6d3f80,0xbec43f35,0x3f6dbf80,0x3ec4bf35,0x3f7bbf80,0x3f55bf6d,0xbe48248d,0xbf0e3ec4
.long 0x0,0x0,0x0,0x0,0xbf55bf35,0xbf7bbf6d,0xbf0ebf35,0xbe48bec4
.long 0x3f6d3f80,0x3ec43f35,0xbf6dbf80,0xbec4bf35,0xbe48bf35,0x3f553ec4,0xbf7bbf35,0xbf0ebf6d
.long 0xbf35250d,0xbf35bf80,0xbf35250d,0xbf35bf80,0x3f7b3f35,0xbf0e3ec4,0xbe483f35,0xbf55bf6d
.long 0xbec4bf80,0x3f6d3f35,0x3ec43f80,0xbf6dbf35,0xbf0e3f35,0x3e48bf6d,0x3f553f35,0xbf7bbec4
.long 0x3f800000,0xbf80250d,0x3f800000,0xbf80250d,0xbf0ebf35,0x3e483f6d,0x3f55bf35,0xbf7b3ec4
.long 0xbec43f80,0x3f6dbf35,0x3ec4bf80,0xbf6d3f35,0x3f7bbf35,0xbf0ebec4,0xbe48bf35,0xbf553f6d
.long 0xbf35250d,0xbf353f80,0xbf35250d,0xbf353f80,0xbe483f35,0x3f55bec4,0xbf7b3f35,0xbf0e3f6d
.long 0x3f6dbf80,0x3ec4bf35,0xbf6d3f80,0xbec43f35,0xbf553f35,0xbf7b3f6d,0xbf0e3f35,0xbe483ec4
.long 0x3f803f80,0x3f803f80,0x3f803f80,0x3f803f80,0xbf0ebf35,0xbe48bec4,0x3f553f35,0x3f7b3f6d
.long 0xbec4248d,0xbf6dbf35,0x3ec4a554,0x3f6d3f35,0x3f7b3f35,0x3f0e3f6d,0xbe48bf35,0x3f553ec4
.long 0xbf35bf80,0x3f35a554,0xbf35bf80,0x3f35a554,0xbe483f35,0xbf55bf6d,0xbf7bbf35,0x3f0ebec4
.long 0x3f6da554,0xbec43f35,0xbf6d248d,0x3ec4bf35,0xbf55bf35,0x3f7b3ec4,0xbf0e3f35,0x3e48bf6d
.long 0x248d3f80,0xa554bf80,0x248d3f80,0xa554bf80,0x3f55bf35,0xbf7b3ec4,0x3f0e3f35,0xbe48bf6d
.long 0xbf6d248d,0x3ec43f35,0x3f6da554,0xbec4bf35,0x3e483f35,0x3f55bf6d,0x3f7bbf35,0xbf0ebec4
.long 0x3f35bf80,0xbf35248d,0x3f35bf80,0xbf35248d,0xbf7b3f35,0xbf0e3f6d,0x3e48bf35,0xbf553ec4
.long 0x3ec4a554,0x3f6dbf35,0xbec4248d,0xbf6d3f35,0x3f0ebf35,0x3e48bec4,0xbf553f35,0xbf7b3f6d
.long 0x3f80,0x3f80,0x3f80,0x3f80,0x3f80,0x3ec43f6d,0x3f353f35,0x3f6d3ec4
.long 0x3f80,0x3f353f35,0x3f80248d,0x3f35bf35,0x3f80,0x3f6d3ec4,0x3f35bf35,0xbec4bf6d
.long 0x3f80,0x3f80248d,0x250dbf80,0xbf80a554,0x3f80,0x3f6dbec4,0xbf35bf35,0xbec43f6d
.long 0x3f80,0x3f35bf35,0xbf80a554,0x3f353f35,0x3f80,0x3ec4bf6d,0xbf353f35,0x3f6dbec4
.long 0x3f80,0x250dbf80,0x3f80,0x250dbf80,0x3f80,0xbec4bf6d,0x3f353f35,0xbf6dbec4
.long 0x3f80,0xbf35bf35,0x3f80248d,0xbf353f35,0x3f80,0xbf6dbec4,0x3f35bf35,0x3ec43f6d
.long 0x3f80,0xbf80a554,0x250dbf80,0x3f80248d,0x3f80,0xbf6d3ec4,0xbf35bf35,0x3ec4bf6d
.long 0x3f80,0xbf353f35,0xbf80a554,0xbf35bf35,0x3f80,0xbec43f6d,0xbf353f35,0xbf6d3ec4
.long 0x3f808000,0x3f808000,0x3f808000,0x3f808000,0x3f808000,0x3f6dbec4,0x3f35bf35,0x3ec4bf6d
.long 0x3f808000,0x3f35bf35,0x248dbf80,0xbf35bf35,0x3f808000,0x3ec4bf6d,0xbf35bf35,0xbf6d3ec4
.long 0x3f808000,0x248dbf80,0xbf80a50d,0xa5543f80,0x3f808000,0xbec4bf6d,0xbf353f35,0x3f6d3ec4
.long 0x3f808000,0xbf35bf35,0xa5543f80,0x3f35bf35,0x3f808000,0xbf6dbec4,0x3f353f35,0xbec4bf6d
.long 0x3f808000,0xbf80a50d,0x3f808000,0xbf80a50d,0x3f808000,0xbf6d3ec4,0x3f35bf35,0xbec43f6d
.long 0x3f808000,0xbf353f35,0x248dbf80,0x3f353f35,0x3f808000,0xbec43f6d,0xbf35bf35,0x3f6dbec4
.long 0x3f808000,0xa5543f80,0xbf80a50d,0x248dbf80,0x3f808000,0x3ec43f6d,0xbf353f35,0xbf6dbec4
.long 0x3f808000,0x3f353f35,0xa5543f80,0xbf353f35,0x3f808000,0x3f6d3ec4,0x3f353f35,0x3ec43f6d
.long 0x3f80,0x3f80,0x3f80,0x3f80,0x3f80248d,0x3f6dbec4,0x3f35bf35,0x3ec4bf6d
.long 0x250dbf80,0xbf35bf35,0xbf80a554,0xbf353f35,0xbf80a554,0xbec43f6d,0x3f353f35,0x3f6dbec4
.long 0x3f80,0x3f80248d,0x250dbf80,0xbf80a554,0x3f80248d,0xbec4bf6d,0xbf353f35,0x3f6d3ec4
.long 0x250dbf80,0xbf353f35,0x3f80248d,0xbf35bf35,0xbf80a554,0x3f6d3ec4,0xbf35bf35,0x3ec43f6d
.long 0x3f80,0x250dbf80,0x3f80,0x250dbf80,0x3f80248d,0xbf6d3ec4,0x3f35bf35,0xbec43f6d
.long 0x250dbf80,0x3f353f35,0xbf80a554,0x3f35bf35,0xbf80a554,0x3ec4bf6d,0x3f353f35,0xbf6d3ec4
.long 0x3f80,0xbf80a554,0x250dbf80,0x3f80248d,0x3f80248d,0x3ec43f6d,0xbf353f35,0xbf6dbec4
.long 0x250dbf80,0x3f35bf35,0x3f80248d,0x3f353f35,0xbf80a554,0xbf6dbec4,0xbf35bf35,0xbec4bf6d
.long 0x3f808000,0x3f808000,0x3f808000,0x3f808000,0x248dbf80,0xbec4bf6d,0xbf35bf35,0xbf6dbec4
.long 0xbf80a50d,0xbf353f35,0xa5543f80,0x3f353f35,0xa5543f80,0x3f6d3ec4,0x3f35bf35,0xbec4bf6d
.long 0x3f808000,0x248dbf80,0xbf80a50d,0xa5543f80,0x248dbf80,0xbf6d3ec4,0x3f353f35,0x3ec4bf6d
.long 0xbf80a50d,0x3f353f35,0x248dbf80,0xbf353f35,0xa5543f80,0x3ec4bf6d,0xbf353f35,0x3f6dbec4
.long 0x3f808000,0xbf80a50d,0x3f808000,0xbf80a50d,0x248dbf80,0x3ec43f6d,0xbf35bf35,0x3f6d3ec4
.long 0xbf80a50d,0x3f35bf35,0xa5543f80,0xbf35bf35,0xa5543f80,0xbf6dbec4,0x3f35bf35,0x3ec43f6d
.long 0x3f808000,0xa5543f80,0xbf80a50d,0x248dbf80,0x248dbf80,0x3f6dbec4,0x3f353f35,0xbec43f6d
.long 0xbf80a50d,0xbf35bf35,0x248dbf80,0x3f35bf35,0xa5543f80,0xbec43f6d,0xbf353f35,0xbf6d3ec4
.long 0x3f80,0x3f80,0x3f80,0x3f80,0x250dbf80,0xbec4bf6d,0xbf35bf35,0xbf6dbec4
.long 0x3f80,0x3f353f35,0x3f80248d,0x3f35bf35,0x250dbf80,0xbf6dbec4,0xbf353f35,0x3ec43f6d
.long 0x3f80,0x3f80248d,0x250dbf80,0xbf80a554,0x250dbf80,0xbf6d3ec4,0x3f353f35,0x3ec4bf6d
.long 0x3f80,0x3f35bf35,0xbf80a554,0x3f353f35,0x250dbf80,0xbec43f6d,0x3f35bf35,0xbf6d3ec4
.long 0x3f80,0x250dbf80,0x3f80,0x250dbf80,0x250dbf80,0x3ec43f6d,0xbf35bf35,0x3f6d3ec4
.long 0x3f80,0xbf35bf35,0x3f80248d,0xbf353f35,0x250dbf80,0x3f6d3ec4,0xbf353f35,0xbec4bf6d
.long 0x3f80,0xbf80a554,0x250dbf80,0x3f80248d,0x250dbf80,0x3f6dbec4,0x3f353f35,0xbec43f6d
.long 0x3f80,0xbf353f35,0xbf80a554,0xbf35bf35,0x250dbf80,0x3ec4bf6d,0x3f35bf35,0x3f6dbec4
.long 0x3f808000,0x3f808000,0x3f808000,0x3f808000,0xbf80a50d,0xbf6d3ec4,0xbf353f35,0xbec43f6d
.long 0x3f808000,0x3f35bf35,0x248dbf80,0xbf35bf35,0xbf80a50d,0xbec43f6d,0x3f353f35,0x3f6dbec4
.long 0x3f808000,0x248dbf80,0xbf80a50d,0xa5543f80,0xbf80a50d,0x3ec43f6d,0x3f35bf35,0xbf6dbec4
.long 0x3f808000,0xbf35bf35,0xa5543f80,0x3f35bf35,0xbf80a50d,0x3f6d3ec4,0xbf35bf35,0x3ec43f6d
.long 0x3f808000,0xbf80a50d,0x3f808000,0xbf80a50d,0xbf80a50d,0x3f6dbec4,0xbf353f35,0x3ec4bf6d
.long 0x3f808000,0xbf353f35,0x248dbf80,0x3f353f35,0xbf80a50d,0x3ec4bf6d,0x3f353f35,0xbf6d3ec4
.long 0x3f808000,0xa5543f80,0xbf80a50d,0x248dbf80,0xbf80a50d,0xbec4bf6d,0x3f35bf35,0x3f6d3ec4
.long 0x3f808000,0x3f353f35,0xa5543f80,0xbf353f35,0xbf80a50d,0xbf6dbec4,0xbf35bf35,0xbec4bf6d
.long 0x3f80,0x3f80,0x3f80,0x3f80,0xbf80a554,0xbf6d3ec4,0xbf353f35,0xbec43f6d
.long 0x250dbf80,0xbf35bf35,0xbf80a554,0xbf353f35,0x3f80248d,0x3ec4bf6d,0xbf35bf35,0xbf6d3ec4
.long 0x3f80,0x3f80248d,0x250dbf80,0xbf80a554,0xbf80a554,0x3ec43f6d,0x3f35bf35,0xbf6dbec4
.long 0x250dbf80,0xbf353f35,0x3f80248d,0xbf35bf35,0x3f80248d,0xbf6dbec4,0x3f353f35,0xbec4bf6d
.long 0x3f80,0x250dbf80,0x3f80,0x250dbf80,0xbf80a554,0x3f6dbec4,0xbf353f35,0x3ec4bf6d
.long 0x250dbf80,0x3f353f35,0xbf80a554,0x3f35bf35,0x3f80248d,0xbec43f6d,0xbf35bf35,0x3f6dbec4
.long 0x3f80,0xbf80a554,0x250dbf80,0x3f80248d,0xbf80a554,0xbec4bf6d,0x3f35bf35,0x3f6d3ec4
.long 0x250dbf80,0x3f35bf35,0x3f80248d,0x3f353f35,0x3f80248d,0x3f6d3ec4,0x3f353f35,0x3ec43f6d
.long 0x3f808000,0x3f808000,0x3f808000,0x3f808000,0xa5543f80,0x3ec43f6d,0x3f353f35,0x3f6d3ec4
.long 0xbf80a50d,0xbf353f35,0xa5543f80,0x3f353f35,0x248dbf80,0xbf6dbec4,0xbf353f35,0x3ec43f6d
.long 0x3f808000,0x248dbf80,0xbf80a50d,0xa5543f80,0xa5543f80,0x3f6dbec4,0xbf35bf35,0xbec43f6d
.long 0xbf80a50d,0x3f353f35,0x248dbf80,0xbf353f35,0x248dbf80,0xbec43f6d,0x3f35bf35,0xbf6d3ec4
.long 0x3f808000,0xbf80a50d,0x3f808000,0xbf80a50d,0xa5543f80,0xbec4bf6d,0x3f353f35,0xbf6dbec4
.long 0xbf80a50d,0x3f35bf35,0xa5543f80,0xbf35bf35,0x248dbf80,0x3f6d3ec4,0xbf353f35,0xbec4bf6d
.long 0x3f808000,0xa5543f80,0xbf80a50d,0x248dbf80,0xa5543f80,0xbf6d3ec4,0xbf35bf35,0x3ec4bf6d
.long 0xbf80a50d,0xbf35bf35,0x248dbf80,0x3f35bf35,0x248dbf80,0x3ec4bf6d,0x3f35bf35,0x3f6dbec4
.size tab1, 20480
.p2align 8
.type tab2,@object
tab2:
.long 0x3f80,0x3f80,0x3f80,0x3f80,0x3f80,0x3dc93f7f,0x3e483f7b,0x3e953f75
.long 0x3f80,0x3e483f7b,0x3ec43f6d,0x3f0e3f55,0x3f80,0x3e953f75,0x3f0e3f55,0x3f463f22
.long 0x3f80,0x3ec43f6d,0x3f353f35,0x3f6d3ec4,0x3f80,0x3ef13f62,0x3f553f0e,0x3f7f3dc9
.long 0x3f80,0x3f0e3f55,0x3f6d3ec4,0x3f7bbe48,0x3f80,0x3f223f46,0x3f7b3e48,0x3f62bef1
.long 0x3f80,0x3f353f35,0x3f80248d,0x3f35bf35,0x3f80,0x3f463f22,0x3f7bbe48,0x3ef1bf62
.long 0x3f80,0x3f553f0e,0x3f6dbec4,0x3e48bf7b,0x3f80,0x3f623ef1,0x3f55bf0e,0xbdc9bf7f
.long 0x3f80,0x3f6d3ec4,0x3f35bf35,0xbec4bf6d,0x3f80,0x3f753e95,0x3f0ebf55,0xbf22bf46
.long 0x3f80,0x3f7b3e48,0x3ec4bf6d,0xbf55bf0e,0x3f80,0x3f7f3dc9,0x3e48bf7b,0xbf75be95
.long 0x3f80,0x3f80,0x3f80,0x3f80,0x3ec43f6d,0x3ef13f62,0x3f0e3f55,0x3f223f46
.long 0x3f353f35,0x3f553f0e,0x3f6d3ec4,0x3f7b3e48,0x3f6d3ec4,0x3f7f3dc9,0x3f7bbe48,0x3f62bef1
.long 0x3f80248d,0x3f6dbec4,0x3f35bf35,0x3ec4bf6d,0x3f6dbec4,0x3f22bf46,0x3e48bf7b,0xbe95bf75
.long 0x3f35bf35,0x3e48bf7b,0xbec4bf6d,0xbf55bf0e,0x3ec4bf6d,0xbe95bf75,0xbf55bf0e,0xbf7f3dc9
.long 0x250dbf80,0xbf35bf35,0xbf80a554,0xbf353f35,0xbec4bf6d,0xbf75be95,0xbf553f0e,0xbdc93f7f
.long 0xbf35bf35,0xbf7b3e48,0xbec43f6d,0x3f0e3f55,0xbf6dbec4,0xbf463f22,0x3e483f7b,0x3f753e95
.long 0xbf80a554,0xbec43f6d,0x3f353f35,0x3f6dbec4,0xbf6d3ec4,0x3dc93f7f,0x3f7b3e48,0x3ef1bf62
.long 0xbf353f35,0x3f0e3f55,0x3f6dbec4,0xbe48bf7b,0xbec43f6d,0x3f623ef1,0x3f0ebf55,0xbf46bf22
.long 0x3f80,0x3f80,0x3f80,0x3f80,0x3f353f35,0x3f463f22,0x3f553f0e,0x3f623ef1
.long 0x3f80248d,0x3f7bbe48,0x3f6dbec4,0x3f55bf0e,0x3f35bf35,0x3ef1bf62,0x3e48bf7b,0xbdc9bf7f
.long 0x250dbf80,0xbec4bf6d,0xbf35bf35,0xbf6dbec4,0xbf35bf35,0xbf75be95,0xbf7b3e48,0xbf463f22
.long 0xbf80a554,0xbf553f0e,0xbec43f6d,0x3e483f7b,0xbf353f35,0xbdc93f7f,0x3f0e3f55,0x3f753e95
.long 0x3f80,0x3f353f35,0x3f80248d,0x3f35bf35,0x3f353f35,0x3f7fbdc9,0x3f0ebf55,0xbe95bf75
.long 0x3f80248d,0x3f0ebf55,0xbec4bf6d,0xbf7bbe48,0x3f35bf35,0xbe95bf75,0xbf7bbe48,0xbf223f46
.long 0x250dbf80,0xbf6dbec4,0xbf353f35,0x3ec43f6d,0xbf35bf35,0xbf623ef1,0x3e483f7b,0x3f7f3dc9
.long 0xbf80a554,0xbe483f7b,0x3f6d3ec4,0x3f0ebf55,0xbf353f35,0x3f223f46,0x3f55bf0e,0xbef1bf62
.long 0x3f80,0x3f80,0x3f80,0x3f80,0x3f6d3ec4,0x3f753e95,0x3f7b3e48,0x3f7f3dc9
.long 0x3f35bf35,0x3f0ebf55,0x3ec4bf6d,0x3e48bf7b,0xbec4bf6d,0xbf22bf46,0xbf55bf0e,0xbf75be95
.long 0xbf80a554,0xbf6d3ec4,0xbf353f35,0xbec43f6d,0xbec43f6d,0x3dc93f7f,0x3f0e3f55,0x3f623ef1
.long 0x3f353f35,0x3f7b3e48,0x3f6dbec4,0x3f0ebf55,0x3f6dbec4,0x3ef1bf62,0xbe48bf7b,0xbf46bf22
.long 0x250dbf80,0xbf35bf35,0xbf80a554,0xbf353f35,0xbf6dbec4,0xbf623ef1,0xbe483f7b,0x3f223f46
.long 0xbf353f35,0x3e483f7b,0x3f6d3ec4,0x3f55bf0e,0x3ec43f6d,0x3f7f3dc9,0x3f0ebf55,0xbef1bf62
.long 0x3f80248d,0x3ec4bf6d,0xbf35bf35,0xbf6d3ec4,0x3ec4bf6d,0xbf46bf22,0xbf553f0e,0x3e953f75
.long 0xbf35bf35,0xbf553f0e,0x3ec43f6d,0x3f7bbe48,0xbf6d3ec4,0x3e953f75,0x3f7bbe48,0xbdc9bf7f
.long 0x3f80,0x3f80,0x3f80,0x3f80,0x3f80248d,0x3f7fbdc9,0x3f7bbe48,0x3f75be95
.long 0x250dbf80,0xbe48bf7b,0xbec4bf6d,0xbf0ebf55,0xbf80a554,0xbf753e95,0xbf553f0e,0xbf223f46
.long 0x3f80,0x3ec43f6d,0x3f353f35,0x3f6d3ec4,0x3f80248d,0x3f62bef1,0x3f0ebf55,0x3dc9bf7f
.long 0x250dbf80,0xbf0ebf55,0xbf6dbec4,0xbf7b3e48,0xbf80a554,0xbf463f22,0xbe483f7b,0x3ef13f62
.long 0x3f80,0x3f353f35,0x3f80248d,0x3f35bf35,0x3f80248d,0x3f22bf46,0xbe48bf7b,0xbf62bef1
.long 0x250dbf80,0xbf55bf0e,0xbf6d3ec4,0xbe483f7b,0xbf80a554,0xbef13f62,0x3f0e3f55,0x3f7fbdc9
.long 0x3f80,0x3f6d3ec4,0x3f35bf35,0xbec4bf6d,0x3f80248d,0x3e95bf75,0xbf55bf0e,0xbf463f22
.long 0x250dbf80,0xbf7bbe48,0xbec43f6d,0x3f553f0e,0xbf80a554,0xbdc93f7f,0x3f7b3e48,0x3e95bf75
.long 0x3f80,0x3f80,0x3f80,0x3f80,0x3f6dbec4,0x3f62bef1,0x3f55bf0e,0x3f46bf22
.long 0xbf35bf35,0xbf55bf0e,0xbf6dbec4,0xbf7bbe48,0xbec43f6d,0xbdc93f7f,0x3e483f7b,0x3ef13f62
.long 0x3f80248d,0x3f6dbec4,0x3f35bf35,0x3ec4bf6d,0xbec4bf6d,0xbf46bf22,0xbf7bbe48,0xbf753e95
.long 0xbf353f35,0xbe483f7b,0x3ec43f6d,0x3f553f0e,0x3f6d3ec4,0x3f75be95,0x3f0ebf55,0xbdc9bf7f
.long 0x250dbf80,0xbf35bf35,0xbf80a554,0xbf353f35,0xbf6d3ec4,0xbe953f75,0x3f0e3f55,0x3f7f3dc9
.long 0x3f353f35,0x3f7bbe48,0x3ec4bf6d,0xbf0ebf55,0x3ec4bf6d,0xbf22bf46,0xbf7b3e48,0xbe953f75
.long 0xbf80a554,0xbec43f6d,0x3f353f35,0x3f6dbec4,0x3ec43f6d,0x3f7fbdc9,0x3e48bf7b,0xbf62bef1
.long 0x3f35bf35,0xbf0ebf55,0xbf6d3ec4,0x3e483f7b,0xbf6dbec4,0xbef13f62,0x3f553f0e,0x3f22bf46
.long 0x3f80,0x3f80,0x3f80,0x3f80,0x3f35bf35,0x3f22bf46,0x3f0ebf55,0x3ef1bf62
.long 0xbf80a554,0xbf7b3e48,0xbf6d3ec4,0xbf553f0e,0x3f353f35,0x3f623ef1,0x3f7b3e48,0x3f7fbdc9
.long 0x250dbf80,0xbec4bf6d,0xbf35bf35,0xbf6dbec4,0xbf353f35,0xbe953f75,0x3e483f7b,0x3f223f46
.long 0x3f80248d,0x3f55bf0e,0x3ec4bf6d,0xbe48bf7b,0xbf35bf35,0xbf7fbdc9,0xbf553f0e,0xbe953f75
.long 0x3f80,0x3f353f35,0x3f80248d,0x3f35bf35,0x3f35bf35,0xbdc9bf7f,0xbf55bf0e,0xbf753e95
.long 0xbf80a554,0xbf0e3f55,0x3ec43f6d,0x3f7b3e48,0x3f353f35,0x3f75be95,0x3e48bf7b,0xbf46bf22
.long 0x250dbf80,0xbf6dbec4,0xbf353f35,0x3ec43f6d,0xbf353f35,0x3ef13f62,0x3f7bbe48,0x3dc9bf7f
.long 0x3f80248d,0x3e48bf7b,0xbf6dbec4,0xbf0e3f55,0xbf35bf35,0xbf463f22,0x3f0e3f55,0x3f62bef1
.long 0x3f80,0x3f80,0x3f80,0x3f80,0x3ec4bf6d,0x3e95bf75,0x3e48bf7b,0x3dc9bf7f
.long 0xbf353f35,0xbf0e3f55,0xbec43f6d,0xbe483f7b,0x3f6dbec4,0x3f46bf22,0x3f0ebf55,0x3e95bf75
.long 0xbf80a554,0xbf6d3ec4,0xbf353f35,0xbec43f6d,0x3f6d3ec4,0x3f7fbdc9,0x3f55bf0e,0x3ef1bf62
.long 0xbf35bf35,0xbf7bbe48,0xbf6d3ec4,0xbf0e3f55,0x3ec43f6d,0x3f623ef1,0x3f7bbe48,0x3f22bf46
.long 0x250dbf80,0xbf35bf35,0xbf80a554,0xbf353f35,0xbec43f6d,0x3ef13f62,0x3f7b3e48,0x3f46bf22
.long 0x3f35bf35,0xbe48bf7b,0xbf6dbec4,0xbf553f0e,0xbf6d3ec4,0xbdc93f7f,0x3f553f0e,0x3f62bef1
.long 0x3f80248d,0x3ec4bf6d,0xbf35bf35,0xbf6d3ec4,0xbf6dbec4,0xbf223f46,0x3f0e3f55,0x3f75be95
.long 0x3f353f35,0x3f55bf0e,0xbec4bf6d,0xbf7b3e48,0xbec4bf6d,0xbf753e95,0x3e483f7b,0x3f7fbdc9
.long 0x3f80,0x3f80,0x3f80,0x3f80,0x250dbf80,0xbdc9bf7f,0xbe48bf7b,0xbe95bf75
.long 0x3f80,0x3e483f7b,0x3ec43f6d,0x3f0e3f55,0x250dbf80,0xbe95bf75,0xbf0ebf55,0xbf46bf22
.long 0x3f80,0x3ec43f6d,0x3f353f35,0x3f6d3ec4,0x250dbf80,0xbef1bf62,0xbf55bf0e,0xbf7fbdc9
.long 0x3f80,0x3f0e3f55,0x3f6d3ec4,0x3f7bbe48,0x250dbf80,0xbf22bf46,0xbf7bbe48,0xbf623ef1
.long 0x3f80,0x3f353f35,0x3f80248d,0x3f35bf35,0x250dbf80,0xbf46bf22,0xbf7b3e48,0xbef13f62
.long 0x3f80,0x3f553f0e,0x3f6dbec4,0x3e48bf7b,0x250dbf80,0xbf62bef1,0xbf553f0e,0x3dc93f7f
.long 0x3f80,0x3f6d3ec4,0x3f35bf35,0xbec4bf6d,0x250dbf80,0xbf75be95,0xbf0e3f55,0x3f223f46
.long 0x3f80,0x3f7b3e48,0x3ec4bf6d,0xbf55bf0e,0x250dbf80,0xbf7fbdc9,0xbe483f7b,0x3f753e95
.long 0x3f80,0x3f80,0x3f80,0x3f80,0xbec4bf6d,0xbef1bf62,0xbf0ebf55,0xbf22bf46
.long 0x3f353f35,0x3f553f0e,0x3f6d3ec4,0x3f7b3e48,0xbf6dbec4,0xbf7fbdc9,0xbf7b3e48,0xbf623ef1
.long 0x3f80248d,0x3f6dbec4,0x3f35bf35,0x3ec4bf6d,0xbf6d3ec4,0xbf223f46,0xbe483f7b,0x3e953f75
.long 0x3f35bf35,0x3e48bf7b,0xbec4bf6d,0xbf55bf0e,0xbec43f6d,0x3e953f75,0x3f553f0e,0x3f7fbdc9
.long 0x250dbf80,0xbf35bf35,0xbf80a554,0xbf353f35,0x3ec43f6d,0x3f753e95,0x3f55bf0e,0x3dc9bf7f
.long 0xbf35bf35,0xbf7b3e48,0xbec43f6d,0x3f0e3f55,0x3f6d3ec4,0x3f46bf22,0xbe48bf7b,0xbf75be95
.long 0xbf80a554,0xbec43f6d,0x3f353f35,0x3f6dbec4,0x3f6dbec4,0xbdc9bf7f,0xbf7bbe48,0xbef13f62
.long 0xbf353f35,0x3f0e3f55,0x3f6dbec4,0xbe48bf7b,0x3ec4bf6d,0xbf62bef1,0xbf0e3f55,0x3f463f22
.long 0x3f80,0x3f80,0x3f80,0x3f80,0xbf35bf35,0xbf46bf22,0xbf55bf0e,0xbf62bef1
.long 0x3f80248d,0x3f7bbe48,0x3f6dbec4,0x3f55bf0e,0xbf353f35,0xbef13f62,0xbe483f7b,0x3dc93f7f
.long 0x250dbf80,0xbec4bf6d,0xbf35bf35,0xbf6dbec4,0x3f353f35,0x3f753e95,0x3f7bbe48,0x3f46bf22
.long 0xbf80a554,0xbf553f0e,0xbec43f6d,0x3e483f7b,0x3f35bf35,0x3dc9bf7f,0xbf0ebf55,0xbf75be95
.long 0x3f80,0x3f353f35,0x3f80248d,0x3f35bf35,0xbf35bf35,0xbf7f3dc9,0xbf0e3f55,0x3e953f75
.long 0x3f80248d,0x3f0ebf55,0xbec4bf6d,0xbf7bbe48,0xbf353f35,0x3e953f75,0x3f7b3e48,0x3f22bf46
.long 0x250dbf80,0xbf6dbec4,0xbf353f35,0x3ec43f6d,0x3f353f35,0x3f62bef1,0xbe48bf7b,0xbf7fbdc9
.long 0xbf80a554,0xbe483f7b,0x3f6d3ec4,0x3f0ebf55,0x3f35bf35,0xbf22bf46,0xbf553f0e,0x3ef13f62
.long 0x3f80,0x3f80,0x3f80,0x3f80,0xbf6dbec4,0xbf75be95,0xbf7bbe48,0xbf7fbdc9
.long 0x3f35bf35,0x3f0ebf55,0x3ec4bf6d,0x3e48bf7b,0x3ec43f6d,0x3f223f46,0x3f553f0e,0x3f753e95
.long 0xbf80a554,0xbf6d3ec4,0xbf353f35,0xbec43f6d,0x3ec4bf6d,0xbdc9bf7f,0xbf0ebf55,0xbf62bef1
.long 0x3f353f35,0x3f7b3e48,0x3f6dbec4,0x3f0ebf55,0xbf6d3ec4,0xbef13f62,0x3e483f7b,0x3f463f22
.long 0x250dbf80,0xbf35bf35,0xbf80a554,0xbf353f35,0x3f6d3ec4,0x3f62bef1,0x3e48bf7b,0xbf22bf46
.long 0xbf353f35,0x3e483f7b,0x3f6d3ec4,0x3f55bf0e,0xbec4bf6d,0xbf7fbdc9,0xbf0e3f55,0x3ef13f62
.long 0x3f80248d,0x3ec4bf6d,0xbf35bf35,0xbf6d3ec4,0xbec43f6d,0x3f463f22,0x3f55bf0e,0xbe95bf75
.long 0xbf35bf35,0xbf553f0e,0x3ec43f6d,0x3f7bbe48,0x3f6dbec4,0xbe95bf75,0xbf7b3e48,0x3dc93f7f
.long 0x3f80,0x3f80,0x3f80,0x3f80,0xbf80a554,0xbf7f3dc9,0xbf7b3e48,0xbf753e95
.long 0x250dbf80,0xbe48bf7b,0xbec4bf6d,0xbf0ebf55,0x3f80248d,0x3f75be95,0x3f55bf0e,0x3f22bf46
.long 0x3f80,0x3ec43f6d,0x3f353f35,0x3f6d3ec4,0xbf80a554,0xbf623ef1,0xbf0e3f55,0xbdc93f7f
.long 0x250dbf80,0xbf0ebf55,0xbf6dbec4,0xbf7b3e48,0x3f80248d,0x3f46bf22,0x3e48bf7b,0xbef1bf62
.long 0x3f80,0x3f353f35,0x3f80248d,0x3f35bf35,0xbf80a554,0xbf223f46,0x3e483f7b,0x3f623ef1
.long 0x250dbf80,0xbf55bf0e,0xbf6d3ec4,0xbe483f7b,0x3f80248d,0x3ef1bf62,0xbf0ebf55,0xbf7f3dc9
.long 0x3f80,0x3f6d3ec4,0x3f35bf35,0xbec4bf6d,0xbf80a554,0xbe953f75,0x3f553f0e,0x3f46bf22
.long 0x250dbf80,0xbf7bbe48,0xbec43f6d,0x3f553f0e,0x3f80248d,0x3dc9bf7f,0xbf7bbe48,0xbe953f75
.long 0x3f80,0x3f80,0x3f80,0x3f80,0xbf6d3ec4,0xbf623ef1,0xbf553f0e,0xbf463f22
.long 0xbf35bf35,0xbf55bf0e,0xbf6dbec4,0xbf7bbe48,0x3ec4bf6d,0x3dc9bf7f,0xbe48bf7b,0xbef1bf62
.long 0x3f80248d,0x3f6dbec4,0x3f35bf35,0x3ec4bf6d,0x3ec43f6d,0x3f463f22,0x3f7b3e48,0x3f75be95
.long 0xbf353f35,0xbe483f7b,0x3ec43f6d,0x3f553f0e,0xbf6dbec4,0xbf753e95,0xbf0e3f55,0x3dc93f7f
.long 0x250dbf80,0xbf35bf35,0xbf80a554,0xbf353f35,0x3f6dbec4,0x3e95bf75,0xbf0ebf55,0xbf7fbdc9
.long 0x3f353f35,0x3f7bbe48,0x3ec4bf6d,0xbf0ebf55,0xbec43f6d,0x3f223f46,0x3f7bbe48,0x3e95bf75
.long 0xbf80a554,0xbec43f6d,0x3f353f35,0x3f6dbec4,0xbec4bf6d,0xbf7f3dc9,0xbe483f7b,0x3f623ef1
.long 0x3f35bf35,0xbf0ebf55,0xbf6d3ec4,0x3e483f7b,0x3f6d3ec4,0x3ef1bf62,0xbf55bf0e,0xbf223f46
.long 0x3f80,0x3f80,0x3f80,0x3f80,0xbf353f35,0xbf223f46,0xbf0e3f55,0xbef13f62
.long 0xbf80a554,0xbf7b3e48,0xbf6d3ec4,0xbf553f0e,0xbf35bf35,0xbf62bef1,0xbf7bbe48,0xbf7f3dc9
.long 0x250dbf80,0xbec4bf6d,0xbf35bf35,0xbf6dbec4,0x3f35bf35,0x3e95bf75,0xbe48bf7b,0xbf22bf46
.long 0x3f80248d,0x3f55bf0e,0x3ec4bf6d,0xbe48bf7b,0x3f353f35,0x3f7f3dc9,0x3f55bf0e,0x3e95bf75
.long 0x3f80,0x3f353f35,0x3f80248d,0x3f35bf35,0xbf353f35,0x3dc93f7f,0x3f553f0e,0x3f75be95
.long 0xbf80a554,0xbf0e3f55,0x3ec43f6d,0x3f7b3e48,0xbf35bf35,0xbf753e95,0xbe483f7b,0x3f463f22
.long 0x250dbf80,0xbf6dbec4,0xbf353f35,0x3ec43f6d,0x3f35bf35,0xbef1bf62,0xbf7b3e48,0xbdc93f7f
.long 0x3f80248d,0x3e48bf7b,0xbf6dbec4,0xbf0e3f55,0x3f353f35,0x3f46bf22,0xbf0ebf55,0xbf623ef1
.long 0x3f80,0x3f80,0x3f80,0x3f80,0xbec43f6d,0xbe953f75,0xbe483f7b,0xbdc93f7f
.long 0xbf353f35,0xbf0e3f55,0xbec43f6d,0xbe483f7b,0xbf6d3ec4,0xbf463f22,0xbf0e3f55,0xbe953f75
.long 0xbf80a554,0xbf6d3ec4,0xbf353f35,0xbec43f6d,0xbf6dbec4,0xbf7f3dc9,0xbf553f0e,0xbef13f62
.long 0xbf35bf35,0xbf7bbe48,0xbf6d3ec4,0xbf0e3f55,0xbec4bf6d,0xbf62bef1,0xbf7b3e48,0xbf223f46
.long 0x250dbf80,0xbf35bf35,0xbf80a554,0xbf353f35,0x3ec4bf6d,0xbef1bf62,0xbf7bbe48,0xbf463f22
.long 0x3f35bf35,0xbe48bf7b,0xbf6dbec4,0xbf553f0e,0x3f6dbec4,0x3dc9bf7f,0xbf55bf0e,0xbf623ef1
.long 0x3f80248d,0x3ec4bf6d,0xbf35bf35,0xbf6d3ec4,0x3f6d3ec4,0x3f22bf46,0xbf0ebf55,0xbf753e95
.long 0x3f353f35,0x3f55bf0e,0xbec4bf6d,0xbf7b3e48,0x3ec43f6d,0x3f75be95,0xbe48bf7b,0xbf7f3dc9
.long 0x3f80,0x3f80248d,0x250dbf80,0xbf80a554,0x3f80,0x3f7fbdc9,0xbe48bf7b,0xbf753e95
.long 0x3f80,0x3f7bbe48,0xbec4bf6d,0xbf553f0e,0x3f80,0x3f75be95,0xbf0ebf55,0xbf223f46
.long 0x3f80,0x3f6dbec4,0xbf35bf35,0xbec43f6d,0x3f80,0x3f62bef1,0xbf55bf0e,0xbdc93f7f
.long 0x3f80,0x3f55bf0e,0xbf6dbec4,0x3e483f7b,0x3f80,0x3f46bf22,0xbf7bbe48,0x3ef13f62
.long 0x3f80,0x3f35bf35,0xbf80a554,0x3f353f35,0x3f80,0x3f22bf46,0xbf7b3e48,0x3f623ef1
.long 0x3f80,0x3f0ebf55,0xbf6d3ec4,0x3f7b3e48,0x3f80,0x3ef1bf62,0xbf553f0e,0x3f7fbdc9
.long 0x3f80,0x3ec4bf6d,0xbf353f35,0x3f6dbec4,0x3f80,0x3e95bf75,0xbf0e3f55,0x3f46bf22
.long 0x3f80,0x3e48bf7b,0xbec43f6d,0x3f0ebf55,0x3f80,0x3dc9bf7f,0xbe483f7b,0x3e95bf75
.long 0x3f80,0x3f80248d,0x250dbf80,0xbf80a554,0x3ec43f6d,0x3f62bef1,0xbf0ebf55,0xbf463f22
.long 0x3f353f35,0x3f0ebf55,0xbf6dbec4,0xbe483f7b,0x3f6d3ec4,0x3dc9bf7f,0xbf7b3e48,0x3ef13f62
.long 0x3f80248d,0xbec4bf6d,0xbf353f35,0x3f6d3ec4,0x3f6dbec4,0xbf46bf22,0xbe483f7b,0x3f75be95
.long 0x3f35bf35,0xbf7bbe48,0x3ec43f6d,0x3f0ebf55,0x3ec4bf6d,0xbf753e95,0x3f553f0e,0xbdc9bf7f
.long 0x250dbf80,0xbf353f35,0x3f80248d,0xbf35bf35,0xbec4bf6d,0xbe953f75,0x3f55bf0e,0xbf7fbdc9
.long 0xbf35bf35,0x3e483f7b,0x3ec4bf6d,0xbf553f0e,0xbf6dbec4,0x3f223f46,0xbe48bf7b,0xbe953f75
.long 0xbf80a554,0x3f6d3ec4,0xbf35bf35,0x3ec43f6d,0xbf6d3ec4,0x3f7fbdc9,0xbf7bbe48,0x3f623ef1
.long 0xbf353f35,0x3f55bf0e,0xbf6d3ec4,0x3f7bbe48,0xbec43f6d,0x3ef1bf62,0xbf0e3f55,0x3f22bf46
.long 0x3f80,0x3f80248d,0x250dbf80,0xbf80a554,0x3f353f35,0x3f22bf46,0xbf55bf0e,0xbef13f62
.long 0x3f80248d,0xbe48bf7b,0xbf6d3ec4,0x3f0e3f55,0x3f35bf35,0xbf62bef1,0xbe483f7b,0x3f7fbdc9
.long 0x250dbf80,0xbf6d3ec4,0x3f353f35,0x3ec4bf6d,0xbf35bf35,0xbe953f75,0x3f7bbe48,0xbf22bf46
.long 0xbf80a554,0x3f0e3f55,0x3ec4bf6d,0xbf7b3e48,0xbf353f35,0x3f7f3dc9,0xbf0ebf55,0xbe953f75
.long 0x3f80,0x3f35bf35,0xbf80a554,0x3f353f35,0x3f353f35,0xbdc9bf7f,0xbf0e3f55,0x3f75be95
.long 0x3f80248d,0xbf55bf0e,0x3ec43f6d,0x3e48bf7b,0x3f35bf35,0xbf753e95,0x3f7b3e48,0xbf46bf22
.long 0x250dbf80,0xbec43f6d,0x3f35bf35,0xbf6d3ec4,0xbf35bf35,0x3ef13f62,0xbe48bf7b,0xbdc93f7f
.long 0xbf80a554,0x3f7b3e48,0xbf6dbec4,0x3f553f0e,0xbf353f35,0x3f46bf22,0xbf553f0e,0x3f62bef1
.long 0x3f80,0x3f80248d,0x250dbf80,0xbf80a554,0x3f6d3ec4,0x3e95bf75,0xbf7bbe48,0xbdc93f7f
.long 0x3f35bf35,0xbf55bf0e,0xbec43f6d,0x3f7b3e48,0xbec4bf6d,0xbf463f22,0x3f553f0e,0x3e95bf75
.long 0xbf80a554,0x3ec43f6d,0x3f35bf35,0xbf6dbec4,0xbec43f6d,0x3f7fbdc9,0xbf0ebf55,0xbef13f62
.long 0x3f353f35,0x3e48bf7b,0xbf6d3ec4,0x3f553f0e,0x3f6dbec4,0xbf62bef1,0x3e483f7b,0x3f22bf46
.long 0x250dbf80,0xbf353f35,0x3f80248d,0xbf35bf35,0xbf6dbec4,0x3ef13f62,0x3e48bf7b,0xbf463f22
.long 0xbf353f35,0x3f7bbe48,0xbf6dbec4,0x3f0e3f55,0x3ec43f6d,0x3dc9bf7f,0xbf0e3f55,0x3f62bef1
.long 0x3f80248d,0xbf6dbec4,0x3f353f35,0xbec4bf6d,0x3ec4bf6d,0xbf223f46,0x3f55bf0e,0xbf753e95
.long 0xbf35bf35,0x3f0e3f55,0xbec4bf6d,0x3e483f7b,0xbf6d3ec4,0x3f75be95,0xbf7b3e48,0x3f7fbdc9
.long 0x3f80,0x3f80248d,0x250dbf80,0xbf80a554,0x3f80248d,0xbdc9bf7f,0xbf7b3e48,0x3e953f75
.long 0x250dbf80,0xbf7b3e48,0x3ec43f6d,0x3f55bf0e,0xbf80a554,0x3e953f75,0x3f55bf0e,0xbf46bf22
.long 0x3f80,0x3f6dbec4,0xbf35bf35,0xbec43f6d,0x3f80248d,0xbef1bf62,0xbf0e3f55,0x3f7f3dc9
.long 0x250dbf80,0xbf553f0e,0x3f6d3ec4,0xbe48bf7b,0xbf80a554,0x3f223f46,0x3e48bf7b,0xbf623ef1
.long 0x3f80,0x3f35bf35,0xbf80a554,0x3f353f35,0x3f80248d,0xbf46bf22,0x3e483f7b,0x3ef1bf62
.long 0x250dbf80,0xbf0e3f55,0x3f6dbec4,0xbf7bbe48,0xbf80a554,0x3f623ef1,0xbf0ebf55,0x3dc93f7f
.long 0x3f80,0x3ec4bf6d,0xbf353f35,0x3f6dbec4,0x3f80248d,0xbf75be95,0x3f553f0e,0xbf22bf46
.long 0x250dbf80,0xbe483f7b,0x3ec4bf6d,0xbf0e3f55,0xbf80a554,0x3f7f3dc9,0xbf7bbe48,0x3f753e95
.long 0x3f80,0x3f80248d,0x250dbf80,0xbf80a554,0x3f6dbec4,0xbef1bf62,0xbf553f0e,0x3f223f46
.long 0xbf35bf35,0xbf0e3f55,0x3f6d3ec4,0x3e48bf7b,0xbec43f6d,0x3f7f3dc9,0xbe48bf7b,0xbf623ef1
.long 0x3f80248d,0xbec4bf6d,0xbf353f35,0x3f6d3ec4,0xbec4bf6d,0xbf223f46,0x3f7b3e48,0xbe95bf75
.long 0xbf353f35,0x3f7b3e48,0xbec4bf6d,0xbf0e3f55,0x3f6d3ec4,0xbe95bf75,0xbf0e3f55,0x3f7fbdc9
.long 0x250dbf80,0xbf353f35,0x3f80248d,0xbf35bf35,0xbf6d3ec4,0x3f753e95,0xbf0ebf55,0xbdc93f7f
.long 0x3f353f35,0xbe48bf7b,0xbec43f6d,0x3f55bf0e,0x3ec4bf6d,0xbf463f22,0x3f7bbe48,0xbf75be95
.long 0xbf80a554,0x3f6d3ec4,0xbf35bf35,0x3ec43f6d,0x3ec43f6d,0xbdc9bf7f,0xbe483f7b,0x3ef1bf62
.long 0x3f35bf35,0xbf553f0e,0x3f6dbec4,0xbf7b3e48,0xbf6dbec4,0x3f623ef1,0xbf55bf0e,0x3f463f22
.long 0x3f80,0x3f80248d,0x250dbf80,0xbf80a554,0x3f35bf35,0xbf46bf22,0xbf0e3f55,0x3f623ef1
.long 0xbf80a554,0x3e483f7b,0x3f6dbec4,0xbf0ebf55,0x3f353f35,0x3ef1bf62,0xbf7bbe48,0x3dc93f7f
.long 0x250dbf80,0xbf6d3ec4,0x3f353f35,0x3ec4bf6d,0xbf353f35,0x3f753e95,0xbe48bf7b,0xbf463f22
.long 0x3f80248d,0xbf0ebf55,0xbec43f6d,0x3f7bbe48,0xbf35bf35,0xbdc93f7f,0x3f55bf0e,0xbf75be95
.long 0x3f80,0x3f35bf35,0xbf80a554,0x3f353f35,0x3f35bf35,0xbf7f3dc9,0x3f553f0e,0xbe95bf75
.long 0xbf80a554,0x3f553f0e,0xbec4bf6d,0xbe483f7b,0x3f353f35,0xbe95bf75,0xbe483f7b,0x3f22bf46
.long 0x250dbf80,0xbec43f6d,0x3f35bf35,0xbf6d3ec4,0xbf353f35,0x3f62bef1,0xbf7b3e48,0x3f7f3dc9
.long 0x3f80248d,0xbf7bbe48,0x3f6d3ec4,0xbf55bf0e,0xbf35bf35,0x3f223f46,0xbf0ebf55,0x3ef13f62
.long 0x3f80,0x3f80248d,0x250dbf80,0xbf80a554,0x3ec4bf6d,0xbf75be95,0xbe483f7b,0x3f7f3dc9
.long 0xbf353f35,0x3f553f0e,0x3ec4bf6d,0xbf7bbe48,0x3f6dbec4,0xbf22bf46,0xbf0e3f55,0x3f753e95
.long 0xbf80a554,0x3ec43f6d,0x3f35bf35,0xbf6dbec4,0x3f6d3ec4,0xbdc9bf7f,0xbf553f0e,0x3f623ef1
.long 0xbf35bf35,0xbe483f7b,0x3f6dbec4,0xbf55bf0e,0x3ec43f6d,0x3ef1bf62,0xbf7b3e48,0x3f463f22
.long 0x250dbf80,0xbf353f35,0x3f80248d,0xbf35bf35,0xbec43f6d,0x3f62bef1,0xbf7bbe48,0x3f223f46
.long 0x3f35bf35,0xbf7b3e48,0x3f6d3ec4,0xbf0ebf55,0xbf6d3ec4,0x3f7f3dc9,0xbf55bf0e,0x3ef13f62
.long 0x3f80248d,0xbf6dbec4,0x3f353f35,0xbec4bf6d,0xbf6dbec4,0x3f463f22,0xbf0ebf55,0x3e953f75
.long 0x3f353f35,0xbf0ebf55,0x3ec43f6d,0xbe48bf7b,0xbec4bf6d,0x3e953f75,0xbe48bf7b,0x3dc93f7f
.long 0x3f80,0x3f80248d,0x250dbf80,0xbf80a554,0x250dbf80,0xbf7f3dc9,0x3e483f7b,0x3f75be95
.long 0x3f80,0x3f7bbe48,0xbec4bf6d,0xbf553f0e,0x250dbf80,0xbf753e95,0x3f0e3f55,0x3f22bf46
.long 0x3f80,0x3f6dbec4,0xbf35bf35,0xbec43f6d,0x250dbf80,0xbf623ef1,0x3f553f0e,0x3dc9bf7f
.long 0x3f80,0x3f55bf0e,0xbf6dbec4,0x3e483f7b,0x250dbf80,0xbf463f22,0x3f7b3e48,0xbef1bf62
.long 0x3f80,0x3f35bf35,0xbf80a554,0x3f353f35,0x250dbf80,0xbf223f46,0x3f7bbe48,0xbf62bef1
.long 0x3f80,0x3f0ebf55,0xbf6d3ec4,0x3f7b3e48,0x250dbf80,0xbef13f62,0x3f55bf0e,0xbf7f3dc9
.long 0x3f80,0x3ec4bf6d,0xbf353f35,0x3f6dbec4,0x250dbf80,0xbe953f75,0x3f0ebf55,0xbf463f22
.long 0x3f80,0x3e48bf7b,0xbec43f6d,0x3f0ebf55,0x250dbf80,0xbdc93f7f,0x3e48bf7b,0xbe953f75
.long 0x3f80,0x3f80248d,0x250dbf80,0xbf80a554,0xbec4bf6d,0xbf623ef1,0x3f0e3f55,0x3f46bf22
.long 0x3f353f35,0x3f0ebf55,0xbf6dbec4,0xbe483f7b,0xbf6dbec4,0xbdc93f7f,0x3f7bbe48,0xbef1bf62
.long 0x3f80248d,0xbec4bf6d,0xbf353f35,0x3f6d3ec4,0xbf6d3ec4,0x3f463f22,0x3e48bf7b,0xbf753e95
.long 0x3f35bf35,0xbf7bbe48,0x3ec43f6d,0x3f0ebf55,0xbec43f6d,0x3f75be95,0xbf55bf0e,0x3dc93f7f
.long 0x250dbf80,0xbf353f35,0x3f80248d,0xbf35bf35,0x3ec43f6d,0x3e95bf75,0xbf553f0e,0x3f7f3dc9
.long 0xbf35bf35,0x3e483f7b,0x3ec4bf6d,0xbf553f0e,0x3f6d3ec4,0xbf22bf46,0x3e483f7b,0x3e95bf75
.long 0xbf80a554,0x3f6d3ec4,0xbf35bf35,0x3ec43f6d,0x3f6dbec4,0xbf7f3dc9,0x3f7b3e48,0xbf62bef1
.long 0xbf353f35,0x3f55bf0e,0xbf6d3ec4,0x3f7bbe48,0x3ec4bf6d,0xbef13f62,0x3f0ebf55,0xbf223f46
.long 0x3f80,0x3f80248d,0x250dbf80,0xbf80a554,0xbf35bf35,0xbf223f46,0x3f553f0e,0x3ef1bf62
.long 0x3f80248d,0xbe48bf7b,0xbf6d3ec4,0x3f0e3f55,0xbf353f35,0x3f623ef1,0x3e48bf7b,0xbf7f3dc9
.long 0x250dbf80,0xbf6d3ec4,0x3f353f35,0x3ec4bf6d,0x3f353f35,0x3e95bf75,0xbf7b3e48,0x3f223f46
.long 0xbf80a554,0x3f0e3f55,0x3ec4bf6d,0xbf7b3e48,0x3f35bf35,0xbf7fbdc9,0x3f0e3f55,0x3e95bf75
.long 0x3f80,0x3f35bf35,0xbf80a554,0x3f353f35,0xbf35bf35,0x3dc93f7f,0x3f0ebf55,0xbf753e95
.long 0x3f80248d,0xbf55bf0e,0x3ec43f6d,0x3e48bf7b,0xbf353f35,0x3f75be95,0xbf7bbe48,0x3f463f22
.long 0x250dbf80,0xbec43f6d,0x3f35bf35,0xbf6d3ec4,0x3f353f35,0xbef1bf62,0x3e483f7b,0x3dc9bf7f
.long 0xbf80a554,0x3f7b3e48,0xbf6dbec4,0x3f553f0e,0x3f35bf35,0xbf463f22,0x3f55bf0e,0xbf623ef1
.long 0x3f80,0x3f80248d,0x250dbf80,0xbf80a554,0xbf6dbec4,0xbe953f75,0x3f7b3e48,0x3dc9bf7f
.long 0x3f35bf35,0xbf55bf0e,0xbec43f6d,0x3f7b3e48,0x3ec43f6d,0x3f46bf22,0xbf55bf0e,0xbe953f75
.long 0xbf80a554,0x3ec43f6d,0x3f35bf35,0xbf6dbec4,0x3ec4bf6d,0xbf7f3dc9,0x3f0e3f55,0x3ef1bf62
.long 0x3f353f35,0x3e48bf7b,0xbf6d3ec4,0x3f553f0e,0xbf6d3ec4,0x3f623ef1,0xbe48bf7b,0xbf223f46
.long 0x250dbf80,0xbf353f35,0x3f80248d,0xbf35bf35,0x3f6d3ec4,0xbef1bf62,0xbe483f7b,0x3f46bf22
.long 0xbf353f35,0x3f7bbe48,0xbf6dbec4,0x3f0e3f55,0xbec4bf6d,0xbdc93f7f,0x3f0ebf55,0xbf623ef1
.long 0x3f80248d,0xbf6dbec4,0x3f353f35,0xbec4bf6d,0xbec43f6d,0x3f22bf46,0xbf553f0e,0x3f75be95
.long 0xbf35bf35,0x3f0e3f55,0xbec4bf6d,0x3e483f7b,0x3f6dbec4,0xbf753e95,0x3f7bbe48,0xbf7f3dc9
.long 0x3f80,0x3f80248d,0x250dbf80,0xbf80a554,0xbf80a554,0x3dc93f7f,0x3f7bbe48,0xbe95bf75
.long 0x250dbf80,0xbf7b3e48,0x3ec43f6d,0x3f55bf0e,0x3f80248d,0xbe95bf75,0xbf553f0e,0x3f463f22
.long 0x3f80,0x3f6dbec4,0xbf35bf35,0xbec43f6d,0xbf80a554,0x3ef13f62,0x3f0ebf55,0xbf7fbdc9
.long 0x250dbf80,0xbf553f0e,0x3f6d3ec4,0xbe48bf7b,0x3f80248d,0xbf22bf46,0xbe483f7b,0x3f62bef1
.long 0x3f80,0x3f35bf35,0xbf80a554,0x3f353f35,0xbf80a554,0x3f463f22,0xbe48bf7b,0xbef13f62
.long 0x250dbf80,0xbf0e3f55,0x3f6dbec4,0xbf7bbe48,0x3f80248d,0xbf62bef1,0x3f0e3f55,0xbdc9bf7f
.long 0x3f80,0x3ec4bf6d,0xbf353f35,0x3f6dbec4,0xbf80a554,0x3f753e95,0xbf55bf0e,0x3f223f46
.long 0x250dbf80,0xbe483f7b,0x3ec4bf6d,0xbf0e3f55,0x3f80248d,0xbf7fbdc9,0x3f7b3e48,0xbf75be95
.long 0x3f80,0x3f80248d,0x250dbf80,0xbf80a554,0xbf6d3ec4,0x3ef13f62,0x3f55bf0e,0xbf22bf46
.long 0xbf35bf35,0xbf0e3f55,0x3f6d3ec4,0x3e48bf7b,0x3ec4bf6d,0xbf7fbdc9,0x3e483f7b,0x3f62bef1
.long 0x3f80248d,0xbec4bf6d,0xbf353f35,0x3f6d3ec4,0x3ec43f6d,0x3f22bf46,0xbf7bbe48,0x3e953f75
.long 0xbf353f35,0x3f7b3e48,0xbec4bf6d,0xbf0e3f55,0xbf6dbec4,0x3e953f75,0x3f0ebf55,0xbf7f3dc9
.long 0x250dbf80,0xbf353f35,0x3f80248d,0xbf35bf35,0x3f6dbec4,0xbf75be95,0x3f0e3f55,0x3dc9bf7f
.long 0x3f353f35,0xbe48bf7b,0xbec43f6d,0x3f55bf0e,0xbec43f6d,0x3f46bf22,0xbf7b3e48,0x3f753e95
.long 0xbf80a554,0x3f6d3ec4,0xbf35bf35,0x3ec43f6d,0xbec4bf6d,0x3dc93f7f,0x3e48bf7b,0xbef13f62
.long 0x3f35bf35,0xbf553f0e,0x3f6dbec4,0xbf7b3e48,0x3f6d3ec4,0xbf62bef1,0x3f553f0e,0xbf46bf22
.long 0x3f80,0x3f80248d,0x250dbf80,0xbf80a554,0xbf353f35,0x3f463f22,0x3f0ebf55,0xbf62bef1
.long 0xbf80a554,0x3e483f7b,0x3f6dbec4,0xbf0ebf55,0xbf35bf35,0xbef13f62,0x3f7b3e48,0xbdc9bf7f
.long 0x250dbf80,0xbf6d3ec4,0x3f353f35,0x3ec4bf6d,0x3f35bf35,0xbf75be95,0x3e483f7b,0x3f46bf22
.long 0x3f80248d,0xbf0ebf55,0xbec43f6d,0x3f7bbe48,0x3f353f35,0x3dc9bf7f,0xbf553f0e,0x3f753e95
.long 0x3f80,0x3f35bf35,0xbf80a554,0x3f353f35,0xbf353f35,0x3f7fbdc9,0xbf55bf0e,0x3e953f75
.long 0xbf80a554,0x3f553f0e,0xbec4bf6d,0xbe483f7b,0xbf35bf35,0x3e953f75,0x3e48bf7b,0xbf223f46
.long 0x250dbf80,0xbec43f6d,0x3f35bf35,0xbf6d3ec4,0x3f35bf35,0xbf623ef1,0x3f7bbe48,0xbf7fbdc9
.long 0x3f80248d,0xbf7bbe48,0x3f6d3ec4,0xbf55bf0e,0x3f353f35,0xbf22bf46,0x3f0e3f55,0xbef1bf62
.long 0x3f80,0x3f80248d,0x250dbf80,0xbf80a554,0xbec43f6d,0x3f753e95,0x3e48bf7b,0xbf7fbdc9
.long 0xbf353f35,0x3f553f0e,0x3ec4bf6d,0xbf7bbe48,0xbf6d3ec4,0x3f223f46,0x3f0ebf55,0xbf75be95
.long 0xbf80a554,0x3ec43f6d,0x3f35bf35,0xbf6dbec4,0xbf6dbec4,0x3dc93f7f,0x3f55bf0e,0xbf62bef1
.long 0xbf35bf35,0xbe483f7b,0x3f6dbec4,0xbf55bf0e,0xbec4bf6d,0xbef13f62,0x3f7bbe48,0xbf46bf22
.long 0x250dbf80,0xbf353f35,0x3f80248d,0xbf35bf35,0x3ec4bf6d,0xbf623ef1,0x3f7b3e48,0xbf22bf46
.long 0x3f35bf35,0xbf7b3e48,0x3f6d3ec4,0xbf0ebf55,0x3f6dbec4,0xbf7fbdc9,0x3f553f0e,0xbef1bf62
.long 0x3f80248d,0xbf6dbec4,0x3f353f35,0xbec4bf6d,0x3f6d3ec4,0xbf46bf22,0x3f0e3f55,0xbe95bf75
.long 0x3f353f35,0xbf0ebf55,0x3ec43f6d,0xbe48bf7b,0x3ec43f6d,0xbe95bf75,0x3e483f7b,0xbdc9bf7f
.long 0x3f80,0x250dbf80,0x3f80,0x250dbf80,0x3f80,0xbdc9bf7f,0x3e483f7b,0xbe95bf75
.long 0x3f80,0xbe48bf7b,0x3ec43f6d,0xbf0ebf55,0x3f80,0xbe95bf75,0x3f0e3f55,0xbf46bf22
.long 0x3f80,0xbec4bf6d,0x3f353f35,0xbf6dbec4,0x3f80,0xbef1bf62,0x3f553f0e,0xbf7fbdc9
.long 0x3f80,0xbf0ebf55,0x3f6d3ec4,0xbf7b3e48,0x3f80,0xbf22bf46,0x3f7b3e48,0xbf623ef1
.long 0x3f80,0xbf35bf35,0x3f80248d,0xbf353f35,0x3f80,0xbf46bf22,0x3f7bbe48,0xbef13f62
.long 0x3f80,0xbf55bf0e,0x3f6dbec4,0xbe483f7b,0x3f80,0xbf62bef1,0x3f55bf0e,0x3dc93f7f
.long 0x3f80,0xbf6dbec4,0x3f35bf35,0x3ec43f6d,0x3f80,0xbf75be95,0x3f0ebf55,0x3f223f46
.long 0x3f80,0xbf7bbe48,0x3ec4bf6d,0x3f553f0e,0x3f80,0xbf7fbdc9,0x3e48bf7b,0x3f753e95
.long 0x3f80,0x250dbf80,0x3f80,0x250dbf80,0x3ec43f6d,0xbef1bf62,0x3f0e3f55,0xbf22bf46
.long 0x3f353f35,0xbf55bf0e,0x3f6d3ec4,0xbf7bbe48,0x3f6d3ec4,0xbf7fbdc9,0x3f7bbe48,0xbf623ef1
.long 0x3f80248d,0xbf6d3ec4,0x3f35bf35,0xbec43f6d,0x3f6dbec4,0xbf223f46,0x3e48bf7b,0x3e953f75
.long 0x3f35bf35,0xbe483f7b,0xbec4bf6d,0x3f553f0e,0x3ec4bf6d,0x3e953f75,0xbf55bf0e,0x3f7fbdc9
.long 0x250dbf80,0x3f353f35,0xbf80a554,0x3f35bf35,0xbec4bf6d,0x3f753e95,0xbf553f0e,0x3dc9bf7f
.long 0xbf35bf35,0x3f7bbe48,0xbec43f6d,0xbf0ebf55,0xbf6dbec4,0x3f46bf22,0x3e483f7b,0xbf75be95
.long 0xbf80a554,0x3ec4bf6d,0x3f353f35,0xbf6d3ec4,0xbf6d3ec4,0xbdc9bf7f,0x3f7b3e48,0xbef13f62
.long 0xbf353f35,0xbf0ebf55,0x3f6dbec4,0x3e483f7b,0xbec43f6d,0xbf62bef1,0x3f0ebf55,0x3f463f22
.long 0x3f80,0x250dbf80,0x3f80,0x250dbf80,0x3f353f35,0xbf46bf22,0x3f553f0e,0xbf62bef1
.long 0x3f80248d,0xbf7b3e48,0x3f6dbec4,0xbf553f0e,0x3f35bf35,0xbef13f62,0x3e48bf7b,0x3dc93f7f
.long 0x250dbf80,0x3ec43f6d,0xbf35bf35,0x3f6d3ec4,0xbf35bf35,0x3f753e95,0xbf7b3e48,0x3f46bf22
.long 0xbf80a554,0x3f55bf0e,0xbec43f6d,0xbe48bf7b,0xbf353f35,0x3dc9bf7f,0x3f0e3f55,0xbf75be95
.long 0x3f80,0xbf35bf35,0x3f80248d,0xbf353f35,0x3f353f35,0xbf7f3dc9,0x3f0ebf55,0x3e953f75
.long 0x3f80248d,0xbf0e3f55,0xbec4bf6d,0x3f7b3e48,0x3f35bf35,0x3e953f75,0xbf7bbe48,0x3f22bf46
.long 0x250dbf80,0x3f6d3ec4,0xbf353f35,0xbec4bf6d,0xbf35bf35,0x3f62bef1,0x3e483f7b,0xbf7fbdc9
.long 0xbf80a554,0x3e48bf7b,0x3f6d3ec4,0xbf0e3f55,0xbf353f35,0xbf22bf46,0x3f55bf0e,0x3ef13f62
.long 0x3f80,0x250dbf80,0x3f80,0x250dbf80,0x3f6d3ec4,0xbf75be95,0x3f7b3e48,0xbf7fbdc9
.long 0x3f35bf35,0xbf0e3f55,0x3ec4bf6d,0xbe483f7b,0xbec4bf6d,0x3f223f46,0xbf55bf0e,0x3f753e95
.long 0xbf80a554,0x3f6dbec4,0xbf353f35,0x3ec4bf6d,0xbec43f6d,0xbdc9bf7f,0x3f0e3f55,0xbf62bef1
.long 0x3f353f35,0xbf7bbe48,0x3f6dbec4,0xbf0e3f55,0x3f6dbec4,0xbef13f62,0xbe48bf7b,0x3f463f22
.long 0x250dbf80,0x3f353f35,0xbf80a554,0x3f35bf35,0xbf6dbec4,0x3f62bef1,0xbe483f7b,0xbf22bf46
.long 0xbf353f35,0xbe48bf7b,0x3f6d3ec4,0xbf553f0e,0x3ec43f6d,0xbf7fbdc9,0x3f0ebf55,0x3ef13f62
.long 0x3f80248d,0xbec43f6d,0xbf35bf35,0x3f6dbec4,0x3ec4bf6d,0x3f463f22,0xbf553f0e,0xbe95bf75
.long 0xbf35bf35,0x3f55bf0e,0x3ec43f6d,0xbf7b3e48,0xbf6d3ec4,0xbe95bf75,0x3f7bbe48,0x3dc93f7f
.long 0x3f80,0x250dbf80,0x3f80,0x250dbf80,0x3f80248d,0xbf7f3dc9,0x3f7bbe48,0xbf753e95
.long 0x250dbf80,0x3e483f7b,0xbec4bf6d,0x3f0e3f55,0xbf80a554,0x3f75be95,0xbf553f0e,0x3f22bf46
.long 0x3f80,0xbec4bf6d,0x3f353f35,0xbf6dbec4,0x3f80248d,0xbf623ef1,0x3f0ebf55,0xbdc93f7f
.long 0x250dbf80,0x3f0e3f55,0xbf6dbec4,0x3f7bbe48,0xbf80a554,0x3f46bf22,0xbe483f7b,0xbef1bf62
.long 0x3f80,0xbf35bf35,0x3f80248d,0xbf353f35,0x3f80248d,0xbf223f46,0xbe48bf7b,0x3f623ef1
.long 0x250dbf80,0x3f553f0e,0xbf6d3ec4,0x3e48bf7b,0xbf80a554,0x3ef1bf62,0x3f0e3f55,0xbf7f3dc9
.long 0x3f80,0xbf6dbec4,0x3f35bf35,0x3ec43f6d,0x3f80248d,0xbe953f75,0xbf55bf0e,0x3f46bf22
.long 0x250dbf80,0x3f7b3e48,0xbec43f6d,0xbf55bf0e,0xbf80a554,0x3dc9bf7f,0x3f7b3e48,0xbe953f75
.long 0x3f80,0x250dbf80,0x3f80,0x250dbf80,0x3f6dbec4,0xbf623ef1,0x3f55bf0e,0xbf463f22
.long 0xbf35bf35,0x3f553f0e,0xbf6dbec4,0x3f7b3e48,0xbec43f6d,0x3dc9bf7f,0x3e483f7b,0xbef1bf62
.long 0x3f80248d,0xbf6d3ec4,0x3f35bf35,0xbec43f6d,0xbec4bf6d,0x3f463f22,0xbf7bbe48,0x3f75be95
.long 0xbf353f35,0x3e48bf7b,0x3ec43f6d,0xbf55bf0e,0x3f6d3ec4,0xbf753e95,0x3f0ebf55,0x3dc93f7f
.long 0x250dbf80,0x3f353f35,0xbf80a554,0x3f35bf35,0xbf6d3ec4,0x3e95bf75,0x3f0e3f55,0xbf7fbdc9
.long 0x3f353f35,0xbf7b3e48,0x3ec4bf6d,0x3f0e3f55,0x3ec4bf6d,0x3f223f46,0xbf7b3e48,0x3e95bf75
.long 0xbf80a554,0x3ec4bf6d,0x3f353f35,0xbf6d3ec4,0x3ec43f6d,0xbf7f3dc9,0x3e48bf7b,0x3f623ef1
.long 0x3f35bf35,0x3f0e3f55,0xbf6d3ec4,0xbe48bf7b,0xbf6dbec4,0x3ef1bf62,0x3f553f0e,0xbf223f46
.long 0x3f80,0x250dbf80,0x3f80,0x250dbf80,0x3f35bf35,0xbf223f46,0x3f0ebf55,0xbef13f62
.long 0xbf80a554,0x3f7bbe48,0xbf6d3ec4,0x3f55bf0e,0x3f353f35,0xbf62bef1,0x3f7b3e48,0xbf7f3dc9
.long 0x250dbf80,0x3ec43f6d,0xbf35bf35,0x3f6d3ec4,0xbf353f35,0x3e95bf75,0x3e483f7b,0xbf22bf46
.long 0x3f80248d,0xbf553f0e,0x3ec4bf6d,0x3e483f7b,0xbf35bf35,0x3f7f3dc9,0xbf553f0e,0x3e95bf75
.long 0x3f80,0xbf35bf35,0x3f80248d,0xbf353f35,0x3f35bf35,0x3dc93f7f,0xbf55bf0e,0x3f75be95
.long 0xbf80a554,0x3f0ebf55,0x3ec43f6d,0xbf7bbe48,0x3f353f35,0xbf753e95,0x3e48bf7b,0x3f463f22
.long 0x250dbf80,0x3f6d3ec4,0xbf353f35,0xbec4bf6d,0xbf353f35,0xbef1bf62,0x3f7bbe48,0xbdc93f7f
.long 0x3f80248d,0xbe483f7b,0xbf6dbec4,0x3f0ebf55,0xbf35bf35,0x3f46bf22,0x3f0e3f55,0xbf623ef1
.long 0x3f80,0x250dbf80,0x3f80,0x250dbf80,0x3ec4bf6d,0xbe953f75,0x3e48bf7b,0xbdc93f7f
.long 0xbf353f35,0x3f0ebf55,0xbec43f6d,0x3e48bf7b,0x3f6dbec4,0xbf463f22,0x3f0ebf55,0xbe953f75
.long 0xbf80a554,0x3f6dbec4,0xbf353f35,0x3ec4bf6d,0x3f6d3ec4,0xbf7f3dc9,0x3f55bf0e,0xbef13f62
.long 0xbf35bf35,0x3f7b3e48,0xbf6d3ec4,0x3f0ebf55,0x3ec43f6d,0xbf62bef1,0x3f7bbe48,0xbf223f46
.long 0x250dbf80,0x3f353f35,0xbf80a554,0x3f35bf35,0xbec43f6d,0xbef1bf62,0x3f7b3e48,0xbf463f22
.long 0x3f35bf35,0x3e483f7b,0xbf6dbec4,0x3f55bf0e,0xbf6d3ec4,0x3dc9bf7f,0x3f553f0e,0xbf623ef1
.long 0x3f80248d,0xbec43f6d,0xbf35bf35,0x3f6dbec4,0xbf6dbec4,0x3f22bf46,0x3f0e3f55,0xbf753e95
.long 0x3f353f35,0xbf553f0e,0xbec4bf6d,0x3f7bbe48,0xbec4bf6d,0x3f75be95,0x3e483f7b,0xbf7f3dc9
.long 0x3f80,0x250dbf80,0x3f80,0x250dbf80,0x250dbf80,0x3dc93f7f,0xbe48bf7b,0x3e953f75
.long 0x3f80,0xbe48bf7b,0x3ec43f6d,0xbf0ebf55,0x250dbf80,0x3e953f75,0xbf0ebf55,0x3f463f22
.long 0x3f80,0xbec4bf6d,0x3f353f35,0xbf6dbec4,0x250dbf80,0x3ef13f62,0xbf55bf0e,0x3f7f3dc9
.long 0x3f80,0xbf0ebf55,0x3f6d3ec4,0xbf7b3e48,0x250dbf80,0x3f223f46,0xbf7bbe48,0x3f62bef1
.long 0x3f80,0xbf35bf35,0x3f80248d,0xbf353f35,0x250dbf80,0x3f463f22,0xbf7b3e48,0x3ef1bf62
.long 0x3f80,0xbf55bf0e,0x3f6dbec4,0xbe483f7b,0x250dbf80,0x3f623ef1,0xbf553f0e,0xbdc9bf7f
.long 0x3f80,0xbf6dbec4,0x3f35bf35,0x3ec43f6d,0x250dbf80,0x3f753e95,0xbf0e3f55,0xbf22bf46
.long 0x3f80,0xbf7bbe48,0x3ec4bf6d,0x3f553f0e,0x250dbf80,0x3f7f3dc9,0xbe483f7b,0xbf75be95
.long 0x3f80,0x250dbf80,0x3f80,0x250dbf80,0xbec4bf6d,0x3ef13f62,0xbf0ebf55,0x3f223f46
.long 0x3f353f35,0xbf55bf0e,0x3f6d3ec4,0xbf7bbe48,0xbf6dbec4,0x3f7f3dc9,0xbf7b3e48,0x3f62bef1
.long 0x3f80248d,0xbf6d3ec4,0x3f35bf35,0xbec43f6d,0xbf6d3ec4,0x3f22bf46,0xbe483f7b,0xbe95bf75
.long 0x3f35bf35,0xbe483f7b,0xbec4bf6d,0x3f553f0e,0xbec43f6d,0xbe95bf75,0x3f553f0e,0xbf7f3dc9
.long 0x250dbf80,0x3f353f35,0xbf80a554,0x3f35bf35,0x3ec43f6d,0xbf75be95,0x3f55bf0e,0xbdc93f7f
.long 0xbf35bf35,0x3f7bbe48,0xbec43f6d,0xbf0ebf55,0x3f6d3ec4,0xbf463f22,0xbe48bf7b,0x3f753e95
.long 0xbf80a554,0x3ec4bf6d,0x3f353f35,0xbf6d3ec4,0x3f6dbec4,0x3dc93f7f,0xbf7bbe48,0x3ef1bf62
.long 0xbf353f35,0xbf0ebf55,0x3f6dbec4,0x3e483f7b,0x3ec4bf6d,0x3f623ef1,0xbf0e3f55,0xbf46bf22
.long 0x3f80,0x250dbf80,0x3f80,0x250dbf80,0xbf35bf35,0x3f463f22,0xbf55bf0e,0x3f623ef1
.long 0x3f80248d,0xbf7b3e48,0x3f6dbec4,0xbf553f0e,0xbf353f35,0x3ef1bf62,0xbe483f7b,0xbdc9bf7f
.long 0x250dbf80,0x3ec43f6d,0xbf35bf35,0x3f6d3ec4,0x3f353f35,0xbf75be95,0x3f7bbe48,0xbf463f22
.long 0xbf80a554,0x3f55bf0e,0xbec43f6d,0xbe48bf7b,0x3f35bf35,0xbdc93f7f,0xbf0ebf55,0x3f753e95
.long 0x3f80,0xbf35bf35,0x3f80248d,0xbf353f35,0xbf35bf35,0x3f7fbdc9,0xbf0e3f55,0xbe95bf75
.long 0x3f80248d,0xbf0e3f55,0xbec4bf6d,0x3f7b3e48,0xbf353f35,0xbe95bf75,0x3f7b3e48,0xbf223f46
.long 0x250dbf80,0x3f6d3ec4,0xbf353f35,0xbec4bf6d,0x3f353f35,0xbf623ef1,0xbe48bf7b,0x3f7f3dc9
.long 0xbf80a554,0x3e48bf7b,0x3f6d3ec4,0xbf0e3f55,0x3f35bf35,0x3f223f46,0xbf553f0e,0xbef1bf62
.long 0x3f80,0x250dbf80,0x3f80,0x250dbf80,0xbf6dbec4,0x3f753e95,0xbf7bbe48,0x3f7f3dc9
.long 0x3f35bf35,0xbf0e3f55,0x3ec4bf6d,0xbe483f7b,0x3ec43f6d,0xbf22bf46,0x3f553f0e,0xbf75be95
.long 0xbf80a554,0x3f6dbec4,0xbf353f35,0x3ec4bf6d,0x3ec4bf6d,0x3dc93f7f,0xbf0ebf55,0x3f623ef1
.long 0x3f353f35,0xbf7bbe48,0x3f6dbec4,0xbf0e3f55,0xbf6d3ec4,0x3ef1bf62,0x3e483f7b,0xbf46bf22
.long 0x250dbf80,0x3f353f35,0xbf80a554,0x3f35bf35,0x3f6d3ec4,0xbf623ef1,0x3e48bf7b,0x3f223f46
.long 0xbf353f35,0xbe48bf7b,0x3f6d3ec4,0xbf553f0e,0xbec4bf6d,0x3f7f3dc9,0xbf0e3f55,0xbef1bf62
.long 0x3f80248d,0xbec43f6d,0xbf35bf35,0x3f6dbec4,0xbec43f6d,0xbf46bf22,0x3f55bf0e,0x3e953f75
.long 0xbf35bf35,0x3f55bf0e,0x3ec43f6d,0xbf7b3e48,0x3f6dbec4,0x3e953f75,0xbf7b3e48,0xbdc9bf7f
.long 0x3f80,0x250dbf80,0x3f80,0x250dbf80,0xbf80a554,0x3f7fbdc9,0xbf7b3e48,0x3f75be95
.long 0x250dbf80,0x3e483f7b,0xbec4bf6d,0x3f0e3f55,0x3f80248d,0xbf753e95,0x3f55bf0e,0xbf223f46
.long 0x3f80,0xbec4bf6d,0x3f353f35,0xbf6dbec4,0xbf80a554,0x3f62bef1,0xbf0e3f55,0x3dc9bf7f
.long 0x250dbf80,0x3f0e3f55,0xbf6dbec4,0x3f7bbe48,0x3f80248d,0xbf463f22,0x3e48bf7b,0x3ef13f62
.long 0x3f80,0xbf35bf35,0x3f80248d,0xbf353f35,0xbf80a554,0x3f22bf46,0x3e483f7b,0xbf62bef1
.long 0x250dbf80,0x3f553f0e,0xbf6d3ec4,0x3e48bf7b,0x3f80248d,0xbef13f62,0xbf0ebf55,0x3f7fbdc9
.long 0x3f80,0xbf6dbec4,0x3f35bf35,0x3ec43f6d,0xbf80a554,0x3e95bf75,0x3f553f0e,0xbf463f22
.long 0x250dbf80,0x3f7b3e48,0xbec43f6d,0xbf55bf0e,0x3f80248d,0xbdc93f7f,0xbf7bbe48,0x3e95bf75
.long 0x3f80,0x250dbf80,0x3f80,0x250dbf80,0xbf6d3ec4,0x3f62bef1,0xbf553f0e,0x3f46bf22
.long 0xbf35bf35,0x3f553f0e,0xbf6dbec4,0x3f7b3e48,0x3ec4bf6d,0xbdc93f7f,0xbe48bf7b,0x3ef13f62
.long 0x3f80248d,0xbf6d3ec4,0x3f35bf35,0xbec43f6d,0x3ec43f6d,0xbf46bf22,0x3f7b3e48,0xbf753e95
.long 0xbf353f35,0x3e48bf7b,0x3ec43f6d,0xbf55bf0e,0xbf6dbec4,0x3f75be95,0xbf0e3f55,0xbdc9bf7f
.long 0x250dbf80,0x3f353f35,0xbf80a554,0x3f35bf35,0x3f6dbec4,0xbe953f75,0xbf0ebf55,0x3f7f3dc9
.long 0x3f353f35,0xbf7b3e48,0x3ec4bf6d,0x3f0e3f55,0xbec43f6d,0xbf22bf46,0x3f7bbe48,0xbe953f75
.long 0xbf80a554,0x3ec4bf6d,0x3f353f35,0xbf6d3ec4,0xbec4bf6d,0x3f7fbdc9,0xbe483f7b,0xbf62bef1
.long 0x3f35bf35,0x3f0e3f55,0xbf6d3ec4,0xbe48bf7b,0x3f6d3ec4,0xbef13f62,0xbf55bf0e,0x3f22bf46
.long 0x3f80,0x250dbf80,0x3f80,0x250dbf80,0xbf353f35,0x3f22bf46,0xbf0e3f55,0x3ef1bf62
.long 0xbf80a554,0x3f7bbe48,0xbf6d3ec4,0x3f55bf0e,0xbf35bf35,0x3f623ef1,0xbf7bbe48,0x3f7fbdc9
.long 0x250dbf80,0x3ec43f6d,0xbf35bf35,0x3f6d3ec4,0x3f35bf35,0xbe953f75,0xbe48bf7b,0x3f223f46
.long 0x3f80248d,0xbf553f0e,0x3ec4bf6d,0x3e483f7b,0x3f353f35,0xbf7fbdc9,0x3f55bf0e,0xbe953f75
.long 0x3f80,0xbf35bf35,0x3f80248d,0xbf353f35,0xbf353f35,0xbdc9bf7f,0x3f553f0e,0xbf753e95
.long 0xbf80a554,0x3f0ebf55,0x3ec43f6d,0xbf7bbe48,0xbf35bf35,0x3f75be95,0xbe483f7b,0xbf46bf22
.long 0x250dbf80,0x3f6d3ec4,0xbf353f35,0xbec4bf6d,0x3f35bf35,0x3ef13f62,0xbf7b3e48,0x3dc9bf7f
.long 0x3f80248d,0xbe483f7b,0xbf6dbec4,0x3f0ebf55,0x3f353f35,0xbf463f22,0xbf0ebf55,0x3f62bef1
.long 0x3f80,0x250dbf80,0x3f80,0x250dbf80,0xbec43f6d,0x3e95bf75,0xbe483f7b,0x3dc9bf7f
.long 0xbf353f35,0x3f0ebf55,0xbec43f6d,0x3e48bf7b,0xbf6d3ec4,0x3f46bf22,0xbf0e3f55,0x3e95bf75
.long 0xbf80a554,0x3f6dbec4,0xbf353f35,0x3ec4bf6d,0xbf6dbec4,0x3f7fbdc9,0xbf553f0e,0x3ef1bf62
.long 0xbf35bf35,0x3f7b3e48,0xbf6d3ec4,0x3f0ebf55,0xbec4bf6d,0x3f623ef1,0xbf7b3e48,0x3f22bf46
.long 0x250dbf80,0x3f353f35,0xbf80a554,0x3f35bf35,0x3ec4bf6d,0x3ef13f62,0xbf7bbe48,0x3f46bf22
.long 0x3f35bf35,0x3e483f7b,0xbf6dbec4,0x3f55bf0e,0x3f6dbec4,0xbdc93f7f,0xbf55bf0e,0x3f62bef1
.long 0x3f80248d,0xbec43f6d,0xbf35bf35,0x3f6dbec4,0x3f6d3ec4,0xbf223f46,0xbf0ebf55,0x3f75be95
.long 0x3f353f35,0xbf553f0e,0xbec4bf6d,0x3f7bbe48,0x3ec43f6d,0xbf753e95,0xbe48bf7b,0x3f7fbdc9
.long 0x3f80,0xbf80a554,0x250dbf80,0x3f80248d,0x3f80,0xbf7f3dc9,0xbe48bf7b,0x3f75be95
.long 0x3f80,0xbf7b3e48,0xbec4bf6d,0x3f55bf0e,0x3f80,0xbf753e95,0xbf0ebf55,0x3f22bf46
.long 0x3f80,0xbf6d3ec4,0xbf35bf35,0x3ec4bf6d,0x3f80,0xbf623ef1,0xbf55bf0e,0x3dc9bf7f
.long 0x3f80,0xbf553f0e,0xbf6dbec4,0xbe48bf7b,0x3f80,0xbf463f22,0xbf7bbe48,0xbef1bf62
.long 0x3f80,0xbf353f35,0xbf80a554,0xbf35bf35,0x3f80,0xbf223f46,0xbf7b3e48,0xbf62bef1
.long 0x3f80,0xbf0e3f55,0xbf6d3ec4,0xbf7bbe48,0x3f80,0xbef13f62,0xbf553f0e,0xbf7f3dc9
.long 0x3f80,0xbec43f6d,0xbf353f35,0xbf6d3ec4,0x3f80,0xbe953f75,0xbf0e3f55,0xbf463f22
.long 0x3f80,0xbe483f7b,0xbec43f6d,0xbf0e3f55,0x3f80,0xbdc93f7f,0xbe483f7b,0xbe953f75
.long 0x3f80,0xbf80a554,0x250dbf80,0x3f80248d,0x3ec43f6d,0xbf623ef1,0xbf0ebf55,0x3f46bf22
.long 0x3f353f35,0xbf0e3f55,0xbf6dbec4,0x3e48bf7b,0x3f6d3ec4,0xbdc93f7f,0xbf7b3e48,0xbef1bf62
.long 0x3f80248d,0x3ec43f6d,0xbf353f35,0xbf6dbec4,0x3f6dbec4,0x3f463f22,0xbe483f7b,0xbf753e95
.long 0x3f35bf35,0x3f7b3e48,0x3ec43f6d,0xbf0e3f55,0x3ec4bf6d,0x3f75be95,0x3f553f0e,0x3dc93f7f
.long 0x250dbf80,0x3f35bf35,0x3f80248d,0x3f353f35,0xbec4bf6d,0x3e95bf75,0x3f55bf0e,0x3f7f3dc9
.long 0xbf35bf35,0xbe48bf7b,0x3ec4bf6d,0x3f55bf0e,0xbf6dbec4,0xbf22bf46,0xbe48bf7b,0x3e95bf75
.long 0xbf80a554,0xbf6dbec4,0xbf35bf35,0xbec4bf6d,0xbf6d3ec4,0xbf7f3dc9,0xbf7bbe48,0xbf62bef1
.long 0xbf353f35,0xbf553f0e,0xbf6d3ec4,0xbf7b3e48,0xbec43f6d,0xbef13f62,0xbf0e3f55,0xbf223f46
.long 0x3f80,0xbf80a554,0x250dbf80,0x3f80248d,0x3f353f35,0xbf223f46,0xbf55bf0e,0x3ef1bf62
.long 0x3f80248d,0x3e483f7b,0xbf6d3ec4,0xbf0ebf55,0x3f35bf35,0x3f623ef1,0xbe483f7b,0xbf7f3dc9
.long 0x250dbf80,0x3f6dbec4,0x3f353f35,0xbec43f6d,0xbf35bf35,0x3e95bf75,0x3f7bbe48,0x3f223f46
.long 0xbf80a554,0xbf0ebf55,0x3ec4bf6d,0x3f7bbe48,0xbf353f35,0xbf7fbdc9,0xbf0ebf55,0x3e95bf75
.long 0x3f80,0xbf353f35,0xbf80a554,0xbf35bf35,0x3f353f35,0x3dc93f7f,0xbf0e3f55,0xbf753e95
.long 0x3f80248d,0x3f553f0e,0x3ec43f6d,0xbe483f7b,0x3f35bf35,0x3f75be95,0x3f7b3e48,0x3f463f22
.long 0x250dbf80,0x3ec4bf6d,0x3f35bf35,0x3f6dbec4,0xbf35bf35,0xbef1bf62,0xbe48bf7b,0x3dc9bf7f
.long 0xbf80a554,0xbf7bbe48,0xbf6dbec4,0xbf55bf0e,0xbf353f35,0xbf463f22,0xbf553f0e,0xbf623ef1
.long 0x3f80,0xbf80a554,0x250dbf80,0x3f80248d,0x3f6d3ec4,0xbe953f75,0xbf7bbe48,0x3dc9bf7f
.long 0x3f35bf35,0x3f553f0e,0xbec43f6d,0xbf7bbe48,0xbec4bf6d,0x3f46bf22,0x3f553f0e,0xbe953f75
.long 0xbf80a554,0xbec4bf6d,0x3f35bf35,0x3f6d3ec4,0xbec43f6d,0xbf7f3dc9,0xbf0ebf55,0x3ef1bf62
.long 0x3f353f35,0xbe483f7b,0xbf6d3ec4,0xbf55bf0e,0x3f6dbec4,0x3f623ef1,0x3e483f7b,0xbf223f46
.long 0x250dbf80,0x3f35bf35,0x3f80248d,0x3f353f35,0xbf6dbec4,0xbef1bf62,0x3e48bf7b,0x3f46bf22
.long 0xbf353f35,0xbf7b3e48,0xbf6dbec4,0xbf0ebf55,0x3ec43f6d,0xbdc93f7f,0xbf0e3f55,0xbf623ef1
.long 0x3f80248d,0x3f6d3ec4,0x3f353f35,0x3ec43f6d,0x3ec4bf6d,0x3f22bf46,0x3f55bf0e,0x3f75be95
.long 0xbf35bf35,0xbf0ebf55,0xbec4bf6d,0xbe48bf7b,0xbf6d3ec4,0xbf753e95,0xbf7b3e48,0xbf7f3dc9
.long 0x3f80,0xbf80a554,0x250dbf80,0x3f80248d,0x3f80248d,0x3dc93f7f,0xbf7b3e48,0xbe95bf75
.long 0x250dbf80,0x3f7bbe48,0x3ec43f6d,0xbf553f0e,0xbf80a554,0xbe95bf75,0x3f55bf0e,0x3f463f22
.long 0x3f80,0xbf6d3ec4,0xbf35bf35,0x3ec4bf6d,0x3f80248d,0x3ef13f62,0xbf0e3f55,0xbf7fbdc9
.long 0x250dbf80,0x3f55bf0e,0x3f6d3ec4,0x3e483f7b,0xbf80a554,0xbf22bf46,0x3e48bf7b,0x3f62bef1
.long 0x3f80,0xbf353f35,0xbf80a554,0xbf35bf35,0x3f80248d,0x3f463f22,0x3e483f7b,0xbef13f62
.long 0x250dbf80,0x3f0ebf55,0x3f6dbec4,0x3f7b3e48,0xbf80a554,0xbf62bef1,0xbf0ebf55,0xbdc9bf7f
.long 0x3f80,0xbec43f6d,0xbf353f35,0xbf6d3ec4,0x3f80248d,0x3f753e95,0x3f553f0e,0x3f223f46
.long 0x250dbf80,0x3e48bf7b,0x3ec4bf6d,0x3f0ebf55,0xbf80a554,0xbf7fbdc9,0xbf7bbe48,0xbf75be95
.long 0x3f80,0xbf80a554,0x250dbf80,0x3f80248d,0x3f6dbec4,0x3ef13f62,0xbf553f0e,0xbf22bf46
.long 0xbf35bf35,0x3f0ebf55,0x3f6d3ec4,0xbe483f7b,0xbec43f6d,0xbf7fbdc9,0xbe48bf7b,0x3f62bef1
.long 0x3f80248d,0x3ec43f6d,0xbf353f35,0xbf6dbec4,0xbec4bf6d,0x3f22bf46,0x3f7b3e48,0x3e953f75
.long 0xbf353f35,0xbf7bbe48,0xbec4bf6d,0x3f0ebf55,0x3f6d3ec4,0x3e953f75,0xbf0e3f55,0xbf7f3dc9
.long 0x250dbf80,0x3f35bf35,0x3f80248d,0x3f353f35,0xbf6d3ec4,0xbf75be95,0xbf0ebf55,0x3dc9bf7f
.long 0x3f353f35,0x3e483f7b,0xbec43f6d,0xbf553f0e,0x3ec4bf6d,0x3f46bf22,0x3f7bbe48,0x3f753e95
.long 0xbf80a554,0xbf6dbec4,0xbf35bf35,0xbec4bf6d,0x3ec43f6d,0x3dc93f7f,0xbe483f7b,0xbef13f62
.long 0x3f35bf35,0x3f55bf0e,0x3f6dbec4,0x3f7bbe48,0xbf6dbec4,0xbf62bef1,0xbf55bf0e,0xbf46bf22
.long 0x3f80,0xbf80a554,0x250dbf80,0x3f80248d,0x3f35bf35,0x3f463f22,0xbf0e3f55,0xbf62bef1
.long 0xbf80a554,0xbe48bf7b,0x3f6dbec4,0x3f0e3f55,0x3f353f35,0xbef13f62,0xbf7bbe48,0xbdc9bf7f
.long 0x250dbf80,0x3f6dbec4,0x3f353f35,0xbec43f6d,0xbf353f35,0xbf75be95,0xbe48bf7b,0x3f46bf22
.long 0x3f80248d,0x3f0e3f55,0xbec43f6d,0xbf7b3e48,0xbf35bf35,0x3dc9bf7f,0x3f55bf0e,0x3f753e95
.long 0x3f80,0xbf353f35,0xbf80a554,0xbf35bf35,0x3f35bf35,0x3f7fbdc9,0x3f553f0e,0x3e953f75
.long 0xbf80a554,0xbf55bf0e,0xbec4bf6d,0x3e48bf7b,0x3f353f35,0x3e953f75,0xbe483f7b,0xbf223f46
.long 0x250dbf80,0x3ec4bf6d,0x3f35bf35,0x3f6dbec4,0xbf353f35,0xbf623ef1,0xbf7b3e48,0xbf7fbdc9
.long 0x3f80248d,0x3f7b3e48,0x3f6d3ec4,0x3f553f0e,0xbf35bf35,0xbf22bf46,0xbf0ebf55,0xbef1bf62
.long 0x3f80,0xbf80a554,0x250dbf80,0x3f80248d,0x3ec4bf6d,0x3f753e95,0xbe483f7b,0xbf7fbdc9
.long 0xbf353f35,0xbf55bf0e,0x3ec4bf6d,0x3f7b3e48,0x3f6dbec4,0x3f223f46,0xbf0e3f55,0xbf75be95
.long 0xbf80a554,0xbec4bf6d,0x3f35bf35,0x3f6d3ec4,0x3f6d3ec4,0x3dc93f7f,0xbf553f0e,0xbf62bef1
.long 0xbf35bf35,0x3e48bf7b,0x3f6dbec4,0x3f553f0e,0x3ec43f6d,0xbef13f62,0xbf7b3e48,0xbf46bf22
.long 0x250dbf80,0x3f35bf35,0x3f80248d,0x3f353f35,0xbec43f6d,0xbf623ef1,0xbf7bbe48,0xbf22bf46
.long 0x3f35bf35,0x3f7bbe48,0x3f6d3ec4,0x3f0e3f55,0xbf6d3ec4,0xbf7fbdc9,0xbf55bf0e,0xbef1bf62
.long 0x3f80248d,0x3f6d3ec4,0x3f353f35,0x3ec43f6d,0xbf6dbec4,0xbf46bf22,0xbf0ebf55,0xbe95bf75
.long 0x3f353f35,0x3f0e3f55,0x3ec43f6d,0x3e483f7b,0xbec4bf6d,0xbe95bf75,0xbe48bf7b,0xbdc9bf7f
.long 0x3f80,0xbf80a554,0x250dbf80,0x3f80248d,0x250dbf80,0x3f7fbdc9,0x3e483f7b,0xbf753e95
.long 0x3f80,0xbf7b3e48,0xbec4bf6d,0x3f55bf0e,0x250dbf80,0x3f75be95,0x3f0e3f55,0xbf223f46
.long 0x3f80,0xbf6d3ec4,0xbf35bf35,0x3ec4bf6d,0x250dbf80,0x3f62bef1,0x3f553f0e,0xbdc93f7f
.long 0x3f80,0xbf553f0e,0xbf6dbec4,0xbe48bf7b,0x250dbf80,0x3f46bf22,0x3f7b3e48,0x3ef13f62
.long 0x3f80,0xbf353f35,0xbf80a554,0xbf35bf35,0x250dbf80,0x3f22bf46,0x3f7bbe48,0x3f623ef1
.long 0x3f80,0xbf0e3f55,0xbf6d3ec4,0xbf7bbe48,0x250dbf80,0x3ef1bf62,0x3f55bf0e,0x3f7fbdc9
.long 0x3f80,0xbec43f6d,0xbf353f35,0xbf6d3ec4,0x250dbf80,0x3e95bf75,0x3f0ebf55,0x3f46bf22
.long 0x3f80,0xbe483f7b,0xbec43f6d,0xbf0e3f55,0x250dbf80,0x3dc9bf7f,0x3e48bf7b,0x3e95bf75
.long 0x3f80,0xbf80a554,0x250dbf80,0x3f80248d,0xbec4bf6d,0x3f62bef1,0x3f0e3f55,0xbf463f22
.long 0x3f353f35,0xbf0e3f55,0xbf6dbec4,0x3e48bf7b,0xbf6dbec4,0x3dc9bf7f,0x3f7bbe48,0x3ef13f62
.long 0x3f80248d,0x3ec43f6d,0xbf353f35,0xbf6dbec4,0xbf6d3ec4,0xbf46bf22,0x3e48bf7b,0x3f75be95
.long 0x3f35bf35,0x3f7b3e48,0x3ec43f6d,0xbf0e3f55,0xbec43f6d,0xbf753e95,0xbf55bf0e,0xbdc9bf7f
.long 0x250dbf80,0x3f35bf35,0x3f80248d,0x3f353f35,0x3ec43f6d,0xbe953f75,0xbf553f0e,0xbf7fbdc9
.long 0xbf35bf35,0xbe48bf7b,0x3ec4bf6d,0x3f55bf0e,0x3f6d3ec4,0x3f223f46,0x3e483f7b,0xbe953f75
.long 0xbf80a554,0xbf6dbec4,0xbf35bf35,0xbec4bf6d,0x3f6dbec4,0x3f7fbdc9,0x3f7b3e48,0x3f623ef1
.long 0xbf353f35,0xbf553f0e,0xbf6d3ec4,0xbf7b3e48,0x3ec4bf6d,0x3ef1bf62,0x3f0ebf55,0x3f22bf46
.long 0x3f80,0xbf80a554,0x250dbf80,0x3f80248d,0xbf35bf35,0x3f22bf46,0x3f553f0e,0xbef13f62
.long 0x3f80248d,0x3e483f7b,0xbf6d3ec4,0xbf0ebf55,0xbf353f35,0xbf62bef1,0x3e48bf7b,0x3f7fbdc9
.long 0x250dbf80,0x3f6dbec4,0x3f353f35,0xbec43f6d,0x3f353f35,0xbe953f75,0xbf7b3e48,0xbf22bf46
.long 0xbf80a554,0xbf0ebf55,0x3ec4bf6d,0x3f7bbe48,0x3f35bf35,0x3f7f3dc9,0x3f0e3f55,0xbe953f75
.long 0x3f80,0xbf353f35,0xbf80a554,0xbf35bf35,0xbf35bf35,0xbdc9bf7f,0x3f0ebf55,0x3f75be95
.long 0x3f80248d,0x3f553f0e,0x3ec43f6d,0xbe483f7b,0xbf353f35,0xbf753e95,0xbf7bbe48,0xbf46bf22
.long 0x250dbf80,0x3ec4bf6d,0x3f35bf35,0x3f6dbec4,0x3f353f35,0x3ef13f62,0x3e483f7b,0xbdc93f7f
.long 0xbf80a554,0xbf7bbe48,0xbf6dbec4,0xbf55bf0e,0x3f35bf35,0x3f46bf22,0x3f55bf0e,0x3f62bef1
.long 0x3f80,0xbf80a554,0x250dbf80,0x3f80248d,0xbf6dbec4,0x3e95bf75,0x3f7b3e48,0xbdc93f7f
.long 0x3f35bf35,0x3f553f0e,0xbec43f6d,0xbf7bbe48,0x3ec43f6d,0xbf463f22,0xbf55bf0e,0x3e95bf75
.long 0xbf80a554,0xbec4bf6d,0x3f35bf35,0x3f6d3ec4,0x3ec4bf6d,0x3f7fbdc9,0x3f0e3f55,0xbef13f62
.long 0x3f353f35,0xbe483f7b,0xbf6d3ec4,0xbf55bf0e,0xbf6d3ec4,0xbf62bef1,0xbe48bf7b,0x3f22bf46
.long 0x250dbf80,0x3f35bf35,0x3f80248d,0x3f353f35,0x3f6d3ec4,0x3ef13f62,0xbe483f7b,0xbf463f22
.long 0xbf353f35,0xbf7b3e48,0xbf6dbec4,0xbf0ebf55,0xbec4bf6d,0x3dc9bf7f,0x3f0ebf55,0x3f62bef1
.long 0x3f80248d,0x3f6d3ec4,0x3f353f35,0x3ec43f6d,0xbec43f6d,0xbf223f46,0xbf553f0e,0xbf753e95
.long 0xbf35bf35,0xbf0ebf55,0xbec4bf6d,0xbe48bf7b,0x3f6dbec4,0x3f75be95,0x3f7bbe48,0x3f7fbdc9
.long 0x3f80,0xbf80a554,0x250dbf80,0x3f80248d,0xbf80a554,0xbdc9bf7f,0x3f7bbe48,0x3e953f75
.long 0x250dbf80,0x3f7bbe48,0x3ec43f6d,0xbf553f0e,0x3f80248d,0x3e953f75,0xbf553f0e,0xbf46bf22
.long 0x3f80,0xbf6d3ec4,0xbf35bf35,0x3ec4bf6d,0xbf80a554,0xbef1bf62,0x3f0ebf55,0x3f7f3dc9
.long 0x250dbf80,0x3f55bf0e,0x3f6d3ec4,0x3e483f7b,0x3f80248d,0x3f223f46,0xbe483f7b,0xbf623ef1
.long 0x3f80,0xbf353f35,0xbf80a554,0xbf35bf35,0xbf80a554,0xbf46bf22,0xbe48bf7b,0x3ef1bf62
.long 0x250dbf80,0x3f0ebf55,0x3f6dbec4,0x3f7b3e48,0x3f80248d,0x3f623ef1,0x3f0e3f55,0x3dc93f7f
.long 0x3f80,0xbec43f6d,0xbf353f35,0xbf6d3ec4,0xbf80a554,0xbf75be95,0xbf55bf0e,0xbf22bf46
.long 0x250dbf80,0x3e48bf7b,0x3ec4bf6d,0x3f0ebf55,0x3f80248d,0x3f7f3dc9,0x3f7b3e48,0x3f753e95
.long 0x3f80,0xbf80a554,0x250dbf80,0x3f80248d,0xbf6d3ec4,0xbef1bf62,0x3f55bf0e,0x3f223f46
.long 0xbf35bf35,0x3f0ebf55,0x3f6d3ec4,0xbe483f7b,0x3ec4bf6d,0x3f7f3dc9,0x3e483f7b,0xbf623ef1
.long 0x3f80248d,0x3ec43f6d,0xbf353f35,0xbf6dbec4,0x3ec43f6d,0xbf223f46,0xbf7bbe48,0xbe95bf75
.long 0xbf353f35,0xbf7bbe48,0xbec4bf6d,0x3f0ebf55,0xbf6dbec4,0xbe95bf75,0x3f0ebf55,0x3f7fbdc9
.long 0x250dbf80,0x3f35bf35,0x3f80248d,0x3f353f35,0x3f6dbec4,0x3f753e95,0x3f0e3f55,0xbdc93f7f
.long 0x3f353f35,0x3e483f7b,0xbec43f6d,0xbf553f0e,0xbec43f6d,0xbf463f22,0xbf7b3e48,0xbf75be95
.long 0xbf80a554,0xbf6dbec4,0xbf35bf35,0xbec4bf6d,0xbec4bf6d,0xbdc9bf7f,0x3e48bf7b,0x3ef1bf62
.long 0x3f35bf35,0x3f55bf0e,0x3f6dbec4,0x3f7bbe48,0x3f6d3ec4,0x3f623ef1,0x3f553f0e,0x3f463f22
.long 0x3f80,0xbf80a554,0x250dbf80,0x3f80248d,0xbf353f35,0xbf46bf22,0x3f0ebf55,0x3f623ef1
.long 0xbf80a554,0xbe48bf7b,0x3f6dbec4,0x3f0e3f55,0xbf35bf35,0x3ef1bf62,0x3f7b3e48,0x3dc93f7f
.long 0x250dbf80,0x3f6dbec4,0x3f353f35,0xbec43f6d,0x3f35bf35,0x3f753e95,0x3e483f7b,0xbf463f22
.long 0x3f80248d,0x3f0e3f55,0xbec43f6d,0xbf7b3e48,0x3f353f35,0xbdc93f7f,0xbf553f0e,0xbf75be95
.long 0x3f80,0xbf353f35,0xbf80a554,0xbf35bf35,0xbf353f35,0xbf7f3dc9,0xbf55bf0e,0xbe95bf75
.long 0xbf80a554,0xbf55bf0e,0xbec4bf6d,0x3e48bf7b,0xbf35bf35,0xbe95bf75,0x3e48bf7b,0x3f22bf46
.long 0x250dbf80,0x3ec4bf6d,0x3f35bf35,0x3f6dbec4,0x3f35bf35,0x3f62bef1,0x3f7bbe48,0x3f7f3dc9
.long 0x3f80248d,0x3f7b3e48,0x3f6d3ec4,0x3f553f0e,0x3f353f35,0x3f223f46,0x3f0e3f55,0x3ef13f62
.long 0x3f80,0xbf80a554,0x250dbf80,0x3f80248d,0xbec43f6d,0xbf75be95,0x3e48bf7b,0x3f7f3dc9
.long 0xbf353f35,0xbf55bf0e,0x3ec4bf6d,0x3f7b3e48,0xbf6d3ec4,0xbf22bf46,0x3f0ebf55,0x3f753e95
.long 0xbf80a554,0xbec4bf6d,0x3f35bf35,0x3f6d3ec4,0xbf6dbec4,0xbdc9bf7f,0x3f55bf0e,0x3f623ef1
.long 0xbf35bf35,0x3e48bf7b,0x3f6dbec4,0x3f553f0e,0xbec4bf6d,0x3ef1bf62,0x3f7bbe48,0x3f463f22
.long 0x250dbf80,0x3f35bf35,0x3f80248d,0x3f353f35,0x3ec4bf6d,0x3f62bef1,0x3f7b3e48,0x3f223f46
.long 0x3f35bf35,0x3f7bbe48,0x3f6d3ec4,0x3f0e3f55,0x3f6dbec4,0x3f7f3dc9,0x3f553f0e,0x3ef13f62
.long 0x3f80248d,0x3f6d3ec4,0x3f353f35,0x3ec43f6d,0x3f6d3ec4,0x3f463f22,0x3f0e3f55,0x3e953f75
.long 0x3f353f35,0x3f0e3f55,0x3ec43f6d,0x3e483f7b,0x3ec43f6d,0x3e953f75,0x3e483f7b,0x3dc93f7f
.long 0x3f808000,0x3f808000,0x3f808000,0x3f808000,0x3f808000,0x3f7fbdc9,0x3f7bbe48,0x3f75be95
.long 0x3f808000,0x3f7bbe48,0x3f6dbec4,0x3f55bf0e,0x3f808000,0x3f75be95,0x3f55bf0e,0x3f22bf46
.long 0x3f808000,0x3f6dbec4,0x3f35bf35,0x3ec4bf6d,0x3f808000,0x3f62bef1,0x3f0ebf55,0x3dc9bf7f
.long 0x3f808000,0x3f55bf0e,0x3ec4bf6d,0xbe48bf7b,0x3f808000,0x3f46bf22,0x3e48bf7b,0xbef1bf62
.long 0x3f808000,0x3f35bf35,0x248dbf80,0xbf35bf35,0x3f808000,0x3f22bf46,0xbe48bf7b,0xbf62bef1
.long 0x3f808000,0x3f0ebf55,0xbec4bf6d,0xbf7bbe48,0x3f808000,0x3ef1bf62,0xbf0ebf55,0xbf7f3dc9
.long 0x3f808000,0x3ec4bf6d,0xbf35bf35,0xbf6d3ec4,0x3f808000,0x3e95bf75,0xbf55bf0e,0xbf463f22
.long 0x3f808000,0x3e48bf7b,0xbf6dbec4,0xbf0e3f55,0x3f808000,0x3dc9bf7f,0xbf7bbe48,0xbe953f75
.long 0x3f808000,0x3f808000,0x3f808000,0x3f808000,0x3f6dbec4,0x3f62bef1,0x3f55bf0e,0x3f46bf22
.long 0x3f35bf35,0x3f0ebf55,0x3ec4bf6d,0x3e48bf7b,0x3ec4bf6d,0x3dc9bf7f,0xbe48bf7b,0xbef1bf62
.long 0x248dbf80,0xbec4bf6d,0xbf35bf35,0xbf6dbec4,0xbec4bf6d,0xbf46bf22,0xbf7bbe48,0xbf753e95
.long 0xbf35bf35,0xbf7bbe48,0xbf6d3ec4,0xbf0e3f55,0xbf6dbec4,0xbf753e95,0xbf0e3f55,0x3dc93f7f
.long 0xbf80a50d,0xbf353f35,0xa5543f80,0x3f353f35,0xbf6d3ec4,0xbe953f75,0x3f0e3f55,0x3f7f3dc9
.long 0xbf353f35,0x3e483f7b,0x3f6d3ec4,0x3f55bf0e,0xbec43f6d,0x3f223f46,0x3f7bbe48,0x3e95bf75
.long 0xa5543f80,0x3f6d3ec4,0x3f35bf35,0xbec4bf6d,0x3ec43f6d,0x3f7fbdc9,0x3e48bf7b,0xbf62bef1
.long 0x3f353f35,0x3f55bf0e,0xbec4bf6d,0xbf7b3e48,0x3f6d3ec4,0x3ef1bf62,0xbf55bf0e,0xbf223f46
.long 0x3f808000,0x3f808000,0x3f808000,0x3f808000,0x3f35bf35,0x3f22bf46,0x3f0ebf55,0x3ef1bf62
.long 0x248dbf80,0xbe48bf7b,0xbec4bf6d,0xbf0ebf55,0xbf35bf35,0xbf62bef1,0xbf7bbe48,0xbf7f3dc9
.long 0xbf80a50d,0xbf6d3ec4,0xbf353f35,0xbec43f6d,0xbf353f35,0xbe953f75,0x3e483f7b,0x3f223f46
.long 0xa5543f80,0x3f0e3f55,0x3f6d3ec4,0x3f7bbe48,0x3f353f35,0x3f7f3dc9,0x3f55bf0e,0x3e95bf75
.long 0x3f808000,0x3f35bf35,0x248dbf80,0xbf35bf35,0x3f35bf35,0xbdc9bf7f,0xbf55bf0e,0xbf753e95
.long 0x248dbf80,0xbf55bf0e,0xbf6d3ec4,0xbe483f7b,0xbf35bf35,0xbf753e95,0xbe483f7b,0x3f463f22
.long 0xbf80a50d,0xbec43f6d,0x3f353f35,0x3f6dbec4,0xbf353f35,0x3ef13f62,0x3f7bbe48,0x3dc9bf7f
.long 0xa5543f80,0x3f7b3e48,0x3ec4bf6d,0xbf55bf0e,0x3f353f35,0x3f46bf22,0xbf0ebf55,0xbf623ef1
.long 0x3f808000,0x3f808000,0x3f808000,0x3f808000,0x3ec4bf6d,0x3e95bf75,0x3e48bf7b,0x3dc9bf7f
.long 0xbf35bf35,0xbf55bf0e,0xbf6dbec4,0xbf7bbe48,0xbf6d3ec4,0xbf463f22,0xbf0e3f55,0xbe953f75
.long 0xa5543f80,0x3ec43f6d,0x3f353f35,0x3f6d3ec4,0x3f6d3ec4,0x3f7fbdc9,0x3f55bf0e,0x3ef1bf62
.long 0x3f35bf35,0x3e48bf7b,0xbec4bf6d,0xbf55bf0e,0xbec4bf6d,0xbf62bef1,0xbf7b3e48,0xbf223f46
.long 0xbf80a50d,0xbf353f35,0xa5543f80,0x3f353f35,0xbec43f6d,0x3ef13f62,0x3f7b3e48,0x3f46bf22
.long 0x3f353f35,0x3f7bbe48,0x3ec4bf6d,0xbf0ebf55,0x3f6dbec4,0x3dc9bf7f,0xbf55bf0e,0xbf623ef1
.long 0x248dbf80,0xbf6dbec4,0xbf353f35,0x3ec43f6d,0xbf6dbec4,0xbf223f46,0x3f0e3f55,0x3f75be95
.long 0xbf353f35,0x3f0e3f55,0x3f6dbec4,0xbe48bf7b,0x3ec43f6d,0x3f75be95,0xbe48bf7b,0xbf7f3dc9
.long 0x3f808000,0x3f808000,0x3f808000,0x3f808000,0x248dbf80,0xbdc9bf7f,0xbe48bf7b,0xbe95bf75
.long 0xbf80a50d,0xbf7b3e48,0xbf6d3ec4,0xbf553f0e,0xa5543f80,0x3e953f75,0x3f0e3f55,0x3f463f22
.long 0x3f808000,0x3f6dbec4,0x3f35bf35,0x3ec4bf6d,0x248dbf80,0xbef1bf62,0xbf55bf0e,0xbf7fbdc9
.long 0xbf80a50d,0xbf553f0e,0xbec43f6d,0x3e483f7b,0xa5543f80,0x3f223f46,0x3f7b3e48,0x3f62bef1
.long 0x3f808000,0x3f35bf35,0x248dbf80,0xbf35bf35,0x248dbf80,0xbf46bf22,0xbf7b3e48,0xbef13f62
.long 0xbf80a50d,0xbf0e3f55,0x3ec43f6d,0x3f7b3e48,0xa5543f80,0x3f623ef1,0x3f55bf0e,0xbdc9bf7f
.long 0x3f808000,0x3ec4bf6d,0xbf35bf35,0xbf6d3ec4,0x248dbf80,0xbf75be95,0xbf0e3f55,0x3f223f46
.long 0xbf80a50d,0xbe483f7b,0x3f6d3ec4,0x3f0ebf55,0xa5543f80,0x3f7f3dc9,0x3e48bf7b,0xbf75be95
.long 0x3f808000,0x3f808000,0x3f808000,0x3f808000,0xbec4bf6d,0xbef1bf62,0xbf0ebf55,0xbf22bf46
.long 0xbf353f35,0xbf0e3f55,0xbec43f6d,0xbe483f7b,0x3f6d3ec4,0x3f7f3dc9,0x3f7bbe48,0x3f62bef1
.long 0x248dbf80,0xbec4bf6d,0xbf35bf35,0xbf6dbec4,0xbf6d3ec4,0xbf223f46,0xbe483f7b,0x3e953f75
.long 0x3f353f35,0x3f7b3e48,0x3f6dbec4,0x3f0ebf55,0x3ec4bf6d,0xbe95bf75,0xbf55bf0e,0xbf7f3dc9
.long 0xbf80a50d,0xbf353f35,0xa5543f80,0x3f353f35,0x3ec43f6d,0x3f753e95,0x3f55bf0e,0x3dc9bf7f
.long 0x3f35bf35,0xbe48bf7b,0xbf6dbec4,0xbf553f0e,0xbf6dbec4,0xbf463f22,0x3e483f7b,0x3f753e95
.long 0xa5543f80,0x3f6d3ec4,0x3f35bf35,0xbec4bf6d,0x3f6dbec4,0xbdc9bf7f,0xbf7bbe48,0xbef13f62
.long 0xbf35bf35,0xbf553f0e,0x3ec43f6d,0x3f7bbe48,0xbec43f6d,0x3f623ef1,0x3f0ebf55,0xbf46bf22
.long 0x3f808000,0x3f808000,0x3f808000,0x3f808000,0xbf35bf35,0xbf46bf22,0xbf55bf0e,0xbf62bef1
.long 0xa5543f80,0x3e483f7b,0x3ec43f6d,0x3f0e3f55,0x3f35bf35,0x3ef1bf62,0x3e48bf7b,0xbdc9bf7f
.long 0xbf80a50d,0xbf6d3ec4,0xbf353f35,0xbec43f6d,0x3f353f35,0x3f753e95,0x3f7bbe48,0x3f46bf22
.long 0x248dbf80,0xbf0ebf55,0xbf6dbec4,0xbf7b3e48,0xbf353f35,0xbdc93f7f,0x3f0e3f55,0x3f753e95
.long 0x3f808000,0x3f35bf35,0x248dbf80,0xbf35bf35,0xbf35bf35,0xbf7f3dc9,0xbf0e3f55,0x3e953f75
.long 0xa5543f80,0x3f553f0e,0x3f6dbec4,0x3e48bf7b,0x3f35bf35,0xbe95bf75,0xbf7bbe48,0xbf223f46
.long 0xbf80a50d,0xbec43f6d,0x3f353f35,0x3f6dbec4,0x3f353f35,0x3f62bef1,0xbe48bf7b,0xbf7fbdc9
.long 0x248dbf80,0xbf7bbe48,0xbec43f6d,0x3f553f0e,0xbf353f35,0x3f223f46,0x3f55bf0e,0xbef1bf62
.long 0x3f808000,0x3f808000,0x3f808000,0x3f808000,0xbf6dbec4,0xbf75be95,0xbf7bbe48,0xbf7fbdc9
.long 0x3f353f35,0x3f553f0e,0x3f6d3ec4,0x3f7b3e48,0xbec4bf6d,0xbf22bf46,0xbf55bf0e,0xbf75be95
.long 0xa5543f80,0x3ec43f6d,0x3f353f35,0x3f6d3ec4,0x3ec4bf6d,0xbdc9bf7f,0xbf0ebf55,0xbf62bef1
.long 0xbf353f35,0xbe483f7b,0x3ec43f6d,0x3f553f0e,0x3f6dbec4,0x3ef1bf62,0xbe48bf7b,0xbf46bf22
.long 0xbf80a50d,0xbf353f35,0xa5543f80,0x3f353f35,0x3f6d3ec4,0x3f62bef1,0x3e48bf7b,0xbf22bf46
.long 0xbf35bf35,0xbf7b3e48,0xbec43f6d,0x3f0e3f55,0x3ec43f6d,0x3f7f3dc9,0x3f0ebf55,0xbef1bf62
.long 0x248dbf80,0xbf6dbec4,0xbf353f35,0x3ec43f6d,0xbec43f6d,0x3f463f22,0x3f55bf0e,0xbe95bf75
.long 0x3f35bf35,0xbf0ebf55,0xbf6d3ec4,0x3e483f7b,0xbf6d3ec4,0x3e953f75,0x3f7bbe48,0xbdc9bf7f
.long 0x3f808000,0x3f808000,0x3f808000,0x3f808000,0xbf80a50d,0xbf7f3dc9,0xbf7b3e48,0xbf753e95
.long 0x3f808000,0x3f7bbe48,0x3f6dbec4,0x3f55bf0e,0xbf80a50d,0xbf753e95,0xbf553f0e,0xbf223f46
.long 0x3f808000,0x3f6dbec4,0x3f35bf35,0x3ec4bf6d,0xbf80a50d,0xbf623ef1,0xbf0e3f55,0xbdc93f7f
.long 0x3f808000,0x3f55bf0e,0x3ec4bf6d,0xbe48bf7b,0xbf80a50d,0xbf463f22,0xbe483f7b,0x3ef13f62
.long 0x3f808000,0x3f35bf35,0x248dbf80,0xbf35bf35,0xbf80a50d,0xbf223f46,0x3e483f7b,0x3f623ef1
.long 0x3f808000,0x3f0ebf55,0xbec4bf6d,0xbf7bbe48,0xbf80a50d,0xbef13f62,0x3f0e3f55,0x3f7fbdc9
.long 0x3f808000,0x3ec4bf6d,0xbf35bf35,0xbf6d3ec4,0xbf80a50d,0xbe953f75,0x3f553f0e,0x3f46bf22
.long 0x3f808000,0x3e48bf7b,0xbf6dbec4,0xbf0e3f55,0xbf80a50d,0xbdc93f7f,0x3f7b3e48,0x3e95bf75
.long 0x3f808000,0x3f808000,0x3f808000,0x3f808000,0xbf6d3ec4,0xbf623ef1,0xbf553f0e,0xbf463f22
.long 0x3f35bf35,0x3f0ebf55,0x3ec4bf6d,0x3e48bf7b,0xbec43f6d,0xbdc93f7f,0x3e483f7b,0x3ef13f62
.long 0x248dbf80,0xbec4bf6d,0xbf35bf35,0xbf6dbec4,0x3ec43f6d,0x3f463f22,0x3f7b3e48,0x3f75be95
.long 0xbf35bf35,0xbf7bbe48,0xbf6d3ec4,0xbf0e3f55,0x3f6d3ec4,0x3f75be95,0x3f0ebf55,0xbdc9bf7f
.long 0xbf80a50d,0xbf353f35,0xa5543f80,0x3f353f35,0x3f6dbec4,0x3e95bf75,0xbf0ebf55,0xbf7fbdc9
.long 0xbf353f35,0x3e483f7b,0x3f6d3ec4,0x3f55bf0e,0x3ec4bf6d,0xbf22bf46,0xbf7b3e48,0xbe953f75
.long 0xa5543f80,0x3f6d3ec4,0x3f35bf35,0xbec4bf6d,0xbec4bf6d,0xbf7f3dc9,0xbe483f7b,0x3f623ef1
.long 0x3f353f35,0x3f55bf0e,0xbec4bf6d,0xbf7b3e48,0xbf6dbec4,0xbef13f62,0x3f553f0e,0x3f22bf46
.long 0x3f808000,0x3f808000,0x3f808000,0x3f808000,0xbf353f35,0xbf223f46,0xbf0e3f55,0xbef13f62
.long 0x248dbf80,0xbe48bf7b,0xbec4bf6d,0xbf0ebf55,0x3f353f35,0x3f623ef1,0x3f7b3e48,0x3f7fbdc9
.long 0xbf80a50d,0xbf6d3ec4,0xbf353f35,0xbec43f6d,0x3f35bf35,0x3e95bf75,0xbe48bf7b,0xbf22bf46
.long 0xa5543f80,0x3f0e3f55,0x3f6d3ec4,0x3f7bbe48,0xbf35bf35,0xbf7fbdc9,0xbf553f0e,0xbe953f75
.long 0x3f808000,0x3f35bf35,0x248dbf80,0xbf35bf35,0xbf353f35,0x3dc93f7f,0x3f553f0e,0x3f75be95
.long 0x248dbf80,0xbf55bf0e,0xbf6d3ec4,0xbe483f7b,0x3f353f35,0x3f75be95,0x3e48bf7b,0xbf46bf22
.long 0xbf80a50d,0xbec43f6d,0x3f353f35,0x3f6dbec4,0x3f35bf35,0xbef1bf62,0xbf7b3e48,0xbdc93f7f
.long 0xa5543f80,0x3f7b3e48,0x3ec4bf6d,0xbf55bf0e,0xbf35bf35,0xbf463f22,0x3f0e3f55,0x3f62bef1
.long 0x3f808000,0x3f808000,0x3f808000,0x3f808000,0xbec43f6d,0xbe953f75,0xbe483f7b,0xbdc93f7f
.long 0xbf35bf35,0xbf55bf0e,0xbf6dbec4,0xbf7bbe48,0x3f6dbec4,0x3f46bf22,0x3f0ebf55,0x3e95bf75
.long 0xa5543f80,0x3ec43f6d,0x3f353f35,0x3f6d3ec4,0xbf6dbec4,0xbf7f3dc9,0xbf553f0e,0xbef13f62
.long 0x3f35bf35,0x3e48bf7b,0xbec4bf6d,0xbf55bf0e,0x3ec43f6d,0x3f623ef1,0x3f7bbe48,0x3f22bf46
.long 0xbf80a50d,0xbf353f35,0xa5543f80,0x3f353f35,0x3ec4bf6d,0xbef1bf62,0xbf7bbe48,0xbf463f22
.long 0x3f353f35,0x3f7bbe48,0x3ec4bf6d,0xbf0ebf55,0xbf6d3ec4,0xbdc93f7f,0x3f553f0e,0x3f62bef1
.long 0x248dbf80,0xbf6dbec4,0xbf353f35,0x3ec43f6d,0x3f6d3ec4,0x3f22bf46,0xbf0ebf55,0xbf753e95
.long 0xbf353f35,0x3f0e3f55,0x3f6dbec4,0xbe48bf7b,0xbec4bf6d,0xbf753e95,0x3e483f7b,0x3f7fbdc9
.long 0x3f808000,0x3f808000,0x3f808000,0x3f808000,0xa5543f80,0x3dc93f7f,0x3e483f7b,0x3e953f75
.long 0xbf80a50d,0xbf7b3e48,0xbf6d3ec4,0xbf553f0e,0x248dbf80,0xbe95bf75,0xbf0ebf55,0xbf46bf22
.long 0x3f808000,0x3f6dbec4,0x3f35bf35,0x3ec4bf6d,0xa5543f80,0x3ef13f62,0x3f553f0e,0x3f7f3dc9
.long 0xbf80a50d,0xbf553f0e,0xbec43f6d,0x3e483f7b,0x248dbf80,0xbf22bf46,0xbf7bbe48,0xbf623ef1
.long 0x3f808000,0x3f35bf35,0x248dbf80,0xbf35bf35,0xa5543f80,0x3f463f22,0x3f7bbe48,0x3ef1bf62
.long 0xbf80a50d,0xbf0e3f55,0x3ec43f6d,0x3f7b3e48,0x248dbf80,0xbf62bef1,0xbf553f0e,0x3dc93f7f
.long 0x3f808000,0x3ec4bf6d,0xbf35bf35,0xbf6d3ec4,0xa5543f80,0x3f753e95,0x3f0ebf55,0xbf22bf46
.long 0xbf80a50d,0xbe483f7b,0x3f6d3ec4,0x3f0ebf55,0x248dbf80,0xbf7fbdc9,0xbe483f7b,0x3f753e95
.long 0x3f808000,0x3f808000,0x3f808000,0x3f808000,0x3ec43f6d,0x3ef13f62,0x3f0e3f55,0x3f223f46
.long 0xbf353f35,0xbf0e3f55,0xbec43f6d,0xbe483f7b,0xbf6dbec4,0xbf7fbdc9,0xbf7b3e48,0xbf623ef1
.long 0x248dbf80,0xbec4bf6d,0xbf35bf35,0xbf6dbec4,0x3f6dbec4,0x3f22bf46,0x3e48bf7b,0xbe95bf75
.long 0x3f353f35,0x3f7b3e48,0x3f6dbec4,0x3f0ebf55,0xbec43f6d,0x3e953f75,0x3f553f0e,0x3f7fbdc9
.long 0xbf80a50d,0xbf353f35,0xa5543f80,0x3f353f35,0xbec4bf6d,0xbf75be95,0xbf553f0e,0xbdc93f7f
.long 0x3f35bf35,0xbe48bf7b,0xbf6dbec4,0xbf553f0e,0x3f6d3ec4,0x3f46bf22,0xbe48bf7b,0xbf75be95
.long 0xa5543f80,0x3f6d3ec4,0x3f35bf35,0xbec4bf6d,0xbf6d3ec4,0x3dc93f7f,0x3f7b3e48,0x3ef1bf62
.long 0xbf35bf35,0xbf553f0e,0x3ec43f6d,0x3f7bbe48,0x3ec4bf6d,0xbf62bef1,0xbf0e3f55,0x3f463f22
.long 0x3f808000,0x3f808000,0x3f808000,0x3f808000,0x3f353f35,0x3f463f22,0x3f553f0e,0x3f623ef1
.long 0xa5543f80,0x3e483f7b,0x3ec43f6d,0x3f0e3f55,0xbf353f35,0xbef13f62,0xbe483f7b,0x3dc93f7f
.long 0xbf80a50d,0xbf6d3ec4,0xbf353f35,0xbec43f6d,0xbf35bf35,0xbf75be95,0xbf7b3e48,0xbf463f22
.long 0x248dbf80,0xbf0ebf55,0xbf6dbec4,0xbf7b3e48,0x3f35bf35,0x3dc9bf7f,0xbf0ebf55,0xbf75be95
.long 0x3f808000,0x3f35bf35,0x248dbf80,0xbf35bf35,0x3f353f35,0x3f7fbdc9,0x3f0ebf55,0xbe95bf75
.long 0xa5543f80,0x3f553f0e,0x3f6dbec4,0x3e48bf7b,0xbf353f35,0x3e953f75,0x3f7b3e48,0x3f22bf46
.long 0xbf80a50d,0xbec43f6d,0x3f353f35,0x3f6dbec4,0xbf35bf35,0xbf623ef1,0x3e483f7b,0x3f7f3dc9
.long 0x248dbf80,0xbf7bbe48,0xbec43f6d,0x3f553f0e,0x3f35bf35,0xbf22bf46,0xbf553f0e,0x3ef13f62
.long 0x3f808000,0x3f808000,0x3f808000,0x3f808000,0x3f6d3ec4,0x3f753e95,0x3f7b3e48,0x3f7f3dc9
.long 0x3f353f35,0x3f553f0e,0x3f6d3ec4,0x3f7b3e48,0x3ec43f6d,0x3f223f46,0x3f553f0e,0x3f753e95
.long 0xa5543f80,0x3ec43f6d,0x3f353f35,0x3f6d3ec4,0xbec43f6d,0x3dc93f7f,0x3f0e3f55,0x3f623ef1
.long 0xbf353f35,0xbe483f7b,0x3ec43f6d,0x3f553f0e,0xbf6d3ec4,0xbef13f62,0x3e483f7b,0x3f463f22
.long 0xbf80a50d,0xbf353f35,0xa5543f80,0x3f353f35,0xbf6dbec4,0xbf623ef1,0xbe483f7b,0x3f223f46
.long 0xbf35bf35,0xbf7b3e48,0xbec43f6d,0x3f0e3f55,0xbec4bf6d,0xbf7fbdc9,0xbf0e3f55,0x3ef13f62
.long 0x248dbf80,0xbf6dbec4,0xbf353f35,0x3ec43f6d,0x3ec4bf6d,0xbf46bf22,0xbf553f0e,0x3e953f75
.long 0x3f35bf35,0xbf0ebf55,0xbf6d3ec4,0x3e483f7b,0x3f6dbec4,0xbe95bf75,0xbf7b3e48,0x3dc93f7f
.long 0x3f808000,0x248dbf80,0xbf80a50d,0xa5543f80,0x3f808000,0xbdc9bf7f,0xbf7b3e48,0x3e953f75
.long 0x3f808000,0xbe48bf7b,0xbf6d3ec4,0x3f0e3f55,0x3f808000,0xbe95bf75,0xbf553f0e,0x3f463f22
.long 0x3f808000,0xbec4bf6d,0xbf353f35,0x3f6d3ec4,0x3f808000,0xbef1bf62,0xbf0e3f55,0x3f7f3dc9
.long 0x3f808000,0xbf0ebf55,0xbec43f6d,0x3f7bbe48,0x3f808000,0xbf22bf46,0xbe483f7b,0x3f62bef1
.long 0x3f808000,0xbf35bf35,0xa5543f80,0x3f35bf35,0x3f808000,0xbf46bf22,0x3e483f7b,0x3ef1bf62
.long 0x3f808000,0xbf55bf0e,0x3ec43f6d,0x3e48bf7b,0x3f808000,0xbf62bef1,0x3f0e3f55,0xbdc9bf7f
.long 0x3f808000,0xbf6dbec4,0x3f353f35,0xbec4bf6d,0x3f808000,0xbf75be95,0x3f553f0e,0xbf22bf46
.long 0x3f808000,0xbf7bbe48,0x3f6d3ec4,0xbf55bf0e,0x3f808000,0xbf7fbdc9,0x3f7b3e48,0xbf75be95
.long 0x3f808000,0x248dbf80,0xbf80a50d,0xa5543f80,0x3f6dbec4,0xbef1bf62,0xbf553f0e,0x3f223f46
.long 0x3f35bf35,0xbf55bf0e,0xbec43f6d,0x3f7b3e48,0x3ec4bf6d,0xbf7fbdc9,0x3e483f7b,0x3f62bef1
.long 0x248dbf80,0xbf6d3ec4,0x3f353f35,0x3ec4bf6d,0xbec4bf6d,0xbf223f46,0x3f7b3e48,0xbe95bf75
.long 0xbf35bf35,0xbe483f7b,0x3f6dbec4,0xbf55bf0e,0xbf6dbec4,0x3e953f75,0x3f0ebf55,0xbf7f3dc9
.long 0xbf80a50d,0x3f353f35,0x248dbf80,0xbf353f35,0xbf6d3ec4,0x3f753e95,0xbf0ebf55,0xbdc93f7f
.long 0xbf353f35,0x3f7bbe48,0xbf6dbec4,0x3f0e3f55,0xbec43f6d,0x3f46bf22,0xbf7b3e48,0x3f753e95
.long 0xa5543f80,0x3ec4bf6d,0xbf353f35,0x3f6dbec4,0x3ec43f6d,0xbdc9bf7f,0xbe483f7b,0x3ef1bf62
.long 0x3f353f35,0xbf0ebf55,0x3ec43f6d,0xbe48bf7b,0x3f6d3ec4,0xbf62bef1,0x3f553f0e,0xbf46bf22
.long 0x3f808000,0x248dbf80,0xbf80a50d,0xa5543f80,0x3f35bf35,0xbf46bf22,0xbf0e3f55,0x3f623ef1
.long 0x248dbf80,0xbf7b3e48,0x3ec43f6d,0x3f55bf0e,0xbf35bf35,0xbef13f62,0x3f7b3e48,0xbdc9bf7f
.long 0xbf80a50d,0x3ec43f6d,0x3f35bf35,0xbf6dbec4,0xbf353f35,0x3f753e95,0xbe48bf7b,0xbf463f22
.long 0xa5543f80,0x3f55bf0e,0xbf6dbec4,0x3e483f7b,0x3f353f35,0x3dc9bf7f,0xbf553f0e,0x3f753e95
.long 0x3f808000,0xbf35bf35,0xa5543f80,0x3f35bf35,0x3f35bf35,0xbf7f3dc9,0x3f553f0e,0xbe95bf75
.long 0x248dbf80,0xbf0e3f55,0x3f6dbec4,0xbf7bbe48,0xbf35bf35,0x3e953f75,0x3e48bf7b,0xbf223f46
.long 0xbf80a50d,0x3f6d3ec4,0xbf35bf35,0x3ec43f6d,0xbf353f35,0x3f62bef1,0xbf7b3e48,0x3f7f3dc9
.long 0xa5543f80,0x3e48bf7b,0xbec43f6d,0x3f0ebf55,0x3f353f35,0xbf22bf46,0x3f0e3f55,0xbef1bf62
.long 0x3f808000,0x248dbf80,0xbf80a50d,0xa5543f80,0x3ec4bf6d,0xbf75be95,0xbe483f7b,0x3f7f3dc9
.long 0xbf35bf35,0xbf0e3f55,0x3f6d3ec4,0x3e48bf7b,0xbf6d3ec4,0x3f223f46,0x3f0ebf55,0xbf75be95
.long 0xa5543f80,0x3f6dbec4,0xbf35bf35,0xbec43f6d,0x3f6d3ec4,0xbdc9bf7f,0xbf553f0e,0x3f623ef1
.long 0x3f35bf35,0xbf7bbe48,0x3ec43f6d,0x3f0ebf55,0xbec4bf6d,0xbef13f62,0x3f7bbe48,0xbf46bf22
.long 0xbf80a50d,0x3f353f35,0x248dbf80,0xbf353f35,0xbec43f6d,0x3f62bef1,0xbf7bbe48,0x3f223f46
.long 0x3f353f35,0xbe48bf7b,0xbec43f6d,0x3f55bf0e,0x3f6dbec4,0xbf7fbdc9,0x3f553f0e,0xbef1bf62
.long 0x248dbf80,0xbec43f6d,0x3f35bf35,0xbf6d3ec4,0xbf6dbec4,0x3f463f22,0xbf0ebf55,0x3e953f75
.long 0xbf353f35,0x3f55bf0e,0xbf6d3ec4,0x3f7bbe48,0x3ec43f6d,0xbe95bf75,0x3e483f7b,0xbdc9bf7f
.long 0x3f808000,0x248dbf80,0xbf80a50d,0xa5543f80,0x248dbf80,0xbf7f3dc9,0x3e483f7b,0x3f75be95
.long 0xbf80a50d,0x3e483f7b,0x3f6dbec4,0xbf0ebf55,0xa5543f80,0x3f75be95,0xbf0ebf55,0xbf223f46
.long 0x3f808000,0xbec4bf6d,0xbf353f35,0x3f6d3ec4,0x248dbf80,0xbf623ef1,0x3f553f0e,0x3dc9bf7f
.long 0xbf80a50d,0x3f0e3f55,0x3ec4bf6d,0xbf7b3e48,0xa5543f80,0x3f46bf22,0xbf7bbe48,0x3ef13f62
.long 0x3f808000,0xbf35bf35,0xa5543f80,0x3f35bf35,0x248dbf80,0xbf223f46,0x3f7bbe48,0xbf62bef1
.long 0xbf80a50d,0x3f553f0e,0xbec4bf6d,0xbe483f7b,0xa5543f80,0x3ef1bf62,0xbf553f0e,0x3f7fbdc9
.long 0x3f808000,0xbf6dbec4,0x3f353f35,0xbec4bf6d,0x248dbf80,0xbe953f75,0x3f0ebf55,0xbf463f22
.long 0xbf80a50d,0x3f7b3e48,0xbf6dbec4,0x3f553f0e,0xa5543f80,0x3dc9bf7f,0xbe483f7b,0x3e95bf75
.long 0x3f808000,0x248dbf80,0xbf80a50d,0xa5543f80,0xbec4bf6d,0xbf623ef1,0x3f0e3f55,0x3f46bf22
.long 0xbf353f35,0x3f553f0e,0x3ec4bf6d,0xbf7bbe48,0x3f6d3ec4,0x3dc9bf7f,0xbf7b3e48,0x3ef13f62
.long 0x248dbf80,0xbf6d3ec4,0x3f353f35,0x3ec4bf6d,0xbf6d3ec4,0x3f463f22,0x3e48bf7b,0xbf753e95
.long 0x3f353f35,0x3e48bf7b,0xbf6d3ec4,0x3f553f0e,0x3ec4bf6d,0xbf753e95,0x3f553f0e,0xbdc9bf7f
.long 0xbf80a50d,0x3f353f35,0x248dbf80,0xbf353f35,0x3ec43f6d,0x3e95bf75,0xbf553f0e,0x3f7f3dc9
.long 0x3f35bf35,0xbf7b3e48,0x3f6d3ec4,0xbf0ebf55,0xbf6dbec4,0x3f223f46,0xbe48bf7b,0xbe953f75
.long 0xa5543f80,0x3ec4bf6d,0xbf353f35,0x3f6dbec4,0x3f6dbec4,0xbf7f3dc9,0x3f7b3e48,0xbf62bef1
.long 0xbf35bf35,0x3f0e3f55,0xbec4bf6d,0x3e483f7b,0xbec43f6d,0x3ef1bf62,0xbf0e3f55,0x3f22bf46
.long 0x3f808000,0x248dbf80,0xbf80a50d,0xa5543f80,0xbf35bf35,0xbf223f46,0x3f553f0e,0x3ef1bf62
.long 0xa5543f80,0x3f7bbe48,0xbec4bf6d,0xbf553f0e,0x3f35bf35,0xbf62bef1,0xbe483f7b,0x3f7fbdc9
.long 0xbf80a50d,0x3ec43f6d,0x3f35bf35,0xbf6dbec4,0x3f353f35,0x3e95bf75,0xbf7b3e48,0x3f223f46
.long 0x248dbf80,0xbf553f0e,0x3f6d3ec4,0xbe48bf7b,0xbf353f35,0x3f7f3dc9,0xbf0ebf55,0xbe953f75
.long 0x3f808000,0xbf35bf35,0xa5543f80,0x3f35bf35,0xbf35bf35,0x3dc93f7f,0x3f0ebf55,0xbf753e95
.long 0xa5543f80,0x3f0ebf55,0xbf6d3ec4,0x3f7b3e48,0x3f35bf35,0xbf753e95,0x3f7b3e48,0xbf46bf22
.long 0xbf80a50d,0x3f6d3ec4,0xbf35bf35,0x3ec43f6d,0x3f353f35,0xbef1bf62,0x3e483f7b,0x3dc9bf7f
.long 0x248dbf80,0xbe483f7b,0x3ec4bf6d,0xbf0e3f55,0xbf353f35,0x3f46bf22,0xbf553f0e,0x3f62bef1
.long 0x3f808000,0x248dbf80,0xbf80a50d,0xa5543f80,0xbf6dbec4,0xbe953f75,0x3f7b3e48,0x3dc9bf7f
.long 0x3f353f35,0x3f0ebf55,0xbf6dbec4,0xbe483f7b,0xbec4bf6d,0xbf463f22,0x3f553f0e,0x3e95bf75
.long 0xa5543f80,0x3f6dbec4,0xbf35bf35,0xbec43f6d,0x3ec4bf6d,0xbf7f3dc9,0x3f0e3f55,0x3ef1bf62
.long 0xbf353f35,0x3f7b3e48,0xbec4bf6d,0xbf0e3f55,0x3f6dbec4,0xbf62bef1,0x3e483f7b,0x3f22bf46
.long 0xbf80a50d,0x3f353f35,0x248dbf80,0xbf353f35,0x3f6d3ec4,0xbef1bf62,0xbe483f7b,0x3f46bf22
.long 0xbf35bf35,0x3e483f7b,0x3ec4bf6d,0xbf553f0e,0x3ec43f6d,0x3dc9bf7f,0xbf0e3f55,0x3f62bef1
.long 0x248dbf80,0xbec43f6d,0x3f35bf35,0xbf6d3ec4,0xbec43f6d,0x3f22bf46,0xbf553f0e,0x3f75be95
.long 0x3f35bf35,0xbf553f0e,0x3f6dbec4,0xbf7b3e48,0xbf6d3ec4,0x3f75be95,0xbf7b3e48,0x3f7fbdc9
.long 0x3f808000,0x248dbf80,0xbf80a50d,0xa5543f80,0xbf80a50d,0x3dc93f7f,0x3f7bbe48,0xbe95bf75
.long 0x3f808000,0xbe48bf7b,0xbf6d3ec4,0x3f0e3f55,0xbf80a50d,0x3e953f75,0x3f55bf0e,0xbf46bf22
.long 0x3f808000,0xbec4bf6d,0xbf353f35,0x3f6d3ec4,0xbf80a50d,0x3ef13f62,0x3f0ebf55,0xbf7fbdc9
.long 0x3f808000,0xbf0ebf55,0xbec43f6d,0x3f7bbe48,0xbf80a50d,0x3f223f46,0x3e48bf7b,0xbf623ef1
.long 0x3f808000,0xbf35bf35,0xa5543f80,0x3f35bf35,0xbf80a50d,0x3f463f22,0xbe48bf7b,0xbef13f62
.long 0x3f808000,0xbf55bf0e,0x3ec43f6d,0x3e48bf7b,0xbf80a50d,0x3f623ef1,0xbf0ebf55,0x3dc93f7f
.long 0x3f808000,0xbf6dbec4,0x3f353f35,0xbec4bf6d,0xbf80a50d,0x3f753e95,0xbf55bf0e,0x3f223f46
.long 0x3f808000,0xbf7bbe48,0x3f6d3ec4,0xbf55bf0e,0xbf80a50d,0x3f7f3dc9,0xbf7bbe48,0x3f753e95
.long 0x3f808000,0x248dbf80,0xbf80a50d,0xa5543f80,0xbf6d3ec4,0x3ef13f62,0x3f55bf0e,0xbf22bf46
.long 0x3f35bf35,0xbf55bf0e,0xbec43f6d,0x3f7b3e48,0xbec43f6d,0x3f7f3dc9,0xbe48bf7b,0xbf623ef1
.long 0x248dbf80,0xbf6d3ec4,0x3f353f35,0x3ec4bf6d,0x3ec43f6d,0x3f22bf46,0xbf7bbe48,0x3e953f75
.long 0xbf35bf35,0xbe483f7b,0x3f6dbec4,0xbf55bf0e,0x3f6d3ec4,0xbe95bf75,0xbf0e3f55,0x3f7fbdc9
.long 0xbf80a50d,0x3f353f35,0x248dbf80,0xbf353f35,0x3f6dbec4,0xbf75be95,0x3f0e3f55,0x3dc9bf7f
.long 0xbf353f35,0x3f7bbe48,0xbf6dbec4,0x3f0e3f55,0x3ec4bf6d,0xbf463f22,0x3f7bbe48,0xbf75be95
.long 0xa5543f80,0x3ec4bf6d,0xbf353f35,0x3f6dbec4,0xbec4bf6d,0x3dc93f7f,0x3e48bf7b,0xbef13f62
.long 0x3f353f35,0xbf0ebf55,0x3ec43f6d,0xbe48bf7b,0xbf6dbec4,0x3f623ef1,0xbf55bf0e,0x3f463f22
.long 0x3f808000,0x248dbf80,0xbf80a50d,0xa5543f80,0xbf353f35,0x3f463f22,0x3f0ebf55,0xbf62bef1
.long 0x248dbf80,0xbf7b3e48,0x3ec43f6d,0x3f55bf0e,0x3f353f35,0x3ef1bf62,0xbf7bbe48,0x3dc93f7f
.long 0xbf80a50d,0x3ec43f6d,0x3f35bf35,0xbf6dbec4,0x3f35bf35,0xbf75be95,0x3e483f7b,0x3f46bf22
.long 0xa5543f80,0x3f55bf0e,0xbf6dbec4,0x3e483f7b,0xbf35bf35,0xbdc93f7f,0x3f55bf0e,0xbf75be95
.long 0x3f808000,0xbf35bf35,0xa5543f80,0x3f35bf35,0xbf353f35,0x3f7fbdc9,0xbf55bf0e,0x3e953f75
.long 0x248dbf80,0xbf0e3f55,0x3f6dbec4,0xbf7bbe48,0x3f353f35,0xbe95bf75,0xbe483f7b,0x3f22bf46
.long 0xbf80a50d,0x3f6d3ec4,0xbf35bf35,0x3ec43f6d,0x3f35bf35,0xbf623ef1,0x3f7bbe48,0xbf7fbdc9
.long 0xa5543f80,0x3e48bf7b,0xbec43f6d,0x3f0ebf55,0xbf35bf35,0x3f223f46,0xbf0ebf55,0x3ef13f62
.long 0x3f808000,0x248dbf80,0xbf80a50d,0xa5543f80,0xbec43f6d,0x3f753e95,0x3e48bf7b,0xbf7fbdc9
.long 0xbf35bf35,0xbf0e3f55,0x3f6d3ec4,0x3e48bf7b,0x3f6dbec4,0xbf22bf46,0xbf0e3f55,0x3f753e95
.long 0xa5543f80,0x3f6dbec4,0xbf35bf35,0xbec43f6d,0xbf6dbec4,0x3dc93f7f,0x3f55bf0e,0xbf62bef1
.long 0x3f35bf35,0xbf7bbe48,0x3ec43f6d,0x3f0ebf55,0x3ec43f6d,0x3ef1bf62,0xbf7b3e48,0x3f463f22
.long 0xbf80a50d,0x3f353f35,0x248dbf80,0xbf353f35,0x3ec4bf6d,0xbf623ef1,0x3f7b3e48,0xbf22bf46
.long 0x3f353f35,0xbe48bf7b,0xbec43f6d,0x3f55bf0e,0xbf6d3ec4,0x3f7f3dc9,0xbf55bf0e,0x3ef13f62
.long 0x248dbf80,0xbec43f6d,0x3f35bf35,0xbf6d3ec4,0x3f6d3ec4,0xbf46bf22,0x3f0e3f55,0xbe95bf75
.long 0xbf353f35,0x3f55bf0e,0xbf6d3ec4,0x3f7bbe48,0xbec4bf6d,0x3e953f75,0xbe48bf7b,0x3dc93f7f
.long 0x3f808000,0x248dbf80,0xbf80a50d,0xa5543f80,0xa5543f80,0x3f7fbdc9,0xbe48bf7b,0xbf753e95
.long 0xbf80a50d,0x3e483f7b,0x3f6dbec4,0xbf0ebf55,0x248dbf80,0xbf753e95,0x3f0e3f55,0x3f22bf46
.long 0x3f808000,0xbec4bf6d,0xbf353f35,0x3f6d3ec4,0xa5543f80,0x3f62bef1,0xbf55bf0e,0xbdc93f7f
.long 0xbf80a50d,0x3f0e3f55,0x3ec4bf6d,0xbf7b3e48,0x248dbf80,0xbf463f22,0x3f7b3e48,0xbef1bf62
.long 0x3f808000,0xbf35bf35,0xa5543f80,0x3f35bf35,0xa5543f80,0x3f22bf46,0xbf7b3e48,0x3f623ef1
.long 0xbf80a50d,0x3f553f0e,0xbec4bf6d,0xbe483f7b,0x248dbf80,0xbef13f62,0x3f55bf0e,0xbf7f3dc9
.long 0x3f808000,0xbf6dbec4,0x3f353f35,0xbec4bf6d,0xa5543f80,0x3e95bf75,0xbf0e3f55,0x3f46bf22
.long 0xbf80a50d,0x3f7b3e48,0xbf6dbec4,0x3f553f0e,0x248dbf80,0xbdc93f7f,0x3e48bf7b,0xbe953f75
.long 0x3f808000,0x248dbf80,0xbf80a50d,0xa5543f80,0x3ec43f6d,0x3f62bef1,0xbf0ebf55,0xbf463f22
.long 0xbf353f35,0x3f553f0e,0x3ec4bf6d,0xbf7bbe48,0xbf6dbec4,0xbdc93f7f,0x3f7bbe48,0xbef1bf62
.long 0x248dbf80,0xbf6d3ec4,0x3f353f35,0x3ec4bf6d,0x3f6dbec4,0xbf46bf22,0xbe483f7b,0x3f75be95
.long 0x3f353f35,0x3e48bf7b,0xbf6d3ec4,0x3f553f0e,0xbec43f6d,0x3f75be95,0xbf55bf0e,0x3dc93f7f
.long 0xbf80a50d,0x3f353f35,0x248dbf80,0xbf353f35,0xbec4bf6d,0xbe953f75,0x3f55bf0e,0xbf7fbdc9
.long 0x3f35bf35,0xbf7b3e48,0x3f6d3ec4,0xbf0ebf55,0x3f6d3ec4,0xbf22bf46,0x3e483f7b,0x3e95bf75
.long 0xa5543f80,0x3ec4bf6d,0xbf353f35,0x3f6dbec4,0xbf6d3ec4,0x3f7fbdc9,0xbf7bbe48,0x3f623ef1
.long 0xbf35bf35,0x3f0e3f55,0xbec4bf6d,0x3e483f7b,0x3ec4bf6d,0xbef13f62,0x3f0ebf55,0xbf223f46
.long 0x3f808000,0x248dbf80,0xbf80a50d,0xa5543f80,0x3f353f35,0x3f22bf46,0xbf55bf0e,0xbef13f62
.long 0xa5543f80,0x3f7bbe48,0xbec4bf6d,0xbf553f0e,0xbf353f35,0x3f623ef1,0x3e48bf7b,0xbf7f3dc9
.long 0xbf80a50d,0x3ec43f6d,0x3f35bf35,0xbf6dbec4,0xbf35bf35,0xbe953f75,0x3f7bbe48,0xbf22bf46
.long 0x248dbf80,0xbf553f0e,0x3f6d3ec4,0xbe48bf7b,0x3f35bf35,0xbf7fbdc9,0x3f0e3f55,0x3e95bf75
.long 0x3f808000,0xbf35bf35,0xa5543f80,0x3f35bf35,0x3f353f35,0xbdc9bf7f,0xbf0e3f55,0x3f75be95
.long 0xa5543f80,0x3f0ebf55,0xbf6d3ec4,0x3f7b3e48,0xbf353f35,0x3f75be95,0xbf7bbe48,0x3f463f22
.long 0xbf80a50d,0x3f6d3ec4,0xbf35bf35,0x3ec43f6d,0xbf35bf35,0x3ef13f62,0xbe48bf7b,0xbdc93f7f
.long 0x248dbf80,0xbe483f7b,0x3ec4bf6d,0xbf0e3f55,0x3f35bf35,0xbf463f22,0x3f55bf0e,0xbf623ef1
.long 0x3f808000,0x248dbf80,0xbf80a50d,0xa5543f80,0x3f6d3ec4,0x3e95bf75,0xbf7bbe48,0xbdc93f7f
.long 0x3f353f35,0x3f0ebf55,0xbf6dbec4,0xbe483f7b,0x3ec43f6d,0x3f46bf22,0xbf55bf0e,0xbe953f75
.long 0xa5543f80,0x3f6dbec4,0xbf35bf35,0xbec43f6d,0xbec43f6d,0x3f7fbdc9,0xbf0ebf55,0xbef13f62
.long 0xbf353f35,0x3f7b3e48,0xbec4bf6d,0xbf0e3f55,0xbf6d3ec4,0x3f623ef1,0xbe48bf7b,0xbf223f46
.long 0xbf80a50d,0x3f353f35,0x248dbf80,0xbf353f35,0xbf6dbec4,0x3ef13f62,0x3e48bf7b,0xbf463f22
.long 0xbf35bf35,0x3e483f7b,0x3ec4bf6d,0xbf553f0e,0xbec4bf6d,0xbdc93f7f,0x3f0ebf55,0xbf623ef1
.long 0x248dbf80,0xbec43f6d,0x3f35bf35,0xbf6d3ec4,0x3ec4bf6d,0xbf223f46,0x3f55bf0e,0xbf753e95
.long 0x3f35bf35,0xbf553f0e,0x3f6dbec4,0xbf7b3e48,0x3f6dbec4,0xbf753e95,0x3f7bbe48,0xbf7f3dc9
.long 0x3f808000,0xbf80a50d,0x3f808000,0xbf80a50d,0x3f808000,0xbf7f3dc9,0x3f7bbe48,0xbf753e95
.long 0x3f808000,0xbf7b3e48,0x3f6dbec4,0xbf553f0e,0x3f808000,0xbf753e95,0x3f55bf0e,0xbf223f46
.long 0x3f808000,0xbf6d3ec4,0x3f35bf35,0xbec43f6d,0x3f808000,0xbf623ef1,0x3f0ebf55,0xbdc93f7f
.long 0x3f808000,0xbf553f0e,0x3ec4bf6d,0x3e483f7b,0x3f808000,0xbf463f22,0x3e48bf7b,0x3ef13f62
.long 0x3f808000,0xbf353f35,0x248dbf80,0x3f353f35,0x3f808000,0xbf223f46,0xbe48bf7b,0x3f623ef1
.long 0x3f808000,0xbf0e3f55,0xbec4bf6d,0x3f7b3e48,0x3f808000,0xbef13f62,0xbf0ebf55,0x3f7fbdc9
.long 0x3f808000,0xbec43f6d,0xbf35bf35,0x3f6dbec4,0x3f808000,0xbe953f75,0xbf55bf0e,0x3f46bf22
.long 0x3f808000,0xbe483f7b,0xbf6dbec4,0x3f0ebf55,0x3f808000,0xbdc93f7f,0xbf7bbe48,0x3e95bf75
.long 0x3f808000,0xbf80a50d,0x3f808000,0xbf80a50d,0x3f6dbec4,0xbf623ef1,0x3f55bf0e,0xbf463f22
.long 0x3f35bf35,0xbf0e3f55,0x3ec4bf6d,0xbe483f7b,0x3ec4bf6d,0xbdc93f7f,0xbe48bf7b,0x3ef13f62
.long 0x248dbf80,0x3ec43f6d,0xbf35bf35,0x3f6d3ec4,0xbec4bf6d,0x3f463f22,0xbf7bbe48,0x3f75be95
.long 0xbf35bf35,0x3f7b3e48,0xbf6d3ec4,0x3f0ebf55,0xbf6dbec4,0x3f75be95,0xbf0e3f55,0xbdc9bf7f
.long 0xbf80a50d,0x3f35bf35,0xa5543f80,0xbf35bf35,0xbf6d3ec4,0x3e95bf75,0x3f0e3f55,0xbf7fbdc9
.long 0xbf353f35,0xbe48bf7b,0x3f6d3ec4,0xbf553f0e,0xbec43f6d,0xbf22bf46,0x3f7bbe48,0xbe953f75
.long 0xa5543f80,0xbf6dbec4,0x3f35bf35,0x3ec43f6d,0x3ec43f6d,0xbf7f3dc9,0x3e48bf7b,0x3f623ef1
.long 0x3f353f35,0xbf553f0e,0xbec4bf6d,0x3f7bbe48,0x3f6d3ec4,0xbef13f62,0xbf55bf0e,0x3f22bf46
.long 0x3f808000,0xbf80a50d,0x3f808000,0xbf80a50d,0x3f35bf35,0xbf223f46,0x3f0ebf55,0xbef13f62
.long 0x248dbf80,0x3e483f7b,0xbec4bf6d,0x3f0e3f55,0xbf35bf35,0x3f623ef1,0xbf7bbe48,0x3f7fbdc9
.long 0xbf80a50d,0x3f6dbec4,0xbf353f35,0x3ec4bf6d,0xbf353f35,0x3e95bf75,0x3e483f7b,0xbf22bf46
.long 0xa5543f80,0xbf0ebf55,0x3f6d3ec4,0xbf7b3e48,0x3f353f35,0xbf7fbdc9,0x3f55bf0e,0xbe953f75
.long 0x3f808000,0xbf353f35,0x248dbf80,0x3f353f35,0x3f35bf35,0x3dc93f7f,0xbf55bf0e,0x3f75be95
.long 0x248dbf80,0x3f553f0e,0xbf6d3ec4,0x3e48bf7b,0xbf35bf35,0x3f75be95,0xbe483f7b,0xbf46bf22
.long 0xbf80a50d,0x3ec4bf6d,0x3f353f35,0xbf6d3ec4,0xbf353f35,0xbef1bf62,0x3f7bbe48,0xbdc93f7f
.long 0xa5543f80,0xbf7bbe48,0x3ec4bf6d,0x3f553f0e,0x3f353f35,0xbf463f22,0xbf0ebf55,0x3f62bef1
.long 0x3f808000,0xbf80a50d,0x3f808000,0xbf80a50d,0x3ec4bf6d,0xbe953f75,0x3e48bf7b,0xbdc93f7f
.long 0xbf35bf35,0x3f553f0e,0xbf6dbec4,0x3f7b3e48,0xbf6d3ec4,0x3f46bf22,0xbf0e3f55,0x3e95bf75
.long 0xa5543f80,0xbec4bf6d,0x3f353f35,0xbf6dbec4,0x3f6d3ec4,0xbf7f3dc9,0x3f55bf0e,0xbef13f62
.long 0x3f35bf35,0xbe483f7b,0xbec4bf6d,0x3f553f0e,0xbec4bf6d,0x3f623ef1,0xbf7b3e48,0x3f22bf46
.long 0xbf80a50d,0x3f35bf35,0xa5543f80,0xbf35bf35,0xbec43f6d,0xbef1bf62,0x3f7b3e48,0xbf463f22
.long 0x3f353f35,0xbf7b3e48,0x3ec4bf6d,0x3f0e3f55,0x3f6dbec4,0xbdc93f7f,0xbf55bf0e,0x3f62bef1
.long 0x248dbf80,0x3f6d3ec4,0xbf353f35,0xbec4bf6d,0xbf6dbec4,0x3f22bf46,0x3f0e3f55,0xbf753e95
.long 0xbf353f35,0xbf0ebf55,0x3f6dbec4,0x3e483f7b,0x3ec43f6d,0xbf753e95,0xbe48bf7b,0x3f7fbdc9
.long 0x3f808000,0xbf80a50d,0x3f808000,0xbf80a50d,0x248dbf80,0x3dc93f7f,0xbe48bf7b,0x3e953f75
.long 0xbf80a50d,0x3f7bbe48,0xbf6d3ec4,0x3f55bf0e,0xa5543f80,0xbe95bf75,0x3f0e3f55,0xbf46bf22
.long 0x3f808000,0xbf6d3ec4,0x3f35bf35,0xbec43f6d,0x248dbf80,0x3ef13f62,0xbf55bf0e,0x3f7f3dc9
.long 0xbf80a50d,0x3f55bf0e,0xbec43f6d,0xbe48bf7b,0xa5543f80,0xbf22bf46,0x3f7b3e48,0xbf623ef1
.long 0x3f808000,0xbf353f35,0x248dbf80,0x3f353f35,0x248dbf80,0x3f463f22,0xbf7b3e48,0x3ef1bf62
.long 0xbf80a50d,0x3f0ebf55,0x3ec43f6d,0xbf7bbe48,0xa5543f80,0xbf62bef1,0x3f55bf0e,0x3dc93f7f
.long 0x3f808000,0xbec43f6d,0xbf35bf35,0x3f6dbec4,0x248dbf80,0x3f753e95,0xbf0e3f55,0xbf22bf46
.long 0xbf80a50d,0x3e48bf7b,0x3f6d3ec4,0xbf0e3f55,0xa5543f80,0xbf7fbdc9,0x3e48bf7b,0x3f753e95
.long 0x3f808000,0xbf80a50d,0x3f808000,0xbf80a50d,0xbec4bf6d,0x3ef13f62,0xbf0ebf55,0x3f223f46
.long 0xbf353f35,0x3f0ebf55,0xbec43f6d,0x3e48bf7b,0x3f6d3ec4,0xbf7fbdc9,0x3f7bbe48,0xbf623ef1
.long 0x248dbf80,0x3ec43f6d,0xbf35bf35,0x3f6d3ec4,0xbf6d3ec4,0x3f22bf46,0xbe483f7b,0xbe95bf75
.long 0x3f353f35,0xbf7bbe48,0x3f6dbec4,0xbf0e3f55,0x3ec4bf6d,0x3e953f75,0xbf55bf0e,0x3f7fbdc9
.long 0xbf80a50d,0x3f35bf35,0xa5543f80,0xbf35bf35,0x3ec43f6d,0xbf75be95,0x3f55bf0e,0xbdc93f7f
.long 0x3f35bf35,0x3e483f7b,0xbf6dbec4,0x3f55bf0e,0xbf6dbec4,0x3f46bf22,0x3e483f7b,0xbf75be95
.long 0xa5543f80,0xbf6dbec4,0x3f35bf35,0x3ec43f6d,0x3f6dbec4,0x3dc93f7f,0xbf7bbe48,0x3ef1bf62
.long 0xbf35bf35,0x3f55bf0e,0x3ec43f6d,0xbf7b3e48,0xbec43f6d,0xbf62bef1,0x3f0ebf55,0x3f463f22
.long 0x3f808000,0xbf80a50d,0x3f808000,0xbf80a50d,0xbf35bf35,0x3f463f22,0xbf55bf0e,0x3f623ef1
.long 0xa5543f80,0xbe48bf7b,0x3ec43f6d,0xbf0ebf55,0x3f35bf35,0xbef13f62,0x3e48bf7b,0x3dc93f7f
.long 0xbf80a50d,0x3f6dbec4,0xbf353f35,0x3ec4bf6d,0x3f353f35,0xbf75be95,0x3f7bbe48,0xbf463f22
.long 0x248dbf80,0x3f0e3f55,0xbf6dbec4,0x3f7bbe48,0xbf353f35,0x3dc9bf7f,0x3f0e3f55,0xbf75be95
.long 0x3f808000,0xbf353f35,0x248dbf80,0x3f353f35,0xbf35bf35,0x3f7fbdc9,0xbf0e3f55,0xbe95bf75
.long 0xa5543f80,0xbf55bf0e,0x3f6dbec4,0xbe483f7b,0x3f35bf35,0x3e953f75,0xbf7bbe48,0x3f22bf46
.long 0xbf80a50d,0x3ec4bf6d,0x3f353f35,0xbf6d3ec4,0x3f353f35,0xbf623ef1,0xbe48bf7b,0x3f7f3dc9
.long 0x248dbf80,0x3f7b3e48,0xbec43f6d,0xbf55bf0e,0xbf353f35,0xbf22bf46,0x3f55bf0e,0x3ef13f62
.long 0x3f808000,0xbf80a50d,0x3f808000,0xbf80a50d,0xbf6dbec4,0x3f753e95,0xbf7bbe48,0x3f7f3dc9
.long 0x3f353f35,0xbf55bf0e,0x3f6d3ec4,0xbf7bbe48,0xbec4bf6d,0x3f223f46,0xbf55bf0e,0x3f753e95
.long 0xa5543f80,0xbec4bf6d,0x3f353f35,0xbf6dbec4,0x3ec4bf6d,0x3dc93f7f,0xbf0ebf55,0x3f623ef1
.long 0xbf353f35,0x3e48bf7b,0x3ec43f6d,0xbf55bf0e,0x3f6dbec4,0xbef13f62,0xbe48bf7b,0x3f463f22
.long 0xbf80a50d,0x3f35bf35,0xa5543f80,0xbf35bf35,0x3f6d3ec4,0xbf623ef1,0x3e48bf7b,0x3f223f46
.long 0xbf35bf35,0x3f7bbe48,0xbec43f6d,0xbf0ebf55,0x3ec43f6d,0xbf7fbdc9,0x3f0ebf55,0x3ef13f62
.long 0x248dbf80,0x3f6d3ec4,0xbf353f35,0xbec4bf6d,0xbec43f6d,0xbf46bf22,0x3f55bf0e,0x3e953f75
.long 0x3f35bf35,0x3f0e3f55,0xbf6d3ec4,0xbe48bf7b,0xbf6d3ec4,0xbe95bf75,0x3f7bbe48,0x3dc93f7f
.long 0x3f808000,0xbf80a50d,0x3f808000,0xbf80a50d,0xbf80a50d,0x3f7fbdc9,0xbf7b3e48,0x3f75be95
.long 0x3f808000,0xbf7b3e48,0x3f6dbec4,0xbf553f0e,0xbf80a50d,0x3f75be95,0xbf553f0e,0x3f22bf46
.long 0x3f808000,0xbf6d3ec4,0x3f35bf35,0xbec43f6d,0xbf80a50d,0x3f62bef1,0xbf0e3f55,0x3dc9bf7f
.long 0x3f808000,0xbf553f0e,0x3ec4bf6d,0x3e483f7b,0xbf80a50d,0x3f46bf22,0xbe483f7b,0xbef1bf62
.long 0x3f808000,0xbf353f35,0x248dbf80,0x3f353f35,0xbf80a50d,0x3f22bf46,0x3e483f7b,0xbf62bef1
.long 0x3f808000,0xbf0e3f55,0xbec4bf6d,0x3f7b3e48,0xbf80a50d,0x3ef1bf62,0x3f0e3f55,0xbf7f3dc9
.long 0x3f808000,0xbec43f6d,0xbf35bf35,0x3f6dbec4,0xbf80a50d,0x3e95bf75,0x3f553f0e,0xbf463f22
.long 0x3f808000,0xbe483f7b,0xbf6dbec4,0x3f0ebf55,0xbf80a50d,0x3dc9bf7f,0x3f7b3e48,0xbe953f75
.long 0x3f808000,0xbf80a50d,0x3f808000,0xbf80a50d,0xbf6d3ec4,0x3f62bef1,0xbf553f0e,0x3f46bf22
.long 0x3f35bf35,0xbf0e3f55,0x3ec4bf6d,0xbe483f7b,0xbec43f6d,0x3dc9bf7f,0x3e483f7b,0xbef1bf62
.long 0x248dbf80,0x3ec43f6d,0xbf35bf35,0x3f6d3ec4,0x3ec43f6d,0xbf46bf22,0x3f7b3e48,0xbf753e95
.long 0xbf35bf35,0x3f7b3e48,0xbf6d3ec4,0x3f0ebf55,0x3f6d3ec4,0xbf753e95,0x3f0ebf55,0x3dc93f7f
.long 0xbf80a50d,0x3f35bf35,0xa5543f80,0xbf35bf35,0x3f6dbec4,0xbe953f75,0xbf0ebf55,0x3f7f3dc9
.long 0xbf353f35,0xbe48bf7b,0x3f6d3ec4,0xbf553f0e,0x3ec4bf6d,0x3f223f46,0xbf7b3e48,0x3e95bf75
.long 0xa5543f80,0xbf6dbec4,0x3f35bf35,0x3ec43f6d,0xbec4bf6d,0x3f7fbdc9,0xbe483f7b,0xbf62bef1
.long 0x3f353f35,0xbf553f0e,0xbec4bf6d,0x3f7bbe48,0xbf6dbec4,0x3ef1bf62,0x3f553f0e,0xbf223f46
.long 0x3f808000,0xbf80a50d,0x3f808000,0xbf80a50d,0xbf353f35,0x3f22bf46,0xbf0e3f55,0x3ef1bf62
.long 0x248dbf80,0x3e483f7b,0xbec4bf6d,0x3f0e3f55,0x3f353f35,0xbf62bef1,0x3f7b3e48,0xbf7f3dc9
.long 0xbf80a50d,0x3f6dbec4,0xbf353f35,0x3ec4bf6d,0x3f35bf35,0xbe953f75,0xbe48bf7b,0x3f223f46
.long 0xa5543f80,0xbf0ebf55,0x3f6d3ec4,0xbf7b3e48,0xbf35bf35,0x3f7f3dc9,0xbf553f0e,0x3e95bf75
.long 0x3f808000,0xbf353f35,0x248dbf80,0x3f353f35,0xbf353f35,0xbdc9bf7f,0x3f553f0e,0xbf753e95
.long 0x248dbf80,0x3f553f0e,0xbf6d3ec4,0x3e48bf7b,0x3f353f35,0xbf753e95,0x3e48bf7b,0x3f463f22
.long 0xbf80a50d,0x3ec4bf6d,0x3f353f35,0xbf6d3ec4,0x3f35bf35,0x3ef13f62,0xbf7b3e48,0x3dc9bf7f
.long 0xa5543f80,0xbf7bbe48,0x3ec4bf6d,0x3f553f0e,0xbf35bf35,0x3f46bf22,0x3f0e3f55,0xbf623ef1
.long 0x3f808000,0xbf80a50d,0x3f808000,0xbf80a50d,0xbec43f6d,0x3e95bf75,0xbe483f7b,0x3dc9bf7f
.long 0xbf35bf35,0x3f553f0e,0xbf6dbec4,0x3f7b3e48,0x3f6dbec4,0xbf463f22,0x3f0ebf55,0xbe953f75
.long 0xa5543f80,0xbec4bf6d,0x3f353f35,0xbf6dbec4,0xbf6dbec4,0x3f7fbdc9,0xbf553f0e,0x3ef1bf62
.long 0x3f35bf35,0xbe483f7b,0xbec4bf6d,0x3f553f0e,0x3ec43f6d,0xbf62bef1,0x3f7bbe48,0xbf223f46
.long 0xbf80a50d,0x3f35bf35,0xa5543f80,0xbf35bf35,0x3ec4bf6d,0x3ef13f62,0xbf7bbe48,0x3f46bf22
.long 0x3f353f35,0xbf7b3e48,0x3ec4bf6d,0x3f0e3f55,0xbf6d3ec4,0x3dc9bf7f,0x3f553f0e,0xbf623ef1
.long 0x248dbf80,0x3f6d3ec4,0xbf353f35,0xbec4bf6d,0x3f6d3ec4,0xbf223f46,0xbf0ebf55,0x3f75be95
.long 0xbf353f35,0xbf0ebf55,0x3f6dbec4,0x3e483f7b,0xbec4bf6d,0x3f75be95,0x3e483f7b,0xbf7f3dc9
.long 0x3f808000,0xbf80a50d,0x3f808000,0xbf80a50d,0xa5543f80,0xbdc9bf7f,0x3e483f7b,0xbe95bf75
.long 0xbf80a50d,0x3f7bbe48,0xbf6d3ec4,0x3f55bf0e,0x248dbf80,0x3e953f75,0xbf0ebf55,0x3f463f22
.long 0x3f808000,0xbf6d3ec4,0x3f35bf35,0xbec43f6d,0xa5543f80,0xbef1bf62,0x3f553f0e,0xbf7fbdc9
.long 0xbf80a50d,0x3f55bf0e,0xbec43f6d,0xbe48bf7b,0x248dbf80,0x3f223f46,0xbf7bbe48,0x3f62bef1
.long 0x3f808000,0xbf353f35,0x248dbf80,0x3f353f35,0xa5543f80,0xbf46bf22,0x3f7bbe48,0xbef13f62
.long 0xbf80a50d,0x3f0ebf55,0x3ec43f6d,0xbf7bbe48,0x248dbf80,0x3f623ef1,0xbf553f0e,0xbdc9bf7f
.long 0x3f808000,0xbec43f6d,0xbf35bf35,0x3f6dbec4,0xa5543f80,0xbf75be95,0x3f0ebf55,0x3f223f46
.long 0xbf80a50d,0x3e48bf7b,0x3f6d3ec4,0xbf0e3f55,0x248dbf80,0x3f7f3dc9,0xbe483f7b,0xbf75be95
.long 0x3f808000,0xbf80a50d,0x3f808000,0xbf80a50d,0x3ec43f6d,0xbef1bf62,0x3f0e3f55,0xbf22bf46
.long 0xbf353f35,0x3f0ebf55,0xbec43f6d,0x3e48bf7b,0xbf6dbec4,0x3f7f3dc9,0xbf7b3e48,0x3f62bef1
.long 0x248dbf80,0x3ec43f6d,0xbf35bf35,0x3f6d3ec4,0x3f6dbec4,0xbf223f46,0x3e48bf7b,0x3e953f75
.long 0x3f353f35,0xbf7bbe48,0x3f6dbec4,0xbf0e3f55,0xbec43f6d,0xbe95bf75,0x3f553f0e,0xbf7f3dc9
.long 0xbf80a50d,0x3f35bf35,0xa5543f80,0xbf35bf35,0xbec4bf6d,0x3f753e95,0xbf553f0e,0x3dc9bf7f
.long 0x3f35bf35,0x3e483f7b,0xbf6dbec4,0x3f55bf0e,0x3f6d3ec4,0xbf463f22,0xbe48bf7b,0x3f753e95
.long 0xa5543f80,0xbf6dbec4,0x3f35bf35,0x3ec43f6d,0xbf6d3ec4,0xbdc9bf7f,0x3f7b3e48,0xbef13f62
.long 0xbf35bf35,0x3f55bf0e,0x3ec43f6d,0xbf7b3e48,0x3ec4bf6d,0x3f623ef1,0xbf0e3f55,0xbf46bf22
.long 0x3f808000,0xbf80a50d,0x3f808000,0xbf80a50d,0x3f353f35,0xbf46bf22,0x3f553f0e,0xbf62bef1
.long 0xa5543f80,0xbe48bf7b,0x3ec43f6d,0xbf0ebf55,0xbf353f35,0x3ef1bf62,0xbe483f7b,0xbdc9bf7f
.long 0xbf80a50d,0x3f6dbec4,0xbf353f35,0x3ec4bf6d,0xbf35bf35,0x3f753e95,0xbf7b3e48,0x3f46bf22
.long 0x248dbf80,0x3f0e3f55,0xbf6dbec4,0x3f7bbe48,0x3f35bf35,0xbdc93f7f,0xbf0ebf55,0x3f753e95
.long 0x3f808000,0xbf353f35,0x248dbf80,0x3f353f35,0x3f353f35,0xbf7f3dc9,0x3f0ebf55,0x3e953f75
.long 0xa5543f80,0xbf55bf0e,0x3f6dbec4,0xbe483f7b,0xbf353f35,0xbe95bf75,0x3f7b3e48,0xbf223f46
.long 0xbf80a50d,0x3ec4bf6d,0x3f353f35,0xbf6d3ec4,0xbf35bf35,0x3f62bef1,0x3e483f7b,0xbf7fbdc9
.long 0x248dbf80,0x3f7b3e48,0xbec43f6d,0xbf55bf0e,0x3f35bf35,0x3f223f46,0xbf553f0e,0xbef1bf62
.long 0x3f808000,0xbf80a50d,0x3f808000,0xbf80a50d,0x3f6d3ec4,0xbf75be95,0x3f7b3e48,0xbf7fbdc9
.long 0x3f353f35,0xbf55bf0e,0x3f6d3ec4,0xbf7bbe48,0x3ec43f6d,0xbf22bf46,0x3f553f0e,0xbf75be95
.long 0xa5543f80,0xbec4bf6d,0x3f353f35,0xbf6dbec4,0xbec43f6d,0xbdc9bf7f,0x3f0e3f55,0xbf62bef1
.long 0xbf353f35,0x3e48bf7b,0x3ec43f6d,0xbf55bf0e,0xbf6d3ec4,0x3ef1bf62,0x3e483f7b,0xbf46bf22
.long 0xbf80a50d,0x3f35bf35,0xa5543f80,0xbf35bf35,0xbf6dbec4,0x3f62bef1,0xbe483f7b,0xbf22bf46
.long 0xbf35bf35,0x3f7bbe48,0xbec43f6d,0xbf0ebf55,0xbec4bf6d,0x3f7f3dc9,0xbf0e3f55,0xbef1bf62
.long 0x248dbf80,0x3f6d3ec4,0xbf353f35,0xbec4bf6d,0x3ec4bf6d,0x3f463f22,0xbf553f0e,0xbe95bf75
.long 0x3f35bf35,0x3f0e3f55,0xbf6d3ec4,0xbe48bf7b,0x3f6dbec4,0x3e953f75,0xbf7b3e48,0xbdc9bf7f
.long 0x3f808000,0xa5543f80,0xbf80a50d,0x248dbf80,0x3f808000,0x3dc93f7f,0xbf7b3e48,0xbe95bf75
.long 0x3f808000,0x3e483f7b,0xbf6d3ec4,0xbf0ebf55,0x3f808000,0x3e953f75,0xbf553f0e,0xbf46bf22
.long 0x3f808000,0x3ec43f6d,0xbf353f35,0xbf6dbec4,0x3f808000,0x3ef13f62,0xbf0e3f55,0xbf7fbdc9
.long 0x3f808000,0x3f0e3f55,0xbec43f6d,0xbf7b3e48,0x3f808000,0x3f223f46,0xbe483f7b,0xbf623ef1
.long 0x3f808000,0x3f353f35,0xa5543f80,0xbf353f35,0x3f808000,0x3f463f22,0x3e483f7b,0xbef13f62
.long 0x3f808000,0x3f553f0e,0x3ec43f6d,0xbe483f7b,0x3f808000,0x3f623ef1,0x3f0e3f55,0x3dc93f7f
.long 0x3f808000,0x3f6d3ec4,0x3f353f35,0x3ec43f6d,0x3f808000,0x3f753e95,0x3f553f0e,0x3f223f46
.long 0x3f808000,0x3f7b3e48,0x3f6d3ec4,0x3f553f0e,0x3f808000,0x3f7f3dc9,0x3f7b3e48,0x3f753e95
.long 0x3f808000,0xa5543f80,0xbf80a50d,0x248dbf80,0x3f6dbec4,0x3ef13f62,0xbf553f0e,0xbf22bf46
.long 0x3f35bf35,0x3f553f0e,0xbec43f6d,0xbf7bbe48,0x3ec4bf6d,0x3f7f3dc9,0x3e483f7b,0xbf623ef1
.long 0x248dbf80,0x3f6dbec4,0x3f353f35,0xbec43f6d,0xbec4bf6d,0x3f22bf46,0x3f7b3e48,0x3e953f75
.long 0xbf35bf35,0x3e48bf7b,0x3f6dbec4,0x3f553f0e,0xbf6dbec4,0xbe95bf75,0x3f0ebf55,0x3f7fbdc9
.long 0xbf80a50d,0xbf35bf35,0x248dbf80,0x3f35bf35,0xbf6d3ec4,0xbf75be95,0xbf0ebf55,0x3dc9bf7f
.long 0xbf353f35,0xbf7b3e48,0xbf6dbec4,0xbf0ebf55,0xbec43f6d,0xbf463f22,0xbf7b3e48,0xbf75be95
.long 0xa5543f80,0xbec43f6d,0xbf353f35,0xbf6d3ec4,0x3ec43f6d,0x3dc93f7f,0xbe483f7b,0xbef13f62
.long 0x3f353f35,0x3f0e3f55,0x3ec43f6d,0x3e483f7b,0x3f6d3ec4,0x3f623ef1,0x3f553f0e,0x3f463f22
.long 0x3f808000,0xa5543f80,0xbf80a50d,0x248dbf80,0x3f35bf35,0x3f463f22,0xbf0e3f55,0xbf62bef1
.long 0x248dbf80,0x3f7bbe48,0x3ec43f6d,0xbf553f0e,0xbf35bf35,0x3ef1bf62,0x3f7b3e48,0x3dc93f7f
.long 0xbf80a50d,0xbec4bf6d,0x3f35bf35,0x3f6d3ec4,0xbf353f35,0xbf75be95,0xbe48bf7b,0x3f46bf22
.long 0xa5543f80,0xbf553f0e,0xbf6dbec4,0xbe48bf7b,0x3f353f35,0xbdc93f7f,0xbf553f0e,0xbf75be95
.long 0x3f808000,0x3f353f35,0xa5543f80,0xbf353f35,0x3f35bf35,0x3f7fbdc9,0x3f553f0e,0x3e953f75
.long 0x248dbf80,0x3f0ebf55,0x3f6dbec4,0x3f7b3e48,0xbf35bf35,0xbe95bf75,0x3e48bf7b,0x3f22bf46
.long 0xbf80a50d,0xbf6dbec4,0xbf35bf35,0xbec4bf6d,0xbf353f35,0xbf623ef1,0xbf7b3e48,0xbf7fbdc9
.long 0xa5543f80,0xbe483f7b,0xbec43f6d,0xbf0e3f55,0x3f353f35,0x3f223f46,0x3f0e3f55,0x3ef13f62
.long 0x3f808000,0xa5543f80,0xbf80a50d,0x248dbf80,0x3ec4bf6d,0x3f753e95,0xbe483f7b,0xbf7fbdc9
.long 0xbf35bf35,0x3f0ebf55,0x3f6d3ec4,0xbe483f7b,0xbf6d3ec4,0xbf22bf46,0x3f0ebf55,0x3f753e95
.long 0xa5543f80,0xbf6d3ec4,0xbf35bf35,0x3ec4bf6d,0x3f6d3ec4,0x3dc93f7f,0xbf553f0e,0xbf62bef1
.long 0x3f35bf35,0x3f7b3e48,0x3ec43f6d,0xbf0e3f55,0xbec4bf6d,0x3ef1bf62,0x3f7bbe48,0x3f463f22
.long 0xbf80a50d,0xbf35bf35,0x248dbf80,0x3f35bf35,0xbec43f6d,0xbf623ef1,0xbf7bbe48,0xbf22bf46
.long 0x3f353f35,0x3e483f7b,0xbec43f6d,0xbf553f0e,0x3f6dbec4,0x3f7f3dc9,0x3f553f0e,0x3ef13f62
.long 0x248dbf80,0x3ec4bf6d,0x3f35bf35,0x3f6dbec4,0xbf6dbec4,0xbf46bf22,0xbf0ebf55,0xbe95bf75
.long 0xbf353f35,0xbf553f0e,0xbf6d3ec4,0xbf7b3e48,0x3ec43f6d,0x3e953f75,0x3e483f7b,0x3dc93f7f
.long 0x3f808000,0xa5543f80,0xbf80a50d,0x248dbf80,0x248dbf80,0x3f7fbdc9,0x3e483f7b,0xbf753e95
.long 0xbf80a50d,0xbe48bf7b,0x3f6dbec4,0x3f0e3f55,0xa5543f80,0xbf753e95,0xbf0ebf55,0x3f22bf46
.long 0x3f808000,0x3ec43f6d,0xbf353f35,0xbf6dbec4,0x248dbf80,0x3f62bef1,0x3f553f0e,0xbdc93f7f
.long 0xbf80a50d,0xbf0ebf55,0x3ec4bf6d,0x3f7bbe48,0xa5543f80,0xbf463f22,0xbf7bbe48,0xbef1bf62
.long 0x3f808000,0x3f353f35,0xa5543f80,0xbf353f35,0x248dbf80,0x3f22bf46,0x3f7bbe48,0x3f623ef1
.long 0xbf80a50d,0xbf55bf0e,0xbec4bf6d,0x3e48bf7b,0xa5543f80,0xbef13f62,0xbf553f0e,0xbf7f3dc9
.long 0x3f808000,0x3f6d3ec4,0x3f353f35,0x3ec43f6d,0x248dbf80,0x3e95bf75,0x3f0ebf55,0x3f46bf22
.long 0xbf80a50d,0xbf7bbe48,0xbf6dbec4,0xbf55bf0e,0xa5543f80,0xbdc93f7f,0xbe483f7b,0xbe953f75
.long 0x3f808000,0xa5543f80,0xbf80a50d,0x248dbf80,0xbec4bf6d,0x3f62bef1,0x3f0e3f55,0xbf463f22
.long 0xbf353f35,0xbf55bf0e,0x3ec4bf6d,0x3f7b3e48,0x3f6d3ec4,0xbdc93f7f,0xbf7b3e48,0xbef1bf62
.long 0x248dbf80,0x3f6dbec4,0x3f353f35,0xbec43f6d,0xbf6d3ec4,0xbf46bf22,0x3e48bf7b,0x3f75be95
.long 0x3f353f35,0xbe483f7b,0xbf6d3ec4,0xbf55bf0e,0x3ec4bf6d,0x3f75be95,0x3f553f0e,0x3dc93f7f
.long 0xbf80a50d,0xbf35bf35,0x248dbf80,0x3f35bf35,0x3ec43f6d,0xbe953f75,0xbf553f0e,0xbf7fbdc9
.long 0x3f35bf35,0x3f7bbe48,0x3f6d3ec4,0x3f0e3f55,0xbf6dbec4,0xbf22bf46,0xbe48bf7b,0x3e95bf75
.long 0xa5543f80,0xbec43f6d,0xbf353f35,0xbf6d3ec4,0x3f6dbec4,0x3f7fbdc9,0x3f7b3e48,0x3f623ef1
.long 0xbf35bf35,0xbf0ebf55,0xbec4bf6d,0xbe48bf7b,0xbec43f6d,0xbef13f62,0xbf0e3f55,0xbf223f46
.long 0x3f808000,0xa5543f80,0xbf80a50d,0x248dbf80,0xbf35bf35,0x3f22bf46,0x3f553f0e,0xbef13f62
.long 0xa5543f80,0xbf7b3e48,0xbec4bf6d,0x3f55bf0e,0x3f35bf35,0x3f623ef1,0xbe483f7b,0xbf7f3dc9
.long 0xbf80a50d,0xbec4bf6d,0x3f35bf35,0x3f6d3ec4,0x3f353f35,0xbe953f75,0xbf7b3e48,0xbf22bf46
.long 0x248dbf80,0x3f55bf0e,0x3f6d3ec4,0x3e483f7b,0xbf353f35,0xbf7fbdc9,0xbf0ebf55,0x3e95bf75
.long 0x3f808000,0x3f353f35,0xa5543f80,0xbf353f35,0xbf35bf35,0xbdc9bf7f,0x3f0ebf55,0x3f75be95
.long 0xa5543f80,0xbf0e3f55,0xbf6d3ec4,0xbf7bbe48,0x3f35bf35,0x3f75be95,0x3f7b3e48,0x3f463f22
.long 0xbf80a50d,0xbf6dbec4,0xbf35bf35,0xbec4bf6d,0x3f353f35,0x3ef13f62,0x3e483f7b,0xbdc93f7f
.long 0x248dbf80,0x3e48bf7b,0x3ec4bf6d,0x3f0ebf55,0xbf353f35,0xbf463f22,0xbf553f0e,0xbf623ef1
.long 0x3f808000,0xa5543f80,0xbf80a50d,0x248dbf80,0xbf6dbec4,0x3e95bf75,0x3f7b3e48,0xbdc93f7f
.long 0x3f353f35,0xbf0e3f55,0xbf6dbec4,0x3e48bf7b,0xbec4bf6d,0x3f46bf22,0x3f553f0e,0xbe953f75
.long 0xa5543f80,0xbf6d3ec4,0xbf35bf35,0x3ec4bf6d,0x3ec4bf6d,0x3f7fbdc9,0x3f0e3f55,0xbef13f62
.long 0xbf353f35,0xbf7bbe48,0xbec4bf6d,0x3f0ebf55,0x3f6dbec4,0x3f623ef1,0x3e483f7b,0xbf223f46
.long 0xbf80a50d,0xbf35bf35,0x248dbf80,0x3f35bf35,0x3f6d3ec4,0x3ef13f62,0xbe483f7b,0xbf463f22
.long 0xbf35bf35,0xbe48bf7b,0x3ec4bf6d,0x3f55bf0e,0x3ec43f6d,0xbdc93f7f,0xbf0e3f55,0xbf623ef1
.long 0x248dbf80,0x3ec4bf6d,0x3f35bf35,0x3f6dbec4,0xbec43f6d,0xbf223f46,0xbf553f0e,0xbf753e95
.long 0x3f35bf35,0x3f55bf0e,0x3f6dbec4,0x3f7bbe48,0xbf6d3ec4,0xbf753e95,0xbf7b3e48,0xbf7f3dc9
.long 0x3f808000,0xa5543f80,0xbf80a50d,0x248dbf80,0xbf80a50d,0xbdc9bf7f,0x3f7bbe48,0x3e953f75
.long 0x3f808000,0x3e483f7b,0xbf6d3ec4,0xbf0ebf55,0xbf80a50d,0xbe95bf75,0x3f55bf0e,0x3f463f22
.long 0x3f808000,0x3ec43f6d,0xbf353f35,0xbf6dbec4,0xbf80a50d,0xbef1bf62,0x3f0ebf55,0x3f7f3dc9
.long 0x3f808000,0x3f0e3f55,0xbec43f6d,0xbf7b3e48,0xbf80a50d,0xbf22bf46,0x3e48bf7b,0x3f62bef1
.long 0x3f808000,0x3f353f35,0xa5543f80,0xbf353f35,0xbf80a50d,0xbf46bf22,0xbe48bf7b,0x3ef1bf62
.long 0x3f808000,0x3f553f0e,0x3ec43f6d,0xbe483f7b,0xbf80a50d,0xbf62bef1,0xbf0ebf55,0xbdc9bf7f
.long 0x3f808000,0x3f6d3ec4,0x3f353f35,0x3ec43f6d,0xbf80a50d,0xbf75be95,0xbf55bf0e,0xbf22bf46
.long 0x3f808000,0x3f7b3e48,0x3f6d3ec4,0x3f553f0e,0xbf80a50d,0xbf7fbdc9,0xbf7bbe48,0xbf75be95
.long 0x3f808000,0xa5543f80,0xbf80a50d,0x248dbf80,0xbf6d3ec4,0xbef1bf62,0x3f55bf0e,0x3f223f46
.long 0x3f35bf35,0x3f553f0e,0xbec43f6d,0xbf7bbe48,0xbec43f6d,0xbf7fbdc9,0xbe48bf7b,0x3f62bef1
.long 0x248dbf80,0x3f6dbec4,0x3f353f35,0xbec43f6d,0x3ec43f6d,0xbf223f46,0xbf7bbe48,0xbe95bf75
.long 0xbf35bf35,0x3e48bf7b,0x3f6dbec4,0x3f553f0e,0x3f6d3ec4,0x3e953f75,0xbf0e3f55,0xbf7f3dc9
.long 0xbf80a50d,0xbf35bf35,0x248dbf80,0x3f35bf35,0x3f6dbec4,0x3f753e95,0x3f0e3f55,0xbdc93f7f
.long 0xbf353f35,0xbf7b3e48,0xbf6dbec4,0xbf0ebf55,0x3ec4bf6d,0x3f46bf22,0x3f7bbe48,0x3f753e95
.long 0xa5543f80,0xbec43f6d,0xbf353f35,0xbf6d3ec4,0xbec4bf6d,0xbdc9bf7f,0x3e48bf7b,0x3ef1bf62
.long 0x3f353f35,0x3f0e3f55,0x3ec43f6d,0x3e483f7b,0xbf6dbec4,0xbf62bef1,0xbf55bf0e,0xbf46bf22
.long 0x3f808000,0xa5543f80,0xbf80a50d,0x248dbf80,0xbf353f35,0xbf46bf22,0x3f0ebf55,0x3f623ef1
.long 0x248dbf80,0x3f7bbe48,0x3ec43f6d,0xbf553f0e,0x3f353f35,0xbef13f62,0xbf7bbe48,0xbdc9bf7f
.long 0xbf80a50d,0xbec4bf6d,0x3f35bf35,0x3f6d3ec4,0x3f35bf35,0x3f753e95,0x3e483f7b,0xbf463f22
.long 0xa5543f80,0xbf553f0e,0xbf6dbec4,0xbe48bf7b,0xbf35bf35,0x3dc9bf7f,0x3f55bf0e,0x3f753e95
.long 0x3f808000,0x3f353f35,0xa5543f80,0xbf353f35,0xbf353f35,0xbf7f3dc9,0xbf55bf0e,0xbe95bf75
.long 0x248dbf80,0x3f0ebf55,0x3f6dbec4,0x3f7b3e48,0x3f353f35,0x3e953f75,0xbe483f7b,0xbf223f46
.long 0xbf80a50d,0xbf6dbec4,0xbf35bf35,0xbec4bf6d,0x3f35bf35,0x3f62bef1,0x3f7bbe48,0x3f7f3dc9
.long 0xa5543f80,0xbe483f7b,0xbec43f6d,0xbf0e3f55,0xbf35bf35,0xbf22bf46,0xbf0ebf55,0xbef1bf62
.long 0x3f808000,0xa5543f80,0xbf80a50d,0x248dbf80,0xbec43f6d,0xbf75be95,0x3e48bf7b,0x3f7f3dc9
.long 0xbf35bf35,0x3f0ebf55,0x3f6d3ec4,0xbe483f7b,0x3f6dbec4,0x3f223f46,0xbf0e3f55,0xbf75be95
.long 0xa5543f80,0xbf6d3ec4,0xbf35bf35,0x3ec4bf6d,0xbf6dbec4,0xbdc9bf7f,0x3f55bf0e,0x3f623ef1
.long 0x3f35bf35,0x3f7b3e48,0x3ec43f6d,0xbf0e3f55,0x3ec43f6d,0xbef13f62,0xbf7b3e48,0xbf46bf22
.long 0xbf80a50d,0xbf35bf35,0x248dbf80,0x3f35bf35,0x3ec4bf6d,0x3f62bef1,0x3f7b3e48,0x3f223f46
.long 0x3f353f35,0x3e483f7b,0xbec43f6d,0xbf553f0e,0xbf6d3ec4,0xbf7fbdc9,0xbf55bf0e,0xbef1bf62
.long 0x248dbf80,0x3ec4bf6d,0x3f35bf35,0x3f6dbec4,0x3f6d3ec4,0x3f463f22,0x3f0e3f55,0x3e953f75
.long 0xbf353f35,0xbf553f0e,0xbf6d3ec4,0xbf7b3e48,0xbec4bf6d,0xbe95bf75,0xbe48bf7b,0xbdc9bf7f
.long 0x3f808000,0xa5543f80,0xbf80a50d,0x248dbf80,0xa5543f80,0xbf7f3dc9,0xbe48bf7b,0x3f75be95
.long 0xbf80a50d,0xbe48bf7b,0x3f6dbec4,0x3f0e3f55,0x248dbf80,0x3f75be95,0x3f0e3f55,0xbf223f46
.long 0x3f808000,0x3ec43f6d,0xbf353f35,0xbf6dbec4,0xa5543f80,0xbf623ef1,0xbf55bf0e,0x3dc9bf7f
.long 0xbf80a50d,0xbf0ebf55,0x3ec4bf6d,0x3f7bbe48,0x248dbf80,0x3f46bf22,0x3f7b3e48,0x3ef13f62
.long 0x3f808000,0x3f353f35,0xa5543f80,0xbf353f35,0xa5543f80,0xbf223f46,0xbf7b3e48,0xbf62bef1
.long 0xbf80a50d,0xbf55bf0e,0xbec4bf6d,0x3e48bf7b,0x248dbf80,0x3ef1bf62,0x3f55bf0e,0x3f7fbdc9
.long 0x3f808000,0x3f6d3ec4,0x3f353f35,0x3ec43f6d,0xa5543f80,0xbe953f75,0xbf0e3f55,0xbf463f22
.long 0xbf80a50d,0xbf7bbe48,0xbf6dbec4,0xbf55bf0e,0x248dbf80,0x3dc9bf7f,0x3e48bf7b,0x3e95bf75
.long 0x3f808000,0xa5543f80,0xbf80a50d,0x248dbf80,0x3ec43f6d,0xbf623ef1,0xbf0ebf55,0x3f46bf22
.long 0xbf353f35,0xbf55bf0e,0x3ec4bf6d,0x3f7b3e48,0xbf6dbec4,0x3dc9bf7f,0x3f7bbe48,0x3ef13f62
.long 0x248dbf80,0x3f6dbec4,0x3f353f35,0xbec43f6d,0x3f6dbec4,0x3f463f22,0xbe483f7b,0xbf753e95
.long 0x3f353f35,0xbe483f7b,0xbf6d3ec4,0xbf55bf0e,0xbec43f6d,0xbf753e95,0xbf55bf0e,0xbdc9bf7f
.long 0xbf80a50d,0xbf35bf35,0x248dbf80,0x3f35bf35,0xbec4bf6d,0x3e95bf75,0x3f55bf0e,0x3f7f3dc9
.long 0x3f35bf35,0x3f7bbe48,0x3f6d3ec4,0x3f0e3f55,0x3f6d3ec4,0x3f223f46,0x3e483f7b,0xbe953f75
.long 0xa5543f80,0xbec43f6d,0xbf353f35,0xbf6d3ec4,0xbf6d3ec4,0xbf7f3dc9,0xbf7bbe48,0xbf62bef1
.long 0xbf35bf35,0xbf0ebf55,0xbec4bf6d,0xbe48bf7b,0x3ec4bf6d,0x3ef1bf62,0x3f0ebf55,0x3f22bf46
.long 0x3f808000,0xa5543f80,0xbf80a50d,0x248dbf80,0x3f353f35,0xbf223f46,0xbf55bf0e,0x3ef1bf62
.long 0xa5543f80,0xbf7b3e48,0xbec4bf6d,0x3f55bf0e,0xbf353f35,0xbf62bef1,0x3e48bf7b,0x3f7fbdc9
.long 0xbf80a50d,0xbec4bf6d,0x3f35bf35,0x3f6d3ec4,0xbf35bf35,0x3e95bf75,0x3f7bbe48,0x3f223f46
.long 0x248dbf80,0x3f55bf0e,0x3f6d3ec4,0x3e483f7b,0x3f35bf35,0x3f7f3dc9,0x3f0e3f55,0xbe953f75
.long 0x3f808000,0x3f353f35,0xa5543f80,0xbf353f35,0x3f353f35,0x3dc93f7f,0xbf0e3f55,0xbf753e95
.long 0xa5543f80,0xbf0e3f55,0xbf6d3ec4,0xbf7bbe48,0xbf353f35,0xbf753e95,0xbf7bbe48,0xbf46bf22
.long 0xbf80a50d,0xbf6dbec4,0xbf35bf35,0xbec4bf6d,0xbf35bf35,0xbef1bf62,0xbe48bf7b,0x3dc9bf7f
.long 0x248dbf80,0x3e48bf7b,0x3ec4bf6d,0x3f0ebf55,0x3f35bf35,0x3f46bf22,0x3f55bf0e,0x3f62bef1
.long 0x3f808000,0xa5543f80,0xbf80a50d,0x248dbf80,0x3f6d3ec4,0xbe953f75,0xbf7bbe48,0x3dc9bf7f
.long 0x3f353f35,0xbf0e3f55,0xbf6dbec4,0x3e48bf7b,0x3ec43f6d,0xbf463f22,0xbf55bf0e,0x3e95bf75
.long 0xa5543f80,0xbf6d3ec4,0xbf35bf35,0x3ec4bf6d,0xbec43f6d,0xbf7f3dc9,0xbf0ebf55,0x3ef1bf62
.long 0xbf353f35,0xbf7bbe48,0xbec4bf6d,0x3f0ebf55,0xbf6d3ec4,0xbf62bef1,0xbe48bf7b,0x3f22bf46
.long 0xbf80a50d,0xbf35bf35,0x248dbf80,0x3f35bf35,0xbf6dbec4,0xbef1bf62,0x3e48bf7b,0x3f46bf22
.long 0xbf35bf35,0xbe48bf7b,0x3ec4bf6d,0x3f55bf0e,0xbec4bf6d,0x3dc9bf7f,0x3f0ebf55,0x3f62bef1
.long 0x248dbf80,0x3ec4bf6d,0x3f35bf35,0x3f6dbec4,0x3ec4bf6d,0x3f22bf46,0x3f55bf0e,0x3f75be95
.long 0x3f35bf35,0x3f55bf0e,0x3f6dbec4,0x3f7bbe48,0x3f6dbec4,0x3f75be95,0x3f7bbe48,0x3f7fbdc9
.size tab2, 32768
.p2align 8
.type tab3,@object
tab3:
.long 0x80003f80,0x80003f80,0x80003f80,0x80003f80,0x80003f80,0xbec43f6d,0xbf353f35,0xbf6d3ec4
.long 0x80003f80,0xbf353f35,0xbf80248d,0xbf35bf35,0x80003f80,0xbf6d3ec4,0xbf35bf35,0x3ec4bf6d
.long 0x80003f80,0xbf80248d,0xa50dbf80,0x3f80a554,0x80003f80,0xbf6dbec4,0x3f35bf35,0x3ec43f6d
.long 0x80003f80,0xbf35bf35,0x3f80a554,0xbf353f35,0x80003f80,0xbec4bf6d,0x3f353f35,0xbf6dbec4
.long 0x80003f80,0xa50dbf80,0x80003f80,0xa50dbf80,0x80003f80,0x3ec4bf6d,0xbf353f35,0x3f6dbec4
.long 0x80003f80,0x3f35bf35,0xbf80248d,0x3f353f35,0x80003f80,0x3f6dbec4,0xbf35bf35,0xbec43f6d
.long 0x80003f80,0x3f80a554,0xa50dbf80,0xbf80248d,0x80003f80,0x3f6d3ec4,0x3f35bf35,0xbec4bf6d
.long 0x80003f80,0x3f353f35,0x3f80a554,0x3f35bf35,0x80003f80,0x3ec43f6d,0x3f353f35,0x3f6d3ec4
.long 0x3f800000,0x3f800000,0x3f800000,0x3f800000,0x3f800000,0x3f6d3ec4,0x3f353f35,0x3ec43f6d
.long 0x3f800000,0x3f353f35,0x248d3f80,0xbf353f35,0x3f800000,0x3ec43f6d,0xbf353f35,0xbf6dbec4
.long 0x3f800000,0x248d3f80,0xbf80250d,0xa554bf80,0x3f800000,0xbec43f6d,0xbf35bf35,0x3f6dbec4
.long 0x3f800000,0xbf353f35,0xa554bf80,0x3f353f35,0x3f800000,0xbf6d3ec4,0x3f35bf35,0xbec43f6d
.long 0x3f800000,0xbf80250d,0x3f800000,0xbf80250d,0x3f800000,0xbf6dbec4,0x3f353f35,0xbec4bf6d
.long 0x3f800000,0xbf35bf35,0x248d3f80,0x3f35bf35,0x3f800000,0xbec4bf6d,0xbf353f35,0x3f6d3ec4
.long 0x3f800000,0xa554bf80,0xbf80250d,0x248d3f80,0x3f800000,0x3ec4bf6d,0xbf35bf35,0xbf6d3ec4
.long 0x3f800000,0x3f35bf35,0xa554bf80,0xbf35bf35,0x3f800000,0x3f6dbec4,0x3f35bf35,0x3ec4bf6d
.long 0x80003f80,0x80003f80,0x80003f80,0x80003f80,0xbf80248d,0xbf6dbec4,0xbf35bf35,0xbec4bf6d
.long 0xa50dbf80,0x3f35bf35,0x3f80a554,0x3f353f35,0x3f80a554,0x3ec43f6d,0xbf353f35,0xbf6dbec4
.long 0x80003f80,0xbf80248d,0xa50dbf80,0x3f80a554,0xbf80248d,0x3ec4bf6d,0x3f353f35,0xbf6d3ec4
.long 0xa50dbf80,0x3f353f35,0xbf80248d,0x3f35bf35,0x3f80a554,0xbf6d3ec4,0x3f35bf35,0xbec43f6d
.long 0x80003f80,0xa50dbf80,0x80003f80,0xa50dbf80,0xbf80248d,0x3f6d3ec4,0xbf35bf35,0x3ec43f6d
.long 0xa50dbf80,0xbf353f35,0x3f80a554,0xbf35bf35,0x3f80a554,0xbec4bf6d,0xbf353f35,0x3f6d3ec4
.long 0x80003f80,0x3f80a554,0xa50dbf80,0xbf80248d,0xbf80248d,0xbec43f6d,0x3f353f35,0x3f6dbec4
.long 0xa50dbf80,0xbf35bf35,0xbf80248d,0xbf353f35,0x3f80a554,0x3f6dbec4,0x3f35bf35,0x3ec4bf6d
.long 0x3f800000,0x3f800000,0x3f800000,0x3f800000,0x248d3f80,0xbec43f6d,0xbf353f35,0xbf6d3ec4
.long 0xbf80250d,0xbf35bf35,0xa554bf80,0x3f35bf35,0xa554bf80,0x3f6dbec4,0x3f353f35,0xbec43f6d
.long 0x3f800000,0x248d3f80,0xbf80250d,0xa554bf80,0x248d3f80,0xbf6dbec4,0x3f35bf35,0x3ec43f6d
.long 0xbf80250d,0x3f35bf35,0x248d3f80,0xbf35bf35,0xa554bf80,0x3ec43f6d,0xbf35bf35,0x3f6d3ec4
.long 0x3f800000,0xbf80250d,0x3f800000,0xbf80250d,0x248d3f80,0x3ec4bf6d,0xbf353f35,0x3f6dbec4
.long 0xbf80250d,0x3f353f35,0xa554bf80,0xbf353f35,0xa554bf80,0xbf6d3ec4,0x3f353f35,0x3ec4bf6d
.long 0x3f800000,0xa554bf80,0xbf80250d,0x248d3f80,0x248d3f80,0x3f6d3ec4,0x3f35bf35,0xbec4bf6d
.long 0xbf80250d,0xbf353f35,0x248d3f80,0x3f353f35,0xa554bf80,0xbec4bf6d,0xbf35bf35,0xbf6dbec4
.long 0x80003f80,0x80003f80,0x80003f80,0x80003f80,0xa50dbf80,0x3ec4bf6d,0x3f35bf35,0x3f6dbec4
.long 0x80003f80,0xbf353f35,0xbf80248d,0xbf35bf35,0xa50dbf80,0x3f6dbec4,0x3f353f35,0xbec43f6d
.long 0x80003f80,0xbf80248d,0xa50dbf80,0x3f80a554,0xa50dbf80,0x3f6d3ec4,0xbf353f35,0xbec4bf6d
.long 0x80003f80,0xbf35bf35,0x3f80a554,0xbf353f35,0xa50dbf80,0x3ec43f6d,0xbf35bf35,0x3f6d3ec4
.long 0x80003f80,0xa50dbf80,0x80003f80,0xa50dbf80,0xa50dbf80,0xbec43f6d,0x3f35bf35,0xbf6d3ec4
.long 0x80003f80,0x3f35bf35,0xbf80248d,0x3f353f35,0xa50dbf80,0xbf6d3ec4,0x3f353f35,0x3ec4bf6d
.long 0x80003f80,0x3f80a554,0xa50dbf80,0xbf80248d,0xa50dbf80,0xbf6dbec4,0xbf353f35,0x3ec43f6d
.long 0x80003f80,0x3f353f35,0x3f80a554,0x3f35bf35,0xa50dbf80,0xbec4bf6d,0xbf35bf35,0xbf6dbec4
.long 0x3f800000,0x3f800000,0x3f800000,0x3f800000,0xbf80250d,0xbf6dbec4,0xbf35bf35,0xbec4bf6d
.long 0x3f800000,0x3f353f35,0x248d3f80,0xbf353f35,0xbf80250d,0xbec4bf6d,0x3f35bf35,0x3f6d3ec4
.long 0x3f800000,0x248d3f80,0xbf80250d,0xa554bf80,0xbf80250d,0x3ec4bf6d,0x3f353f35,0xbf6d3ec4
.long 0x3f800000,0xbf353f35,0xa554bf80,0x3f353f35,0xbf80250d,0x3f6dbec4,0xbf353f35,0x3ec4bf6d
.long 0x3f800000,0xbf80250d,0x3f800000,0xbf80250d,0xbf80250d,0x3f6d3ec4,0xbf35bf35,0x3ec43f6d
.long 0x3f800000,0xbf35bf35,0x248d3f80,0x3f35bf35,0xbf80250d,0x3ec43f6d,0x3f35bf35,0xbf6dbec4
.long 0x3f800000,0xa554bf80,0xbf80250d,0x248d3f80,0xbf80250d,0xbec43f6d,0x3f353f35,0x3f6dbec4
.long 0x3f800000,0x3f35bf35,0xa554bf80,0xbf35bf35,0xbf80250d,0xbf6d3ec4,0xbf353f35,0xbec43f6d
.long 0x80003f80,0x80003f80,0x80003f80,0x80003f80,0x3f80a554,0x3f6d3ec4,0x3f353f35,0x3ec43f6d
.long 0xa50dbf80,0x3f35bf35,0x3f80a554,0x3f353f35,0xbf80248d,0xbec4bf6d,0x3f35bf35,0x3f6d3ec4
.long 0x80003f80,0xbf80248d,0xa50dbf80,0x3f80a554,0x3f80a554,0xbec43f6d,0xbf35bf35,0x3f6dbec4
.long 0xa50dbf80,0x3f353f35,0xbf80248d,0x3f35bf35,0xbf80248d,0x3f6dbec4,0xbf353f35,0x3ec4bf6d
.long 0x80003f80,0xa50dbf80,0x80003f80,0xa50dbf80,0x3f80a554,0xbf6dbec4,0x3f353f35,0xbec4bf6d
.long 0xa50dbf80,0xbf353f35,0x3f80a554,0xbf35bf35,0xbf80248d,0x3ec43f6d,0x3f35bf35,0xbf6dbec4
.long 0x80003f80,0x3f80a554,0xa50dbf80,0xbf80248d,0x3f80a554,0x3ec4bf6d,0xbf35bf35,0xbf6d3ec4
.long 0xa50dbf80,0xbf35bf35,0xbf80248d,0xbf353f35,0xbf80248d,0xbf6d3ec4,0xbf353f35,0xbec43f6d
.long 0x3f800000,0x3f800000,0x3f800000,0x3f800000,0xa554bf80,0x3ec4bf6d,0x3f35bf35,0x3f6dbec4
.long 0xbf80250d,0xbf35bf35,0xa554bf80,0x3f35bf35,0x248d3f80,0xbf6d3ec4,0xbf35bf35,0x3ec4bf6d
.long 0x3f800000,0x248d3f80,0xbf80250d,0xa554bf80,0xa554bf80,0x3f6d3ec4,0xbf353f35,0xbec4bf6d
.long 0xbf80250d,0x3f35bf35,0x248d3f80,0xbf35bf35,0x248d3f80,0xbec4bf6d,0x3f353f35,0xbf6dbec4
.long 0x3f800000,0xbf80250d,0x3f800000,0xbf80250d,0xa554bf80,0xbec43f6d,0x3f35bf35,0xbf6d3ec4
.long 0xbf80250d,0x3f353f35,0xa554bf80,0xbf353f35,0x248d3f80,0x3f6dbec4,0xbf35bf35,0xbec43f6d
.long 0x3f800000,0xa554bf80,0xbf80250d,0x248d3f80,0xa554bf80,0xbf6dbec4,0xbf353f35,0x3ec43f6d
.long 0xbf80250d,0xbf353f35,0x248d3f80,0x3f353f35,0x248d3f80,0x3ec43f6d,0x3f353f35,0x3f6d3ec4
.long 0x80003f80,0x80003f80,0x80003f80,0x80003f80,0x80003f80,0xbec43f6d,0xbf353f35,0xbf6d3ec4
.long 0x80003f80,0xbf353f35,0xbf80248d,0xbf35bf35,0x80003f80,0xbf6d3ec4,0xbf35bf35,0x3ec4bf6d
.long 0x80003f80,0xbf80248d,0xa50dbf80,0x3f80a554,0x80003f80,0xbf6dbec4,0x3f35bf35,0x3ec43f6d
.long 0x80003f80,0xbf35bf35,0x3f80a554,0xbf353f35,0x80003f80,0xbec4bf6d,0x3f353f35,0xbf6dbec4
.long 0x80003f80,0xa50dbf80,0x80003f80,0xa50dbf80,0x80003f80,0x3ec4bf6d,0xbf353f35,0x3f6dbec4
.long 0x80003f80,0x3f35bf35,0xbf80248d,0x3f353f35,0x80003f80,0x3f6dbec4,0xbf35bf35,0xbec43f6d
.long 0x80003f80,0x3f80a554,0xa50dbf80,0xbf80248d,0x80003f80,0x3f6d3ec4,0x3f35bf35,0xbec4bf6d
.long 0x80003f80,0x3f353f35,0x3f80a554,0x3f35bf35,0x80003f80,0x3ec43f6d,0x3f353f35,0x3f6d3ec4
.long 0x3f800000,0x3f800000,0x3f800000,0x3f800000,0x3f800000,0x3f6d3ec4,0x3f353f35,0x3ec43f6d
.long 0x3f800000,0x3f353f35,0x248d3f80,0xbf353f35,0x3f800000,0x3ec43f6d,0xbf353f35,0xbf6dbec4
.long 0x3f800000,0x248d3f80,0xbf80250d,0xa554bf80,0x3f800000,0xbec43f6d,0xbf35bf35,0x3f6dbec4
.long 0x3f800000,0xbf353f35,0xa554bf80,0x3f353f35,0x3f800000,0xbf6d3ec4,0x3f35bf35,0xbec43f6d
.long 0x3f800000,0xbf80250d,0x3f800000,0xbf80250d,0x3f800000,0xbf6dbec4,0x3f353f35,0xbec4bf6d
.long 0x3f800000,0xbf35bf35,0x248d3f80,0x3f35bf35,0x3f800000,0xbec4bf6d,0xbf353f35,0x3f6d3ec4
.long 0x3f800000,0xa554bf80,0xbf80250d,0x248d3f80,0x3f800000,0x3ec4bf6d,0xbf35bf35,0xbf6d3ec4
.long 0x3f800000,0x3f35bf35,0xa554bf80,0xbf35bf35,0x3f800000,0x3f6dbec4,0x3f35bf35,0x3ec4bf6d
.long 0x80003f80,0x80003f80,0x80003f80,0x80003f80,0xbf80248d,0xbf6dbec4,0xbf35bf35,0xbec4bf6d
.long 0xa50dbf80,0x3f35bf35,0x3f80a554,0x3f353f35,0x3f80a554,0x3ec43f6d,0xbf353f35,0xbf6dbec4
.long 0x80003f80,0xbf80248d,0xa50dbf80,0x3f80a554,0xbf80248d,0x3ec4bf6d,0x3f353f35,0xbf6d3ec4
.long 0xa50dbf80,0x3f353f35,0xbf80248d,0x3f35bf35,0x3f80a554,0xbf6d3ec4,0x3f35bf35,0xbec43f6d
.long 0x80003f80,0xa50dbf80,0x80003f80,0xa50dbf80,0xbf80248d,0x3f6d3ec4,0xbf35bf35,0x3ec43f6d
.long 0xa50dbf80,0xbf353f35,0x3f80a554,0xbf35bf35,0x3f80a554,0xbec4bf6d,0xbf353f35,0x3f6d3ec4
.long 0x80003f80,0x3f80a554,0xa50dbf80,0xbf80248d,0xbf80248d,0xbec43f6d,0x3f353f35,0x3f6dbec4
.long 0xa50dbf80,0xbf35bf35,0xbf80248d,0xbf353f35,0x3f80a554,0x3f6dbec4,0x3f35bf35,0x3ec4bf6d
.long 0x3f800000,0x3f800000,0x3f800000,0x3f800000,0x248d3f80,0xbec43f6d,0xbf353f35,0xbf6d3ec4
.long 0xbf80250d,0xbf35bf35,0xa554bf80,0x3f35bf35,0xa554bf80,0x3f6dbec4,0x3f353f35,0xbec43f6d
.long 0x3f800000,0x248d3f80,0xbf80250d,0xa554bf80,0x248d3f80,0xbf6dbec4,0x3f35bf35,0x3ec43f6d
.long 0xbf80250d,0x3f35bf35,0x248d3f80,0xbf35bf35,0xa554bf80,0x3ec43f6d,0xbf35bf35,0x3f6d3ec4
.long 0x3f800000,0xbf80250d,0x3f800000,0xbf80250d,0x248d3f80,0x3ec4bf6d,0xbf353f35,0x3f6dbec4
.long 0xbf80250d,0x3f353f35,0xa554bf80,0xbf353f35,0xa554bf80,0xbf6d3ec4,0x3f353f35,0x3ec4bf6d
.long 0x3f800000,0xa554bf80,0xbf80250d,0x248d3f80,0x248d3f80,0x3f6d3ec4,0x3f35bf35,0xbec4bf6d
.long 0xbf80250d,0xbf353f35,0x248d3f80,0x3f353f35,0xa554bf80,0xbec4bf6d,0xbf35bf35,0xbf6dbec4
.long 0x80003f80,0x80003f80,0x80003f80,0x80003f80,0xa50dbf80,0x3ec4bf6d,0x3f35bf35,0x3f6dbec4
.long 0x80003f80,0xbf353f35,0xbf80248d,0xbf35bf35,0xa50dbf80,0x3f6dbec4,0x3f353f35,0xbec43f6d
.long 0x80003f80,0xbf80248d,0xa50dbf80,0x3f80a554,0xa50dbf80,0x3f6d3ec4,0xbf353f35,0xbec4bf6d
.long 0x80003f80,0xbf35bf35,0x3f80a554,0xbf353f35,0xa50dbf80,0x3ec43f6d,0xbf35bf35,0x3f6d3ec4
.long 0x80003f80,0xa50dbf80,0x80003f80,0xa50dbf80,0xa50dbf80,0xbec43f6d,0x3f35bf35,0xbf6d3ec4
.long 0x80003f80,0x3f35bf35,0xbf80248d,0x3f353f35,0xa50dbf80,0xbf6d3ec4,0x3f353f35,0x3ec4bf6d
.long 0x80003f80,0x3f80a554,0xa50dbf80,0xbf80248d,0xa50dbf80,0xbf6dbec4,0xbf353f35,0x3ec43f6d
.long 0x80003f80,0x3f353f35,0x3f80a554,0x3f35bf35,0xa50dbf80,0xbec4bf6d,0xbf35bf35,0xbf6dbec4
.long 0x3f800000,0x3f800000,0x3f800000,0x3f800000,0xbf80250d,0xbf6dbec4,0xbf35bf35,0xbec4bf6d
.long 0x3f800000,0x3f353f35,0x248d3f80,0xbf353f35,0xbf80250d,0xbec4bf6d,0x3f35bf35,0x3f6d3ec4
.long 0x3f800000,0x248d3f80,0xbf80250d,0xa554bf80,0xbf80250d,0x3ec4bf6d,0x3f353f35,0xbf6d3ec4
.long 0x3f800000,0xbf353f35,0xa554bf80,0x3f353f35,0xbf80250d,0x3f6dbec4,0xbf353f35,0x3ec4bf6d
.long 0x3f800000,0xbf80250d,0x3f800000,0xbf80250d,0xbf80250d,0x3f6d3ec4,0xbf35bf35,0x3ec43f6d
.long 0x3f800000,0xbf35bf35,0x248d3f80,0x3f35bf35,0xbf80250d,0x3ec43f6d,0x3f35bf35,0xbf6dbec4
.long 0x3f800000,0xa554bf80,0xbf80250d,0x248d3f80,0xbf80250d,0xbec43f6d,0x3f353f35,0x3f6dbec4
.long 0x3f800000,0x3f35bf35,0xa554bf80,0xbf35bf35,0xbf80250d,0xbf6d3ec4,0xbf353f35,0xbec43f6d
.long 0x80003f80,0x80003f80,0x80003f80,0x80003f80,0x3f80a554,0x3f6d3ec4,0x3f353f35,0x3ec43f6d
.long 0xa50dbf80,0x3f35bf35,0x3f80a554,0x3f353f35,0xbf80248d,0xbec4bf6d,0x3f35bf35,0x3f6d3ec4
.long 0x80003f80,0xbf80248d,0xa50dbf80,0x3f80a554,0x3f80a554,0xbec43f6d,0xbf35bf35,0x3f6dbec4
.long 0xa50dbf80,0x3f353f35,0xbf80248d,0x3f35bf35,0xbf80248d,0x3f6dbec4,0xbf353f35,0x3ec4bf6d
.long 0x80003f80,0xa50dbf80,0x80003f80,0xa50dbf80,0x3f80a554,0xbf6dbec4,0x3f353f35,0xbec4bf6d
.long 0xa50dbf80,0xbf353f35,0x3f80a554,0xbf35bf35,0xbf80248d,0x3ec43f6d,0x3f35bf35,0xbf6dbec4
.long 0x80003f80,0x3f80a554,0xa50dbf80,0xbf80248d,0x3f80a554,0x3ec4bf6d,0xbf35bf35,0xbf6d3ec4
.long 0xa50dbf80,0xbf35bf35,0xbf80248d,0xbf353f35,0xbf80248d,0xbf6d3ec4,0xbf353f35,0xbec43f6d
.long 0x3f800000,0x3f800000,0x3f800000,0x3f800000,0xa554bf80,0x3ec4bf6d,0x3f35bf35,0x3f6dbec4
.long 0xbf80250d,0xbf35bf35,0xa554bf80,0x3f35bf35,0x248d3f80,0xbf6d3ec4,0xbf35bf35,0x3ec4bf6d
.long 0x3f800000,0x248d3f80,0xbf80250d,0xa554bf80,0xa554bf80,0x3f6d3ec4,0xbf353f35,0xbec4bf6d
.long 0xbf80250d,0x3f35bf35,0x248d3f80,0xbf35bf35,0x248d3f80,0xbec4bf6d,0x3f353f35,0xbf6dbec4
.long 0x3f800000,0xbf80250d,0x3f800000,0xbf80250d,0xa554bf80,0xbec43f6d,0x3f35bf35,0xbf6d3ec4
.long 0xbf80250d,0x3f353f35,0xa554bf80,0xbf353f35,0x248d3f80,0x3f6dbec4,0xbf35bf35,0xbec43f6d
.long 0x3f800000,0xa554bf80,0xbf80250d,0x248d3f80,0xa554bf80,0xbf6dbec4,0xbf353f35,0x3ec43f6d
.long 0xbf80250d,0xbf353f35,0x248d3f80,0x3f353f35,0x248d3f80,0x3ec43f6d,0x3f353f35,0x3f6d3ec4
.long 0x80003f80,0xbe483f7b,0xbec43f6d,0xbf0e3f55,0x80003f80,0xbf0e3f55,0xbf6d3ec4,0xbf7bbe48
.long 0x80003f80,0xbf553f0e,0xbf6dbec4,0xbe48bf7b,0x80003f80,0xbf7b3e48,0xbec4bf6d,0x3f55bf0e
.long 0x80003f80,0xbf7bbe48,0x3ec4bf6d,0x3f553f0e,0x80003f80,0xbf55bf0e,0x3f6dbec4,0xbe483f7b
.long 0x80003f80,0xbf0ebf55,0x3f6d3ec4,0xbf7b3e48,0x80003f80,0xbe48bf7b,0x3ec43f6d,0xbf0ebf55
.long 0x80003f80,0x3e48bf7b,0xbec43f6d,0x3f0ebf55,0x80003f80,0x3f0ebf55,0xbf6d3ec4,0x3f7b3e48
.long 0x80003f80,0x3f55bf0e,0xbf6dbec4,0x3e483f7b,0x80003f80,0x3f7bbe48,0xbec4bf6d,0xbf553f0e
.long 0x80003f80,0x3f7b3e48,0x3ec4bf6d,0xbf55bf0e,0x80003f80,0x3f553f0e,0x3f6dbec4,0x3e48bf7b
.long 0x80003f80,0x3f0e3f55,0x3f6d3ec4,0x3f7bbe48,0x80003f80,0x3e483f7b,0x3ec43f6d,0x3f0e3f55
.long 0x3f800000,0x3f7b3e48,0x3f6d3ec4,0x3f553f0e,0x3f800000,0x3f553f0e,0x3ec43f6d,0xbe483f7b
.long 0x3f800000,0x3f0e3f55,0xbec43f6d,0xbf7b3e48,0x3f800000,0x3e483f7b,0xbf6d3ec4,0xbf0ebf55
.long 0x3f800000,0xbe483f7b,0xbf6dbec4,0x3f0ebf55,0x3f800000,0xbf0e3f55,0xbec4bf6d,0x3f7b3e48
.long 0x3f800000,0xbf553f0e,0x3ec4bf6d,0x3e483f7b,0x3f800000,0xbf7b3e48,0x3f6dbec4,0xbf553f0e
.long 0x3f800000,0xbf7bbe48,0x3f6d3ec4,0xbf55bf0e,0x3f800000,0xbf55bf0e,0x3ec43f6d,0x3e48bf7b
.long 0x3f800000,0xbf0ebf55,0xbec43f6d,0x3f7bbe48,0x3f800000,0xbe48bf7b,0xbf6d3ec4,0x3f0e3f55
.long 0x3f800000,0x3e48bf7b,0xbf6dbec4,0xbf0e3f55,0x3f800000,0x3f0ebf55,0xbec4bf6d,0xbf7bbe48
.long 0x3f800000,0x3f55bf0e,0x3ec4bf6d,0xbe48bf7b,0x3f800000,0x3f7bbe48,0x3f6dbec4,0x3f55bf0e
.long 0xbf353f35,0xbf553f0e,0xbf6d3ec4,0xbf7b3e48,0xbf35bf35,0xbe48bf7b,0x3ec4bf6d,0x3f55bf0e
.long 0x3f35bf35,0x3f7b3e48,0x3ec43f6d,0xbf0e3f55,0x3f353f35,0xbf0e3f55,0xbf6dbec4,0x3e48bf7b
.long 0xbf353f35,0xbf0ebf55,0x3f6dbec4,0x3e483f7b,0xbf35bf35,0x3f7bbe48,0xbec43f6d,0xbf0ebf55
.long 0x3f35bf35,0xbe483f7b,0xbec4bf6d,0x3f553f0e,0x3f353f35,0xbf55bf0e,0x3f6d3ec4,0xbf7bbe48
.long 0xbf353f35,0x3f55bf0e,0xbf6d3ec4,0x3f7bbe48,0xbf35bf35,0x3e483f7b,0x3ec4bf6d,0xbf553f0e
.long 0x3f35bf35,0xbf7bbe48,0x3ec43f6d,0x3f0ebf55,0x3f353f35,0x3f0ebf55,0xbf6dbec4,0xbe483f7b
.long 0xbf353f35,0x3f0e3f55,0x3f6dbec4,0xbe48bf7b,0xbf35bf35,0xbf7b3e48,0xbec43f6d,0x3f0e3f55
.long 0x3f35bf35,0x3e48bf7b,0xbec4bf6d,0xbf55bf0e,0x3f353f35,0x3f553f0e,0x3f6d3ec4,0x3f7b3e48
.long 0x3f353f35,0x3f0e3f55,0x3ec43f6d,0x3e483f7b,0xbf353f35,0xbf7b3e48,0xbf6dbec4,0xbf0ebf55
.long 0xbf35bf35,0x3e48bf7b,0x3f6dbec4,0x3f553f0e,0x3f35bf35,0x3f553f0e,0xbec43f6d,0xbf7bbe48
.long 0x3f353f35,0xbf553f0e,0xbec4bf6d,0x3f7bbe48,0xbf353f35,0xbe48bf7b,0x3f6d3ec4,0xbf553f0e
.long 0xbf35bf35,0x3f7b3e48,0xbf6d3ec4,0x3f0ebf55,0x3f35bf35,0xbf0e3f55,0x3ec4bf6d,0xbe483f7b
.long 0x3f353f35,0xbf0ebf55,0x3ec43f6d,0xbe48bf7b,0xbf353f35,0x3f7bbe48,0xbf6dbec4,0x3f0e3f55
.long 0xbf35bf35,0xbe483f7b,0x3f6dbec4,0xbf55bf0e,0x3f35bf35,0xbf55bf0e,0xbec43f6d,0x3f7b3e48
.long 0x3f353f35,0x3f55bf0e,0xbec4bf6d,0xbf7b3e48,0xbf353f35,0x3e483f7b,0x3f6d3ec4,0x3f55bf0e
.long 0xbf35bf35,0xbf7bbe48,0xbf6d3ec4,0xbf0e3f55,0x3f35bf35,0x3f0ebf55,0x3ec4bf6d,0x3e48bf7b
.long 0xbf80248d,0xbf7bbe48,0xbf6dbec4,0xbf55bf0e,0x3f80a554,0x3f553f0e,0x3ec43f6d,0xbe483f7b
.long 0xbf80248d,0xbf0ebf55,0x3ec4bf6d,0x3f7bbe48,0x3f80a554,0x3e483f7b,0xbf6d3ec4,0xbf0ebf55
.long 0xbf80248d,0x3e48bf7b,0x3f6d3ec4,0xbf0e3f55,0x3f80a554,0xbf0e3f55,0xbec4bf6d,0x3f7b3e48
.long 0xbf80248d,0x3f55bf0e,0xbec43f6d,0xbe48bf7b,0x3f80a554,0xbf7b3e48,0x3f6dbec4,0xbf553f0e
.long 0xbf80248d,0x3f7b3e48,0xbf6dbec4,0x3f553f0e,0x3f80a554,0xbf55bf0e,0x3ec43f6d,0x3e48bf7b
.long 0xbf80248d,0x3f0e3f55,0x3ec4bf6d,0xbf7b3e48,0x3f80a554,0xbe48bf7b,0xbf6d3ec4,0x3f0e3f55
.long 0xbf80248d,0xbe483f7b,0x3f6d3ec4,0x3f0ebf55,0x3f80a554,0x3f0ebf55,0xbec4bf6d,0xbf7bbe48
.long 0xbf80248d,0xbf553f0e,0xbec43f6d,0x3e483f7b,0x3f80a554,0x3f7bbe48,0x3f6dbec4,0x3f55bf0e
.long 0x248d3f80,0xbe483f7b,0xbec43f6d,0xbf0e3f55,0xa554bf80,0x3f0ebf55,0x3f6dbec4,0x3f7b3e48
.long 0x248d3f80,0xbf553f0e,0xbf6dbec4,0xbe48bf7b,0xa554bf80,0x3f7bbe48,0x3ec43f6d,0xbf553f0e
.long 0x248d3f80,0xbf7bbe48,0x3ec4bf6d,0x3f553f0e,0xa554bf80,0x3f553f0e,0xbf6d3ec4,0x3e48bf7b
.long 0x248d3f80,0xbf0ebf55,0x3f6d3ec4,0xbf7b3e48,0xa554bf80,0x3e483f7b,0xbec4bf6d,0x3f0e3f55
.long 0x248d3f80,0x3e48bf7b,0xbec43f6d,0x3f0ebf55,0xa554bf80,0xbf0e3f55,0x3f6dbec4,0xbf7bbe48
.long 0x248d3f80,0x3f55bf0e,0xbf6dbec4,0x3e483f7b,0xa554bf80,0xbf7b3e48,0x3ec43f6d,0x3f55bf0e
.long 0x248d3f80,0x3f7b3e48,0x3ec4bf6d,0xbf55bf0e,0xa554bf80,0xbf55bf0e,0xbf6d3ec4,0xbe483f7b
.long 0x248d3f80,0x3f0e3f55,0x3f6d3ec4,0x3f7bbe48,0xa554bf80,0xbe48bf7b,0xbec4bf6d,0xbf0ebf55
.long 0xbf35bf35,0xbf0ebf55,0xbec4bf6d,0xbe48bf7b,0xbf353f35,0xbf7b3e48,0xbf6dbec4,0xbf0ebf55
.long 0x3f353f35,0xbe483f7b,0xbf6d3ec4,0xbf55bf0e,0x3f35bf35,0x3f553f0e,0xbec43f6d,0xbf7bbe48
.long 0xbf35bf35,0x3f55bf0e,0x3ec43f6d,0xbf7b3e48,0xbf353f35,0xbe48bf7b,0x3f6d3ec4,0xbf553f0e
.long 0x3f353f35,0xbf7bbe48,0x3f6dbec4,0xbf0e3f55,0x3f35bf35,0xbf0e3f55,0x3ec4bf6d,0xbe483f7b
.long 0xbf35bf35,0x3f0e3f55,0xbec4bf6d,0x3e483f7b,0xbf353f35,0x3f7bbe48,0xbf6dbec4,0x3f0e3f55
.long 0x3f353f35,0x3e48bf7b,0xbf6d3ec4,0x3f553f0e,0x3f35bf35,0xbf55bf0e,0xbec43f6d,0x3f7b3e48
.long 0xbf35bf35,0xbf553f0e,0x3ec43f6d,0x3f7bbe48,0xbf353f35,0x3e483f7b,0x3f6d3ec4,0x3f55bf0e
.long 0x3f353f35,0x3f7b3e48,0x3f6dbec4,0x3f0ebf55,0x3f35bf35,0x3f0ebf55,0x3ec4bf6d,0x3e48bf7b
.long 0xbf353f35,0xbf553f0e,0xbf6d3ec4,0xbf7b3e48,0x3f353f35,0x3e483f7b,0xbec43f6d,0xbf553f0e
.long 0x3f35bf35,0x3f7b3e48,0x3ec43f6d,0xbf0e3f55,0xbf35bf35,0x3f0ebf55,0x3f6d3ec4,0xbe483f7b
.long 0xbf353f35,0xbf0ebf55,0x3f6dbec4,0x3e483f7b,0x3f353f35,0xbf7b3e48,0x3ec4bf6d,0x3f0e3f55
.long 0x3f35bf35,0xbe483f7b,0xbec4bf6d,0x3f553f0e,0xbf35bf35,0x3f553f0e,0xbf6dbec4,0x3f7b3e48
.long 0xbf353f35,0x3f55bf0e,0xbf6d3ec4,0x3f7bbe48,0x3f353f35,0xbe48bf7b,0xbec43f6d,0x3f55bf0e
.long 0x3f35bf35,0xbf7bbe48,0x3ec43f6d,0x3f0ebf55,0xbf35bf35,0xbf0e3f55,0x3f6d3ec4,0x3e48bf7b
.long 0xbf353f35,0x3f0e3f55,0x3f6dbec4,0xbe48bf7b,0x3f353f35,0x3f7bbe48,0x3ec4bf6d,0xbf0ebf55
.long 0x3f35bf35,0x3e48bf7b,0xbec4bf6d,0xbf55bf0e,0xbf35bf35,0xbf55bf0e,0xbf6dbec4,0xbf7bbe48
.long 0xa50dbf80,0x3e48bf7b,0x3ec4bf6d,0x3f0ebf55,0xa50dbf80,0x3f0ebf55,0x3f6dbec4,0x3f7b3e48
.long 0xa50dbf80,0x3f55bf0e,0x3f6d3ec4,0x3e483f7b,0xa50dbf80,0x3f7bbe48,0x3ec43f6d,0xbf553f0e
.long 0xa50dbf80,0x3f7b3e48,0xbec43f6d,0xbf55bf0e,0xa50dbf80,0x3f553f0e,0xbf6d3ec4,0x3e48bf7b
.long 0xa50dbf80,0x3f0e3f55,0xbf6dbec4,0x3f7bbe48,0xa50dbf80,0x3e483f7b,0xbec4bf6d,0x3f0e3f55
.long 0xa50dbf80,0xbe483f7b,0x3ec4bf6d,0xbf0e3f55,0xa50dbf80,0xbf0e3f55,0x3f6dbec4,0xbf7bbe48
.long 0xa50dbf80,0xbf553f0e,0x3f6d3ec4,0xbe48bf7b,0xa50dbf80,0xbf7b3e48,0x3ec43f6d,0x3f55bf0e
.long 0xa50dbf80,0xbf7bbe48,0xbec43f6d,0x3f553f0e,0xa50dbf80,0xbf55bf0e,0xbf6d3ec4,0xbe483f7b
.long 0xa50dbf80,0xbf0ebf55,0xbf6dbec4,0xbf7b3e48,0xa50dbf80,0xbe48bf7b,0xbec4bf6d,0xbf0ebf55
.long 0xbf80250d,0xbf7bbe48,0xbf6dbec4,0xbf55bf0e,0xbf80250d,0xbf55bf0e,0xbec4bf6d,0x3e48bf7b
.long 0xbf80250d,0xbf0ebf55,0x3ec4bf6d,0x3f7bbe48,0xbf80250d,0xbe48bf7b,0x3f6dbec4,0x3f0e3f55
.long 0xbf80250d,0x3e48bf7b,0x3f6d3ec4,0xbf0e3f55,0xbf80250d,0x3f0ebf55,0x3ec43f6d,0xbf7bbe48
.long 0xbf80250d,0x3f55bf0e,0xbec43f6d,0xbe48bf7b,0xbf80250d,0x3f7bbe48,0xbf6d3ec4,0x3f55bf0e
.long 0xbf80250d,0x3f7b3e48,0xbf6dbec4,0x3f553f0e,0xbf80250d,0x3f553f0e,0xbec4bf6d,0xbe483f7b
.long 0xbf80250d,0x3f0e3f55,0x3ec4bf6d,0xbf7b3e48,0xbf80250d,0x3e483f7b,0x3f6dbec4,0xbf0ebf55
.long 0xbf80250d,0xbe483f7b,0x3f6d3ec4,0x3f0ebf55,0xbf80250d,0xbf0e3f55,0x3ec43f6d,0x3f7b3e48
.long 0xbf80250d,0xbf553f0e,0xbec43f6d,0x3e483f7b,0xbf80250d,0xbf7b3e48,0xbf6d3ec4,0xbf553f0e
.long 0x3f35bf35,0x3f55bf0e,0x3f6dbec4,0x3f7bbe48,0x3f353f35,0x3e483f7b,0xbec43f6d,0xbf553f0e
.long 0xbf353f35,0xbf7bbe48,0xbec4bf6d,0x3f0ebf55,0xbf35bf35,0x3f0ebf55,0x3f6d3ec4,0xbe483f7b
.long 0x3f35bf35,0x3f0e3f55,0xbf6d3ec4,0xbe48bf7b,0x3f353f35,0xbf7b3e48,0x3ec4bf6d,0x3f0e3f55
.long 0xbf353f35,0x3e48bf7b,0x3ec43f6d,0xbf55bf0e,0xbf35bf35,0x3f553f0e,0xbf6dbec4,0x3f7b3e48
.long 0x3f35bf35,0xbf553f0e,0x3f6dbec4,0xbf7b3e48,0x3f353f35,0xbe48bf7b,0xbec43f6d,0x3f55bf0e
.long 0xbf353f35,0x3f7b3e48,0xbec4bf6d,0xbf0e3f55,0xbf35bf35,0xbf0e3f55,0x3f6d3ec4,0x3e48bf7b
.long 0x3f35bf35,0xbf0ebf55,0xbf6d3ec4,0x3e483f7b,0x3f353f35,0x3f7bbe48,0x3ec4bf6d,0xbf0ebf55
.long 0xbf353f35,0xbe483f7b,0x3ec43f6d,0x3f553f0e,0xbf35bf35,0xbf55bf0e,0xbf6dbec4,0xbf7bbe48
.long 0xbf35bf35,0xbf0ebf55,0xbec4bf6d,0xbe48bf7b,0x3f35bf35,0x3f7bbe48,0x3f6d3ec4,0x3f0e3f55
.long 0x3f353f35,0xbe483f7b,0xbf6d3ec4,0xbf55bf0e,0xbf353f35,0xbf55bf0e,0x3ec4bf6d,0x3f7b3e48
.long 0xbf35bf35,0x3f55bf0e,0x3ec43f6d,0xbf7b3e48,0x3f35bf35,0x3e483f7b,0xbf6dbec4,0x3f55bf0e
.long 0x3f353f35,0xbf7bbe48,0x3f6dbec4,0xbf0e3f55,0xbf353f35,0x3f0ebf55,0xbec43f6d,0x3e48bf7b
.long 0xbf35bf35,0x3f0e3f55,0xbec4bf6d,0x3e483f7b,0x3f35bf35,0xbf7b3e48,0x3f6d3ec4,0xbf0ebf55
.long 0x3f353f35,0x3e48bf7b,0xbf6d3ec4,0x3f553f0e,0xbf353f35,0x3f553f0e,0x3ec4bf6d,0xbf7bbe48
.long 0xbf35bf35,0xbf553f0e,0x3ec43f6d,0x3f7bbe48,0x3f35bf35,0xbe48bf7b,0xbf6dbec4,0xbf553f0e
.long 0x3f353f35,0x3f7b3e48,0x3f6dbec4,0x3f0ebf55,0xbf353f35,0xbf0e3f55,0xbec43f6d,0xbe483f7b
.long 0x3f80a554,0x3f7b3e48,0x3f6d3ec4,0x3f553f0e,0xbf80248d,0xbf55bf0e,0xbec4bf6d,0x3e48bf7b
.long 0x3f80a554,0x3f0e3f55,0xbec43f6d,0xbf7b3e48,0xbf80248d,0xbe48bf7b,0x3f6dbec4,0x3f0e3f55
.long 0x3f80a554,0xbe483f7b,0xbf6dbec4,0x3f0ebf55,0xbf80248d,0x3f0ebf55,0x3ec43f6d,0xbf7bbe48
.long 0x3f80a554,0xbf553f0e,0x3ec4bf6d,0x3e483f7b,0xbf80248d,0x3f7bbe48,0xbf6d3ec4,0x3f55bf0e
.long 0x3f80a554,0xbf7bbe48,0x3f6d3ec4,0xbf55bf0e,0xbf80248d,0x3f553f0e,0xbec4bf6d,0xbe483f7b
.long 0x3f80a554,0xbf0ebf55,0xbec43f6d,0x3f7bbe48,0xbf80248d,0x3e483f7b,0x3f6dbec4,0xbf0ebf55
.long 0x3f80a554,0x3e48bf7b,0xbf6dbec4,0xbf0e3f55,0xbf80248d,0xbf0e3f55,0x3ec43f6d,0x3f7b3e48
.long 0x3f80a554,0x3f55bf0e,0x3ec4bf6d,0xbe48bf7b,0xbf80248d,0xbf7b3e48,0xbf6d3ec4,0xbf553f0e
.long 0xa554bf80,0x3e48bf7b,0x3ec4bf6d,0x3f0ebf55,0x248d3f80,0xbf0e3f55,0xbf6d3ec4,0xbf7bbe48
.long 0xa554bf80,0x3f55bf0e,0x3f6d3ec4,0x3e483f7b,0x248d3f80,0xbf7b3e48,0xbec4bf6d,0x3f55bf0e
.long 0xa554bf80,0x3f7b3e48,0xbec43f6d,0xbf55bf0e,0x248d3f80,0xbf55bf0e,0x3f6dbec4,0xbe483f7b
.long 0xa554bf80,0x3f0e3f55,0xbf6dbec4,0x3f7bbe48,0x248d3f80,0xbe48bf7b,0x3ec43f6d,0xbf0ebf55
.long 0xa554bf80,0xbe483f7b,0x3ec4bf6d,0xbf0e3f55,0x248d3f80,0x3f0ebf55,0xbf6d3ec4,0x3f7b3e48
.long 0xa554bf80,0xbf553f0e,0x3f6d3ec4,0xbe48bf7b,0x248d3f80,0x3f7bbe48,0xbec4bf6d,0xbf553f0e
.long 0xa554bf80,0xbf7bbe48,0xbec43f6d,0x3f553f0e,0x248d3f80,0x3f553f0e,0x3f6dbec4,0x3e48bf7b
.long 0xa554bf80,0xbf0ebf55,0xbf6dbec4,0xbf7b3e48,0x248d3f80,0x3e483f7b,0x3ec43f6d,0x3f0e3f55
.long 0x3f353f35,0x3f0e3f55,0x3ec43f6d,0x3e483f7b,0x3f35bf35,0x3f7bbe48,0x3f6d3ec4,0x3f0e3f55
.long 0xbf35bf35,0x3e48bf7b,0x3f6dbec4,0x3f553f0e,0xbf353f35,0xbf55bf0e,0x3ec4bf6d,0x3f7b3e48
.long 0x3f353f35,0xbf553f0e,0xbec4bf6d,0x3f7bbe48,0x3f35bf35,0x3e483f7b,0xbf6dbec4,0x3f55bf0e
.long 0xbf35bf35,0x3f7b3e48,0xbf6d3ec4,0x3f0ebf55,0xbf353f35,0x3f0ebf55,0xbec43f6d,0x3e48bf7b
.long 0x3f353f35,0xbf0ebf55,0x3ec43f6d,0xbe48bf7b,0x3f35bf35,0xbf7b3e48,0x3f6d3ec4,0xbf0ebf55
.long 0xbf35bf35,0xbe483f7b,0x3f6dbec4,0xbf55bf0e,0xbf353f35,0x3f553f0e,0x3ec4bf6d,0xbf7bbe48
.long 0x3f353f35,0x3f55bf0e,0xbec4bf6d,0xbf7b3e48,0x3f35bf35,0xbe48bf7b,0xbf6dbec4,0xbf553f0e
.long 0xbf35bf35,0xbf7bbe48,0xbf6d3ec4,0xbf0e3f55,0xbf353f35,0xbf0e3f55,0xbec43f6d,0xbe483f7b
.long 0x3f35bf35,0x3f55bf0e,0x3f6dbec4,0x3f7bbe48,0xbf35bf35,0xbe48bf7b,0x3ec4bf6d,0x3f55bf0e
.long 0xbf353f35,0xbf7bbe48,0xbec4bf6d,0x3f0ebf55,0x3f353f35,0xbf0e3f55,0xbf6dbec4,0x3e48bf7b
.long 0x3f35bf35,0x3f0e3f55,0xbf6d3ec4,0xbe48bf7b,0xbf35bf35,0x3f7bbe48,0xbec43f6d,0xbf0ebf55
.long 0xbf353f35,0x3e48bf7b,0x3ec43f6d,0xbf55bf0e,0x3f353f35,0xbf55bf0e,0x3f6d3ec4,0xbf7bbe48
.long 0x3f35bf35,0xbf553f0e,0x3f6dbec4,0xbf7b3e48,0xbf35bf35,0x3e483f7b,0x3ec4bf6d,0xbf553f0e
.long 0xbf353f35,0x3f7b3e48,0xbec4bf6d,0xbf0e3f55,0x3f353f35,0x3f0ebf55,0xbf6dbec4,0xbe483f7b
.long 0x3f35bf35,0xbf0ebf55,0xbf6d3ec4,0x3e483f7b,0xbf35bf35,0xbf7b3e48,0xbec43f6d,0x3f0e3f55
.long 0xbf353f35,0xbe483f7b,0x3ec43f6d,0x3f553f0e,0x3f353f35,0x3f553f0e,0x3f6d3ec4,0x3f7b3e48
.long 0x80003f80,0x80003f80,0x80003f80,0x80003f80,0x80003f80,0xbe483f7b,0xbec43f6d,0xbf0e3f55
.long 0x80003f80,0xbec43f6d,0xbf353f35,0xbf6d3ec4,0x80003f80,0xbf0e3f55,0xbf6d3ec4,0xbf7bbe48
.long 0x80003f80,0xbf353f35,0xbf80248d,0xbf35bf35,0x80003f80,0xbf553f0e,0xbf6dbec4,0xbe48bf7b
.long 0x80003f80,0xbf6d3ec4,0xbf35bf35,0x3ec4bf6d,0x80003f80,0xbf7b3e48,0xbec4bf6d,0x3f55bf0e
.long 0x80003f80,0xbf80248d,0xa50dbf80,0x3f80a554,0x80003f80,0xbf7bbe48,0x3ec4bf6d,0x3f553f0e
.long 0x80003f80,0xbf6dbec4,0x3f35bf35,0x3ec43f6d,0x80003f80,0xbf55bf0e,0x3f6dbec4,0xbe483f7b
.long 0x80003f80,0xbf35bf35,0x3f80a554,0xbf353f35,0x80003f80,0xbf0ebf55,0x3f6d3ec4,0xbf7b3e48
.long 0x80003f80,0xbec4bf6d,0x3f353f35,0xbf6dbec4,0x80003f80,0xbe48bf7b,0x3ec43f6d,0xbf0ebf55
.long 0x80003f80,0xa50dbf80,0x80003f80,0xa50dbf80,0x80003f80,0x3e48bf7b,0xbec43f6d,0x3f0ebf55
.long 0x80003f80,0x3ec4bf6d,0xbf353f35,0x3f6dbec4,0x80003f80,0x3f0ebf55,0xbf6d3ec4,0x3f7b3e48
.long 0x80003f80,0x3f35bf35,0xbf80248d,0x3f353f35,0x80003f80,0x3f55bf0e,0xbf6dbec4,0x3e483f7b
.long 0x80003f80,0x3f6dbec4,0xbf35bf35,0xbec43f6d,0x80003f80,0x3f7bbe48,0xbec4bf6d,0xbf553f0e
.long 0x80003f80,0x3f80a554,0xa50dbf80,0xbf80248d,0x80003f80,0x3f7b3e48,0x3ec4bf6d,0xbf55bf0e
.long 0x80003f80,0x3f6d3ec4,0x3f35bf35,0xbec4bf6d,0x80003f80,0x3f553f0e,0x3f6dbec4,0x3e48bf7b
.long 0x80003f80,0x3f353f35,0x3f80a554,0x3f35bf35,0x80003f80,0x3f0e3f55,0x3f6d3ec4,0x3f7bbe48
.long 0x80003f80,0x3ec43f6d,0x3f353f35,0x3f6d3ec4,0x80003f80,0x3e483f7b,0x3ec43f6d,0x3f0e3f55
.long 0x80003f80,0x80003f80,0x80003f80,0x80003f80,0xbf353f35,0xbf553f0e,0xbf6d3ec4,0xbf7b3e48
.long 0xbf80248d,0xbf6dbec4,0xbf35bf35,0xbec4bf6d,0xbf35bf35,0xbe48bf7b,0x3ec4bf6d,0x3f55bf0e
.long 0xa50dbf80,0x3f35bf35,0x3f80a554,0x3f353f35,0x3f35bf35,0x3f7b3e48,0x3ec43f6d,0xbf0e3f55
.long 0x3f80a554,0x3ec43f6d,0xbf353f35,0xbf6dbec4,0x3f353f35,0xbf0e3f55,0xbf6dbec4,0x3e48bf7b
.long 0x80003f80,0xbf80248d,0xa50dbf80,0x3f80a554,0xbf353f35,0xbf0ebf55,0x3f6dbec4,0x3e483f7b
.long 0xbf80248d,0x3ec4bf6d,0x3f353f35,0xbf6d3ec4,0xbf35bf35,0x3f7bbe48,0xbec43f6d,0xbf0ebf55
.long 0xa50dbf80,0x3f353f35,0xbf80248d,0x3f35bf35,0x3f35bf35,0xbe483f7b,0xbec4bf6d,0x3f553f0e
.long 0x3f80a554,0xbf6d3ec4,0x3f35bf35,0xbec43f6d,0x3f353f35,0xbf55bf0e,0x3f6d3ec4,0xbf7bbe48
.long 0x80003f80,0xa50dbf80,0x80003f80,0xa50dbf80,0xbf353f35,0x3f55bf0e,0xbf6d3ec4,0x3f7bbe48
.long 0xbf80248d,0x3f6d3ec4,0xbf35bf35,0x3ec43f6d,0xbf35bf35,0x3e483f7b,0x3ec4bf6d,0xbf553f0e
.long 0xa50dbf80,0xbf353f35,0x3f80a554,0xbf35bf35,0x3f35bf35,0xbf7bbe48,0x3ec43f6d,0x3f0ebf55
.long 0x3f80a554,0xbec4bf6d,0xbf353f35,0x3f6d3ec4,0x3f353f35,0x3f0ebf55,0xbf6dbec4,0xbe483f7b
.long 0x80003f80,0x3f80a554,0xa50dbf80,0xbf80248d,0xbf353f35,0x3f0e3f55,0x3f6dbec4,0xbe48bf7b
.long 0xbf80248d,0xbec43f6d,0x3f353f35,0x3f6dbec4,0xbf35bf35,0xbf7b3e48,0xbec43f6d,0x3f0e3f55
.long 0xa50dbf80,0xbf35bf35,0xbf80248d,0xbf353f35,0x3f35bf35,0x3e48bf7b,0xbec4bf6d,0xbf55bf0e
.long 0x3f80a554,0x3f6dbec4,0x3f35bf35,0x3ec4bf6d,0x3f353f35,0x3f553f0e,0x3f6d3ec4,0x3f7b3e48
.long 0x80003f80,0x80003f80,0x80003f80,0x80003f80,0xbf80248d,0xbf7bbe48,0xbf6dbec4,0xbf55bf0e
.long 0xa50dbf80,0x3ec4bf6d,0x3f35bf35,0x3f6dbec4,0x3f80a554,0x3f553f0e,0x3ec43f6d,0xbe483f7b
.long 0x80003f80,0xbf353f35,0xbf80248d,0xbf35bf35,0xbf80248d,0xbf0ebf55,0x3ec4bf6d,0x3f7bbe48
.long 0xa50dbf80,0x3f6dbec4,0x3f353f35,0xbec43f6d,0x3f80a554,0x3e483f7b,0xbf6d3ec4,0xbf0ebf55
.long 0x80003f80,0xbf80248d,0xa50dbf80,0x3f80a554,0xbf80248d,0x3e48bf7b,0x3f6d3ec4,0xbf0e3f55
.long 0xa50dbf80,0x3f6d3ec4,0xbf353f35,0xbec4bf6d,0x3f80a554,0xbf0e3f55,0xbec4bf6d,0x3f7b3e48
.long 0x80003f80,0xbf35bf35,0x3f80a554,0xbf353f35,0xbf80248d,0x3f55bf0e,0xbec43f6d,0xbe48bf7b
.long 0xa50dbf80,0x3ec43f6d,0xbf35bf35,0x3f6d3ec4,0x3f80a554,0xbf7b3e48,0x3f6dbec4,0xbf553f0e
.long 0x80003f80,0xa50dbf80,0x80003f80,0xa50dbf80,0xbf80248d,0x3f7b3e48,0xbf6dbec4,0x3f553f0e
.long 0xa50dbf80,0xbec43f6d,0x3f35bf35,0xbf6d3ec4,0x3f80a554,0xbf55bf0e,0x3ec43f6d,0x3e48bf7b
.long 0x80003f80,0x3f35bf35,0xbf80248d,0x3f353f35,0xbf80248d,0x3f0e3f55,0x3ec4bf6d,0xbf7b3e48
.long 0xa50dbf80,0xbf6d3ec4,0x3f353f35,0x3ec4bf6d,0x3f80a554,0xbe48bf7b,0xbf6d3ec4,0x3f0e3f55
.long 0x80003f80,0x3f80a554,0xa50dbf80,0xbf80248d,0xbf80248d,0xbe483f7b,0x3f6d3ec4,0x3f0ebf55
.long 0xa50dbf80,0xbf6dbec4,0xbf353f35,0x3ec43f6d,0x3f80a554,0x3f0ebf55,0xbec4bf6d,0xbf7bbe48
.long 0x80003f80,0x3f353f35,0x3f80a554,0x3f35bf35,0xbf80248d,0xbf553f0e,0xbec43f6d,0x3e483f7b
.long 0xa50dbf80,0xbec4bf6d,0xbf35bf35,0xbf6dbec4,0x3f80a554,0x3f7bbe48,0x3f6dbec4,0x3f55bf0e
.long 0x80003f80,0x80003f80,0x80003f80,0x80003f80,0xbf35bf35,0xbf0ebf55,0xbec4bf6d,0xbe48bf7b
.long 0x3f80a554,0x3f6d3ec4,0x3f353f35,0x3ec43f6d,0xbf353f35,0xbf7b3e48,0xbf6dbec4,0xbf0ebf55
.long 0xa50dbf80,0x3f35bf35,0x3f80a554,0x3f353f35,0x3f353f35,0xbe483f7b,0xbf6d3ec4,0xbf55bf0e
.long 0xbf80248d,0xbec4bf6d,0x3f35bf35,0x3f6d3ec4,0x3f35bf35,0x3f553f0e,0xbec43f6d,0xbf7bbe48
.long 0x80003f80,0xbf80248d,0xa50dbf80,0x3f80a554,0xbf35bf35,0x3f55bf0e,0x3ec43f6d,0xbf7b3e48
.long 0x3f80a554,0xbec43f6d,0xbf35bf35,0x3f6dbec4,0xbf353f35,0xbe48bf7b,0x3f6d3ec4,0xbf553f0e
.long 0xa50dbf80,0x3f353f35,0xbf80248d,0x3f35bf35,0x3f353f35,0xbf7bbe48,0x3f6dbec4,0xbf0e3f55
.long 0xbf80248d,0x3f6dbec4,0xbf353f35,0x3ec4bf6d,0x3f35bf35,0xbf0e3f55,0x3ec4bf6d,0xbe483f7b
.long 0x80003f80,0xa50dbf80,0x80003f80,0xa50dbf80,0xbf35bf35,0x3f0e3f55,0xbec4bf6d,0x3e483f7b
.long 0x3f80a554,0xbf6dbec4,0x3f353f35,0xbec4bf6d,0xbf353f35,0x3f7bbe48,0xbf6dbec4,0x3f0e3f55
.long 0xa50dbf80,0xbf353f35,0x3f80a554,0xbf35bf35,0x3f353f35,0x3e48bf7b,0xbf6d3ec4,0x3f553f0e
.long 0xbf80248d,0x3ec43f6d,0x3f35bf35,0xbf6dbec4,0x3f35bf35,0xbf55bf0e,0xbec43f6d,0x3f7b3e48
.long 0x80003f80,0x3f80a554,0xa50dbf80,0xbf80248d,0xbf35bf35,0xbf553f0e,0x3ec43f6d,0x3f7bbe48
.long 0x3f80a554,0x3ec4bf6d,0xbf35bf35,0xbf6d3ec4,0xbf353f35,0x3e483f7b,0x3f6d3ec4,0x3f55bf0e
.long 0xa50dbf80,0xbf35bf35,0xbf80248d,0xbf353f35,0x3f353f35,0x3f7b3e48,0x3f6dbec4,0x3f0ebf55
.long 0xbf80248d,0xbf6d3ec4,0xbf353f35,0xbec43f6d,0x3f35bf35,0x3f0ebf55,0x3ec4bf6d,0x3e48bf7b
.long 0x3f800000,0x3f800000,0x3f800000,0x3f800000,0x3f800000,0x3f7b3e48,0x3f6d3ec4,0x3f553f0e
.long 0x3f800000,0x3f6d3ec4,0x3f353f35,0x3ec43f6d,0x3f800000,0x3f553f0e,0x3ec43f6d,0xbe483f7b
.long 0x3f800000,0x3f353f35,0x248d3f80,0xbf353f35,0x3f800000,0x3f0e3f55,0xbec43f6d,0xbf7b3e48
.long 0x3f800000,0x3ec43f6d,0xbf353f35,0xbf6dbec4,0x3f800000,0x3e483f7b,0xbf6d3ec4,0xbf0ebf55
.long 0x3f800000,0x248d3f80,0xbf80250d,0xa554bf80,0x3f800000,0xbe483f7b,0xbf6dbec4,0x3f0ebf55
.long 0x3f800000,0xbec43f6d,0xbf35bf35,0x3f6dbec4,0x3f800000,0xbf0e3f55,0xbec4bf6d,0x3f7b3e48
.long 0x3f800000,0xbf353f35,0xa554bf80,0x3f353f35,0x3f800000,0xbf553f0e,0x3ec4bf6d,0x3e483f7b
.long 0x3f800000,0xbf6d3ec4,0x3f35bf35,0xbec43f6d,0x3f800000,0xbf7b3e48,0x3f6dbec4,0xbf553f0e
.long 0x3f800000,0xbf80250d,0x3f800000,0xbf80250d,0x3f800000,0xbf7bbe48,0x3f6d3ec4,0xbf55bf0e
.long 0x3f800000,0xbf6dbec4,0x3f353f35,0xbec4bf6d,0x3f800000,0xbf55bf0e,0x3ec43f6d,0x3e48bf7b
.long 0x3f800000,0xbf35bf35,0x248d3f80,0x3f35bf35,0x3f800000,0xbf0ebf55,0xbec43f6d,0x3f7bbe48
.long 0x3f800000,0xbec4bf6d,0xbf353f35,0x3f6d3ec4,0x3f800000,0xbe48bf7b,0xbf6d3ec4,0x3f0e3f55
.long 0x3f800000,0xa554bf80,0xbf80250d,0x248d3f80,0x3f800000,0x3e48bf7b,0xbf6dbec4,0xbf0e3f55
.long 0x3f800000,0x3ec4bf6d,0xbf35bf35,0xbf6d3ec4,0x3f800000,0x3f0ebf55,0xbec4bf6d,0xbf7bbe48
.long 0x3f800000,0x3f35bf35,0xa554bf80,0xbf35bf35,0x3f800000,0x3f55bf0e,0x3ec4bf6d,0xbe48bf7b
.long 0x3f800000,0x3f6dbec4,0x3f35bf35,0x3ec4bf6d,0x3f800000,0x3f7bbe48,0x3f6dbec4,0x3f55bf0e
.long 0x3f800000,0x3f800000,0x3f800000,0x3f800000,0x3f353f35,0x3f0e3f55,0x3ec43f6d,0x3e483f7b
.long 0x248d3f80,0xbec43f6d,0xbf353f35,0xbf6d3ec4,0xbf353f35,0xbf7b3e48,0xbf6dbec4,0xbf0ebf55
.long 0xbf80250d,0xbf35bf35,0xa554bf80,0x3f35bf35,0xbf35bf35,0x3e48bf7b,0x3f6dbec4,0x3f553f0e
.long 0xa554bf80,0x3f6dbec4,0x3f353f35,0xbec43f6d,0x3f35bf35,0x3f553f0e,0xbec43f6d,0xbf7bbe48
.long 0x3f800000,0x248d3f80,0xbf80250d,0xa554bf80,0x3f353f35,0xbf553f0e,0xbec4bf6d,0x3f7bbe48
.long 0x248d3f80,0xbf6dbec4,0x3f35bf35,0x3ec43f6d,0xbf353f35,0xbe48bf7b,0x3f6d3ec4,0xbf553f0e
.long 0xbf80250d,0x3f35bf35,0x248d3f80,0xbf35bf35,0xbf35bf35,0x3f7b3e48,0xbf6d3ec4,0x3f0ebf55
.long 0xa554bf80,0x3ec43f6d,0xbf35bf35,0x3f6d3ec4,0x3f35bf35,0xbf0e3f55,0x3ec4bf6d,0xbe483f7b
.long 0x3f800000,0xbf80250d,0x3f800000,0xbf80250d,0x3f353f35,0xbf0ebf55,0x3ec43f6d,0xbe48bf7b
.long 0x248d3f80,0x3ec4bf6d,0xbf353f35,0x3f6dbec4,0xbf353f35,0x3f7bbe48,0xbf6dbec4,0x3f0e3f55
.long 0xbf80250d,0x3f353f35,0xa554bf80,0xbf353f35,0xbf35bf35,0xbe483f7b,0x3f6dbec4,0xbf55bf0e
.long 0xa554bf80,0xbf6d3ec4,0x3f353f35,0x3ec4bf6d,0x3f35bf35,0xbf55bf0e,0xbec43f6d,0x3f7b3e48
.long 0x3f800000,0xa554bf80,0xbf80250d,0x248d3f80,0x3f353f35,0x3f55bf0e,0xbec4bf6d,0xbf7b3e48
.long 0x248d3f80,0x3f6d3ec4,0x3f35bf35,0xbec4bf6d,0xbf353f35,0x3e483f7b,0x3f6d3ec4,0x3f55bf0e
.long 0xbf80250d,0xbf353f35,0x248d3f80,0x3f353f35,0xbf35bf35,0xbf7bbe48,0xbf6d3ec4,0xbf0e3f55
.long 0xa554bf80,0xbec4bf6d,0xbf35bf35,0xbf6dbec4,0x3f35bf35,0x3f0ebf55,0x3ec4bf6d,0x3e48bf7b
.long 0x3f800000,0x3f800000,0x3f800000,0x3f800000,0x248d3f80,0xbe483f7b,0xbec43f6d,0xbf0e3f55
.long 0xbf80250d,0xbf6dbec4,0xbf35bf35,0xbec4bf6d,0xa554bf80,0x3f0ebf55,0x3f6dbec4,0x3f7b3e48
.long 0x3f800000,0x3f353f35,0x248d3f80,0xbf353f35,0x248d3f80,0xbf553f0e,0xbf6dbec4,0xbe48bf7b
.long 0xbf80250d,0xbec4bf6d,0x3f35bf35,0x3f6d3ec4,0xa554bf80,0x3f7bbe48,0x3ec43f6d,0xbf553f0e
.long 0x3f800000,0x248d3f80,0xbf80250d,0xa554bf80,0x248d3f80,0xbf7bbe48,0x3ec4bf6d,0x3f553f0e
.long 0xbf80250d,0x3ec4bf6d,0x3f353f35,0xbf6d3ec4,0xa554bf80,0x3f553f0e,0xbf6d3ec4,0x3e48bf7b
.long 0x3f800000,0xbf353f35,0xa554bf80,0x3f353f35,0x248d3f80,0xbf0ebf55,0x3f6d3ec4,0xbf7b3e48
.long 0xbf80250d,0x3f6dbec4,0xbf353f35,0x3ec4bf6d,0xa554bf80,0x3e483f7b,0xbec4bf6d,0x3f0e3f55
.long 0x3f800000,0xbf80250d,0x3f800000,0xbf80250d,0x248d3f80,0x3e48bf7b,0xbec43f6d,0x3f0ebf55
.long 0xbf80250d,0x3f6d3ec4,0xbf35bf35,0x3ec43f6d,0xa554bf80,0xbf0e3f55,0x3f6dbec4,0xbf7bbe48
.long 0x3f800000,0xbf35bf35,0x248d3f80,0x3f35bf35,0x248d3f80,0x3f55bf0e,0xbf6dbec4,0x3e483f7b
.long 0xbf80250d,0x3ec43f6d,0x3f35bf35,0xbf6dbec4,0xa554bf80,0xbf7b3e48,0x3ec43f6d,0x3f55bf0e
.long 0x3f800000,0xa554bf80,0xbf80250d,0x248d3f80,0x248d3f80,0x3f7b3e48,0x3ec4bf6d,0xbf55bf0e
.long 0xbf80250d,0xbec43f6d,0x3f353f35,0x3f6dbec4,0xa554bf80,0xbf55bf0e,0xbf6d3ec4,0xbe483f7b
.long 0x3f800000,0x3f35bf35,0xa554bf80,0xbf35bf35,0x248d3f80,0x3f0e3f55,0x3f6d3ec4,0x3f7bbe48
.long 0xbf80250d,0xbf6d3ec4,0xbf353f35,0xbec43f6d,0xa554bf80,0xbe48bf7b,0xbec4bf6d,0xbf0ebf55
.long 0x3f800000,0x3f800000,0x3f800000,0x3f800000,0xbf353f35,0xbf553f0e,0xbf6d3ec4,0xbf7b3e48
.long 0xa554bf80,0x3ec4bf6d,0x3f35bf35,0x3f6dbec4,0x3f353f35,0x3e483f7b,0xbec43f6d,0xbf553f0e
.long 0xbf80250d,0xbf35bf35,0xa554bf80,0x3f35bf35,0x3f35bf35,0x3f7b3e48,0x3ec43f6d,0xbf0e3f55
.long 0x248d3f80,0xbf6d3ec4,0xbf35bf35,0x3ec4bf6d,0xbf35bf35,0x3f0ebf55,0x3f6d3ec4,0xbe483f7b
.long 0x3f800000,0x248d3f80,0xbf80250d,0xa554bf80,0xbf353f35,0xbf0ebf55,0x3f6dbec4,0x3e483f7b
.long 0xa554bf80,0x3f6d3ec4,0xbf353f35,0xbec4bf6d,0x3f353f35,0xbf7b3e48,0x3ec4bf6d,0x3f0e3f55
.long 0xbf80250d,0x3f35bf35,0x248d3f80,0xbf35bf35,0x3f35bf35,0xbe483f7b,0xbec4bf6d,0x3f553f0e
.long 0x248d3f80,0xbec4bf6d,0x3f353f35,0xbf6dbec4,0xbf35bf35,0x3f553f0e,0xbf6dbec4,0x3f7b3e48
.long 0x3f800000,0xbf80250d,0x3f800000,0xbf80250d,0xbf353f35,0x3f55bf0e,0xbf6d3ec4,0x3f7bbe48
.long 0xa554bf80,0xbec43f6d,0x3f35bf35,0xbf6d3ec4,0x3f353f35,0xbe48bf7b,0xbec43f6d,0x3f55bf0e
.long 0xbf80250d,0x3f353f35,0xa554bf80,0xbf353f35,0x3f35bf35,0xbf7bbe48,0x3ec43f6d,0x3f0ebf55
.long 0x248d3f80,0x3f6dbec4,0xbf35bf35,0xbec43f6d,0xbf35bf35,0xbf0e3f55,0x3f6d3ec4,0x3e48bf7b
.long 0x3f800000,0xa554bf80,0xbf80250d,0x248d3f80,0xbf353f35,0x3f0e3f55,0x3f6dbec4,0xbe48bf7b
.long 0xa554bf80,0xbf6dbec4,0xbf353f35,0x3ec43f6d,0x3f353f35,0x3f7bbe48,0x3ec4bf6d,0xbf0ebf55
.long 0xbf80250d,0xbf353f35,0x248d3f80,0x3f353f35,0x3f35bf35,0x3e48bf7b,0xbec4bf6d,0xbf55bf0e
.long 0x248d3f80,0x3ec43f6d,0x3f353f35,0x3f6d3ec4,0xbf35bf35,0xbf55bf0e,0xbf6dbec4,0xbf7bbe48
.long 0x3f800000,0x3f800000,0x3f800000,0x3f800000,0x3f800000,0x3f7ffec4,0x3f7ffb11,0x3f7ff4e6
.long 0x3f800000,0x3f7ffb11,0x3f7fec43,0x3f7fd397,0x3f800000,0x3f7ff4e6,0x3f7fd397,0x3f7f9c18
.long 0x3f800000,0x3f7fec43,0x3f7fb10f,0x3f7f4e6d,0x3f800000,0x3f7fe129,0x3f7f84ab,0x3f7eea9d
.long 0x3f800000,0x3f7fd397,0x3f7f4e6d,0x3f7e70b0,0x3f800000,0x3f7fc38f,0x3f7f0e58,0x3f7de0b1
.long 0x3f800000,0x3f7fb10f,0x3f7ec46d,0x3f7d3aac,0x3f800000,0x3f7f9c18,0x3f7e70b0,0x3f7c7eb0
.long 0x3f800000,0x3f7f84ab,0x3f7e1324,0x3f7baccd,0x3f800000,0x3f7f6ac7,0x3f7dabcc,0x3f7ac516
.long 0x3f800000,0x3f7f4e6d,0x3f7d3aac,0x3f79c79d,0x3f800000,0x3f7f2f9d,0x3f7cbfc9,0x3f78b47b
.long 0x3f800000,0x3f7f0e58,0x3f7c3b28,0x3f778bc5,0x3f800000,0x3f7eea9d,0x3f7baccd,0x3f764d97
.long 0x3f800000,0x3f7ec46d,0x3f7b14be,0x3f74fa0b,0x3f800000,0x3f7e9bc9,0x3f7a7302,0x3f73913f
.long 0x3f800000,0x3f7e70b0,0x3f79c79d,0x3f721352,0x3f800000,0x3f7e4323,0x3f791298,0x3f708066
.long 0x3f800000,0x3f7e1324,0x3f7853f8,0x3f6ed89e,0x3f800000,0x3f7de0b1,0x3f778bc5,0x3f6d1c1d
.long 0x3f800000,0x3f7dabcc,0x3f76ba07,0x3f6b4b0c,0x3f800000,0x3f7d7474,0x3f75dec6,0x3f696591
.long 0x3f800000,0x3f7d3aac,0x3f74fa0b,0x3f676bd8,0x3f800000,0x3f7cfe73,0x3f740bdd,0x3f655e0b
.long 0x3f800000,0x3f7cbfc9,0x3f731447,0x3f633c5a,0x3f800000,0x3f7c7eb0,0x3f721352,0x3f6106f2
.long 0x3f800000,0x3f7c3b28,0x3f710908,0x3f5ebe05,0x3f800000,0x3f7bf531,0x3f6ff573,0x3f5c61c7
.long 0x3f800000,0x3f7baccd,0x3f6ed89e,0x3f59f26a,0x3f800000,0x3f7b61fc,0x3f6db293,0x3f577026
.long 0x3f800000,0x3f800000,0x3f800000,0x3f800000,0x3f7fec43,0x3f7fe129,0x3f7fd397,0x3f7fc38f
.long 0x3f7fb10f,0x3f7f84ab,0x3f7f4e6d,0x3f7f0e58,0x3f7f4e6d,0x3f7eea9d,0x3f7e70b0,0x3f7de0b1
.long 0x3f7ec46d,0x3f7e1324,0x3f7d3aac,0x3f7c3b28,0x3f7e1324,0x3f7cfe73,0x3f7baccd,0x3f7a1e84
.long 0x3f7d3aac,0x3f7baccd,0x3f79c79d,0x3f778bc5,0x3f7c3b28,0x3f7a1e84,0x3f778bc5,0x3f748422
.long 0x3f7b14be,0x3f7853f8,0x3f74fa0b,0x3f710908,0x3f79c79d,0x3f764d97,0x3f721352,0x3f6d1c1d
.long 0x3f7853f8,0x3f740bdd,0x3f6ed89e,0x3f68bf3c,0x3f76ba07,0x3f718f57,0x3f6b4b0c,0x3f63f473
.long 0x3f74fa0b,0x3f6ed89e,0x3f676bd8,0x3f5ebe05,0x3f731447,0x3f6be858,0x3f633c5a,0x3f591e6a
.long 0x3f710908,0x3f68bf3c,0x3f5ebe05,0x3f531849,0x3f6ed89e,0x3f655e0b,0x3f59f26a,0x3f4cae79
.long 0x3f6c835e,0x3f61c598,0x3f54db31,0x3f45e403,0x3f6a09a7,0x3f5df6be,0x3f4f7a1f,0x3f3ebc1b
.long 0x3f676bd8,0x3f59f26a,0x3f49d112,0x3f373a23,0x3f64aa59,0x3f55b993,0x3f43e200,0x3f2f61a5
.long 0x3f61c598,0x3f514d3d,0x3f3daef9,0x3f273656,0x3f5ebe05,0x3f4cae79,0x3f373a23,0x3f1ebc12
.long 0x3f5b941a,0x3f47de65,0x3f3085bb,0x3f15f6d9,0x3f584853,0x3f42de29,0x3f299415,0x3f0cead0
.long 0x3f54db31,0x3f3daef9,0x3f226799,0x3f039c3d,0x3f514d3d,0x3f385216,0x3f1b02c6,0x3ef41f07
.long 0x3f4d9f02,0x3f32c8c9,0x3f13682a,0x3ee0924f,0x3f49d112,0x3f2d1469,0x3f0b9a6b,0x3ecc9b8b
.long 0x3f45e403,0x3f273656,0x3f039c3d,0x3eb8442a,0x3f41d870,0x3f212ff9,0x3ef6e0cb,0x3ea395c5
.long 0x3f3daef9,0x3f1b02c6,0x3ee63375,0x3e8e9a22,0x3f396842,0x3f14b039,0x3ed53641,0x3e72b651
.long 0x3f800000,0x3f800000,0x3f800000,0x3f800000,0x3f7fb10f,0x3f7f9c18,0x3f7f84ab,0x3f7f6ac7
.long 0x3f7ec46d,0x3f7e70b0,0x3f7e1324,0x3f7dabcc,0x3f7d3aac,0x3f7c7eb0,0x3f7baccd,0x3f7ac516
.long 0x3f7b14be,0x3f79c79d,0x3f7853f8,0x3f76ba07,0x3f7853f8,0x3f764d97,0x3f740bdd,0x3f718f57
.long 0x3f74fa0b,0x3f721352,0x3f6ed89e,0x3f6b4b0c,0x3f710908,0x3f6d1c1d,0x3f68bf3c,0x3f63f473
.long 0x3f6c835e,0x3f676bd8,0x3f61c598,0x3f5b941a,0x3f676bd8,0x3f6106f2,0x3f59f26a,0x3f5233c6
.long 0x3f61c598,0x3f59f26a,0x3f514d3d,0x3f47de65,0x3f5b941a,0x3f5233c6,0x3f47de65,0x3f3ca003
.long 0x3f54db31,0x3f49d112,0x3f3daef9,0x3f3085bb,0x3f4d9f02,0x3f40d0da,0x3f32c8c9,0x3f239da9
.long 0x3f45e403,0x3f373a23,0x3f273656,0x3f15f6d9,0x3f3daef9,0x3f2d1469,0x3f1b02c6,0x3f07a136
.long 0x3f3504f3,0x3f226799,0x3f0e39da,0x3ef15aea,0x3f2beb4a,0x3f173c07,0x3f00e7e4,0x3ed25a09
.long 0x3f226799,0x3f0b9a6b,0x3ee63375,0x3eb263ef,0x3f187fc0,0x3eff17b2,0x3ec9b953,0x3e919ddd
.long 0x3f0e39da,0x3ee63375,0x3eac7cd4,0x3e605c13,0x3f039c3d,0x3ecc9b8b,0x3e8e9a22,0x3e1c76de
.long 0x3ef15aea,0x3eb263ef,0x3e605c13,0x3dafb680,0x3edae880,0x3e97a117,0x3e22abb6,0x3c96c9b6
.long 0x3ec3ef15,0x3e78cfcc,0x3dc8bd36,0xbd48fb30,0x3eac7cd4,0x3e419b37,0x3d16c32c,0xbdee3876
.long 0x3e94a031,0x3e09cf86,0xbcc90ab0,0xbe3b6ecf,0x3e78cfcc,0x3da3308c,0xbdafb680,0xbe7ee6e1
.long 0x3e47c5c2,0x3cc90ab0,0xbe164083,0xbea09ae5,0x3e164083,0xbcfb49ba,0xbe541501,0xbec1071e
.long 0x3dc8bd36,0xbdafb680,0xbe888e93,0xbee0924f,0x3d48fb30,0xbe1008b7,0xbea68f12,0xbeff17b2
.long 0x3f800000,0x3f800000,0x3f800000,0x3f800000,0x3f7f4e6d,0x3f7f2f9d,0x3f7f0e58,0x3f7eea9d
.long 0x3f7d3aac,0x3f7cbfc9,0x3f7c3b28,0x3f7baccd,0x3f79c79d,0x3f78b47b,0x3f778bc5,0x3f764d97
.long 0x3f74fa0b,0x3f731447,0x3f710908,0x3f6ed89e,0x3f6ed89e,0x3f6be858,0x3f68bf3c,0x3f655e0b
.long 0x3f676bd8,0x3f633c5a,0x3f5ebe05,0x3f59f26a,0x3f5ebe05,0x3f591e6a,0x3f531849,0x3f4cae79
.long 0x3f54db31,0x3f4d9f02,0x3f45e403,0x3f3daef9,0x3f49d112,0x3f40d0da,0x3f373a23,0x3f2d1469
.long 0x3f3daef9,0x3f32c8c9,0x3f273656,0x3f1b02c6,0x3f3085bb,0x3f239da9,0x3f15f6d9,0x3f07a136
.long 0x3f226799,0x3f13682a,0x3f039c3d,0x3ee63375,0x3f13682a,0x3f0242b1,0x3ee0924f,0x3ebb31a0
.long 0x3f039c3d,0x3ee0924f,0x3eb8442a,0x3e8e9a22,0x3ee63375,0x3ebb31a0,0x3e8e9a22,0x3e419b37
.long 0x3ec3ef15,0x3e94a031,0x3e47c5c2,0x3dc8bd36,0x3ea09ae5,0x3e5a3997,0x3de1bc2e,0x3bc90f88
.long 0x3e78cfcc,0x3e09cf86,0x3cc90ab0,0xbdafb680,0x3e2f10a2,0x3d621469,0xbd7b2b74,0xbe354098
.long 0x3dc8bd36,0xbcc90ab0,0xbe164083,0xbe888e93,0x3cc90ab0,0xbdd53db9,0xbe6c9a7f,0xbeb554ec
.long 0xbd48fb30,0xbe3b6ecf,0xbea09ae5,0xbee0924f,0xbdfab273,0xbe8586ce,0xbec9b953,0xbf04f484
.long 0xbe47c5c2,0xbeac7cd4,0xbef15aea,0xbf187fc0,0xbe888e93,0xbed25a09,0xbf0b9a6b,0xbf2ac082
.long 0xbeac7cd4,0xbef6e0cb,0xbf1d7fd1,0xbf3b8f3b,0xbecf7bca,0xbf0cead0,0xbf2e3bde,0xbf4ac77f
.long 0xbef15aea,0xbf1d7fd1,0xbf3daef9,0xbf584853,0xbf08f59b,0xbf2d1469,0xbf4bbbf8,0xbf63f473
.long 0xbf187fc0,0xbf3b8f3b,0xbf584853,0xbf6db293,0xbf273656,0xbf48d8b3,0xbf633c5a,0xbf756d97
.long 0x3f800000,0x3f800000,0x3f800000,0x3f800000,0x3f7ec46d,0x3f7e9bc9,0x3f7e70b0,0x3f7e4323
.long 0x3f7b14be,0x3f7a7302,0x3f79c79d,0x3f791298,0x3f74fa0b,0x3f73913f,0x3f721352,0x3f708066
.long 0x3f6c835e,0x3f6a09a7,0x3f676bd8,0x3f64aa59,0x3f61c598,0x3f5df6be,0x3f59f26a,0x3f55b993
.long 0x3f54db31,0x3f4f7a1f,0x3f49d112,0x3f43e200,0x3f45e403,0x3f3ebc1b,0x3f373a23,0x3f2f61a5
.long 0x3f3504f3,0x3f2beb4a,0x3f226799,0x3f187fc0,0x3f226799,0x3f173c07,0x3f0b9a6b,0x3eff17b2
.long 0x3f0e39da,0x3f00e7e4,0x3ee63375,0x3ec9b953,0x3ef15aea,0x3ed25a09,0x3eb263ef,0x3e919ddd
.long 0x3ec3ef15,0x3ea09ae5,0x3e78cfcc,0x3e2f10a2,0x3e94a031,0x3e5a3997,0x3e09cf86,0x3d621469
.long 0x3e47c5c2,0x3de1bc2e,0x3cc90ab0,0xbd7b2b74,0x3dc8bd36,0x3bc90f88,0xbdafb680,0xbe354098
.long 0x248d3132,0xbdc8bd36,0xbe47c5c2,0xbe94a031,0xbdc8bd36,0xbe4dee60,0xbe9aa086,0xbecc9b8b
.long 0xbe47c5c2,0xbe9aa086,0xbecf7bca,0xbf00e7e4,0xbe94a031,0xbecc9b8b,0xbf00e7e4,0xbf19c200
.long 0xbec3ef15,0xbefc5d27,0xbf187fc0,0xbf3085bb,0xbef15aea,0xbf14b039,0xbf2e3bde,0xbf44e3f5
.long 0xbf0e39da,0xbf299415,0xbf41d870,0xbf5695e5,0xbf226799,0xbf3ca003,0xbf531849,0xbf655e0b
.long 0xbf3504f3,0xbf4d9f02,0xbf61c598,0xbf710908,0xbf45e403,0xbf5c61c7,0xbf6db293,0xbf796e4e
.long 0xbf54db31,0xbf68bf3c,0xbf76ba07,0xbf7e70b0,0xbf61c598,0xbf7294f8,0xbf7cbfc9,0xbf7ffec4
.long 0xbf6c835e,0xbf79c79d,0xbf7fb10f,0xbf7e1324,0xbf74fa0b,0xbf7e4323,0xbf7f84ab,0xbf78b47b
.long 0xbf7b14be,0xbf7ffb11,0xbf7c3b28,0xbf6ff573,0xbf7ec46d,0xbf7eea9d,0xbf75dec6,0xbf63f473
.long 0x3f800000,0x3f800000,0x3f800000,0x3f800000,0x3f7e1324,0x3f7de0b1,0x3f7dabcc,0x3f7d7474
.long 0x3f7853f8,0x3f778bc5,0x3f76ba07,0x3f75dec6,0x3f6ed89e,0x3f6d1c1d,0x3f6b4b0c,0x3f696591
.long 0x3f61c598,0x3f5ebe05,0x3f5b941a,0x3f584853,0x3f514d3d,0x3f4cae79,0x3f47de65,0x3f42de29
.long 0x3f3daef9,0x3f373a23,0x3f3085bb,0x3f299415,0x3f273656,0x3f1ebc12,0x3f15f6d9,0x3f0cead0
.long 0x3f0e39da,0x3f039c3d,0x3ef15aea,0x3edae880,0x3ee63375,0x3ecc9b8b,0x3eb263ef,0x3e97a117
.long 0x3eac7cd4,0x3e8e9a22,0x3e605c13,0x3e22abb6,0x3e605c13,0x3e1c76de,0x3dafb680,0x3c96c9b6
.long 0x3dc8bd36,0x3cc90ab0,0xbd48fb30,0xbdfab273,0xbcc90ab0,0xbdd53db9,0xbe3b6ecf,0xbe8586ce
.long 0xbe164083,0xbe6c9a7f,0xbea09ae5,0xbec9b953,0xbe888e93,0xbeb554ec,0xbee0924f,0xbf04f484
.long 0xbec3ef15,0xbef15aea,0xbf0e39da,0xbf226799,0xbefc5d27,0xbf14b039,0xbf299415,0xbf3ca003
.long 0xbf187fc0,0xbf2e3bde,0xbf41d870,0xbf531849,0xbf3085bb,0xbf44e3f5,0xbf5695e5,0xbf655e0b
.long 0xbf45e403,0xbf584853,0xbf676bd8,0xbf731447,0xbf584853,0xbf6816a8,0xbf740bdd,0xbf7bf531
.long 0xbf676bd8,0xbf740bdd,0xbf7c3b28,0xbf7fd397,0xbf731447,0xbf7bf531,0xbf7fd397,0xbf7e9bc9
.long 0xbf7b14be,0xbf7fb10f,0xbf7ec46d,0xbf7853f8,0xbf7f4e6d,0xbf7f2f9d,0xbf791298,0xbf6d1c1d
.long 0xbf7fb10f,0xbf7a7302,0xbf6ed89e,0xbf5d2d53,0xbf7c3b28,0xbf718f57,0xbf604621,0xbf48d8b3
.long 0xbf74fa0b,0xbf64aa59,0xbf4d9f02,0xbf3085bb,0xbf6a09a7,0xbf53fac3,0xbf373a23,0xbf14b039
.long 0xbf5b941a,0xbf3fc767,0xbf1d7fd1,0xbeebcbbb,0xbf49d112,0xbf286605,0xbf00e7e4,0xbea986c4
.long 0x3f800000,0x3f800000,0x3f800000,0x3f800000,0x3f7d3aac,0x3f7cfe73,0x3f7cbfc9,0x3f7c7eb0
.long 0x3f74fa0b,0x3f740bdd,0x3f731447,0x3f721352,0x3f676bd8,0x3f655e0b,0x3f633c5a,0x3f6106f2
.long 0x3f54db31,0x3f514d3d,0x3f4d9f02,0x3f49d112,0x3f3daef9,0x3f385216,0x3f32c8c9,0x3f2d1469
.long 0x3f226799,0x3f1b02c6,0x3f13682a,0x3f0b9a6b,0x3f039c3d,0x3ef41f07,0x3ee0924f,0x3ecc9b8b
.long 0x3ec3ef15,0x3eac7cd4,0x3e94a031,0x3e78cfcc,0x3e78cfcc,0x3e419b37,0x3e09cf86,0x3da3308c
.long 0x3dc8bd36,0x3d16c32c,0xbcc90ab0,0xbdafb680,0xbd48fb30,0xbdee3876,0xbe3b6ecf,0xbe7ee6e1
.long 0xbe47c5c2,0xbe888e93,0xbeac7cd4,0xbecf7bca,0xbeac7cd4,0xbed25a09,0xbef6e0cb,0xbf0cead0
.long 0xbef15aea,0xbf0b9a6b,0xbf1d7fd1,0xbf2e3bde,0xbf187fc0,0xbf2ac082,0xbf3b8f3b,0xbf4ac77f
.long 0xbf3504f3,0xbf45e403,0xbf54db31,0xbf61c598,0xbf4d9f02,0xbf5c61c7,0xbf68bf3c,0xbf7294f8
.long 0xbf61c598,0xbf6db293,0xbf76ba07,0xbf7cbfc9,0xbf710908,0xbf796e4e,0xbf7e70b0,0xbf7ffec4
.long 0xbf7b14be,0xbf7f4e6d,0xbf7fb10f,0xbf7c3b28,0xbf7fb10f,0xbf7f2f9d,0xbf7a7302,0xbf718f57
.long 0xbf7ec46d,0xbf791298,0xbf6ed89e,0xbf604621,0xbf7853f8,0xbf6d1c1d,0xbf5d2d53,0xbf48d8b3
.long 0xbf6c835e,0xbf5b941a,0xbf45e403,0xbf2beb4a,0xbf5b941a,0xbf44e3f5,0xbf299415,0xbf0a48ad
.long 0xbf45e403,0xbf299415,0xbf08f59b,0xbec9b953,0xbf2beb4a,0xbf0a48ad,0xbec9b953,0xbe72b651
.long 0xbf0e39da,0xbecf7bca,0xbe78cfcc,0xbd96a905,0xbedae880,0xbe8586ce,0xbdafb680,0x3dbc3ac3
.long 0xbe94a031,0xbde1bc2e,0x3d96a905,0x3e827dc0,0xbe164083,0x3d2fe007,0x3e6c9a7f,0x3ed25a09
.long 0x3f800000,0x3f800000,0x3f800000,0x3f800000,0x3f7c3b28,0x3f7bf531,0x3f7baccd,0x3f7b61fc
.long 0x3f710908,0x3f6ff573,0x3f6ed89e,0x3f6db293,0x3f5ebe05,0x3f5c61c7,0x3f59f26a,0x3f577026
.long 0x3f45e403,0x3f41d870,0x3f3daef9,0x3f396842,0x3f273656,0x3f212ff9,0x3f1b02c6,0x3f14b039
.long 0x3f039c3d,0x3ef6e0cb,0x3ee63375,0x3ed53641,0x3eb8442a,0x3ea395c5,0x3e8e9a22,0x3e72b651
.long 0x3e47c5c2,0x3e164083,0x3dc8bd36,0x3d48fb30,0x3cc90ab0,0xbcfb49ba,0xbdafb680,0xbe1008b7
.long 0xbe164083,0xbe541501,0xbe888e93,0xbea68f12,0xbea09ae5,0xbec1071e,0xbee0924f,0xbeff17b2
.long 0xbef15aea,0xbf08f59b,0xbf187fc0,0xbf273656,0xbf1d7fd1,0xbf2d1469,0xbf3b8f3b,0xbf48d8b3
.long 0xbf3daef9,0xbf4bbbf8,0xbf584853,0xbf633c5a,0xbf584853,0xbf63f473,0xbf6db293,0xbf756d97
.long 0xbf6c835e,0xbf74fa0b,0xbf7b14be,0xbf7ec46d,0xbf79c79d,0xbf7e4323,0xbf7ffb11,0xbf7eea9d
.long 0xbf7fb10f,0xbf7f84ab,0xbf7c3b28,0xbf75dec6,0xbf7e1324,0xbf78b47b,0xbf6ff573,0xbf63f473
.long 0xbf74fa0b,0xbf6a09a7,0xbf5b941a,0xbf49d112,0xbf64aa59,0xbf53fac3,0xbf3fc767,0xbf286605
.long 0xbf4d9f02,0xbf373a23,0xbf1d7fd1,0xbf00e7e4,0xbf3085bb,0xbf14b039,0xbeebcbbb,0xbea986c4
.long 0xbf0e39da,0xbedae880,0xbe94a031,0xbe164083,0xbecf7bca,0xbe8586ce,0xbde1bc2e,0x3d2fe007
.long 0xbe78cfcc,0xbdafb680,0x3d96a905,0x3e6c9a7f,0xbd96a905,0x3dbc3ac3,0x3e827dc0,0x3ed25a09
.long 0x3dc8bd36,0x3e888e93,0x3edae880,0x3f13682a,0x3e888e93,0x3eddbe79,0x3f15f6d9,0x3f385216
.long 0x3edae880,0x3f15f6d9,0x3f396842,0x3f5695e5,0x3f13682a,0x3f385216,0x3f5695e5,0x3f6d1c1d
.long 0x0,0x0,0x0,0x0,0x0,0x3bc90f88,0x3c490e90,0x3c96c9b6
.long 0x0,0x3c490e90,0x3cc90ab0,0x3d16c32c,0x0,0x3c96c9b6,0x3d16c32c,0x3d621469
.long 0x0,0x3cc90ab0,0x3d48fb30,0x3d96a905,0x0,0x3cfb49ba,0x3d7b2b74,0x3dbc3ac3
.long 0x0,0x3d16c32c,0x3d96a905,0x3de1bc2e,0x0,0x3d2fe007,0x3dafb680,0x3e039502
.long 0x0,0x3d48fb30,0x3dc8bd36,0x3e164083,0x0,0x3d621469,0x3de1bc2e,0x3e28defc
.long 0x0,0x3d7b2b74,0x3dfab273,0x3e3b6ecf,0x0,0x3d8a200a,0x3e09cf86,0x3e4dee60
.long 0x0,0x3d96a905,0x3e164083,0x3e605c13,0x0,0x3da3308c,0x3e22abb6,0x3e72b651
.long 0x0,0x3dafb680,0x3e2f10a2,0x3e827dc0,0x0,0x3dbc3ac3,0x3e3b6ecf,0x3e8b9507
.long 0x0,0x3dc8bd36,0x3e47c5c2,0x3e94a031,0x0,0x3dd53db9,0x3e541501,0x3e9d9e78
.long 0x0,0x3de1bc2e,0x3e605c13,0x3ea68f12,0x0,0x3dee3876,0x3e6c9a7f,0x3eaf713a
.long 0x0,0x3dfab273,0x3e78cfcc,0x3eb8442a,0x0,0x3e039502,0x3e827dc0,0x3ec1071e
.long 0x0,0x3e09cf86,0x3e888e93,0x3ec9b953,0x0,0x3e1008b7,0x3e8e9a22,0x3ed25a09
.long 0x0,0x3e164083,0x3e94a031,0x3edae880,0x0,0x3e1c76de,0x3e9aa086,0x3ee363fa
.long 0x0,0x3e22abb6,0x3ea09ae5,0x3eebcbbb,0x0,0x3e28defc,0x3ea68f12,0x3ef41f07
.long 0x0,0x3e2f10a2,0x3eac7cd4,0x3efc5d27,0x0,0x3e354098,0x3eb263ef,0x3f0242b1
.long 0x0,0x3e3b6ecf,0x3eb8442a,0x3f064b82,0x0,0x3e419b37,0x3ebe1d4a,0x3f0a48ad
.long 0x0,0x0,0x0,0x0,0x3cc90ab0,0x3cfb49ba,0x3d16c32c,0x3d2fe007
.long 0x3d48fb30,0x3d7b2b74,0x3d96a905,0x3dafb680,0x3d96a905,0x3dbc3ac3,0x3de1bc2e,0x3e039502
.long 0x3dc8bd36,0x3dfab273,0x3e164083,0x3e2f10a2,0x3dfab273,0x3e1c76de,0x3e3b6ecf,0x3e5a3997
.long 0x3e164083,0x3e3b6ecf,0x3e605c13,0x3e827dc0,0x3e2f10a2,0x3e5a3997,0x3e827dc0,0x3e97a117
.long 0x3e47c5c2,0x3e78cfcc,0x3e94a031,0x3eac7cd4,0x3e605c13,0x3e8b9507,0x3ea68f12,0x3ec1071e
.long 0x3e78cfcc,0x3e9aa086,0x3eb8442a,0x3ed53641,0x3e888e93,0x3ea986c4,0x3ec9b953,0x3ee900b7
.long 0x3e94a031,0x3eb8442a,0x3edae880,0x3efc5d27,0x3ea09ae5,0x3ec6d529,0x3eebcbbb,0x3f07a136
.long 0x3eac7cd4,0x3ed53641,0x3efc5d27,0x3f10d3cd,0x3eb8442a,0x3ee363fa,0x3f064b82,0x3f19c200
.long 0x3ec3ef15,0x3ef15aea,0x3f0e39da,0x3f226799,0x3ecf7bca,0x3eff17b2,0x3f15f6d9,0x3f2ac082
.long 0x3edae880,0x3f064b82,0x3f1d7fd1,0x3f32c8c9,0x3ee63375,0x3f0cead0,0x3f24d225,0x3f3a7ca4
.long 0x3ef15aea,0x3f13682a,0x3f2beb4a,0x3f41d870,0x3efc5d27,0x3f19c200,0x3f32c8c9,0x3f48d8b3
.long 0x3f039c3d,0x3f1ff6cb,0x3f396842,0x3f4f7a1f,0x3f08f59b,0x3f26050a,0x3f3fc767,0x3f55b993
.long 0x3f0e39da,0x3f2beb4a,0x3f45e403,0x3f5b941a,0x3f13682a,0x3f31a81d,0x3f4bbbf8,0x3f6106f2
.long 0x3f187fc0,0x3f373a23,0x3f514d3d,0x3f660f88,0x3f1d7fd1,0x3f3ca003,0x3f5695e5,0x3f6aab7b
.long 0x3f226799,0x3f41d870,0x3f5b941a,0x3f6ed89e,0x3f273656,0x3f46e22a,0x3f604621,0x3f7294f8
.long 0x3f2beb4a,0x3f4bbbf8,0x3f64aa59,0x3f75dec6,0x3f3085bb,0x3f5064af,0x3f68bf3c,0x3f78b47b
.long 0x0,0x0,0x0,0x0,0x3d48fb30,0x3d621469,0x3d7b2b74,0x3d8a200a
.long 0x3dc8bd36,0x3de1bc2e,0x3dfab273,0x3e09cf86,0x3e164083,0x3e28defc,0x3e3b6ecf,0x3e4dee60
.long 0x3e47c5c2,0x3e605c13,0x3e78cfcc,0x3e888e93,0x3e78cfcc,0x3e8b9507,0x3e9aa086,0x3ea986c4
.long 0x3e94a031,0x3ea68f12,0x3eb8442a,0x3ec9b953,0x3eac7cd4,0x3ec1071e,0x3ed53641,0x3ee900b7
.long 0x3ec3ef15,0x3edae880,0x3ef15aea,0x3f039c3d,0x3edae880,0x3ef41f07,0x3f064b82,0x3f121eb0
.long 0x3ef15aea,0x3f064b82,0x3f13682a,0x3f1ff6cb,0x3f039c3d,0x3f121eb0,0x3f1ff6cb,0x3f2d1469
.long 0x3f0e39da,0x3f1d7fd1,0x3f2beb4a,0x3f396842,0x3f187fc0,0x3f286605,0x3f373a23,0x3f44e3f5
.long 0x3f226799,0x3f32c8c9,0x3f41d870,0x3f4f7a1f,0x3f2beb4a,0x3f3ca003,0x3f4bbbf8,0x3f591e6a
.long 0x3f3504f3,0x3f45e403,0x3f54db31,0x3f61c598,0x3f3daef9,0x3f4e8d90,0x3f5d2d53,0x3f696591
.long 0x3f45e403,0x3f5695e5,0x3f64aa59,0x3f6ff573,0x3f4d9f02,0x3f5df6be,0x3f6b4b0c,0x3f756d97
.long 0x3f54db31,0x3f64aa59,0x3f710908,0x3f79c79d,0x3f5b941a,0x3f6aab7b,0x3f75dec6,0x3f7cfe73
.long 0x3f61c598,0x3f6ff573,0x3f79c79d,0x3f7f0e58,0x3f676bd8,0x3f748422,0x3f7cbfc9,0x3f7ff4e6
.long 0x3f6c835e,0x3f7853f8,0x3f7ec46d,0x3f7fb10f,0x3f710908,0x3f7b61fc,0x3f7fd397,0x3f7e4323
.long 0x3f74fa0b,0x3f7dabcc,0x3f7fec43,0x3f7baccd,0x3f7853f8,0x3f7f2f9d,0x3f7f0e58,0x3f77f110
.long 0x3f7b14be,0x3f7fec43,0x3f7d3aac,0x3f731447,0x3f7d3aac,0x3f7fe129,0x3f7a7302,0x3f6d1c1d
.long 0x3f7ec46d,0x3f7f0e58,0x3f76ba07,0x3f660f88,0x3f7fb10f,0x3f7d7474,0x3f721352,0x3f5df6be
.long 0x0,0x0,0x0,0x0,0x3d96a905,0x3da3308c,0x3dafb680,0x3dbc3ac3
.long 0x3e164083,0x3e22abb6,0x3e2f10a2,0x3e3b6ecf,0x3e605c13,0x3e72b651,0x3e827dc0,0x3e8b9507
.long 0x3e94a031,0x3ea09ae5,0x3eac7cd4,0x3eb8442a,0x3eb8442a,0x3ec6d529,0x3ed53641,0x3ee363fa
.long 0x3edae880,0x3eebcbbb,0x3efc5d27,0x3f064b82,0x3efc5d27,0x3f07a136,0x3f10d3cd,0x3f19c200
.long 0x3f0e39da,0x3f187fc0,0x3f226799,0x3f2beb4a,0x3f1d7fd1,0x3f286605,0x3f32c8c9,0x3f3ca003
.long 0x3f2beb4a,0x3f373a23,0x3f41d870,0x3f4bbbf8,0x3f396842,0x3f44e3f5,0x3f4f7a1f,0x3f591e6a
.long 0x3f45e403,0x3f514d3d,0x3f5b941a,0x3f64aa59,0x3f514d3d,0x3f5c61c7,0x3f660f88,0x3f6e46be
.long 0x3f5b941a,0x3f660f88,0x3f6ed89e,0x3f75dec6,0x3f64aa59,0x3f6e46be,0x3f75dec6,0x3f7b61fc
.long 0x3f6c835e,0x3f74fa0b,0x3f7b14be,0x3f7ec46d,0x3f731447,0x3f7a1e84,0x3f7e70b0,0x3f7ffec4
.long 0x3f7853f8,0x3f7dabcc,0x3f7fec43,0x3f7f0e58,0x3f7c3b28,0x3f7f9c18,0x3f7f84ab,0x3f7bf531
.long 0x3f7ec46d,0x3f7fec43,0x3f7d3aac,0x3f76ba07,0x3f7fec43,0x3f7e9bc9,0x3f791298,0x3f6f6830
.long 0x3f7fb10f,0x3f7baccd,0x3f731447,0x3f660f88,0x3f7e1324,0x3f772417,0x3f6b4b0c,0x3f5ac450
.long 0x3f7b14be,0x3f710908,0x3f61c598,0x3f4d9f02,0x3f76ba07,0x3f696591,0x3f5695e5,0x3f3ebc1b
.long 0x3f710908,0x3f604621,0x3f49d112,0x3f2e3bde,0x3f6a09a7,0x3f55b993,0x3f3b8f3b,0x3f1c420c
.long 0x3f61c598,0x3f49d112,0x3f2beb4a,0x3f08f59b,0x3f584853,0x3f3ca003,0x3f1b02c6,0x3ee900b7
.long 0x3f4d9f02,0x3f2e3bde,0x3f08f59b,0x3ebe1d4a,0x3f41d870,0x3f1ebc12,0x3eebcbbb,0x3e919ddd
.long 0x0,0x0,0x0,0x0,0x3dc8bd36,0x3dd53db9,0x3de1bc2e,0x3dee3876
.long 0x3e47c5c2,0x3e541501,0x3e605c13,0x3e6c9a7f,0x3e94a031,0x3e9d9e78,0x3ea68f12,0x3eaf713a
.long 0x3ec3ef15,0x3ecf7bca,0x3edae880,0x3ee63375,0x3ef15aea,0x3eff17b2,0x3f064b82,0x3f0cead0
.long 0x3f0e39da,0x3f15f6d9,0x3f1d7fd1,0x3f24d225,0x3f226799,0x3f2ac082,0x3f32c8c9,0x3f3a7ca4
.long 0x3f3504f3,0x3f3daef9,0x3f45e403,0x3f4d9f02,0x3f45e403,0x3f4e8d90,0x3f5695e5,0x3f5df6be
.long 0x3f54db31,0x3f5d2d53,0x3f64aa59,0x3f6b4b0c,0x3f61c598,0x3f696591,0x3f6ff573,0x3f756d97
.long 0x3f6c835e,0x3f731447,0x3f7853f8,0x3f7c3b28,0x3f74fa0b,0x3f7a1e84,0x3f7dabcc,0x3f7f9c18
.long 0x3f7b14be,0x3f7e70b0,0x3f7fec43,0x3f7f84ab,0x3f7ec46d,0x3f7ffec4,0x3f7f0e58,0x3f7bf531
.long 0x3f800000,0x3f7ec46d,0x3f7b14be,0x3f74fa0b,0x3f7ec46d,0x3f7ac516,0x3f740bdd,0x3f6aab7b
.long 0x3f7b14be,0x3f740bdd,0x3f6a09a7,0x3f5d2d53,0x3f74fa0b,0x3f6aab7b,0x3f5d2d53,0x3f4cae79
.long 0x3f6c835e,0x3f5ebe05,0x3f4d9f02,0x3f396842,0x3f61c598,0x3f5064af,0x3f3b8f3b,0x3f239da9
.long 0x3f54db31,0x3f3fc767,0x3f273656,0x3f0b9a6b,0x3f45e403,0x3f2d1469,0x3f10d3cd,0x3ee363fa
.long 0x3f3504f3,0x3f187fc0,0x3ef15aea,0x3eac7cd4,0x3f226799,0x3f0242b1,0x3ebe1d4a,0x3e667c66
.long 0x3f0e39da,0x3ed53641,0x3e888e93,0x3de1bc2e,0x3ef15aea,0x3ea395c5,0x3e22abb6,0xbbc90f88
.long 0x3ec3ef15,0x3e605c13,0x3d48fb30,0xbdfab273,0x3e94a031,0x3dee3876,0xbd7b2b74,0xbe72b651
.long 0x3e47c5c2,0x3c490e90,0xbe2f10a2,0xbeb263ef,0x3dc8bd36,0xbdbc3ac3,0xbe8e9a22,0xbee900b7
.long 0x0,0x0,0x0,0x0,0x3dfab273,0x3e039502,0x3e09cf86,0x3e1008b7
.long 0x3e78cfcc,0x3e827dc0,0x3e888e93,0x3e8e9a22,0x3eb8442a,0x3ec1071e,0x3ec9b953,0x3ed25a09
.long 0x3ef15aea,0x3efc5d27,0x3f039c3d,0x3f08f59b,0x3f13682a,0x3f19c200,0x3f1ff6cb,0x3f26050a
.long 0x3f2beb4a,0x3f32c8c9,0x3f396842,0x3f3fc767,0x3f41d870,0x3f48d8b3,0x3f4f7a1f,0x3f55b993
.long 0x3f54db31,0x3f5b941a,0x3f61c598,0x3f676bd8,0x3f64aa59,0x3f6aab7b,0x3f6ff573,0x3f748422
.long 0x3f710908,0x3f75dec6,0x3f79c79d,0x3f7cbfc9,0x3f79c79d,0x3f7cfe73,0x3f7f0e58,0x3f7ff4e6
.long 0x3f7ec46d,0x3f7fec43,0x3f7fb10f,0x3f7e1324,0x3f7fec43,0x3f7e9bc9,0x3f7baccd,0x3f772417
.long 0x3f7d3aac,0x3f791298,0x3f731447,0x3f6b4b0c,0x3f76ba07,0x3f6f6830,0x3f660f88,0x3f5ac450
.long 0x3f6c835e,0x3f61c598,0x3f54db31,0x3f45e403,0x3f5ebe05,0x3f5064af,0x3f3fc767,0x3f2d1469
.long 0x3f4d9f02,0x3f3b8f3b,0x3f273656,0x3f10d3cd,0x3f396842,0x3f239da9,0x3f0b9a6b,0x3ee363fa
.long 0x3f226799,0x3f08f59b,0x3edae880,0x3ea09ae5,0x3f08f59b,0x3ed8106b,0x3e9aa086,0x3e354098
.long 0x3edae880,0x3e9aa086,0x3e2f10a2,0x3d16c32c,0x3ea09ae5,0x3e354098,0x3d16c32c,0xbdd53db9
.long 0x3e47c5c2,0x3d48fb30,0xbdc8bd36,0xbe78cfcc,0x3d96a905,0xbda3308c,0xbe6c9a7f,0xbec1071e
.long 0xbd48fb30,0xbe541501,0xbeb8442a,0xbf00e7e4,0xbe2f10a2,0xbea986c4,0xbef6e0cb,0xbf1ebc12
.long 0xbe94a031,0xbee63375,0xbf187fc0,0xbf396842,0xbecf7bca,0xbf0f8784,0xbf32c8c9,0xbf5064af
.long 0xbf039c3d,0xbf299415,0xbf49d112,0xbf633c5a,0xbf1d7fd1,0xbf40d0da,0xbf5d2d53,0xbf718f57
.long 0x0,0x0,0x0,0x0,0x3e164083,0x3e1c76de,0x3e22abb6,0x3e28defc
.long 0x3e94a031,0x3e9aa086,0x3ea09ae5,0x3ea68f12,0x3edae880,0x3ee363fa,0x3eebcbbb,0x3ef41f07
.long 0x3f0e39da,0x3f13682a,0x3f187fc0,0x3f1d7fd1,0x3f2beb4a,0x3f31a81d,0x3f373a23,0x3f3ca003
.long 0x3f45e403,0x3f4bbbf8,0x3f514d3d,0x3f5695e5,0x3f5b941a,0x3f6106f2,0x3f660f88,0x3f6aab7b
.long 0x3f6c835e,0x3f710908,0x3f74fa0b,0x3f7853f8,0x3f7853f8,0x3f7b61fc,0x3f7dabcc,0x3f7f2f9d
.long 0x3f7ec46d,0x3f7fd397,0x3f7fec43,0x3f7f0e58,0x3f7fb10f,0x3f7e4323,0x3f7baccd,0x3f77f110
.long 0x3f7b14be,0x3f76ba07,0x3f710908,0x3f6a09a7,0x3f710908,0x3f696591,0x3f604621,0x3f55b993
.long 0x3f61c598,0x3f5695e5,0x3f49d112,0x3f3b8f3b,0x3f4d9f02,0x3f3ebc1b,0x3f2e3bde,0x3f1c420c
.long 0x3f3504f3,0x3f226799,0x3f0e39da,0x3ef15aea,0x3f187fc0,0x3f0242b1,0x3ed53641,0x3ea395c5
.long 0x3ef15aea,0x3ebe1d4a,0x3e888e93,0x3e22abb6,0x3eac7cd4,0x3e667c66,0x3de1bc2e,0xbbc90f88
.long 0x3e47c5c2,0x3d96a905,0xbd48fb30,0xbe2f10a2,0x3d48fb30,0xbda3308c,0xbe541501,0xbea986c4
.long 0xbdc8bd36,0xbe6c9a7f,0xbeb8442a,0xbef6e0cb,0xbe78cfcc,0xbec1071e,0xbf00e7e4,0xbf1ebc12
.long 0xbec3ef15,0xbf039c3d,0xbf226799,0xbf3daef9,0xbf039c3d,0xbf239da9,0xbf3fc767,0xbf577026
.long 0xbf226799,0xbf3fc767,0xbf584853,0xbf6b4b0c,0xbf3daef9,0xbf577026,0xbf6b4b0c,0xbf78b47b
.long 0xbf54db31,0xbf6a09a7,0xbf7853f8,0xbf7f4e6d,0xbf676bd8,0xbf772417,0xbf7f0e58,0xbf7eea9d
.long 0xbf74fa0b,0xbf7e70b0,0xbf7f4e6d,0xbf778bc5,0xbf7d3aac,0xbf7fc38f,0xbf791298,0xbf696591
.long 0x0,0x0,0x0,0x0,0x3e2f10a2,0x3e354098,0x3e3b6ecf,0x3e419b37
.long 0x3eac7cd4,0x3eb263ef,0x3eb8442a,0x3ebe1d4a,0x3efc5d27,0x3f0242b1,0x3f064b82,0x3f0a48ad
.long 0x3f226799,0x3f273656,0x3f2beb4a,0x3f3085bb,0x3f41d870,0x3f46e22a,0x3f4bbbf8,0x3f5064af
.long 0x3f5b941a,0x3f604621,0x3f64aa59,0x3f68bf3c,0x3f6ed89e,0x3f7294f8,0x3f75dec6,0x3f78b47b
.long 0x3f7b14be,0x3f7d3aac,0x3f7ec46d,0x3f7fb10f,0x3f7fec43,0x3f7fe129,0x3f7f0e58,0x3f7d7474
.long 0x3f7d3aac,0x3f7a7302,0x3f76ba07,0x3f721352,0x3f731447,0x3f6d1c1d,0x3f660f88,0x3f5df6be
.long 0x3f61c598,0x3f584853,0x3f4d9f02,0x3f41d870,0x3f49d112,0x3f3ca003,0x3f2e3bde,0x3f1ebc12
.long 0x3f2beb4a,0x3f1b02c6,0x3f08f59b,0x3eebcbbb,0x3f08f59b,0x3ee900b7,0x3ebe1d4a,0x3e919ddd
.long 0x3ec3ef15,0x3e94a031,0x3e47c5c2,0x3dc8bd36,0x3e605c13,0x3dee3876,0x3c490e90,0xbdbc3ac3
.long 0x3d48fb30,0xbd7b2b74,0xbe2f10a2,0xbe8e9a22,0xbdfab273,0xbe72b651,0xbeb263ef,0xbee900b7
.long 0xbe94a031,0xbecf7bca,0xbf039c3d,0xbf1d7fd1,0xbee63375,0xbf0f8784,0xbf299415,0xbf40d0da
.long 0xbf187fc0,0xbf32c8c9,0xbf49d112,0xbf5d2d53,0xbf396842,0xbf5064af,0xbf633c5a,0xbf718f57
.long 0xbf54db31,0xbf676bd8,0xbf74fa0b,0xbf7d3aac,0xbf6a09a7,0xbf772417,0xbf7e70b0,0xbf7fc38f
.long 0xbf7853f8,0xbf7f0e58,0xbf7f4e6d,0xbf791298,0xbf7f4e6d,0xbf7eea9d,0xbf778bc5,0xbf696591
.long 0xbf7ec46d,0xbf76ba07,0xbf676bd8,0xbf514d3d,0xbf76ba07,0xbf66becc,0xbf4f7a1f,0xbf31a81d
.long 0xbf676bd8,0xbf4f7a1f,0xbf3085bb,0xbf0b9a6b,0xbf514d3d,0xbf31a81d,0xbf0b9a6b,0xbec1071e
.long 0x80003f80,0x80003f80,0x80003f80,0x80003f80,0x80003f80,0xbe483f7b,0xbec43f6d,0xbf0e3f55
.long 0x80003f80,0xbec43f6d,0xbf353f35,0xbf6d3ec4,0x80003f80,0xbf0e3f55,0xbf6d3ec4,0xbf7bbe48
.long 0x80003f80,0xbf353f35,0xbf80248d,0xbf35bf35,0x80003f80,0xbf553f0e,0xbf6dbec4,0xbe48bf7b
.long 0x80003f80,0xbf6d3ec4,0xbf35bf35,0x3ec4bf6d,0x80003f80,0xbf7b3e48,0xbec4bf6d,0x3f55bf0e
.long 0x80003f80,0xbf80248d,0xa50dbf80,0x3f80a554,0x80003f80,0xbf7bbe48,0x3ec4bf6d,0x3f553f0e
.long 0x80003f80,0xbf6dbec4,0x3f35bf35,0x3ec43f6d,0x80003f80,0xbf55bf0e,0x3f6dbec4,0xbe483f7b
.long 0x80003f80,0xbf35bf35,0x3f80a554,0xbf353f35,0x80003f80,0xbf0ebf55,0x3f6d3ec4,0xbf7b3e48
.long 0x80003f80,0xbec4bf6d,0x3f353f35,0xbf6dbec4,0x80003f80,0xbe48bf7b,0x3ec43f6d,0xbf0ebf55
.long 0x80003f80,0xa50dbf80,0x80003f80,0xa50dbf80,0x80003f80,0x3e48bf7b,0xbec43f6d,0x3f0ebf55
.long 0x80003f80,0x3ec4bf6d,0xbf353f35,0x3f6dbec4,0x80003f80,0x3f0ebf55,0xbf6d3ec4,0x3f7b3e48
.long 0x80003f80,0x3f35bf35,0xbf80248d,0x3f353f35,0x80003f80,0x3f55bf0e,0xbf6dbec4,0x3e483f7b
.long 0x80003f80,0x3f6dbec4,0xbf35bf35,0xbec43f6d,0x80003f80,0x3f7bbe48,0xbec4bf6d,0xbf553f0e
.long 0x80003f80,0x3f80a554,0xa50dbf80,0xbf80248d,0x80003f80,0x3f7b3e48,0x3ec4bf6d,0xbf55bf0e
.long 0x80003f80,0x3f6d3ec4,0x3f35bf35,0xbec4bf6d,0x80003f80,0x3f553f0e,0x3f6dbec4,0x3e48bf7b
.long 0x80003f80,0x3f353f35,0x3f80a554,0x3f35bf35,0x80003f80,0x3f0e3f55,0x3f6d3ec4,0x3f7bbe48
.long 0x80003f80,0x3ec43f6d,0x3f353f35,0x3f6d3ec4,0x80003f80,0x3e483f7b,0x3ec43f6d,0x3f0e3f55
.long 0x80003f80,0x80003f80,0x80003f80,0x80003f80,0xbf353f35,0xbf553f0e,0xbf6d3ec4,0xbf7b3e48
.long 0xbf80248d,0xbf6dbec4,0xbf35bf35,0xbec4bf6d,0xbf35bf35,0xbe48bf7b,0x3ec4bf6d,0x3f55bf0e
.long 0xa50dbf80,0x3f35bf35,0x3f80a554,0x3f353f35,0x3f35bf35,0x3f7b3e48,0x3ec43f6d,0xbf0e3f55
.long 0x3f80a554,0x3ec43f6d,0xbf353f35,0xbf6dbec4,0x3f353f35,0xbf0e3f55,0xbf6dbec4,0x3e48bf7b
.long 0x80003f80,0xbf80248d,0xa50dbf80,0x3f80a554,0xbf353f35,0xbf0ebf55,0x3f6dbec4,0x3e483f7b
.long 0xbf80248d,0x3ec4bf6d,0x3f353f35,0xbf6d3ec4,0xbf35bf35,0x3f7bbe48,0xbec43f6d,0xbf0ebf55
.long 0xa50dbf80,0x3f353f35,0xbf80248d,0x3f35bf35,0x3f35bf35,0xbe483f7b,0xbec4bf6d,0x3f553f0e
.long 0x3f80a554,0xbf6d3ec4,0x3f35bf35,0xbec43f6d,0x3f353f35,0xbf55bf0e,0x3f6d3ec4,0xbf7bbe48
.long 0x80003f80,0xa50dbf80,0x80003f80,0xa50dbf80,0xbf353f35,0x3f55bf0e,0xbf6d3ec4,0x3f7bbe48
.long 0xbf80248d,0x3f6d3ec4,0xbf35bf35,0x3ec43f6d,0xbf35bf35,0x3e483f7b,0x3ec4bf6d,0xbf553f0e
.long 0xa50dbf80,0xbf353f35,0x3f80a554,0xbf35bf35,0x3f35bf35,0xbf7bbe48,0x3ec43f6d,0x3f0ebf55
.long 0x3f80a554,0xbec4bf6d,0xbf353f35,0x3f6d3ec4,0x3f353f35,0x3f0ebf55,0xbf6dbec4,0xbe483f7b
.long 0x80003f80,0x3f80a554,0xa50dbf80,0xbf80248d,0xbf353f35,0x3f0e3f55,0x3f6dbec4,0xbe48bf7b
.long 0xbf80248d,0xbec43f6d,0x3f353f35,0x3f6dbec4,0xbf35bf35,0xbf7b3e48,0xbec43f6d,0x3f0e3f55
.long 0xa50dbf80,0xbf35bf35,0xbf80248d,0xbf353f35,0x3f35bf35,0x3e48bf7b,0xbec4bf6d,0xbf55bf0e
.long 0x3f80a554,0x3f6dbec4,0x3f35bf35,0x3ec4bf6d,0x3f353f35,0x3f553f0e,0x3f6d3ec4,0x3f7b3e48
.long 0x80003f80,0x80003f80,0x80003f80,0x80003f80,0xbf80248d,0xbf7bbe48,0xbf6dbec4,0xbf55bf0e
.long 0xa50dbf80,0x3ec4bf6d,0x3f35bf35,0x3f6dbec4,0x3f80a554,0x3f553f0e,0x3ec43f6d,0xbe483f7b
.long 0x80003f80,0xbf353f35,0xbf80248d,0xbf35bf35,0xbf80248d,0xbf0ebf55,0x3ec4bf6d,0x3f7bbe48
.long 0xa50dbf80,0x3f6dbec4,0x3f353f35,0xbec43f6d,0x3f80a554,0x3e483f7b,0xbf6d3ec4,0xbf0ebf55
.long 0x80003f80,0xbf80248d,0xa50dbf80,0x3f80a554,0xbf80248d,0x3e48bf7b,0x3f6d3ec4,0xbf0e3f55
.long 0xa50dbf80,0x3f6d3ec4,0xbf353f35,0xbec4bf6d,0x3f80a554,0xbf0e3f55,0xbec4bf6d,0x3f7b3e48
.long 0x80003f80,0xbf35bf35,0x3f80a554,0xbf353f35,0xbf80248d,0x3f55bf0e,0xbec43f6d,0xbe48bf7b
.long 0xa50dbf80,0x3ec43f6d,0xbf35bf35,0x3f6d3ec4,0x3f80a554,0xbf7b3e48,0x3f6dbec4,0xbf553f0e
.long 0x80003f80,0xa50dbf80,0x80003f80,0xa50dbf80,0xbf80248d,0x3f7b3e48,0xbf6dbec4,0x3f553f0e
.long 0xa50dbf80,0xbec43f6d,0x3f35bf35,0xbf6d3ec4,0x3f80a554,0xbf55bf0e,0x3ec43f6d,0x3e48bf7b
.long 0x80003f80,0x3f35bf35,0xbf80248d,0x3f353f35,0xbf80248d,0x3f0e3f55,0x3ec4bf6d,0xbf7b3e48
.long 0xa50dbf80,0xbf6d3ec4,0x3f353f35,0x3ec4bf6d,0x3f80a554,0xbe48bf7b,0xbf6d3ec4,0x3f0e3f55
.long 0x80003f80,0x3f80a554,0xa50dbf80,0xbf80248d,0xbf80248d,0xbe483f7b,0x3f6d3ec4,0x3f0ebf55
.long 0xa50dbf80,0xbf6dbec4,0xbf353f35,0x3ec43f6d,0x3f80a554,0x3f0ebf55,0xbec4bf6d,0xbf7bbe48
.long 0x80003f80,0x3f353f35,0x3f80a554,0x3f35bf35,0xbf80248d,0xbf553f0e,0xbec43f6d,0x3e483f7b
.long 0xa50dbf80,0xbec4bf6d,0xbf35bf35,0xbf6dbec4,0x3f80a554,0x3f7bbe48,0x3f6dbec4,0x3f55bf0e
.long 0x80003f80,0x80003f80,0x80003f80,0x80003f80,0xbf35bf35,0xbf0ebf55,0xbec4bf6d,0xbe48bf7b
.long 0x3f80a554,0x3f6d3ec4,0x3f353f35,0x3ec43f6d,0xbf353f35,0xbf7b3e48,0xbf6dbec4,0xbf0ebf55
.long 0xa50dbf80,0x3f35bf35,0x3f80a554,0x3f353f35,0x3f353f35,0xbe483f7b,0xbf6d3ec4,0xbf55bf0e
.long 0xbf80248d,0xbec4bf6d,0x3f35bf35,0x3f6d3ec4,0x3f35bf35,0x3f553f0e,0xbec43f6d,0xbf7bbe48
.long 0x80003f80,0xbf80248d,0xa50dbf80,0x3f80a554,0xbf35bf35,0x3f55bf0e,0x3ec43f6d,0xbf7b3e48
.long 0x3f80a554,0xbec43f6d,0xbf35bf35,0x3f6dbec4,0xbf353f35,0xbe48bf7b,0x3f6d3ec4,0xbf553f0e
.long 0xa50dbf80,0x3f353f35,0xbf80248d,0x3f35bf35,0x3f353f35,0xbf7bbe48,0x3f6dbec4,0xbf0e3f55
.long 0xbf80248d,0x3f6dbec4,0xbf353f35,0x3ec4bf6d,0x3f35bf35,0xbf0e3f55,0x3ec4bf6d,0xbe483f7b
.long 0x80003f80,0xa50dbf80,0x80003f80,0xa50dbf80,0xbf35bf35,0x3f0e3f55,0xbec4bf6d,0x3e483f7b
.long 0x3f80a554,0xbf6dbec4,0x3f353f35,0xbec4bf6d,0xbf353f35,0x3f7bbe48,0xbf6dbec4,0x3f0e3f55
.long 0xa50dbf80,0xbf353f35,0x3f80a554,0xbf35bf35,0x3f353f35,0x3e48bf7b,0xbf6d3ec4,0x3f553f0e
.long 0xbf80248d,0x3ec43f6d,0x3f35bf35,0xbf6dbec4,0x3f35bf35,0xbf55bf0e,0xbec43f6d,0x3f7b3e48
.long 0x80003f80,0x3f80a554,0xa50dbf80,0xbf80248d,0xbf35bf35,0xbf553f0e,0x3ec43f6d,0x3f7bbe48
.long 0x3f80a554,0x3ec4bf6d,0xbf35bf35,0xbf6d3ec4,0xbf353f35,0x3e483f7b,0x3f6d3ec4,0x3f55bf0e
.long 0xa50dbf80,0xbf35bf35,0xbf80248d,0xbf353f35,0x3f353f35,0x3f7b3e48,0x3f6dbec4,0x3f0ebf55
.long 0xbf80248d,0xbf6d3ec4,0xbf353f35,0xbec43f6d,0x3f35bf35,0x3f0ebf55,0x3ec4bf6d,0x3e48bf7b
.long 0x80003f80,0x80003f80,0x80003f80,0x80003f80,0xa50dbf80,0x3e48bf7b,0x3ec4bf6d,0x3f0ebf55
.long 0x80003f80,0xbec43f6d,0xbf353f35,0xbf6d3ec4,0xa50dbf80,0x3f0ebf55,0x3f6dbec4,0x3f7b3e48
.long 0x80003f80,0xbf353f35,0xbf80248d,0xbf35bf35,0xa50dbf80,0x3f55bf0e,0x3f6d3ec4,0x3e483f7b
.long 0x80003f80,0xbf6d3ec4,0xbf35bf35,0x3ec4bf6d,0xa50dbf80,0x3f7bbe48,0x3ec43f6d,0xbf553f0e
.long 0x80003f80,0xbf80248d,0xa50dbf80,0x3f80a554,0xa50dbf80,0x3f7b3e48,0xbec43f6d,0xbf55bf0e
.long 0x80003f80,0xbf6dbec4,0x3f35bf35,0x3ec43f6d,0xa50dbf80,0x3f553f0e,0xbf6d3ec4,0x3e48bf7b
.long 0x80003f80,0xbf35bf35,0x3f80a554,0xbf353f35,0xa50dbf80,0x3f0e3f55,0xbf6dbec4,0x3f7bbe48
.long 0x80003f80,0xbec4bf6d,0x3f353f35,0xbf6dbec4,0xa50dbf80,0x3e483f7b,0xbec4bf6d,0x3f0e3f55
.long 0x80003f80,0xa50dbf80,0x80003f80,0xa50dbf80,0xa50dbf80,0xbe483f7b,0x3ec4bf6d,0xbf0e3f55
.long 0x80003f80,0x3ec4bf6d,0xbf353f35,0x3f6dbec4,0xa50dbf80,0xbf0e3f55,0x3f6dbec4,0xbf7bbe48
.long 0x80003f80,0x3f35bf35,0xbf80248d,0x3f353f35,0xa50dbf80,0xbf553f0e,0x3f6d3ec4,0xbe48bf7b
.long 0x80003f80,0x3f6dbec4,0xbf35bf35,0xbec43f6d,0xa50dbf80,0xbf7b3e48,0x3ec43f6d,0x3f55bf0e
.long 0x80003f80,0x3f80a554,0xa50dbf80,0xbf80248d,0xa50dbf80,0xbf7bbe48,0xbec43f6d,0x3f553f0e
.long 0x80003f80,0x3f6d3ec4,0x3f35bf35,0xbec4bf6d,0xa50dbf80,0xbf55bf0e,0xbf6d3ec4,0xbe483f7b
.long 0x80003f80,0x3f353f35,0x3f80a554,0x3f35bf35,0xa50dbf80,0xbf0ebf55,0xbf6dbec4,0xbf7b3e48
.long 0x80003f80,0x3ec43f6d,0x3f353f35,0x3f6d3ec4,0xa50dbf80,0xbe48bf7b,0xbec4bf6d,0xbf0ebf55
.long 0x80003f80,0x80003f80,0x80003f80,0x80003f80,0x3f35bf35,0x3f55bf0e,0x3f6dbec4,0x3f7bbe48
.long 0xbf80248d,0xbf6dbec4,0xbf35bf35,0xbec4bf6d,0x3f353f35,0x3e483f7b,0xbec43f6d,0xbf553f0e
.long 0xa50dbf80,0x3f35bf35,0x3f80a554,0x3f353f35,0xbf353f35,0xbf7bbe48,0xbec4bf6d,0x3f0ebf55
.long 0x3f80a554,0x3ec43f6d,0xbf353f35,0xbf6dbec4,0xbf35bf35,0x3f0ebf55,0x3f6d3ec4,0xbe483f7b
.long 0x80003f80,0xbf80248d,0xa50dbf80,0x3f80a554,0x3f35bf35,0x3f0e3f55,0xbf6d3ec4,0xbe48bf7b
.long 0xbf80248d,0x3ec4bf6d,0x3f353f35,0xbf6d3ec4,0x3f353f35,0xbf7b3e48,0x3ec4bf6d,0x3f0e3f55
.long 0xa50dbf80,0x3f353f35,0xbf80248d,0x3f35bf35,0xbf353f35,0x3e48bf7b,0x3ec43f6d,0xbf55bf0e
.long 0x3f80a554,0xbf6d3ec4,0x3f35bf35,0xbec43f6d,0xbf35bf35,0x3f553f0e,0xbf6dbec4,0x3f7b3e48
.long 0x80003f80,0xa50dbf80,0x80003f80,0xa50dbf80,0x3f35bf35,0xbf553f0e,0x3f6dbec4,0xbf7b3e48
.long 0xbf80248d,0x3f6d3ec4,0xbf35bf35,0x3ec43f6d,0x3f353f35,0xbe48bf7b,0xbec43f6d,0x3f55bf0e
.long 0xa50dbf80,0xbf353f35,0x3f80a554,0xbf35bf35,0xbf353f35,0x3f7b3e48,0xbec4bf6d,0xbf0e3f55
.long 0x3f80a554,0xbec4bf6d,0xbf353f35,0x3f6d3ec4,0xbf35bf35,0xbf0e3f55,0x3f6d3ec4,0x3e48bf7b
.long 0x80003f80,0x3f80a554,0xa50dbf80,0xbf80248d,0x3f35bf35,0xbf0ebf55,0xbf6d3ec4,0x3e483f7b
.long 0xbf80248d,0xbec43f6d,0x3f353f35,0x3f6dbec4,0x3f353f35,0x3f7bbe48,0x3ec4bf6d,0xbf0ebf55
.long 0xa50dbf80,0xbf35bf35,0xbf80248d,0xbf353f35,0xbf353f35,0xbe483f7b,0x3ec43f6d,0x3f553f0e
.long 0x3f80a554,0x3f6dbec4,0x3f35bf35,0x3ec4bf6d,0xbf35bf35,0xbf55bf0e,0xbf6dbec4,0xbf7bbe48
.long 0x80003f80,0x80003f80,0x80003f80,0x80003f80,0x3f80a554,0x3f7b3e48,0x3f6d3ec4,0x3f553f0e
.long 0xa50dbf80,0x3ec4bf6d,0x3f35bf35,0x3f6dbec4,0xbf80248d,0xbf55bf0e,0xbec4bf6d,0x3e48bf7b
.long 0x80003f80,0xbf353f35,0xbf80248d,0xbf35bf35,0x3f80a554,0x3f0e3f55,0xbec43f6d,0xbf7b3e48
.long 0xa50dbf80,0x3f6dbec4,0x3f353f35,0xbec43f6d,0xbf80248d,0xbe48bf7b,0x3f6dbec4,0x3f0e3f55
.long 0x80003f80,0xbf80248d,0xa50dbf80,0x3f80a554,0x3f80a554,0xbe483f7b,0xbf6dbec4,0x3f0ebf55
.long 0xa50dbf80,0x3f6d3ec4,0xbf353f35,0xbec4bf6d,0xbf80248d,0x3f0ebf55,0x3ec43f6d,0xbf7bbe48
.long 0x80003f80,0xbf35bf35,0x3f80a554,0xbf353f35,0x3f80a554,0xbf553f0e,0x3ec4bf6d,0x3e483f7b
.long 0xa50dbf80,0x3ec43f6d,0xbf35bf35,0x3f6d3ec4,0xbf80248d,0x3f7bbe48,0xbf6d3ec4,0x3f55bf0e
.long 0x80003f80,0xa50dbf80,0x80003f80,0xa50dbf80,0x3f80a554,0xbf7bbe48,0x3f6d3ec4,0xbf55bf0e
.long 0xa50dbf80,0xbec43f6d,0x3f35bf35,0xbf6d3ec4,0xbf80248d,0x3f553f0e,0xbec4bf6d,0xbe483f7b
.long 0x80003f80,0x3f35bf35,0xbf80248d,0x3f353f35,0x3f80a554,0xbf0ebf55,0xbec43f6d,0x3f7bbe48
.long 0xa50dbf80,0xbf6d3ec4,0x3f353f35,0x3ec4bf6d,0xbf80248d,0x3e483f7b,0x3f6dbec4,0xbf0ebf55
.long 0x80003f80,0x3f80a554,0xa50dbf80,0xbf80248d,0x3f80a554,0x3e48bf7b,0xbf6dbec4,0xbf0e3f55
.long 0xa50dbf80,0xbf6dbec4,0xbf353f35,0x3ec43f6d,0xbf80248d,0xbf0e3f55,0x3ec43f6d,0x3f7b3e48
.long 0x80003f80,0x3f353f35,0x3f80a554,0x3f35bf35,0x3f80a554,0x3f55bf0e,0x3ec4bf6d,0xbe48bf7b
.long 0xa50dbf80,0xbec4bf6d,0xbf35bf35,0xbf6dbec4,0xbf80248d,0xbf7b3e48,0xbf6d3ec4,0xbf553f0e
.long 0x80003f80,0x80003f80,0x80003f80,0x80003f80,0x3f353f35,0x3f0e3f55,0x3ec43f6d,0x3e483f7b
.long 0x3f80a554,0x3f6d3ec4,0x3f353f35,0x3ec43f6d,0x3f35bf35,0x3f7bbe48,0x3f6d3ec4,0x3f0e3f55
.long 0xa50dbf80,0x3f35bf35,0x3f80a554,0x3f353f35,0xbf35bf35,0x3e48bf7b,0x3f6dbec4,0x3f553f0e
.long 0xbf80248d,0xbec4bf6d,0x3f35bf35,0x3f6d3ec4,0xbf353f35,0xbf55bf0e,0x3ec4bf6d,0x3f7b3e48
.long 0x80003f80,0xbf80248d,0xa50dbf80,0x3f80a554,0x3f353f35,0xbf553f0e,0xbec4bf6d,0x3f7bbe48
.long 0x3f80a554,0xbec43f6d,0xbf35bf35,0x3f6dbec4,0x3f35bf35,0x3e483f7b,0xbf6dbec4,0x3f55bf0e
.long 0xa50dbf80,0x3f353f35,0xbf80248d,0x3f35bf35,0xbf35bf35,0x3f7b3e48,0xbf6d3ec4,0x3f0ebf55
.long 0xbf80248d,0x3f6dbec4,0xbf353f35,0x3ec4bf6d,0xbf353f35,0x3f0ebf55,0xbec43f6d,0x3e48bf7b
.long 0x80003f80,0xa50dbf80,0x80003f80,0xa50dbf80,0x3f353f35,0xbf0ebf55,0x3ec43f6d,0xbe48bf7b
.long 0x3f80a554,0xbf6dbec4,0x3f353f35,0xbec4bf6d,0x3f35bf35,0xbf7b3e48,0x3f6d3ec4,0xbf0ebf55
.long 0xa50dbf80,0xbf353f35,0x3f80a554,0xbf35bf35,0xbf35bf35,0xbe483f7b,0x3f6dbec4,0xbf55bf0e
.long 0xbf80248d,0x3ec43f6d,0x3f35bf35,0xbf6dbec4,0xbf353f35,0x3f553f0e,0x3ec4bf6d,0xbf7bbe48
.long 0x80003f80,0x3f80a554,0xa50dbf80,0xbf80248d,0x3f353f35,0x3f55bf0e,0xbec4bf6d,0xbf7b3e48
.long 0x3f80a554,0x3ec4bf6d,0xbf35bf35,0xbf6d3ec4,0x3f35bf35,0xbe48bf7b,0xbf6dbec4,0xbf553f0e
.long 0xa50dbf80,0xbf35bf35,0xbf80248d,0xbf353f35,0xbf35bf35,0xbf7bbe48,0xbf6d3ec4,0xbf0e3f55
.long 0xbf80248d,0xbf6d3ec4,0xbf353f35,0xbec43f6d,0xbf353f35,0xbf0e3f55,0xbec43f6d,0xbe483f7b
.size tab3, 24576
.p2align 8
.type tabX,@object
tabX:
.long 0x5020502,0x5020502,0x5020502,0x5020502,0x502,0x0,0x0,0x0
.long 0x5020502,0x5020502,0x5020502,0x5020502,0x502,0x0,0x0,0x0
.long 0x5000502,0x5000500,0x4fe0500,0x4fe04fe,0x4fe,0x0,0x0,0x0
.long 0x4fe04fe,0x4fe04fe,0x4fc04fc,0x4fc04fc,0x4fc,0x0,0x0,0x0
.long 0x4fc04fc,0x4fc04fc,0x4fa04fc,0x4fa04fa,0x4fa,0x0,0x0,0x0
.long 0x4fa04fa,0x4fa04fa,0x4f804f8,0x4f804f8,0x4f8,0x0,0x0,0x0
.long 0x4f804f8,0x4f804f8,0x4f604f8,0x4f604f6,0x4f6,0x0,0x0,0x0
.long 0x4f604f6,0x4f604f6,0x4f404f4,0x4f404f4,0x4f4,0x0,0x0,0x0
.long 0x4f404f4,0x4f404f4,0x4f204f4,0x4f204f2,0x4f2,0x0,0x0,0x0
.long 0x4f204f2,0x4f204f2,0x4f004f0,0x4f004f0,0x4f0,0x0,0x0,0x0
.long 0x4f004f0,0x4f004f0,0x4ee04f0,0x4ee04ee,0x4ee,0x0,0x0,0x0
.long 0x4ee04ee,0x4ee04ee,0x4ec04ec,0x4ec04ec,0x4ec,0x0,0x0,0x0
.long 0x4ec04ec,0x4ec04ec,0x4ea04ec,0x4ea04ea,0x4ea,0x0,0x0,0x0
.long 0x4ea04ea,0x4ea04ea,0x4e804e8,0x4e804e8,0x4e8,0x0,0x0,0x0
.long 0x4e804e8,0x4e804e8,0x4e604e8,0x4e604e6,0x4e6,0x0,0x0,0x0
.long 0x4e604e6,0x4e604e6,0x4e404e4,0x4e404e4,0x4e4,0x0,0x0,0x0
.long 0x4e404e4,0x4e404e4,0x4e204e4,0x4e204e2,0x4e2,0x0,0x0,0x0
.long 0x4e204e2,0x4e204e2,0x4e004e0,0x4e004e0,0x4e0,0x0,0x0,0x0
.long 0x4e004e0,0x4e004e0,0x4de04e0,0x4de04de,0x4de,0x0,0x0,0x0
.long 0x4de04de,0x4de04de,0x4dc04dc,0x4dc04dc,0x4dc,0x0,0x0,0x0
.long 0x4dc04dc,0x4dc04dc,0x4da04dc,0x4da04da,0x4da,0x0,0x0,0x0
.long 0x4da04da,0x4da04da,0x4d804d8,0x4d804d8,0x4d8,0x0,0x0,0x0
.long 0x4d804d8,0x4d804d8,0x4d604d8,0x4d604d6,0x4d6,0x0,0x0,0x0
.long 0x4d604d6,0x4d604d6,0x4d404d4,0x4d404d4,0x4d4,0x0,0x0,0x0
.long 0x4d404d4,0x4d404d4,0x4d204d4,0x4d204d2,0x4d2,0x0,0x0,0x0
.long 0x4d204d2,0x4d204d2,0x4d004d0,0x4d004d0,0x4d0,0x0,0x0,0x0
.long 0x4d004d0,0x4d004d0,0x4ce04d0,0x4ce04ce,0x4ce,0x0,0x0,0x0
.long 0x4ce04ce,0x4ce04ce,0x4cc04cc,0x4cc04cc,0x4cc,0x0,0x0,0x0
.long 0x4cc04cc,0x4cc04cc,0x4ca04cc,0x4ca04ca,0x4ca,0x0,0x0,0x0
.long 0x4ca04ca,0x4ca04ca,0x4c804c8,0x4c804c8,0x4c8,0x0,0x0,0x0
.long 0x4c804c8,0x4c804c8,0x4c604c8,0x4c604c6,0x4c6,0x0,0x0,0x0
.long 0x4c604c6,0x4c604c6,0x4c404c4,0x4c404c4,0x4c4,0x0,0x0,0x0
.long 0x4c404c4,0x4c404c4,0x4c204c4,0x4c204c2,0x4c2,0x0,0x0,0x0
.long 0x4c204c2,0x4c204c2,0x4c004c0,0x4c004c0,0x4c0,0x0,0x0,0x0
.long 0x4c004c0,0x4c004c0,0x4be04c0,0x4be04be,0x4be,0x0,0x0,0x0
.long 0x4be04be,0x4be04be,0x4bc04bc,0x4bc04bc,0x4bc,0x0,0x0,0x0
.long 0x4bc04bc,0x4bc04bc,0x4ba04bc,0x4ba04ba,0x4ba,0x0,0x0,0x0
.long 0x4ba04ba,0x4ba04ba,0x4b804b8,0x4b804b8,0x4b8,0x0,0x0,0x0
.long 0x4b804b8,0x4b804b8,0x4b604b8,0x4b604b6,0x4b6,0x0,0x0,0x0
.long 0x4b604b6,0x4b604b6,0x4b404b4,0x4b404b4,0x4b4,0x0,0x0,0x0
.long 0x4b404b4,0x4b404b4,0x4b204b4,0x4b204b2,0x4b2,0x0,0x0,0x0
.long 0x4b204b2,0x4b204b2,0x4b004b0,0x4b004b0,0x4b0,0x0,0x0,0x0
.long 0x4b004b0,0x4b004b0,0x4ae04b0,0x4ae04ae,0x4ae,0x0,0x0,0x0
.long 0x4ae04ae,0x4ae04ae,0x4ac04ac,0x4ac04ac,0x4ac,0x0,0x0,0x0
.long 0x4ac04ac,0x4ac04ac,0x4aa04ac,0x4aa04aa,0x4aa,0x0,0x0,0x0
.long 0x4aa04aa,0x4aa04aa,0x4a804a8,0x4a804a8,0x4a8,0x0,0x0,0x0
.long 0x4a804a8,0x4a804a8,0x4a604a8,0x4a604a6,0x4a6,0x0,0x0,0x0
.long 0x4a604a6,0x4a604a6,0x4a404a4,0x4a404a4,0x4a4,0x0,0x0,0x0
.long 0x4a404a4,0x4a404a4,0x4a204a4,0x4a204a2,0x4a2,0x0,0x0,0x0
.long 0x4a204a2,0x4a204a2,0x4a004a0,0x4a004a0,0x4a0,0x0,0x0,0x0
.long 0x4a004a0,0x4a004a0,0x49e04a0,0x49e049e,0x49e,0x0,0x0,0x0
.long 0x49e049e,0x49e049e,0x49c049c,0x49c049c,0x49c,0x0,0x0,0x0
.long 0x49c049c,0x49c049c,0x49a049c,0x49a049a,0x49a,0x0,0x0,0x0
.long 0x49a049a,0x49a049a,0x4980498,0x4980498,0x498,0x0,0x0,0x0
.long 0x4980498,0x4980498,0x4960498,0x4960496,0x496,0x0,0x0,0x0
.long 0x4960496,0x4960496,0x4940494,0x4940494,0x494,0x0,0x0,0x0
.long 0x4940494,0x4940494,0x4920494,0x4920492,0x492,0x0,0x0,0x0
.long 0x4920492,0x4920492,0x4900490,0x4900490,0x490,0x0,0x0,0x0
.long 0x4900490,0x4900490,0x48e0490,0x48e048e,0x48e,0x0,0x0,0x0
.long 0x48e048e,0x48e048e,0x48c048c,0x48c048c,0x48c,0x0,0x0,0x0
.long 0x48c048c,0x48c048c,0x48a048c,0x48a048a,0x48a,0x0,0x0,0x0
.long 0x48a048a,0x48a048a,0x4880488,0x4880488,0x488,0x0,0x0,0x0
.long 0x4880488,0x4880488,0x4860488,0x4860486,0x486,0x0,0x0,0x0
.long 0x4860486,0x4860486,0x4840484,0x4840484,0x484,0x0,0x0,0x0
.long 0x4840484,0x4840484,0x4820484,0x4820482,0x482,0x0,0x0,0x0
.long 0x4820482,0x4820482,0x4800480,0x4800480,0x480,0x0,0x0,0x0
.long 0x4800480,0x4800480,0x47e0480,0x47e047e,0x47e,0x0,0x0,0x0
.long 0x47e047e,0x47e047e,0x47c047c,0x47c047c,0x47c,0x0,0x0,0x0
.long 0x47c047c,0x47c047c,0x47a047c,0x47a047a,0x47a,0x0,0x0,0x0
.long 0x47a047a,0x47a047a,0x4780478,0x4780478,0x478,0x0,0x0,0x0
.long 0x4780478,0x4780478,0x4760478,0x4760476,0x476,0x0,0x0,0x0
.long 0x4760476,0x4760476,0x4740474,0x4740474,0x474,0x0,0x0,0x0
.long 0x4740474,0x4740474,0x4720474,0x4720472,0x472,0x0,0x0,0x0
.long 0x4720472,0x4720472,0x4700470,0x4700470,0x470,0x0,0x0,0x0
.long 0x4700470,0x4700470,0x46e0470,0x46e046e,0x46e,0x0,0x0,0x0
.long 0x46e046e,0x46e046e,0x46c046c,0x46c046c,0x46c,0x0,0x0,0x0
.long 0x46c046c,0x46c046c,0x46a046c,0x46a046a,0x46a,0x0,0x0,0x0
.long 0x46a046a,0x46a046a,0x4680468,0x4680468,0x468,0x0,0x0,0x0
.long 0x4680468,0x4680468,0x4660468,0x4660466,0x466,0x0,0x0,0x0
.long 0x4660466,0x4660466,0x4640464,0x4640464,0x464,0x0,0x0,0x0
.long 0x4640464,0x4640464,0x4620464,0x4620462,0x462,0x0,0x0,0x0
.long 0x4620462,0x4620462,0x4600460,0x4600460,0x460,0x0,0x0,0x0
.long 0x4600460,0x4600460,0x45e0460,0x45e045e,0x45e,0x0,0x0,0x0
.long 0x45e045e,0x45e045e,0x45c045c,0x45c045c,0x45c,0x0,0x0,0x0
.long 0x45c045c,0x45c045c,0x45a045c,0x45a045a,0x45a,0x0,0x0,0x0
.long 0x45a045a,0x45a045a,0x4580458,0x4580458,0x458,0x0,0x0,0x0
.long 0x4580458,0x4580458,0x4560458,0x4560456,0x456,0x0,0x0,0x0
.long 0x4560456,0x4560456,0x4540454,0x4540454,0x454,0x0,0x0,0x0
.long 0x4540454,0x4540454,0x4520454,0x4520452,0x452,0x0,0x0,0x0
.long 0x4520452,0x4520452,0x4500450,0x4500450,0x450,0x0,0x0,0x0
.long 0x4500450,0x4500450,0x44e0450,0x44e044e,0x44e,0x0,0x0,0x0
.long 0x44e044e,0x44e044e,0x44c044c,0x44c044c,0x44c,0x0,0x0,0x0
.long 0x44c044c,0x44c044c,0x44a044c,0x44a044a,0x44a,0x0,0x0,0x0
.long 0x44a044a,0x44a044a,0x4480448,0x4480448,0x448,0x0,0x0,0x0
.long 0x4480448,0x4480448,0x4460448,0x4460446,0x446,0x0,0x0,0x0
.long 0x4460446,0x4460446,0x4440444,0x4440444,0x444,0x0,0x0,0x0
.long 0x4440444,0x4440444,0x4420444,0x4420442,0x442,0x0,0x0,0x0
.long 0x4420442,0x4420442,0x4400440,0x4400440,0x440,0x0,0x0,0x0
.long 0x4400440,0x4400440,0x43e0440,0x43e043e,0x43e,0x0,0x0,0x0
.long 0x43e043e,0x43e043e,0x43c043c,0x43c043c,0x43c,0x0,0x0,0x0
.long 0x43c043c,0x43c043c,0x43a043c,0x43a043a,0x43a,0x0,0x0,0x0
.long 0x43a043a,0x43a043a,0x4380438,0x4380438,0x438,0x0,0x0,0x0
.long 0x4380438,0x4380438,0x4360438,0x4360436,0x436,0x0,0x0,0x0
.long 0x4360436,0x4360436,0x4340434,0x4340434,0x434,0x0,0x0,0x0
.long 0x4340434,0x4340434,0x4320434,0x4320432,0x432,0x0,0x0,0x0
.long 0x4320432,0x4320432,0x4300430,0x4300430,0x430,0x0,0x0,0x0
.long 0x4300430,0x4300430,0x42e0430,0x42e042e,0x42e,0x0,0x0,0x0
.long 0x42e042e,0x42e042e,0x42c042c,0x42c042c,0x42c,0x0,0x0,0x0
.long 0x42c042c,0x42c042c,0x42a042c,0x42a042a,0x42a,0x0,0x0,0x0
.long 0x42a042a,0x42a042a,0x4280428,0x4280428,0x428,0x0,0x0,0x0
.long 0x4280428,0x4280428,0x4260428,0x4260426,0x426,0x0,0x0,0x0
.long 0x4260426,0x4260426,0x4240424,0x4240424,0x424,0x0,0x0,0x0
.long 0x4240424,0x4240424,0x4220424,0x4220422,0x422,0x0,0x0,0x0
.long 0x4220422,0x4220422,0x4200420,0x4200420,0x420,0x0,0x0,0x0
.long 0x4200420,0x4200420,0x41e0420,0x41e041e,0x41e,0x0,0x0,0x0
.long 0x41e041e,0x41e041e,0x41c041c,0x41c041c,0x41c,0x0,0x0,0x0
.long 0x41c041c,0x41c041c,0x41a041c,0x41a041a,0x41a,0x0,0x0,0x0
.long 0x41a041a,0x41a041a,0x4180418,0x4180418,0x418,0x0,0x0,0x0
.long 0x4180418,0x4180418,0x4160418,0x4160416,0x416,0x0,0x0,0x0
.long 0x4160416,0x4160416,0x4140414,0x4140414,0x414,0x0,0x0,0x0
.long 0x4140414,0x4140414,0x4120414,0x4120412,0x412,0x0,0x0,0x0
.long 0x4120412,0x4120412,0x4100410,0x4100410,0x410,0x0,0x0,0x0
.long 0x4100410,0x4100410,0x40e0410,0x40e040e,0x40e,0x0,0x0,0x0
.long 0x40e040e,0x40e040e,0x40c040c,0x40c040c,0x40c,0x0,0x0,0x0
.long 0x40c040c,0x40c040c,0x40a040c,0x40a040a,0x40a,0x0,0x0,0x0
.long 0x40a040a,0x40a040a,0x4080408,0x4080408,0x408,0x0,0x0,0x0
.long 0x4080408,0x4080408,0x4060408,0x4060406,0x406,0x0,0x0,0x0
.long 0x4060406,0x4060406,0x4040404,0x4040404,0x404,0x0,0x0,0x0
.long 0x4040404,0x4040404,0x4020404,0x4020402,0x402,0x0,0x0,0x0
.long 0x4020402,0x4020402,0x4000400,0x4000400,0x400,0x0,0x0,0x0
.long 0x4000400,0x3fe0400,0x3fe03fe,0x3fc03fc,0x3fc,0x0,0x0,0x0
.long 0x3fc03fc,0x3fa03fc,0x3fa03fa,0x3f803f8,0x3f8,0x0,0x0,0x0
.long 0x3f803f8,0x3f603f8,0x3f603f6,0x3f403f4,0x3f4,0x0,0x0,0x0
.long 0x3f403f4,0x3f203f4,0x3f203f2,0x3f003f0,0x3f0,0x0,0x0,0x0
.long 0x3f003f0,0x3ee03f0,0x3ee03ee,0x3ec03ec,0x3ec,0x0,0x0,0x0
.long 0x3ec03ec,0x3ea03ec,0x3ea03ea,0x3e803e8,0x3e8,0x0,0x0,0x0
.long 0x3e803e8,0x3e603e8,0x3e603e6,0x3e403e4,0x3e4,0x0,0x0,0x0
.long 0x3e403e4,0x3e203e4,0x3e203e2,0x3e003e0,0x3e0,0x0,0x0,0x0
.long 0x3e003e0,0x3de03e0,0x3de03de,0x3dc03dc,0x3dc,0x0,0x0,0x0
.long 0x3dc03dc,0x3da03dc,0x3da03da,0x3d803d8,0x3d8,0x0,0x0,0x0
.long 0x3d803d8,0x3d603d8,0x3d603d6,0x3d403d4,0x3d4,0x0,0x0,0x0
.long 0x3d403d4,0x3d203d4,0x3d203d2,0x3d003d0,0x3d0,0x0,0x0,0x0
.long 0x3d003d0,0x3ce03d0,0x3ce03ce,0x3cc03cc,0x3cc,0x0,0x0,0x0
.long 0x3cc03cc,0x3ca03cc,0x3ca03ca,0x3c803c8,0x3c8,0x0,0x0,0x0
.long 0x3c803c8,0x3c603c8,0x3c603c6,0x3c403c4,0x3c4,0x0,0x0,0x0
.long 0x3c403c4,0x3c203c4,0x3c203c2,0x3c003c0,0x3c0,0x0,0x0,0x0
.long 0x3c003c0,0x3be03c0,0x3be03be,0x3bc03bc,0x3bc,0x0,0x0,0x0
.long 0x3bc03bc,0x3ba03bc,0x3ba03ba,0x3b803b8,0x3b8,0x0,0x0,0x0
.long 0x3b803b8,0x3b603b8,0x3b603b6,0x3b403b4,0x3b4,0x0,0x0,0x0
.long 0x3b403b4,0x3b203b4,0x3b203b2,0x3b003b0,0x3b0,0x0,0x0,0x0
.long 0x3b003b0,0x3ae03b0,0x3ae03ae,0x3ac03ac,0x3ac,0x0,0x0,0x0
.long 0x3ac03ac,0x3aa03ac,0x3aa03aa,0x3a803a8,0x3a8,0x0,0x0,0x0
.long 0x3a803a8,0x3a603a8,0x3a603a6,0x3a403a4,0x3a4,0x0,0x0,0x0
.long 0x3a403a4,0x3a203a4,0x3a203a2,0x3a003a0,0x3a0,0x0,0x0,0x0
.long 0x3a003a0,0x39e03a0,0x39e039e,0x39c039c,0x39c,0x0,0x0,0x0
.long 0x39c039c,0x39a039c,0x39a039a,0x3980398,0x398,0x0,0x0,0x0
.long 0x3980398,0x3960398,0x3960396,0x3940394,0x394,0x0,0x0,0x0
.long 0x3940394,0x3920394,0x3920392,0x3900390,0x390,0x0,0x0,0x0
.long 0x3900390,0x38e0390,0x38e038e,0x38c038c,0x38c,0x0,0x0,0x0
.long 0x38c038c,0x38a038c,0x38a038a,0x3880388,0x388,0x0,0x0,0x0
.long 0x3880388,0x3860388,0x3860386,0x3840384,0x384,0x0,0x0,0x0
.long 0x3840384,0x3820384,0x3820382,0x3800380,0x380,0x0,0x0,0x0
.long 0x3800380,0x37e0380,0x37e037e,0x37c037c,0x37c,0x0,0x0,0x0
.long 0x37c037c,0x37a037c,0x37a037a,0x3780378,0x378,0x0,0x0,0x0
.long 0x3780378,0x3760378,0x3760376,0x3740374,0x374,0x0,0x0,0x0
.long 0x3740374,0x3720374,0x3720372,0x3700370,0x370,0x0,0x0,0x0
.long 0x3700370,0x36e0370,0x36e036e,0x36c036c,0x36c,0x0,0x0,0x0
.long 0x36c036c,0x36a036c,0x36a036a,0x3680368,0x368,0x0,0x0,0x0
.long 0x3680368,0x3660368,0x3660366,0x3640364,0x364,0x0,0x0,0x0
.long 0x3640364,0x3620364,0x3620362,0x3600360,0x360,0x0,0x0,0x0
.long 0x3600360,0x35e0360,0x35e035e,0x35c035c,0x35c,0x0,0x0,0x0
.long 0x35c035c,0x35a035c,0x35a035a,0x3580358,0x358,0x0,0x0,0x0
.long 0x3580358,0x3560358,0x3560356,0x3540354,0x354,0x0,0x0,0x0
.long 0x3540354,0x3520354,0x3520352,0x3500350,0x350,0x0,0x0,0x0
.long 0x3500350,0x34e0350,0x34e034e,0x34c034c,0x34c,0x0,0x0,0x0
.long 0x34c034c,0x34a034c,0x34a034a,0x3480348,0x348,0x0,0x0,0x0
.long 0x3480348,0x3460348,0x3460346,0x3440344,0x344,0x0,0x0,0x0
.long 0x3440344,0x3420344,0x3420342,0x3400340,0x340,0x0,0x0,0x0
.long 0x3400340,0x33e0340,0x33e033e,0x33c033c,0x33c,0x0,0x0,0x0
.long 0x33c033c,0x33a033c,0x33a033a,0x3380338,0x338,0x0,0x0,0x0
.long 0x3380338,0x3360338,0x3360336,0x3340334,0x334,0x0,0x0,0x0
.long 0x3340334,0x3320334,0x3320332,0x3300330,0x330,0x0,0x0,0x0
.long 0x3300330,0x32e0330,0x32e032e,0x32c032c,0x32c,0x0,0x0,0x0
.long 0x32c032c,0x32a032c,0x32a032a,0x3280328,0x328,0x0,0x0,0x0
.long 0x3280328,0x3260328,0x3260326,0x3240324,0x324,0x0,0x0,0x0
.long 0x3240324,0x3220324,0x3220322,0x3200320,0x320,0x0,0x0,0x0
.long 0x3200320,0x31e0320,0x31e031e,0x31c031c,0x31c,0x0,0x0,0x0
.long 0x31c031c,0x31a031c,0x31a031a,0x3180318,0x318,0x0,0x0,0x0
.long 0x3180318,0x3160318,0x3160316,0x3140314,0x314,0x0,0x0,0x0
.long 0x3140314,0x3120314,0x3120312,0x3100310,0x310,0x0,0x0,0x0
.long 0x3100310,0x30e0310,0x30e030e,0x30c030c,0x30c,0x0,0x0,0x0
.long 0x30c030c,0x30a030c,0x30a030a,0x3080308,0x308,0x0,0x0,0x0
.long 0x3080308,0x3060308,0x3060306,0x3040304,0x304,0x0,0x0,0x0
.long 0x3040304,0x3020304,0x3020302,0x3000300,0x300,0x0,0x0,0x0
.long 0x3000300,0x2fc02fe,0x2fc02fc,0x2f802fa,0x2f8,0x0,0x0,0x0
.long 0x2f802f8,0x2f402f6,0x2f402f4,0x2f002f2,0x2f0,0x0,0x0,0x0
.long 0x2f002f0,0x2ec02ee,0x2ec02ec,0x2e802ea,0x2e8,0x0,0x0,0x0
.long 0x2e802e8,0x2e402e6,0x2e402e4,0x2e002e2,0x2e0,0x0,0x0,0x0
.long 0x2e002e0,0x2dc02de,0x2dc02dc,0x2d802da,0x2d8,0x0,0x0,0x0
.long 0x2d802d8,0x2d402d6,0x2d402d4,0x2d002d2,0x2d0,0x0,0x0,0x0
.long 0x2d002d0,0x2cc02ce,0x2cc02cc,0x2c802ca,0x2c8,0x0,0x0,0x0
.long 0x2c802c8,0x2c402c6,0x2c402c4,0x2c002c2,0x2c0,0x0,0x0,0x0
.long 0x2c002c0,0x2bc02be,0x2bc02bc,0x2b802ba,0x2b8,0x0,0x0,0x0
.long 0x2b802b8,0x2b402b6,0x2b402b4,0x2b002b2,0x2b0,0x0,0x0,0x0
.long 0x2b002b0,0x2ac02ae,0x2ac02ac,0x2a802aa,0x2a8,0x0,0x0,0x0
.long 0x2a802a8,0x2a402a6,0x2a402a4,0x2a002a2,0x2a0,0x0,0x0,0x0
.long 0x2a002a0,0x29c029e,0x29c029c,0x298029a,0x298,0x0,0x0,0x0
.long 0x2980298,0x2940296,0x2940294,0x2900292,0x290,0x0,0x0,0x0
.long 0x2900290,0x28c028e,0x28c028c,0x288028a,0x288,0x0,0x0,0x0
.long 0x2880288,0x2840286,0x2840284,0x2800282,0x280,0x0,0x0,0x0
.long 0x2800280,0x27c027e,0x27c027c,0x278027a,0x278,0x0,0x0,0x0
.long 0x2780278,0x2740276,0x2740274,0x2700272,0x270,0x0,0x0,0x0
.long 0x2700270,0x26c026e,0x26c026c,0x268026a,0x268,0x0,0x0,0x0
.long 0x2680268,0x2640266,0x2640264,0x2600262,0x260,0x0,0x0,0x0
.long 0x2600260,0x25c025e,0x25c025c,0x258025a,0x258,0x0,0x0,0x0
.long 0x2580258,0x2540256,0x2540254,0x2500252,0x250,0x0,0x0,0x0
.long 0x2500250,0x24c024e,0x24c024c,0x248024a,0x248,0x0,0x0,0x0
.long 0x2480248,0x2440246,0x2440244,0x2400242,0x240,0x0,0x0,0x0
.long 0x2400240,0x23c023e,0x23c023c,0x238023a,0x238,0x0,0x0,0x0
.long 0x2380238,0x2340236,0x2340234,0x2300232,0x230,0x0,0x0,0x0
.long 0x2300230,0x22c022e,0x22c022c,0x228022a,0x228,0x0,0x0,0x0
.long 0x2280228,0x2240226,0x2240224,0x2200222,0x220,0x0,0x0,0x0
.long 0x2200220,0x21c021e,0x21c021c,0x218021a,0x218,0x0,0x0,0x0
.long 0x2180218,0x2140216,0x2140214,0x2100212,0x210,0x0,0x0,0x0
.long 0x2100210,0x20c020e,0x20c020c,0x208020a,0x208,0x0,0x0,0x0
.long 0x2080208,0x2040206,0x2040204,0x2000202,0x200,0x0,0x0,0x0
.long 0x1fe0200,0x1fa01fc,0x1f601f8,0x1f201f4,0x1f0,0x0,0x0,0x0
.long 0x1ee01f0,0x1ea01ec,0x1e601e8,0x1e201e4,0x1e0,0x0,0x0,0x0
.long 0x1de01e0,0x1da01dc,0x1d601d8,0x1d201d4,0x1d0,0x0,0x0,0x0
.long 0x1ce01d0,0x1ca01cc,0x1c601c8,0x1c201c4,0x1c0,0x0,0x0,0x0
.long 0x1be01c0,0x1ba01bc,0x1b601b8,0x1b201b4,0x1b0,0x0,0x0,0x0
.long 0x1ae01b0,0x1aa01ac,0x1a601a8,0x1a201a4,0x1a0,0x0,0x0,0x0
.long 0x19e01a0,0x19a019c,0x1960198,0x1920194,0x190,0x0,0x0,0x0
.long 0x18e0190,0x18a018c,0x1860188,0x1820184,0x180,0x0,0x0,0x0
.long 0x17e0180,0x17a017c,0x1760178,0x1720174,0x170,0x0,0x0,0x0
.long 0x16e0170,0x16a016c,0x1660168,0x1620164,0x160,0x0,0x0,0x0
.long 0x15e0160,0x15a015c,0x1560158,0x1520154,0x150,0x0,0x0,0x0
.long 0x14e0150,0x14a014c,0x1460148,0x1420144,0x140,0x0,0x0,0x0
.long 0x13e0140,0x13a013c,0x1360138,0x1320134,0x130,0x0,0x0,0x0
.long 0x12e0130,0x12a012c,0x1260128,0x1220124,0x120,0x0,0x0,0x0
.long 0x11e0120,0x11a011c,0x1160118,0x1120114,0x110,0x0,0x0,0x0
.long 0x10e0110,0x10a010c,0x1060108,0x1020104,0x100,0x0,0x0,0x0
.long 0xfe0100,0xfa00fc,0xf600f8,0xf200f4,0xf0,0x0,0x0,0x0
.long 0xee00f0,0xea00ec,0xe600e8,0xe200e4,0xe0,0x0,0x0,0x0
.long 0xde00e0,0xda00dc,0xd600d8,0xd200d4,0xd0,0x0,0x0,0x0
.long 0xce00d0,0xca00cc,0xc600c8,0xc200c4,0xc0,0x0,0x0,0x0
.long 0xbe00c0,0xba00bc,0xb600b8,0xb200b4,0xb0,0x0,0x0,0x0
.long 0xae00b0,0xaa00ac,0xa600a8,0xa200a4,0xa0,0x0,0x0,0x0
.long 0x9e00a0,0x9a009c,0x960098,0x920094,0x90,0x0,0x0,0x0
.long 0x8e0090,0x8a008c,0x860088,0x820084,0x80,0x0,0x0,0x0
.long 0x7e0080,0x7a007c,0x760078,0x720074,0x70,0x0,0x0,0x0
.long 0x6e0070,0x6a006c,0x660068,0x620064,0x60,0x0,0x0,0x0
.long 0x5e0060,0x5a005c,0x560058,0x520054,0x50,0x0,0x0,0x0
.long 0x4e0050,0x4a004c,0x460048,0x420044,0x40,0x0,0x0,0x0
.long 0x3e0040,0x3a003c,0x360038,0x320034,0x30,0x0,0x0,0x0
.long 0x2e0030,0x2a002c,0x260028,0x220024,0x20,0x0,0x0,0x0
.long 0x1e0020,0x1a001c,0x160018,0x120014,0x10,0x0,0x0,0x0
.long 0xe0010,0xa000c,0x60008,0x20004,0x0,0x0,0x0,0x0
.long 0x5020000,0x5020502,0x5020502,0x5020502,0x502,0x0,0x0,0x0
.long 0x5020502,0x5020502,0x5020502,0x5020502,0x502,0x0,0x0,0x0
.long 0x5020502,0x5020502,0x5020502,0x5020502,0x502,0x0,0x0,0x0
.long 0x5020502,0x5020502,0x5020502,0x5020502,0x502,0x0,0x0,0x0
.long 0x5020502,0x5020502,0x5020502,0x5020502,0x502,0x0,0x0,0x0
.long 0x5020502,0x5020502,0x5020502,0x5020502,0x502,0x0,0x0,0x0
.long 0x5020502,0x5020502,0x5020502,0x5020502,0x502,0x0,0x0,0x0
.long 0x5020502,0x5020502,0x5020502,0x5020502,0x502,0x0,0x0,0x0
.long 0x5020502,0x5020502,0x5020502,0x5020502,0x502,0x0,0x0,0x0
.long 0x5020502,0x5020502,0x5020502,0x5020502,0x502,0x0,0x0,0x0
.long 0x5020502,0x5020502,0x5020502,0x5020502,0x502,0x0,0x0,0x0
.long 0x5020502,0x5020502,0x5020502,0x5020502,0x502,0x0,0x0,0x0
.long 0x5020502,0x5020502,0x5020502,0x5020502,0x502,0x0,0x0,0x0
.long 0x5020502,0x5020502,0x5020502,0x5020502,0x502,0x0,0x0,0x0
.long 0x5020502,0x5020502,0x5020502,0x5020502,0x502,0x0,0x0,0x0
.long 0x5020502,0x5020502,0x5020502,0x5020502,0x502,0x0,0x0,0x0
.long 0x5020502,0x5020502,0x5020502,0x5020502,0x502,0x0,0x0,0x0
.long 0x5020502,0x5020502,0x5020502,0x5020502,0x502,0x0,0x0,0x0
.long 0x5020502,0x5020502,0x5020502,0x5020502,0x502,0x0,0x0,0x0
.long 0x5020502,0x5020502,0x5020502,0x5020502,0x502,0x0,0x0,0x0
.long 0x5020502,0x5020502,0x5020502,0x5020502,0x502,0x0,0x0,0x0
.long 0x5020502,0x5020502,0x5020502,0x5020502,0x502,0x0,0x0,0x0
.long 0x5020502,0x5020502,0x5020502,0x5020502,0x502,0x0,0x0,0x0
.long 0x5020502,0x5020502,0x5020502,0x5020502,0x502,0x0,0x0,0x0
.long 0x5020502,0x5020502,0x5020502,0x5020502,0x502,0x0,0x0,0x0
.long 0x5020502,0x5020502,0x5020502,0x5020502,0x502,0x0,0x0,0x0
.long 0x5020502,0x5020502,0x5020502,0x5020502,0x502,0x0,0x0,0x0
.long 0x5020502,0x5020502,0x5020502,0x5020502,0x502,0x0,0x0,0x0
.long 0x5020502,0x5020502,0x5020502,0x5020502,0x502,0x0,0x0,0x0
.long 0x5020502,0x5020502,0x5020502,0x5020502,0x502,0x0,0x0,0x0
.long 0x5020502,0x5020502,0x5020502,0x5020502,0x502,0x0,0x0,0x0
.long 0x5020502,0x5020502,0x5020502,0x5020502,0x502,0x0,0x0,0x0
.long 0x5020502,0x5020502,0x5020502,0x5020502,0x502,0x0,0x0,0x0
.long 0x5020502,0x5020502,0x5020502,0x5020502,0x502,0x0,0x0,0x0
.long 0x5020502,0x5020502,0x5020502,0x5020502,0x502,0x0,0x0,0x0
.long 0x5020502,0x5020502,0x5020502,0x5020502,0x502,0x0,0x0,0x0
.long 0x5020502,0x5020502,0x5020502,0x5020502,0x502,0x0,0x0,0x0
.long 0x5020502,0x5020502,0x5020502,0x5020502,0x502,0x0,0x0,0x0
.long 0x5020502,0x5020502,0x5020502,0x5020502,0x502,0x0,0x0,0x0
.long 0x5020502,0x5020502,0x5020502,0x5020502,0x502,0x0,0x0,0x0
.long 0x5020502,0x5020502,0x5020502,0x5020502,0x502,0x0,0x0,0x0
.long 0x5020502,0x5020502,0x5020502,0x5020502,0x502,0x0,0x0,0x0
.long 0x5020502,0x5020502,0x5020502,0x5020502,0x502,0x0,0x0,0x0
.long 0x5020502,0x5020502,0x5020502,0x5020502,0x502,0x0,0x0,0x0
.long 0x5020502,0x5020502,0x5020502,0x5020502,0x502,0x0,0x0,0x0
.long 0x5020502,0x5020502,0x5020502,0x5020502,0x502,0x0,0x0,0x0
.long 0x5020502,0x5020502,0x5020502,0x5020502,0x502,0x0,0x0,0x0
.long 0x5020502,0x5020502,0x5020502,0x5020502,0x502,0x0,0x0,0x0
.long 0x5020502,0x5020502,0x5020502,0x5020502,0x502,0x0,0x0,0x0
.long 0x5020502,0x5020502,0x5020502,0x5020502,0x502,0x0,0x0,0x0
.long 0x5020502,0x5020502,0x5020502,0x5020502,0x502,0x0,0x0,0x0
.long 0x5020502,0x5020502,0x5020502,0x5020502,0x502,0x0,0x0,0x0
.long 0x5020502,0x5020502,0x5020502,0x5020502,0x502,0x0,0x0,0x0
.long 0x5020502,0x5020502,0x5020502,0x5020502,0x502,0x0,0x0,0x0
.long 0x5020502,0x5020502,0x5020502,0x5020502,0x502,0x0,0x0,0x0
.long 0x5020502,0x5020502,0x5020502,0x5020502,0x502,0x0,0x0,0x0
.long 0x5020502,0x5020502,0x5020502,0x5020502,0x502,0x0,0x0,0x0
.long 0x5020502,0x5020502,0x5020502,0x5020502,0x502,0x0,0x0,0x0
.long 0x5020502,0x5020502,0x5020502,0x5020502,0x502,0x0,0x0,0x0
.long 0x5020502,0x5020502,0x5020502,0x5020502,0x502,0x0,0x0,0x0
.long 0x5020502,0x5020502,0x5020502,0x5020502,0x502,0x0,0x0,0x0
.long 0x5020502,0x5020502,0x5020502,0x5020502,0x502,0x0,0x0,0x0
.long 0x5020502,0x5020502,0x5020502,0x5020502,0x502,0x0,0x0,0x0
.long 0x5020502,0x5020502,0x5020502,0x5020502,0x502,0x0,0x0,0x0
.long 0x5020502,0x5020502,0x5020502,0x5020502,0x502,0x0,0x0,0x0
.long 0x5020502,0x5020502,0x5020502,0x5020502,0x502,0x0,0x0,0x0
.long 0x5020502,0x5020502,0x5020502,0x5020502,0x502,0x0,0x0,0x0
.long 0x5020502,0x5020502,0x5020502,0x5020502,0x502,0x0,0x0,0x0
.long 0x5020502,0x5020502,0x5020502,0x5020502,0x502,0x0,0x0,0x0
.long 0x5020502,0x5020502,0x5020502,0x5020502,0x502,0x0,0x0,0x0
.long 0x5020502,0x5020502,0x5020502,0x5020502,0x502,0x0,0x0,0x0
.long 0x5020502,0x5020502,0x5020502,0x5020502,0x502,0x0,0x0,0x0
.long 0x5020502,0x5020502,0x5020502,0x5020502,0x502,0x0,0x0,0x0
.long 0x5020502,0x5020502,0x5020502,0x5020502,0x502,0x0,0x0,0x0
.long 0x5020502,0x5020502,0x5020502,0x5020502,0x502,0x0,0x0,0x0
.long 0x5020502,0x5020502,0x5020502,0x5020502,0x502,0x0,0x0,0x0
.long 0x5020502,0x5020502,0x5020502,0x5020502,0x502,0x0,0x0,0x0
.long 0x5020502,0x5020502,0x5020502,0x5020502,0x502,0x0,0x0,0x0
.long 0x5020502,0x5020502,0x5020502,0x5020502,0x502,0x0,0x0,0x0
.long 0x5020502,0x5020502,0x5020502,0x5020502,0x502,0x0,0x0,0x0
.long 0x5020502,0x5020502,0x5020502,0x5020502,0x502,0x0,0x0,0x0
.long 0x5020502,0x5020502,0x5020502,0x5020502,0x502,0x0,0x0,0x0
.long 0x5020502,0x5020502,0x5020502,0x5020502,0x502,0x0,0x0,0x0
.long 0x5020502,0x5020502,0x5020502,0x5020502,0x502,0x0,0x0,0x0
.long 0x5020502,0x5020502,0x5020502,0x5020502,0x502,0x0,0x0,0x0
.long 0x5020502,0x5020502,0x5020502,0x5020502,0x502,0x0,0x0,0x0
.long 0x5020502,0x5020502,0x5020502,0x5020502,0x502,0x0,0x0,0x0
.long 0x5020502,0x5020502,0x5020502,0x5020502,0x502,0x0,0x0,0x0
.long 0x5020502,0x5020502,0x5020502,0x5020502,0x502,0x0,0x0,0x0
.long 0x5020502,0x5020502,0x5020502,0x5020502,0x502,0x0,0x0,0x0
.long 0x5020502,0x5020502,0x5020502,0x5020502,0x502,0x0,0x0,0x0
.long 0x5020502,0x5020502,0x5020502,0x5020502,0x502,0x0,0x0,0x0
.long 0x5020502,0x5020502,0x5020502,0x5020502,0x502,0x0,0x0,0x0
.long 0x5020502,0x5020502,0x5020502,0x5020502,0x502,0x0,0x0,0x0
.long 0x5020502,0x5020502,0x5020502,0x5020502,0x502,0x0,0x0,0x0
.long 0x5020502,0x5020502,0x5020502,0x5020502,0x502,0x0,0x0,0x0
.long 0x5020502,0x5020502,0x5020502,0x5020502,0x502,0x0,0x0,0x0
.long 0x5020502,0x5020502,0x5020502,0x5020502,0x502,0x0,0x0,0x0
.long 0x5020502,0x5020502,0x5020502,0x5020502,0x502,0x0,0x0,0x0
.long 0x5020502,0x5020502,0x5020502,0x5020502,0x502,0x0,0x0,0x0
.long 0x5020502,0x5020502,0x5020502,0x5020502,0x502,0x0,0x0,0x0
.long 0x5020502,0x5020502,0x5020502,0x5020502,0x502,0x0,0x0,0x0
.long 0x5020502,0x5020502,0x5020502,0x5020502,0x502,0x0,0x0,0x0
.long 0x5020502,0x5020502,0x5020502,0x5020502,0x502,0x0,0x0,0x0
.long 0x5020502,0x5020502,0x5020502,0x5020502,0x502,0x0,0x0,0x0
.long 0x5020502,0x5020502,0x5020502,0x5020502,0x502,0x0,0x0,0x0
.long 0x5020502,0x5020502,0x5020502,0x5020502,0x502,0x0,0x0,0x0
.long 0x5020502,0x5020502,0x5020502,0x5020502,0x502,0x0,0x0,0x0
.long 0x5020502,0x5020502,0x5020502,0x5020502,0x502,0x0,0x0,0x0
.long 0x5020502,0x5020502,0x5020502,0x5020502,0x502,0x0,0x0,0x0
.long 0x5020502,0x5020502,0x5020502,0x5020502,0x502,0x0,0x0,0x0
.long 0x5020502,0x5020502,0x5020502,0x5020502,0x502,0x0,0x0,0x0
.long 0x5020502,0x5020502,0x5020502,0x5020502,0x502,0x0,0x0,0x0
.long 0x5020502,0x5020502,0x5020502,0x5020502,0x502,0x0,0x0,0x0
.long 0x5020502,0x5020502,0x5020502,0x5020502,0x502,0x0,0x0,0x0
.long 0x5020502,0x5020502,0x5020502,0x5020502,0x502,0x0,0x0,0x0
.long 0x5020502,0x5020502,0x5020502,0x5020502,0x502,0x0,0x0,0x0
.long 0x5020502,0x5020502,0x5020502,0x5020502,0x502,0x0,0x0,0x0
.long 0x5020502,0x5020502,0x5020502,0x5020502,0x502,0x0,0x0,0x0
.long 0x5020502,0x5020502,0x5020502,0x5020502,0x502,0x0,0x0,0x0
.long 0x5020502,0x5020502,0x5020502,0x5020502,0x502,0x0,0x0,0x0
.long 0x5020502,0x5020502,0x5020502,0x5020502,0x502,0x0,0x0,0x0
.long 0x5020502,0x5020502,0x5020502,0x5020502,0x502,0x0,0x0,0x0
.long 0x5020502,0x5020502,0x5020502,0x5020502,0x502,0x0,0x0,0x0
.long 0x5020502,0x5020502,0x5020502,0x5020502,0x502,0x0,0x0,0x0
.long 0x5020502,0x5020502,0x5020502,0x5020502,0x502,0x0,0x0,0x0
.size tabX, 12288
```
